```python
import torch

def _softmax(x, axis=-1):
    return torch.softmax(x, dim=axis)
def _gelu(x):
    return torch.nn.functional.gelu(x, approximate="tanh")
def _silu(x):
    return torch.nn.functional.silu(x)
def _sigmoid(x):
    return torch.sigmoid(x)
def _layernorm(x, axis=-1, eps=1e-5):
    m = x.mean(dim=axis, keepdim=True)
    v = x.var(dim=axis, keepdim=True, unbiased=False)
    return (x - m) / torch.sqrt(v + eps)
def _scatter_add(tgt, idx, src, axis=0):
    return tgt.clone().index_add_(axis, idx, src)
def _segment_sum(src, seg, n):
    out = torch.zeros((n,) + src.shape[1:], dtype=src.dtype)
    return out.index_add_(0, seg, src)
def _pad(x, pw):
    flat = tuple(v for pair in reversed(pw) for v in pair)
    return torch.nn.functional.pad(x, flat)

kernel_name = 'sequential_preLN__compressed_kv_cla__mixer_token_mlp__prompt'

def setup_inputs():

    _w = (lambda a: (lambda t: t.to(torch.bfloat16) if t.is_floating_point() else t)(torch.as_tensor(a)))
    def _A_setup():
        B, H, Sq, Sk, D, M = 1, 16, 2048, 2048, 256, 448
        Dc = 4 * D
        return {
            "x": _w((lambda *s: torch.randn(*s, dtype=torch.bfloat16) * 0.05)(B, Sq, M)),
            "c_kv": _w((lambda *s: torch.randn(*s, dtype=torch.bfloat16) * 0.2)(B, Sk, Dc)),
            "w_q": _w((lambda *s: torch.randn(*s, dtype=torch.bfloat16) * 3.2)(M, H, D) * (M ** -0.5)),
            "w_uk": _w((lambda *s: torch.randn(*s, dtype=torch.bfloat16) * 6.4)(Dc, H, D) * (Dc ** -0.5)),
            "w_uv": _w((lambda *s: torch.randn(*s, dtype=torch.bfloat16) * 0.2)(Dc, H, D) * (Dc ** -0.5)),
            "w_o": _w((lambda *s: torch.randn(*s, dtype=torch.bfloat16) * 0.2)(H, D, M) * ((H * D) ** -0.5)),
        }
    _A_in = _A_setup()

    def _B_setup():
        B, S, D, F = 1, 2048, 448, 1792
        return {
            "x": _w((lambda *s: torch.randn(*s, dtype=torch.bfloat16) * 0.05)(B, S, D)),
            "w1": _w((lambda *s: torch.randn(*s, dtype=torch.bfloat16) * 0.4)(S, F) * (S ** -0.5)),
            "b1": _w((lambda *s: torch.randn(*s, dtype=torch.bfloat16) * 3.2)(F) * 0.02),
            "w2": _w((lambda *s: torch.randn(*s, dtype=torch.bfloat16) * 0.2)(F, S) * (F ** -0.5)),
            "b2": _w((lambda *s: torch.randn(*s, dtype=torch.bfloat16) * 0.8)(S) * 0.02),
        }
    _B_in = _B_setup()

    return {
        "A_x": _A_in["x"],
        "A_c_kv": _A_in["c_kv"],
        "A_w_q": _A_in["w_q"],
        "A_w_uk": _A_in["w_uk"],
        "A_w_uv": _A_in["w_uv"],
        "A_w_o": _A_in["w_o"],
        "B_x": _B_in["x"],
        "B_w1": _B_in["w1"],
        "B_b1": _B_in["b1"],
        "B_w2": _B_in["w2"],
        "B_b2": _B_in["b2"],
    }

def reference(A_x, A_c_kv, A_w_q, A_w_uk, A_w_uv, A_w_o, B_x, B_w1, B_b1, B_w2, B_b2):
    def _A_ref(x, c_kv, w_q, w_uk, w_uv, w_o):
        B, Sq, M = x.shape[0], x.shape[1], x.shape[2]
        Sk = c_kv.shape[1]
        H, D = w_q.shape[1], w_q.shape[2]
        q = torch.einsum("bqm,mhd->bhqd", x, w_q)
        k = torch.einsum("bkc,chd->bhkd", c_kv, w_uk)
        v = torch.einsum("bkc,chd->bhkd", c_kv, w_uv)
        scores = torch.einsum("bhqd,bhkd->bhqk", q, k) * (D ** -0.5)
        off = Sk - Sq
        qi = torch.arange(Sq)[:, None]
        kj = torch.arange(Sk)[None, :]
        cmask = kj <= (qi + off)
        scores = torch.where(cmask[None, None], scores, -1e9)
        p = _softmax(scores, axis=-1)
        ctx = torch.einsum("bhqk,bhkd->bhqd", p, v)
        return torch.einsum("bhqd,hdm->bqm", ctx, w_o)

    def _B_ref(x, w1, b1, w2, b2):
        B, S, D = x.shape
        h = _layernorm(x, axis=-1)
        u = torch.einsum("bsd,sf->bdf", h, w1) + b1
        u = _gelu(u)
        y = torch.einsum("bdf,fs->bds", u, w2) + b2
        return (lambda x, *d: x.permute(*d))(y, 0, 2, 1)

    x = A_x
    h = x + _A_ref(_layernorm(x, axis=-1), A_c_kv, A_w_q, A_w_uk, A_w_uv, A_w_o)
    h2 = h + _B_ref(_layernorm(h, axis=-1), B_w1, B_b1, B_w2, B_b2)
    return h2
```

```asm
; @launch grid=(256,1,1) block=(256,1,1) lds=163840
.amdgcn_target "amdgcn-amd-amdhsa--gfx950"
.text
.globl sequential_preLN__compressed_kv_cla__mixer_token_mlp__prompt_kernel
.p2align 8
.type sequential_preLN__compressed_kv_cla__mixer_token_mlp__prompt_kernel,@function
sequential_preLN__compressed_kv_cla__mixer_token_mlp__prompt_kernel:
  s_cmp_ge_u32 s2, 256
  s_cbranch_scc1 MN_END
  s_load_dwordx4 s[76:79], s[0:1], 0
  s_load_dwordx4 s[80:83], s[0:1], 24
  s_load_dwordx4 s[16:19], s[0:1], 96
  s_load_dwordx2 s[68:69], s[0:1], 16
  s_load_dwordx2 s[100:101], s[0:1], 40
  s_load_dwordx2 s[84:85], s[0:1], 56
  s_load_dwordx2 s[86:87], s[0:1], 72
  v_lshrrev_b32 v2, 6, v0
  v_and_b32 v1, 63, v0
  v_readfirstlane_b32 s20, v2
  s_and_b32 s21, s2, 7
  s_lshl_b32 s21, s21, 1
  s_bfe_u32 s22, s2, 0x10003
  s_add_u32 s21, s21, s22
  s_bfe_u32 s22, s2, 0x10004
  s_lshr_b32 s23, s2, 5
  v_lshrrev_b32 v2, 3, v1
  v_lshrrev_b32 v3, 4, v1
  v_and_b32 v16, 7, v1
  s_lshl_b32 s60, s23, 7
  s_lshl_b32 s61, s20, 5
  s_add_u32 s60, s60, s61
  v_add_u32 v2, s60, v2
  v_lshlrev_b32 v2, 11, v2
  v_xor_b32 v17, v16, v3
  v_lshl_add_u32 v32, v17, 4, v2
  v_xor_b32 v33, 64, v32
  v_add_u32 v34, 30720, v32
  v_add_u32 v35, 46080, v33
  v_add_u32 v33, 15360, v33
  s_lshl_b32 s60, s20, 4
  v_add_u32 v2, s60, v3
  v_lshlrev_b32 v2, 13, v2
  s_lshl_b32 s60, s21, 9
  v_add_u32 v2, s60, v2
  v_and_b32 v16, 1, v1
  v_lshl_add_u32 v2, v16, 4, v2
  v_bfe_u32 v16, v1, 1, 3
  v_xor_b32 v16, v16, v3
  v_lshrrev_b32 v17, 2, v16
  v_lshl_add_u32 v2, v17, 8, v2
  v_and_b32 v17, 3, v16
  v_lshl_add_u32 v36, v17, 5, v2
  v_xor_b32 v38, 256, v36
  v_add_u32 v37, 31744, v36
  v_add_u32 v39, 95232, v38
  v_add_u32 v38, 63488, v38
  s_lshl_b32 s27, s20, 12
  s_mov_b32 s24, 0
  s_mov_b32 s25, 0
  s_mov_b32 m0, s27
  s_waitcnt lgkmcnt(0)
  s_mov_b32 s4, s78
  s_mov_b32 s5, s79
  s_mov_b32 s6, 4194304
  s_mov_b32 s7, 0x20000
  s_cmp_eq_u32 s22, 0
  s_cselect_b32 s8, s80, s82
  s_cselect_b32 s9, s81, s83
  s_mov_b32 s10, 8388608
  s_mov_b32 s11, 0x20000
  s_mov_b32 s78, 1835008
  s_mov_b32 s79, 0x20000
  buffer_load_dwordx4 v32, s[4:7], s24 offen offset:0 lds
  buffer_load_dwordx4 v33, s[4:7], s24 offen offset:1024 lds
  buffer_load_dwordx4 v34, s[4:7], s24 offen offset:2048 lds
  buffer_load_dwordx4 v35, s[4:7], s24 offen offset:3072 lds
  s_add_u32 m0, s27, 16384
  s_add_u32 s24, s24, 2097152
  buffer_load_dwordx4 v36, s[8:11], s25 offen offset:0 lds
  buffer_load_dwordx4 v37, s[8:11], s25 offen offset:1024 lds
  buffer_load_dwordx4 v38, s[8:11], s25 offen offset:2048 lds
  buffer_load_dwordx4 v39, s[8:11], s25 offen offset:3072 lds
  s_add_u32 m0, s27, 32768
  s_add_u32 s25, s25, 128
  s_getpc_b64 s[96:97]
PC_1:
  s_mov_b32 s98, MN_END-PC_1
  s_mov_b32 s99, 0x20000
  s_lshr_b32 s60, s2, 3
  s_lshl_b32 s61, s20, 5
  s_add_u32 s60, s60, s61
  s_lshl_b32 s60, s60, 13
  v_lshlrev_b32 v26, 7, v1
  buffer_load_dword v27, v26, s[96:99], s60 offen
  s_mov_b32 s12, s18
  s_mov_b32 s13, s19
  s_mov_b32 s14, 268435456
  s_mov_b32 s15, 0x20000
  s_lshl_b32 s62, s2, 3
  s_lshl_b32 s63, s20, 1
  s_add_u32 s62, s62, s63
  buffer_load_dwordx4 v32, s[4:7], s24 offen offset:0 lds
  s_mul_i32 s63, s62, 896
  v_lshrrev_b32 v18, 2, v1
  v_and_b32 v19, 3, v1
  buffer_load_dwordx4 v33, s[4:7], s24 offen offset:1024 lds
  v_lshlrev_b32 v20, 6, v18
  v_lshl_add_u32 v20, v19, 3, v20
  v_mov_b32 v21, 0x7fff0000
  buffer_load_dwordx4 v34, s[4:7], s24 offen offset:2048 lds
  v_cmp_gt_u32 vcc, 56, v1
  s_nop 1
  v_cndmask_b32 v20, v21, v20, vcc
  v_lshrrev_b32 v3, 4, v1
  v_and_b32 v2, 15, v1
  buffer_load_dwordx4 v35, s[4:7], s24 offen offset:3072 lds
  s_add_u32 m0, s27, 49152
  s_add_u32 s24, s24, 4292870272
  s_lshr_b32 s60, s20, 1
  s_lshl_b32 s60, s60, 13
  v_lshlrev_b32 v16, 7, v2
  buffer_load_dwordx4 v36, s[8:11], s25 offen offset:0 lds
  buffer_load_dwordx2 v[52:53], v20, s[76:79], s63 offen offset:0
  buffer_load_dwordx2 v[54:55], v20, s[76:79], s63 offen offset:32
  buffer_load_dwordx2 v[56:57], v20, s[76:79], s63 offen offset:896
  buffer_load_dwordx2 v[58:59], v20, s[76:79], s63 offen offset:928
  v_add_u32 v16, s60, v16
  v_lshrrev_b32 v17, 1, v2
  v_xor_b32 v17, v17, v3
  buffer_load_dwordx4 v37, s[8:11], s25 offen offset:1024 lds
  v_lshl_add_u32 v40, v17, 4, v16
  v_xor_b32 v41, 64, v40
  v_add_u32 v42, 0x10000, v40
  buffer_load_dwordx4 v38, s[8:11], s25 offen offset:2048 lds
  v_add_u32 v43, 0x10000, v41
  v_bfe_u32 v16, v1, 2, 2
  v_lshl_add_u32 v17, v3, 3, v16
  buffer_load_dwordx4 v39, s[8:11], s25 offen offset:3072 lds
  s_add_u32 m0, s27, 65536
  s_add_u32 s25, s25, 524160
  v_lshlrev_b32 v17, 8, v17
  v_and_b32 v23, 3, v1
  v_lshl_add_u32 v17, v23, 3, v17
  buffer_load_dwordx4 v32, s[4:7], s24 offen offset:0 lds
  v_add_u32 v17, 16384, v17
  v_and_b32 v23, 1, v3
  v_lshl_add_u32 v16, v23, 2, v16
  buffer_load_dwordx4 v33, s[4:7], s24 offen offset:1024 lds
  s_and_b32 s60, s20, 1
  s_lshl_b32 s60, s60, 2
  v_xor_b32 v16, s60, v16
  buffer_load_dwordx4 v34, s[4:7], s24 offen offset:2048 lds
  v_xor_b32 v23, 0, v16
  v_lshl_add_u32 v44, v23, 5, v17
  v_add_u32 v48, 0x10000, v44
  buffer_load_dwordx4 v35, s[4:7], s24 offen offset:3072 lds
  s_add_u32 m0, s27, 81920
  s_add_u32 s24, s24, 2097152
  v_xor_b32 v23, 1, v16
  v_lshl_add_u32 v45, v23, 5, v17
  v_add_u32 v49, 0x10000, v45
  buffer_load_dwordx4 v36, s[8:11], s25 offen offset:0 lds
  v_xor_b32 v23, 2, v16
  v_lshl_add_u32 v46, v23, 5, v17
  v_add_u32 v50, 0x10000, v46
  buffer_load_dwordx4 v37, s[8:11], s25 offen offset:1024 lds
  v_xor_b32 v23, 3, v16
  v_lshl_add_u32 v47, v23, 5, v17
  v_add_u32 v51, 0x10000, v47
  buffer_load_dwordx4 v38, s[8:11], s25 offen offset:2048 lds
  buffer_load_dwordx4 v39, s[8:11], s25 offen offset:3072 lds
  s_add_u32 m0, s27, 98304
  s_add_u32 s25, s25, 128
  s_waitcnt vmcnt(21)
  s_barrier
  ds_read_b128 a[64:67], v40 offset:0
  ds_read_b128 a[68:71], v41 offset:0
  ds_read_b128 a[72:75], v40 offset:2048
  ds_read_b128 a[76:79], v41 offset:2048
  ds_read_b128 a[80:83], v40 offset:4096
  ds_read_b128 a[84:87], v41 offset:4096
  ds_read_b128 a[88:91], v40 offset:6144
  ds_read_b128 a[92:95], v41 offset:6144
  ds_read_b64_tr_b16 a[128:129], v44 offset:0
  ds_read_b64_tr_b16 a[130:131], v44 offset:1024
  ds_read_b64_tr_b16 a[132:133], v44 offset:8192
  ds_read_b64_tr_b16 a[134:135], v44 offset:9216
  ds_read_b64_tr_b16 a[136:137], v45 offset:0
  ds_read_b64_tr_b16 a[138:139], v45 offset:1024
  ds_read_b64_tr_b16 a[140:141], v45 offset:8192
  ds_read_b64_tr_b16 a[142:143], v45 offset:9216
  ds_read_b64_tr_b16 a[144:145], v46 offset:0
  ds_read_b64_tr_b16 a[146:147], v46 offset:1024
  ds_read_b64_tr_b16 a[148:149], v46 offset:8192
  ds_read_b64_tr_b16 a[150:151], v46 offset:9216
  ds_read_b64_tr_b16 a[152:153], v47 offset:0
  ds_read_b64_tr_b16 a[154:155], v47 offset:1024
  ds_read_b64_tr_b16 a[156:157], v47 offset:8192
  ds_read_b64_tr_b16 a[158:159], v47 offset:9216
  s_waitcnt vmcnt(8) lgkmcnt(0)
  s_cmp_eq_u32 s22, 0
  s_cbranch_scc0 KV_V
  v_mfma_f32_16x16x32_bf16 a[0:3], a[128:131], a[64:67], 0
  s_barrier
  v_mfma_f32_16x16x32_bf16 a[0:3], a[132:135], a[68:71], a[0:3]
  s_add_u32 m0, s27, 98304
  ds_read_b64_tr_b16 a[160:161], v44 offset:32768
  v_lshlrev_b32 v10, 16, v52
  v_mfma_f32_16x16x32_bf16 a[4:7], a[140:143], a[68:71], 0
  buffer_load_dwordx4 v32, s[4:7], s24 offen offset:0 lds
  v_mfma_f32_16x16x32_bf16 a[4:7], a[136:139], a[64:67], a[4:7]
  s_mov_b64 s[72:73], s[16:17]
  ds_read_b64_tr_b16 a[162:163], v44 offset:33792
  v_and_b32 v11, 0xffff0000, v52
  v_mfma_f32_16x16x32_bf16 a[8:11], a[144:147], a[64:67], 0
  s_mov_b32 s74, 256
  ds_read_b64_tr_b16 a[164:165], v44 offset:40960
  v_lshlrev_b32 v12, 16, v53
  v_mfma_f32_16x16x32_bf16 a[8:11], a[148:151], a[68:71], a[8:11]
  s_mov_b32 s75, 0x20000
  ds_read_b64_tr_b16 a[166:167], v44 offset:41984
  v_and_b32 v13, 0xffff0000, v53
  v_mfma_f32_16x16x32_bf16 a[12:15], a[156:159], a[68:71], 0
  buffer_load_dwordx4 v33, s[4:7], s24 offen offset:1024 lds
  v_mfma_f32_16x16x32_bf16 a[12:15], a[152:155], a[64:67], a[12:15]
  s_mov_b32 s70, 3670016
  ds_read_b64_tr_b16 a[168:169], v45 offset:32768
  v_lshlrev_b32 v14, 16, v54
  v_mfma_f32_16x16x32_bf16 a[28:31], a[152:155], a[72:75], 0
  s_mov_b32 s71, 0x20000
  ds_read_b64_tr_b16 a[170:171], v45 offset:33792
  v_and_b32 v15, 0xffff0000, v54
  v_mfma_f32_16x16x32_bf16 a[28:31], a[156:159], a[76:79], a[28:31]
  s_sub_u32 s61, 15, s23
  ds_read_b64_tr_b16 a[172:173], v45 offset:40960
  v_lshlrev_b32 v16, 16, v55
  v_mfma_f32_16x16x32_bf16 a[24:27], a[148:151], a[76:79], 0
  buffer_load_dwordx4 v34, s[4:7], s24 offen offset:2048 lds
  v_mfma_f32_16x16x32_bf16 a[24:27], a[144:147], a[72:75], a[24:27]
  s_cmp_eq_u32 s22, 0
  s_cselect_b32 s40, s23, s61
  s_cselect_b32 s62, 0, 0
  ds_read_b64_tr_b16 a[174:175], v45 offset:41984
  v_and_b32 v17, 0xffff0000, v55
  v_mfma_f32_16x16x32_bf16 a[20:23], a[136:139], a[72:75], 0
  s_xor_b32 s17, s21, s62
  ds_read_b64_tr_b16 a[176:177], v46 offset:32768
  v_lshlrev_b32 v18, 16, v56
  v_mfma_f32_16x16x32_bf16 a[20:23], a[140:143], a[76:79], a[20:23]
  s_lshl_b32 s62, s62, 14
  ds_read_b64_tr_b16 a[178:179], v46 offset:33792
  v_and_b32 v19, 0xffff0000, v56
  v_mfma_f32_16x16x32_bf16 a[16:19], a[132:135], a[76:79], 0
  buffer_load_dwordx4 v35, s[4:7], s24 offen offset:3072 lds
  v_mfma_f32_16x16x32_bf16 a[16:19], a[128:131], a[72:75], a[16:19]
  s_add_u32 s24, s24, 4292870272
  ds_read_b64_tr_b16 a[180:181], v46 offset:40960
  v_lshlrev_b32 v20, 16, v57
  v_mfma_f32_16x16x32_bf16 a[32:35], a[128:131], a[80:83], 0
  s_lshl_b32 s56, s21, 14
  ds_read_b64_tr_b16 a[182:183], v46 offset:41984
  v_and_b32 v21, 0xffff0000, v57
  v_mfma_f32_16x16x32_bf16 a[32:35], a[132:135], a[84:87], a[32:35]
  s_add_u32 m0, s27, 114688
  ds_read_b64_tr_b16 a[184:185], v47 offset:32768
  v_lshlrev_b32 v22, 16, v58
  v_mfma_f32_16x16x32_bf16 a[36:39], a[140:143], a[84:87], 0
  buffer_load_dwordx4 v36, s[8:11], s25 offen offset:0 lds
  v_mfma_f32_16x16x32_bf16 a[36:39], a[136:139], a[80:83], a[36:39]
  s_add_u32 s56, s56, 44564480
  ds_read_b64_tr_b16 a[186:187], v47 offset:33792
  v_and_b32 v23, 0xffff0000, v58
  v_mfma_f32_16x16x32_bf16 a[40:43], a[144:147], a[80:83], 0
  s_lshr_b32 s60, s2, 4
  ds_read_b64_tr_b16 a[188:189], v47 offset:40960
  v_lshlrev_b32 v24, 16, v59
  v_mfma_f32_16x16x32_bf16 a[40:43], a[148:151], a[84:87], a[40:43]
  s_lshl_b32 s60, s60, 7
  ds_read_b64_tr_b16 a[190:191], v47 offset:41984
  v_and_b32 v25, 0xffff0000, v59
  v_mfma_f32_16x16x32_bf16 a[44:47], a[156:159], a[84:87], 0
  buffer_load_dwordx4 v37, s[8:11], s25 offen offset:1024 lds
  v_mfma_f32_16x16x32_bf16 a[44:47], a[152:155], a[80:83], a[44:47]
  s_lshl_b32 s61, s20, 7
  v_add_f32 v60, v10, v11
  v_mul_f32 v62, v10, v10
  v_mfma_f32_16x16x32_bf16 a[60:63], a[152:155], a[88:91], 0
  s_add_u32 s66, s60, s56
  v_fmac_f32 v62, v11, v11
  v_add_f32 v60, v60, v12
  v_mfma_f32_16x16x32_bf16 a[60:63], a[156:159], a[92:95], a[60:63]
  s_cmp_eq_u32 s20, 0
  s_cselect_b32 s66, s66, 268435456
  v_fmac_f32 v62, v12, v12
  v_add_f32 v60, v60, v13
  v_mfma_f32_16x16x32_bf16 a[56:59], a[148:151], a[92:95], 0
  buffer_load_dwordx4 v38, s[8:11], s25 offen offset:2048 lds
  v_mfma_f32_16x16x32_bf16 a[56:59], a[144:147], a[88:91], a[56:59]
  s_lshl_b32 s60, s23, 9
  v_fmac_f32 v62, v13, v13
  v_add_f32 v60, v60, v14
  v_mfma_f32_16x16x32_bf16 a[52:55], a[136:139], a[88:91], 0
  s_add_u32 s60, s60, s61
  v_fmac_f32 v62, v14, v14
  v_add_f32 v60, v60, v15
  v_mfma_f32_16x16x32_bf16 a[52:55], a[140:143], a[92:95], a[52:55]
  s_add_u32 s60, s60, s56
  v_fmac_f32 v62, v15, v15
  v_add_f32 v60, v60, v16
  v_mfma_f32_16x16x32_bf16 a[48:51], a[132:135], a[92:95], 0
  buffer_load_dwordx4 v39, s[8:11], s25 offen offset:3072 lds
  v_mfma_f32_16x16x32_bf16 a[48:51], a[128:131], a[88:91], a[48:51]
  s_waitcnt lgkmcnt(0)
  s_add_u32 s25, s25, 524160
  ds_read_b128 a[96:99], v40 offset:32768
  v_mfma_f32_16x16x32_bf16 v[64:67], a[160:163], a[64:67], 0
  s_xor_b32 s60, s60, s62
  v_fmac_f32 v62, v16, v16
  v_add_f32 v60, v60, v17
  v_mfma_f32_16x16x32_bf16 v[64:67], a[164:167], a[68:71], v[64:67]
  s_add_u32 m0, s27, 0
  ds_read_b128 a[100:103], v41 offset:32768
  v_fmac_f32 v62, v17, v17
  v_mfma_f32_16x16x32_bf16 v[68:71], a[172:175], a[68:71], 0
  buffer_load_dwordx4 v32, s[4:7], s24 offen offset:0 lds
  v_mfma_f32_16x16x32_bf16 v[68:71], a[168:171], a[64:67], v[68:71]
  s_add_u32 s60, s60, 8192
  ds_read_b128 a[104:107], v40 offset:34816
  v_add_f32 v61, v18, v19
  v_mfma_f32_16x16x32_bf16 v[72:75], a[176:179], a[64:67], 0
  s_add_u32 s61, s60, 4096
  v_mul_f32 v63, v18, v18
  v_fmac_f32 v63, v19, v19
  v_mfma_f32_16x16x32_bf16 v[72:75], a[180:183], a[68:71], v[72:75]
  s_cmp_eq_u32 s22, 0
  s_cselect_b32 s67, s61, s60
  s_cselect_b32 s51, s60, s61
  ds_read_b128 a[108:111], v41 offset:34816
  v_add_f32 v61, v61, v20
  v_mfma_f32_16x16x32_bf16 v[76:79], a[188:191], a[68:71], 0
  buffer_load_dwordx4 v33, s[4:7], s24 offen offset:1024 lds
  v_mfma_f32_16x16x32_bf16 v[76:79], a[184:187], a[64:67], v[76:79]
  s_lshl_b32 s61, s20, 9
  ds_read_b128 a[112:115], v40 offset:36864
  v_fmac_f32 v63, v20, v20
  v_mfma_f32_16x16x32_bf16 v[92:95], a[184:187], a[72:75], 0
  s_add_u32 s56, s56, s61
  v_add_f32 v61, v61, v21
  v_fmac_f32 v63, v21, v21
  v_mfma_f32_16x16x32_bf16 v[92:95], a[188:191], a[76:79], v[92:95]
  ds_read_b128 a[116:119], v41 offset:36864
  v_add_f32 v61, v61, v22
  v_mfma_f32_16x16x32_bf16 v[88:91], a[180:183], a[76:79], 0
  buffer_load_dwordx4 v34, s[4:7], s24 offen offset:2048 lds
  v_mfma_f32_16x16x32_bf16 v[88:91], a[176:179], a[72:75], v[88:91]
  ds_read_b128 a[120:123], v40 offset:38912
  v_fmac_f32 v63, v22, v22
  v_mfma_f32_16x16x32_bf16 v[84:87], a[168:171], a[72:75], 0
  v_add_f32 v61, v61, v23
  v_fmac_f32 v63, v23, v23
  v_mfma_f32_16x16x32_bf16 v[84:87], a[172:175], a[76:79], v[84:87]
  ds_read_b128 a[124:127], v41 offset:38912
  v_add_f32 v61, v61, v24
  v_mfma_f32_16x16x32_bf16 v[80:83], a[164:167], a[76:79], 0
  buffer_load_dwordx4 v35, s[4:7], s24 offen offset:3072 lds
  v_mfma_f32_16x16x32_bf16 v[80:83], a[160:163], a[72:75], v[80:83]
  s_add_u32 s24, s24, 2097152
  v_fmac_f32 v63, v24, v24
  v_add_f32 v61, v61, v25
  v_mfma_f32_16x16x32_bf16 v[96:99], a[160:163], a[80:83], 0
  v_fmac_f32 v63, v25, v25
  v_mov_b32 v5, 0x7fff0000
  v_mfma_f32_16x16x32_bf16 v[96:99], a[164:167], a[84:87], v[96:99]
  s_add_u32 m0, s27, 16384
  v_mfma_f32_16x16x32_bf16 v[100:103], a[172:175], a[84:87], 0
  buffer_load_dwordx4 v36, s[8:11], s25 offen offset:0 lds
  v_mfma_f32_16x16x32_bf16 v[100:103], a[168:171], a[80:83], v[100:103]
  s_lshl_b64 exec, 0xff, 0
  v_mov_b32 v5, s66
  s_mov_b64 exec, -1
  v_add_f32_dpp v60, v60, v60 quad_perm:[1,0,3,2] row_mask:0xf bank_mask:0xf
  v_add_f32_dpp v61, v61, v61 quad_perm:[1,0,3,2] row_mask:0xf bank_mask:0xf
  v_mfma_f32_16x16x32_bf16 v[104:107], a[176:179], a[80:83], 0
  s_lshl_b64 exec, 0xff, 8
  v_mov_b32 v5, s67
  s_mov_b64 exec, -1
  v_add_f32_dpp v62, v62, v62 quad_perm:[1,0,3,2] row_mask:0xf bank_mask:0xf
  v_add_f32_dpp v63, v63, v63 quad_perm:[1,0,3,2] row_mask:0xf bank_mask:0xf
  v_mfma_f32_16x16x32_bf16 v[104:107], a[180:183], a[84:87], v[104:107]
  s_add_u32 s60, s66, 2048
  v_add_f32_dpp v60, v60, v60 quad_perm:[2,3,0,1] row_mask:0xf bank_mask:0xf
  v_add_f32_dpp v61, v61, v61 quad_perm:[2,3,0,1] row_mask:0xf bank_mask:0xf
  v_mfma_f32_16x16x32_bf16 v[108:111], a[188:191], a[84:87], 0
  buffer_load_dwordx4 v37, s[8:11], s25 offen offset:1024 lds
  v_mfma_f32_16x16x32_bf16 v[108:111], a[184:187], a[80:83], v[108:111]
  s_lshl_b64 exec, 0xff, 32
  v_mov_b32 v5, s60
  s_mov_b64 exec, -1
  v_add_f32_dpp v62, v62, v62 quad_perm:[2,3,0,1] row_mask:0xf bank_mask:0xf
  v_add_f32_dpp v63, v63, v63 quad_perm:[2,3,0,1] row_mask:0xf bank_mask:0xf
  v_mfma_f32_16x16x32_bf16 v[124:127], a[184:187], a[88:91], 0
  s_lshl_b32 s60, s40, 2
  v_add_f32_dpp v60, v60, v60 row_half_mirror row_mask:0xf bank_mask:0xf
  v_add_f32_dpp v61, v61, v61 row_half_mirror row_mask:0xf bank_mask:0xf
  v_mfma_f32_16x16x32_bf16 v[124:127], a[188:191], a[92:95], v[124:127]
  s_add_u32 s60, s60, s20
  v_add_f32_dpp v62, v62, v62 row_half_mirror row_mask:0xf bank_mask:0xf
  v_add_f32_dpp v63, v63, v63 row_half_mirror row_mask:0xf bank_mask:0xf
  v_mfma_f32_16x16x32_bf16 v[120:123], a[180:183], a[92:95], 0
  buffer_load_dwordx4 v38, s[8:11], s25 offen offset:2048 lds
  v_mfma_f32_16x16x32_bf16 v[120:123], a[176:179], a[88:91], v[120:123]
  s_lshl_b32 s60, s60, 4
  v_add_f32_dpp v60, v60, v60 row_mirror row_mask:0xf bank_mask:0xf
  v_add_f32_dpp v61, v61, v61 row_mirror row_mask:0xf bank_mask:0xf
  v_mfma_f32_16x16x32_bf16 v[116:119], a[168:171], a[88:91], 0
  s_add_u32 s60, s60, s21
  v_add_f32_dpp v62, v62, v62 row_mirror row_mask:0xf bank_mask:0xf
  v_add_f32_dpp v63, v63, v63 row_mirror row_mask:0xf bank_mask:0xf
  v_mfma_f32_16x16x32_bf16 v[116:119], a[172:175], a[92:95], v[116:119]
  s_lshl_b32 s60, s60, 7
  v_mov_b32 v26, v60
  v_mov_b32 v28, v61
  v_mfma_f32_16x16x32_bf16 v[112:115], a[164:167], a[92:95], 0
  buffer_load_dwordx4 v39, s[8:11], s25 offen offset:3072 lds
  v_mfma_f32_16x16x32_bf16 v[112:115], a[160:163], a[88:91], v[112:115]
  s_add_u32 s25, s25, 128
  s_waitcnt vmcnt(16) lgkmcnt(0)
  v_mfma_f32_16x16x32_bf16 v[128:131], a[160:163], a[96:99], 0
  s_barrier
  v_mfma_f32_16x16x32_bf16 v[128:131], a[164:167], a[100:103], v[128:131]
  s_add_u32 s60, s60, 94371840
  ds_read_b128 a[64:67], v42 offset:0
  v_mov_b32 v29, v62
  v_mfma_f32_16x16x32_bf16 v[132:135], a[172:175], a[100:103], 0
  s_add_u32 m0, s27, 32768
  v_mov_b32 v30, v63
  v_mfma_f32_16x16x32_bf16 v[132:135], a[168:171], a[96:99], v[132:135]
  buffer_load_dwordx4 v32, s[4:7], s24 offen offset:0 lds
  v_mfma_f32_16x16x32_bf16 v[136:139], a[176:179], a[96:99], 0
  s_lshl_b64 exec, 0xff, 16
  v_mov_b32 v5, s60
  s_mov_b64 exec, -1
  ds_read_b128 a[68:71], v43 offset:0
  v_mfma_f32_16x16x32_bf16 v[136:139], a[180:183], a[100:103], v[136:139]
  s_lshl_b32 s60, s20, 8
  v_permlane16_swap_b32 v60, v26
  v_mfma_f32_16x16x32_bf16 v[140:143], a[188:191], a[100:103], 0
  s_add_u32 s60, s60, s2
  ds_read_b128 a[72:75], v42 offset:2048
  v_mfma_f32_16x16x32_bf16 v[140:143], a[184:187], a[96:99], v[140:143]
  s_lshl_b32 s61, s60, 7
  v_permlane16_swap_b32 v61, v28
  v_mfma_f32_16x16x32_bf16 v[156:159], a[184:187], a[104:107], 0
  buffer_load_dwordx4 v33, s[4:7], s24 offen offset:1024 lds
  v_mfma_f32_16x16x32_bf16 v[156:159], a[188:191], a[108:111], v[156:159]
  s_add_u32 s61, s61, 94502912
  ds_read_b128 a[76:79], v43 offset:2048
  v_mfma_f32_16x16x32_bf16 v[152:155], a[180:183], a[108:111], 0
  s_cmp_lt_u32 s60, 480
  s_cselect_b32 s61, s61, 0x7fff0000
  v_permlane16_swap_b32 v62, v29
  v_mfma_f32_16x16x32_bf16 v[152:155], a[176:179], a[104:107], v[152:155]
  s_lshl_b64 exec, 0xff, 24
  v_mov_b32 v5, s61
  s_mov_b64 exec, -1
  ds_read_b128 a[80:83], v42 offset:4096
  v_mfma_f32_16x16x32_bf16 v[148:151], a[168:171], a[104:107], 0
  s_lshl_b32 s61, s60, 13
  v_permlane16_swap_b32 v63, v30
  v_mfma_f32_16x16x32_bf16 v[148:151], a[172:175], a[108:111], v[148:151]
  buffer_load_dwordx4 v34, s[4:7], s24 offen offset:2048 lds
  v_mfma_f32_16x16x32_bf16 v[144:147], a[164:167], a[108:111], 0
  s_add_u32 s80, s68, s61
  s_addc_u32 s81, s69, 0
  ds_read_b128 a[84:87], v43 offset:4096
  v_add_f32 v60, v60, v26
  v_mfma_f32_16x16x32_bf16 v[144:147], a[160:163], a[104:107], v[144:147]
  s_mov_b32 s83, 0x20000
  v_add_f32 v61, v61, v28
  v_add_f32 v62, v62, v29
  v_mfma_f32_16x16x32_bf16 v[160:163], a[160:163], a[112:115], 0
  s_mul_i32 s33, s60, 11
  ds_read_b128 a[88:91], v42 offset:6144
  v_add_f32 v63, v63, v30
  v_mfma_f32_16x16x32_bf16 v[160:163], a[164:167], a[116:119], v[160:163]
  s_lshr_b32 s33, s33, 10
  v_mov_b32 v26, v60
  v_mov_b32 v28, v61
  v_mfma_f32_16x16x32_bf16 v[164:167], a[172:175], a[116:119], 0
  buffer_load_dwordx4 v35, s[4:7], s24 offen offset:3072 lds
  v_mfma_f32_16x16x32_bf16 v[164:167], a[168:171], a[112:115], v[164:167]
  s_add_u32 s24, s24, 4292870272
  ds_read_b128 a[92:95], v43 offset:6144
  v_mov_b32 v29, v62
  v_mfma_f32_16x16x32_bf16 v[168:171], a[176:179], a[112:115], 0
  s_sub_u32 s33, 6, s33
  v_mov_b32 v30, v63
  v_mfma_f32_16x16x32_bf16 v[168:171], a[180:183], a[116:119], v[168:171]
  s_cmp_ge_u32 s60, 448
  s_cmov_b32 s33, 99
  v_permlane32_swap_b32 v60, v26
  v_mfma_f32_16x16x32_bf16 v[172:175], a[188:191], a[116:119], 0
  s_add_u32 m0, s27, 49152
  v_permlane32_swap_b32 v61, v28
  v_mfma_f32_16x16x32_bf16 v[172:175], a[184:187], a[112:115], v[172:175]
  buffer_load_dwordx4 v36, s[8:11], s25 offen offset:0 lds
  v_mfma_f32_16x16x32_bf16 v[188:191], a[184:187], a[120:123], 0
  s_bfe_u32 s64, s2, 0x20003
  v_permlane32_swap_b32 v62, v29
  v_mfma_f32_16x16x32_bf16 v[188:191], a[188:191], a[124:127], v[188:191]
  s_sub_u32 s64, 5, s64
  v_permlane32_swap_b32 v63, v30
  v_mfma_f32_16x16x32_bf16 v[184:187], a[180:183], a[124:127], 0
  s_cmp_eq_u32 s20, 0
  s_cselect_b32 s64, s64, 99
  v_add_f32 v60, v60, v26
  v_add_f32 v61, v61, v28
  v_mfma_f32_16x16x32_bf16 v[184:187], a[176:179], a[120:123], v[184:187]
  s_lshl_b32 s65, s21, 2
  v_add_f32 v62, v62, v29
  v_add_f32 v63, v63, v30
  v_mfma_f32_16x16x32_bf16 v[180:183], a[168:171], a[120:123], 0
  buffer_load_dwordx4 v37, s[8:11], s25 offen offset:1024 lds
  v_mfma_f32_16x16x32_bf16 v[180:183], a[172:175], a[124:127], v[180:183]
  s_lshr_b32 s63, s2, 1
  v_mul_f32 v60, 0x3b124925, v60
  v_mul_f32 v62, 0x3b124925, v62
  v_mfma_f32_16x16x32_bf16 v[176:179], a[164:167], a[124:127], 0
  s_mul_i32 s63, s63, 14336
  v_fma_f32 v62, -v60, v60, v62
  v_max_f32 v62, 0, v62
  v_mfma_f32_16x16x32_bf16 v[176:179], a[160:163], a[120:123], v[176:179]
  s_and_b32 s60, s2, 1
  v_add_f32 v62, 0x3727c5ac, v62
  v_mfma_f32_16x16x32_bf16 v[192:195], a[128:131], a[96:99], 0
  s_lshl_b32 s60, s60, 7
  ds_read_b64_tr_b16 a[160:161], v48 offset:0
  v_mfma_f32_16x16x32_bf16 v[192:195], a[132:135], a[100:103], v[192:195]
  buffer_load_dwordx4 v38, s[8:11], s25 offen offset:2048 lds
  v_mfma_f32_16x16x32_bf16 v[196:199], a[140:143], a[100:103], 0
  s_add_u32 s63, s63, s60
  ds_read_b64_tr_b16 a[162:163], v48 offset:1024
  v_mfma_f32_16x16x32_bf16 v[196:199], a[136:139], a[96:99], v[196:199]
  s_add_u32 s63, s63, 33554432
  ds_read_b64_tr_b16 a[164:165], v48 offset:8192
  v_mfma_f32_16x16x32_bf16 v[200:203], a[144:147], a[96:99], 0
  s_mov_b32 s26, 6
  ds_read_b64_tr_b16 a[166:167], v48 offset:9216
  v_and_b32 v6, 7, v1
  v_mfma_f32_16x16x32_bf16 v[200:203], a[148:151], a[100:103], v[200:203]
  ds_read_b64_tr_b16 a[168:169], v49 offset:0
  v_lshl_add_u32 v5, v6, 4, v5
  v_mfma_f32_16x16x32_bf16 v[204:207], a[156:159], a[100:103], 0
  buffer_load_dwordx4 v39, s[8:11], s25 offen offset:3072 lds
  v_mfma_f32_16x16x32_bf16 v[204:207], a[152:155], a[96:99], v[204:207]
  s_add_u32 s25, s25, 524160
  ds_read_b64_tr_b16 a[170:171], v49 offset:1024
  v_mfma_f32_16x16x32_bf16 v[220:223], a[152:155], a[104:107], 0
  ds_read_b64_tr_b16 a[172:173], v49 offset:8192
  v_mfma_f32_16x16x32_bf16 v[220:223], a[156:159], a[108:111], v[220:223]
  ds_read_b64_tr_b16 a[174:175], v49 offset:9216
  v_mfma_f32_16x16x32_bf16 v[216:219], a[148:151], a[108:111], 0
  ds_read_b64_tr_b16 a[176:177], v50 offset:0
  v_mfma_f32_16x16x32_bf16 v[216:219], a[144:147], a[104:107], v[216:219]
  ds_read_b64_tr_b16 a[178:179], v50 offset:1024
  v_mfma_f32_16x16x32_bf16 v[212:215], a[136:139], a[104:107], 0
  ds_read_b64_tr_b16 a[180:181], v50 offset:8192
  v_mfma_f32_16x16x32_bf16 v[212:215], a[140:143], a[108:111], v[212:215]
  ds_read_b64_tr_b16 a[182:183], v50 offset:9216
  v_mfma_f32_16x16x32_bf16 v[208:211], a[132:135], a[108:111], 0
  ds_read_b64_tr_b16 a[184:185], v51 offset:0
  v_mfma_f32_16x16x32_bf16 v[208:211], a[128:131], a[104:107], v[208:211]
  ds_read_b64_tr_b16 a[186:187], v51 offset:1024
  v_mfma_f32_16x16x32_bf16 v[224:227], a[128:131], a[112:115], 0
  ds_read_b64_tr_b16 a[188:189], v51 offset:8192
  v_mfma_f32_16x16x32_bf16 v[224:227], a[132:135], a[116:119], v[224:227]
  ds_read_b64_tr_b16 a[190:191], v51 offset:9216
  v_mfma_f32_16x16x32_bf16 v[228:231], a[140:143], a[116:119], 0
  v_rsq_f32 v62, v62
  v_mfma_f32_16x16x32_bf16 v[228:231], a[136:139], a[112:115], v[228:231]
  v_mul_f32 v62, 0x3db8aa3b, v62
  v_sub_f32 v10, v10, v60
  v_mfma_f32_16x16x32_bf16 v[232:235], a[144:147], a[112:115], 0
  v_mul_f32 v10, v10, v62
  v_sub_f32 v11, v11, v60
  v_mfma_f32_16x16x32_bf16 v[232:235], a[148:151], a[116:119], v[232:235]
  v_mul_f32 v11, v11, v62
  v_sub_f32 v12, v12, v60
  v_mfma_f32_16x16x32_bf16 v[236:239], a[156:159], a[116:119], 0
  v_mul_f32 v12, v12, v62
  v_sub_f32 v13, v13, v60
  v_mfma_f32_16x16x32_bf16 v[236:239], a[152:155], a[112:115], v[236:239]
  v_mul_f32 v13, v13, v62
  v_sub_f32 v14, v14, v60
  v_mfma_f32_16x16x32_bf16 v[252:255], a[152:155], a[120:123], 0
  v_mul_f32 v14, v14, v62
  v_sub_f32 v15, v15, v60
  v_mfma_f32_16x16x32_bf16 v[252:255], a[156:159], a[124:127], v[252:255]
  v_mul_f32 v15, v15, v62
  v_sub_f32 v16, v16, v60
  v_mfma_f32_16x16x32_bf16 v[248:251], a[148:151], a[124:127], 0
  v_mul_f32 v16, v16, v62
  v_sub_f32 v17, v17, v60
  v_mfma_f32_16x16x32_bf16 v[248:251], a[144:147], a[120:123], v[248:251]
  v_mul_f32 v17, v17, v62
  v_cvt_pk_bf16_f32 v52, v10, v11
  v_mfma_f32_16x16x32_bf16 v[244:247], a[136:139], a[120:123], 0
  v_cvt_pk_bf16_f32 v53, v12, v13
  v_cvt_pk_bf16_f32 v54, v14, v15
  v_mfma_f32_16x16x32_bf16 v[244:247], a[140:143], a[124:127], v[244:247]
  v_cvt_pk_bf16_f32 v55, v16, v17
  v_mul_f32 v61, 0x3b124925, v61
  v_mfma_f32_16x16x32_bf16 v[240:243], a[132:135], a[124:127], 0
  v_mul_f32 v63, 0x3b124925, v63
  v_fma_f32 v63, -v61, v61, v63
  v_mfma_f32_16x16x32_bf16 v[240:243], a[128:131], a[120:123], v[240:243]
  s_waitcnt vmcnt(16) lgkmcnt(0)
  v_mfma_f32_16x16x32_bf16 a[0:3], a[160:163], a[64:67], a[0:3]
  s_barrier
  v_mfma_f32_16x16x32_bf16 a[0:3], a[164:167], a[68:71], a[0:3]
  ds_read_b64_tr_b16 a[128:129], v48 offset:32768
  v_max_f32 v63, 0, v63
  v_mfma_f32_16x16x32_bf16 a[4:7], a[172:175], a[68:71], a[4:7]
  s_add_u32 m0, s27, 65536
  ds_read_b64_tr_b16 a[130:131], v48 offset:33792
  v_add_f32 v63, 0x3727c5ac, v63
  v_mfma_f32_16x16x32_bf16 a[4:7], a[168:171], a[64:67], a[4:7]
  buffer_load_dwordx4 v32, s[4:7], s24 offen offset:0 lds
  v_mfma_f32_16x16x32_bf16 a[8:11], a[176:179], a[64:67], a[8:11]
  ds_read_b64_tr_b16 a[132:133], v48 offset:40960
  v_mfma_f32_16x16x32_bf16 a[8:11], a[180:183], a[68:71], a[8:11]
  ds_read_b64_tr_b16 a[134:135], v48 offset:41984
  v_mfma_f32_16x16x32_bf16 a[12:15], a[188:191], a[68:71], a[12:15]
  ds_read_b64_tr_b16 a[136:137], v49 offset:32768
  v_mfma_f32_16x16x32_bf16 a[12:15], a[184:187], a[64:67], a[12:15]
  ds_read_b64_tr_b16 a[138:139], v49 offset:33792
  v_mfma_f32_16x16x32_bf16 a[28:31], a[184:187], a[72:75], a[28:31]
  buffer_load_dwordx4 v33, s[4:7], s24 offen offset:1024 lds
  v_mfma_f32_16x16x32_bf16 a[28:31], a[188:191], a[76:79], a[28:31]
  ds_read_b64_tr_b16 a[140:141], v49 offset:40960
  v_mfma_f32_16x16x32_bf16 a[24:27], a[180:183], a[76:79], a[24:27]
  ds_read_b64_tr_b16 a[142:143], v49 offset:41984
  v_mfma_f32_16x16x32_bf16 a[24:27], a[176:179], a[72:75], a[24:27]
  ds_read_b64_tr_b16 a[144:145], v50 offset:32768
  v_mfma_f32_16x16x32_bf16 a[20:23], a[168:171], a[72:75], a[20:23]
  ds_read_b64_tr_b16 a[146:147], v50 offset:33792
  v_mfma_f32_16x16x32_bf16 a[20:23], a[172:175], a[76:79], a[20:23]
  buffer_load_dwordx4 v34, s[4:7], s24 offen offset:2048 lds
  v_mfma_f32_16x16x32_bf16 a[16:19], a[164:167], a[76:79], a[16:19]
  ds_read_b64_tr_b16 a[148:149], v50 offset:40960
  v_mfma_f32_16x16x32_bf16 a[16:19], a[160:163], a[72:75], a[16:19]
  ds_read_b64_tr_b16 a[150:151], v50 offset:41984
  v_mfma_f32_16x16x32_bf16 a[32:35], a[160:163], a[80:83], a[32:35]
  ds_read_b64_tr_b16 a[152:153], v51 offset:32768
  v_mfma_f32_16x16x32_bf16 a[32:35], a[164:167], a[84:87], a[32:35]
  ds_read_b64_tr_b16 a[154:155], v51 offset:33792
  v_mfma_f32_16x16x32_bf16 a[36:39], a[172:175], a[84:87], a[36:39]
  buffer_load_dwordx4 v35, s[4:7], s24 offen offset:3072 lds
  v_mfma_f32_16x16x32_bf16 a[36:39], a[168:171], a[80:83], a[36:39]
  s_add_u32 s24, s24, 2097152
  ds_read_b64_tr_b16 a[156:157], v51 offset:40960
  v_mfma_f32_16x16x32_bf16 a[40:43], a[176:179], a[80:83], a[40:43]
  ds_read_b64_tr_b16 a[158:159], v51 offset:41984
  v_mfma_f32_16x16x32_bf16 a[40:43], a[180:183], a[84:87], a[40:43]
  v_rsq_f32 v63, v63
  v_mfma_f32_16x16x32_bf16 a[44:47], a[188:191], a[84:87], a[44:47]
  s_add_u32 m0, s27, 81920
  v_mul_f32 v63, 0x3db8aa3b, v63
  v_sub_f32 v18, v18, v61
  v_mfma_f32_16x16x32_bf16 a[44:47], a[184:187], a[80:83], a[44:47]
  buffer_load_dwordx4 v36, s[8:11], s25 offen offset:0 lds
  v_mfma_f32_16x16x32_bf16 a[60:63], a[184:187], a[88:91], a[60:63]
  v_mul_f32 v18, v18, v63
  v_sub_f32 v19, v19, v61
  v_mfma_f32_16x16x32_bf16 a[60:63], a[188:191], a[92:95], a[60:63]
  v_mul_f32 v19, v19, v63
  v_sub_f32 v20, v20, v61
  v_mfma_f32_16x16x32_bf16 a[56:59], a[180:183], a[92:95], a[56:59]
  v_mul_f32 v20, v20, v63
  v_sub_f32 v21, v21, v61
  v_mfma_f32_16x16x32_bf16 a[56:59], a[176:179], a[88:91], a[56:59]
  v_mul_f32 v21, v21, v63
  v_sub_f32 v22, v22, v61
  v_mfma_f32_16x16x32_bf16 a[52:55], a[168:171], a[88:91], a[52:55]
  buffer_load_dwordx4 v37, s[8:11], s25 offen offset:1024 lds
  v_mfma_f32_16x16x32_bf16 a[52:55], a[172:175], a[92:95], a[52:55]
  v_mul_f32 v22, v22, v63
  v_sub_f32 v23, v23, v61
  v_mfma_f32_16x16x32_bf16 a[48:51], a[164:167], a[92:95], a[48:51]
  ds_read_b128 a[96:99], v42 offset:32768
  v_mul_f32 v23, v23, v63
  v_mfma_f32_16x16x32_bf16 a[48:51], a[160:163], a[88:91], a[48:51]
  s_waitcnt lgkmcnt(1)
  v_sub_f32 v24, v24, v61
  v_mul_f32 v24, v24, v63
  v_mfma_f32_16x16x32_bf16 v[64:67], a[128:131], a[64:67], v[64:67]
  ds_read_b128 a[100:103], v43 offset:32768
  v_sub_f32 v25, v25, v61
  v_mfma_f32_16x16x32_bf16 v[64:67], a[132:135], a[68:71], v[64:67]
  buffer_load_dwordx4 v38, s[8:11], s25 offen offset:2048 lds
  v_mfma_f32_16x16x32_bf16 v[68:71], a[140:143], a[68:71], v[68:71]
  ds_read_b128 a[104:107], v42 offset:34816
  v_mul_f32 v25, v25, v63
  v_mfma_f32_16x16x32_bf16 v[68:71], a[136:139], a[64:67], v[68:71]
  v_cvt_pk_bf16_f32 v56, v18, v19
  v_cvt_pk_bf16_f32 v57, v20, v21
  v_mfma_f32_16x16x32_bf16 v[72:75], a[144:147], a[64:67], v[72:75]
  ds_read_b128 a[108:111], v43 offset:34816
  v_cvt_pk_bf16_f32 v58, v22, v23
  v_mfma_f32_16x16x32_bf16 v[72:75], a[148:151], a[68:71], v[72:75]
  v_cvt_pk_bf16_f32 v59, v24, v25
  v_mul_u32_u24 v22, 144, v1
  v_mfma_f32_16x16x32_bf16 v[76:79], a[156:159], a[68:71], v[76:79]
  buffer_load_dwordx4 v39, s[8:11], s25 offen offset:3072 lds
  v_mfma_f32_16x16x32_bf16 v[76:79], a[152:155], a[64:67], v[76:79]
  s_add_u32 s25, s25, 128
  ds_read_b128 a[112:115], v42 offset:36864
  v_lshl_add_u32 v22, s20, 5, v22
  v_mfma_f32_16x16x32_bf16 v[92:95], a[152:155], a[72:75], v[92:95]
  v_add_u32 v22, 0x20000, v22
  v_lshrrev_b32 v18, 3, v0
  v_mfma_f32_16x16x32_bf16 v[92:95], a[156:159], a[76:79], v[92:95]
  ds_read_b128 a[116:119], v43 offset:36864
  v_add_u32 v18, v18, v0
  v_mfma_f32_16x16x32_bf16 v[88:91], a[148:151], a[76:79], v[88:91]
  v_lshlrev_b32 v18, 4, v18
  v_add_u32 v18, 0x20000, v18
  v_mfma_f32_16x16x32_bf16 v[88:91], a[144:147], a[72:75], v[88:91]
  ds_read_b128 a[120:123], v42 offset:38912
  v_lshrrev_b32 v19, 3, v0
  v_mfma_f32_16x16x32_bf16 v[84:87], a[136:139], a[72:75], v[84:87]
  v_lshlrev_b32 v19, 8, v19
  v_and_b32 v20, 7, v0
  v_mfma_f32_16x16x32_bf16 v[84:87], a[140:143], a[76:79], v[84:87]
  ds_read_b128 a[124:127], v43 offset:38912
  v_lshl_add_u32 v19, v20, 4, v19
  v_mfma_f32_16x16x32_bf16 v[80:83], a[132:135], a[76:79], v[80:83]
  v_cmp_gt_u32 vcc, 192, v0
  v_add_u32 v20, 8192, v19
  v_mfma_f32_16x16x32_bf16 v[80:83], a[128:131], a[72:75], v[80:83]
  v_mov_b32 v21, 0x7fff0000
  v_cndmask_b32 v20, v21, v20, vcc
  v_mfma_f32_16x16x32_bf16 v[96:99], a[128:131], a[80:83], v[96:99]
  v_mov_b64 v[60:61], 0
  v_mov_b64 v[62:63], 0
  v_mfma_f32_16x16x32_bf16 v[96:99], a[132:135], a[84:87], v[96:99]
  v_lshlrev_b32 v0, 7, v1
  v_lshlrev_b32 v9, 4, v1
  v_mfma_f32_16x16x32_bf16 v[100:103], a[140:143], a[84:87], v[100:103]
  v_lshlrev_b32 v31, 2, v1
  v_mfma_f32_16x16x32_bf16 v[100:103], a[136:139], a[80:83], v[100:103]
  v_mfma_f32_16x16x32_bf16 v[104:107], a[144:147], a[80:83], v[104:107]
  ds_write_b128 v22, v[52:55] offset:0
  v_mfma_f32_16x16x32_bf16 v[104:107], a[148:151], a[84:87], v[104:107]
  v_mfma_f32_16x16x32_bf16 v[108:111], a[156:159], a[84:87], v[108:111]
  v_mfma_f32_16x16x32_bf16 v[108:111], a[152:155], a[80:83], v[108:111]
  v_mfma_f32_16x16x32_bf16 v[124:127], a[152:155], a[88:91], v[124:127]
  ds_write_b128 v22, v[56:59] offset:16
  v_mfma_f32_16x16x32_bf16 v[124:127], a[156:159], a[92:95], v[124:127]
  v_mfma_f32_16x16x32_bf16 v[120:123], a[148:151], a[92:95], v[120:123]
  v_mfma_f32_16x16x32_bf16 v[120:123], a[144:147], a[88:91], v[120:123]
  v_mfma_f32_16x16x32_bf16 v[116:119], a[136:139], a[88:91], v[116:119]
  v_mfma_f32_16x16x32_bf16 v[116:119], a[140:143], a[92:95], v[116:119]
  v_mfma_f32_16x16x32_bf16 v[112:115], a[132:135], a[92:95], v[112:115]
  v_mfma_f32_16x16x32_bf16 v[112:115], a[128:131], a[88:91], v[112:115]
  s_waitcnt vmcnt(16) lgkmcnt(0)
  v_mfma_f32_16x16x32_bf16 v[128:131], a[128:131], a[96:99], v[128:131]
  s_barrier
  v_mfma_f32_16x16x32_bf16 v[128:131], a[132:135], a[100:103], v[128:131]
  ds_read_b128 a[64:67], v40 offset:0
  v_lshrrev_b32 v2, 3, v1
  v_mfma_f32_16x16x32_bf16 v[132:135], a[140:143], a[100:103], v[132:135]
  s_add_u32 m0, s27, 98304
  ds_read_b128 v[52:55], v18 offset:0
  v_mfma_f32_16x16x32_bf16 v[132:135], a[136:139], a[96:99], v[132:135]
  buffer_load_dwordx4 v32, s[4:7], s24 offen offset:0 lds
  v_mfma_f32_16x16x32_bf16 v[136:139], a[144:147], a[96:99], v[136:139]
  s_lshl_b32 s61, s20, 3
  ds_read_b128 v[56:59], v18 offset:4608
  v_add_u32 v2, s61, v2
  v_mfma_f32_16x16x32_bf16 v[136:139], a[148:151], a[100:103], v[136:139]
  ds_read_b128 a[68:71], v41 offset:0
  v_bfe_u32 v3, v1, 1, 2
  v_mfma_f32_16x16x32_bf16 v[140:143], a[156:159], a[100:103], v[140:143]
  v_lshrrev_b32 v16, 4, v1
  v_xor_b32 v3, v3, v16
  v_mfma_f32_16x16x32_bf16 v[140:143], a[152:155], a[96:99], v[140:143]
  ds_read_b128 a[72:75], v40 offset:2048
  v_lshlrev_b32 v3, 5, v3
  v_mfma_f32_16x16x32_bf16 v[156:159], a[152:155], a[104:107], v[156:159]
  buffer_load_dwordx4 v33, s[4:7], s24 offen offset:1024 lds
  v_mfma_f32_16x16x32_bf16 v[156:159], a[156:159], a[108:111], v[156:159]
  ds_read_b128 a[76:79], v41 offset:2048
  v_and_b32 v16, 1, v1
  v_mfma_f32_16x16x32_bf16 v[152:155], a[148:151], a[108:111], v[152:155]
  v_lshl_add_u32 v3, v16, 4, v3
  v_lshl_add_u32 v4, v2, 13, v3
  v_mfma_f32_16x16x32_bf16 v[152:155], a[144:147], a[104:107], v[152:155]
  s_lshl_b32 s61, s21, 9
  ds_read_b128 a[80:83], v40 offset:4096
  v_add_u32 v4, s61, v4
  v_mfma_f32_16x16x32_bf16 v[148:151], a[136:139], a[104:107], v[148:151]
  s_lshl_b32 s61, s21, 8
  v_add_u32 v2, s61, v2
  v_mul_u32_u24 v7, 896, v2
  v_mfma_f32_16x16x32_bf16 v[148:151], a[140:143], a[108:111], v[148:151]
  buffer_load_dwordx4 v34, s[4:7], s24 offen offset:2048 lds
  v_mfma_f32_16x16x32_bf16 v[144:147], a[132:135], a[108:111], v[144:147]
  ds_read_b128 a[84:87], v41 offset:4096
  v_add_u32 v7, v7, v3
  v_mfma_f32_16x16x32_bf16 v[144:147], a[128:131], a[104:107], v[144:147]
  s_mov_b32 s30, 262144
  v_mfma_f32_16x16x32_bf16 v[160:163], a[128:131], a[112:115], v[160:163]
  s_lshl_b32 s31, s20, 10
  ds_read_b128 a[88:91], v40 offset:6144
  v_mfma_f32_16x16x32_bf16 v[160:163], a[132:135], a[116:119], v[160:163]
  s_lshl_b32 s3, s20, 13
  v_mfma_f32_16x16x32_bf16 v[164:167], a[140:143], a[116:119], v[164:167]
  buffer_load_dwordx4 v35, s[4:7], s24 offen offset:3072 lds
  v_mfma_f32_16x16x32_bf16 v[164:167], a[136:139], a[112:115], v[164:167]
  s_add_u32 s24, s24, 4292870272
  ds_read_b128 a[92:95], v41 offset:6144
  v_mfma_f32_16x16x32_bf16 v[168:171], a[144:147], a[112:115], v[168:171]
  s_lshl_b32 s48, s40, 3
  v_mfma_f32_16x16x32_bf16 v[168:171], a[148:151], a[116:119], v[168:171]
  s_add_u32 s48, s48, s20
  v_mfma_f32_16x16x32_bf16 v[172:175], a[156:159], a[116:119], v[172:175]
  s_add_u32 m0, s27, 114688
  v_mfma_f32_16x16x32_bf16 v[172:175], a[152:155], a[112:115], v[172:175]
  buffer_load_dwordx4 v36, s[8:11], s25 offen offset:0 lds
  v_mfma_f32_16x16x32_bf16 v[188:191], a[152:155], a[120:123], v[188:191]
  s_mul_i32 s48, s48, 14336
  v_mfma_f32_16x16x32_bf16 v[188:191], a[156:159], a[124:127], v[188:191]
  s_add_u32 s48, s48, 33554432
  v_mfma_f32_16x16x32_bf16 v[184:187], a[148:151], a[124:127], v[184:187]
  s_add_u32 s49, s48, 57344
  v_mfma_f32_16x16x32_bf16 v[184:187], a[144:147], a[120:123], v[184:187]
  s_lshr_b32 s16, s2, 3
  v_mfma_f32_16x16x32_bf16 v[180:183], a[136:139], a[120:123], v[180:183]
  buffer_load_dwordx4 v37, s[8:11], s25 offen offset:1024 lds
  v_mfma_f32_16x16x32_bf16 v[180:183], a[140:143], a[124:127], v[180:183]
  s_lshl_b32 s61, s20, 5
  v_mfma_f32_16x16x32_bf16 v[176:179], a[132:135], a[124:127], v[176:179]
  s_waitcnt lgkmcnt(0)
  v_mfma_f32_16x16x32_bf16 v[176:179], a[128:131], a[120:123], v[176:179]
  s_add_u32 s16, s16, s61
  v_mfma_f32_16x16x32_bf16 v[192:195], a[160:163], a[96:99], v[192:195]
  s_lshl_b32 s16, s16, 13
  ds_read_b64_tr_b16 a[128:129], v44 offset:0
  v_mfma_f32_16x16x32_bf16 v[192:195], a[164:167], a[100:103], v[192:195]
  buffer_load_dwordx4 v38, s[8:11], s25 offen offset:2048 lds
  v_mfma_f32_16x16x32_bf16 v[196:199], a[172:175], a[100:103], v[196:199]
  ds_read_b64_tr_b16 a[130:131], v44 offset:1024
  v_mfma_f32_16x16x32_bf16 v[196:199], a[168:171], a[96:99], v[196:199]
  ds_read_b64_tr_b16 a[132:133], v44 offset:8192
  v_mfma_f32_16x16x32_bf16 v[200:203], a[176:179], a[96:99], v[200:203]
  ds_read_b64_tr_b16 a[134:135], v44 offset:9216
  v_mfma_f32_16x16x32_bf16 v[200:203], a[180:183], a[100:103], v[200:203]
  ds_read_b64_tr_b16 a[136:137], v45 offset:0
  v_mfma_f32_16x16x32_bf16 v[204:207], a[188:191], a[100:103], v[204:207]
  buffer_load_dwordx4 v39, s[8:11], s25 offen offset:3072 lds
  v_mfma_f32_16x16x32_bf16 v[204:207], a[184:187], a[96:99], v[204:207]
  s_add_u32 s25, s25, 524160
  ds_read_b64_tr_b16 a[138:139], v45 offset:1024
  v_mfma_f32_16x16x32_bf16 v[220:223], a[184:187], a[104:107], v[220:223]
  ds_read_b64_tr_b16 a[140:141], v45 offset:8192
  v_mfma_f32_16x16x32_bf16 v[220:223], a[188:191], a[108:111], v[220:223]
  ds_read_b64_tr_b16 a[142:143], v45 offset:9216
  v_mfma_f32_16x16x32_bf16 v[216:219], a[180:183], a[108:111], v[216:219]
  ds_read_b64_tr_b16 a[144:145], v46 offset:0
  v_mfma_f32_16x16x32_bf16 v[216:219], a[176:179], a[104:107], v[216:219]
  ds_read_b64_tr_b16 a[146:147], v46 offset:1024
  v_mfma_f32_16x16x32_bf16 v[212:215], a[168:171], a[104:107], v[212:215]
  buffer_store_dwordx4 v[52:55], v19, s[12:15], s63 offen sc1
  v_mfma_f32_16x16x32_bf16 v[212:215], a[172:175], a[108:111], v[212:215]
  ds_read_b64_tr_b16 a[148:149], v46 offset:8192
  v_mfma_f32_16x16x32_bf16 v[208:211], a[164:167], a[108:111], v[208:211]
  ds_read_b64_tr_b16 a[150:151], v46 offset:9216
  v_mfma_f32_16x16x32_bf16 v[208:211], a[160:163], a[104:107], v[208:211]
  ds_read_b64_tr_b16 a[152:153], v47 offset:0
  v_mfma_f32_16x16x32_bf16 v[224:227], a[160:163], a[112:115], v[224:227]
  ds_read_b64_tr_b16 a[154:155], v47 offset:1024
  v_mfma_f32_16x16x32_bf16 v[224:227], a[164:167], a[116:119], v[224:227]
  buffer_store_dwordx4 v[56:59], v20, s[12:15], s63 offen sc1
  v_mfma_f32_16x16x32_bf16 v[228:231], a[172:175], a[116:119], v[228:231]
  ds_read_b64_tr_b16 a[156:157], v47 offset:8192
  v_mfma_f32_16x16x32_bf16 v[228:231], a[168:171], a[112:115], v[228:231]
  ds_read_b64_tr_b16 a[158:159], v47 offset:9216
  v_mfma_f32_16x16x32_bf16 v[232:235], a[176:179], a[112:115], v[232:235]
  v_mfma_f32_16x16x32_bf16 v[232:235], a[180:183], a[116:119], v[232:235]
  v_mfma_f32_16x16x32_bf16 v[236:239], a[188:191], a[116:119], v[236:239]
  buffer_store_dwordx4 v[60:63], v5, s[12:15], 0 offen sc1
  v_mfma_f32_16x16x32_bf16 v[236:239], a[184:187], a[112:115], v[236:239]
  v_mfma_f32_16x16x32_bf16 v[252:255], a[184:187], a[120:123], v[252:255]
  v_mfma_f32_16x16x32_bf16 v[252:255], a[188:191], a[124:127], v[252:255]
  v_mfma_f32_16x16x32_bf16 v[248:251], a[180:183], a[124:127], v[248:251]
  v_mfma_f32_16x16x32_bf16 v[248:251], a[176:179], a[120:123], v[248:251]
  v_mfma_f32_16x16x32_bf16 v[244:247], a[168:171], a[120:123], v[244:247]
  v_mfma_f32_16x16x32_bf16 v[244:247], a[172:175], a[124:127], v[244:247]
  v_mfma_f32_16x16x32_bf16 v[240:243], a[164:167], a[124:127], v[240:243]
  v_mfma_f32_16x16x32_bf16 v[240:243], a[160:163], a[120:123], v[240:243]
  s_waitcnt vmcnt(19) lgkmcnt(0)
.p2align 6
KV_LOOP0:
  v_mfma_f32_16x16x32_bf16 a[0:3], a[128:131], a[64:67], a[0:3]
  s_barrier
  v_mfma_f32_16x16x32_bf16 a[0:3], a[132:135], a[68:71], a[0:3]
  ds_read_b64_tr_b16 a[160:161], v44 offset:32768
  v_mfma_f32_16x16x32_bf16 a[4:7], a[140:143], a[68:71], a[4:7]
  s_add_u32 m0, s27, 0
  ds_read_b64_tr_b16 a[162:163], v44 offset:33792
  v_mfma_f32_16x16x32_bf16 a[4:7], a[136:139], a[64:67], a[4:7]
  buffer_load_dwordx4 v32, s[4:7], s24 offen offset:0 lds
  v_mfma_f32_16x16x32_bf16 a[8:11], a[144:147], a[64:67], a[8:11]
  ds_read_b64_tr_b16 a[164:165], v44 offset:40960
  v_mfma_f32_16x16x32_bf16 a[8:11], a[148:151], a[68:71], a[8:11]
  ds_read_b64_tr_b16 a[166:167], v44 offset:41984
  v_mfma_f32_16x16x32_bf16 a[12:15], a[156:159], a[68:71], a[12:15]
  ds_read_b64_tr_b16 a[168:169], v45 offset:32768
  v_mfma_f32_16x16x32_bf16 a[12:15], a[152:155], a[64:67], a[12:15]
  ds_read_b64_tr_b16 a[170:171], v45 offset:33792
  v_mfma_f32_16x16x32_bf16 a[28:31], a[152:155], a[72:75], a[28:31]
  buffer_load_dwordx4 v33, s[4:7], s24 offen offset:1024 lds
  v_mfma_f32_16x16x32_bf16 a[28:31], a[156:159], a[76:79], a[28:31]
  ds_read_b64_tr_b16 a[172:173], v45 offset:40960
  v_mfma_f32_16x16x32_bf16 a[24:27], a[148:151], a[76:79], a[24:27]
  ds_read_b64_tr_b16 a[174:175], v45 offset:41984
  v_mfma_f32_16x16x32_bf16 a[24:27], a[144:147], a[72:75], a[24:27]
  ds_read_b64_tr_b16 a[176:177], v46 offset:32768
  v_mfma_f32_16x16x32_bf16 a[20:23], a[136:139], a[72:75], a[20:23]
  ds_read_b64_tr_b16 a[178:179], v46 offset:33792
  v_mfma_f32_16x16x32_bf16 a[20:23], a[140:143], a[76:79], a[20:23]
  buffer_load_dwordx4 v34, s[4:7], s24 offen offset:2048 lds
  v_mfma_f32_16x16x32_bf16 a[16:19], a[132:135], a[76:79], a[16:19]
  ds_read_b64_tr_b16 a[180:181], v46 offset:40960
  v_mfma_f32_16x16x32_bf16 a[16:19], a[128:131], a[72:75], a[16:19]
  ds_read_b64_tr_b16 a[182:183], v46 offset:41984
  v_mfma_f32_16x16x32_bf16 a[32:35], a[128:131], a[80:83], a[32:35]
  ds_read_b64_tr_b16 a[184:185], v47 offset:32768
  v_mfma_f32_16x16x32_bf16 a[32:35], a[132:135], a[84:87], a[32:35]
  ds_read_b64_tr_b16 a[186:187], v47 offset:33792
  v_mfma_f32_16x16x32_bf16 a[36:39], a[140:143], a[84:87], a[36:39]
  buffer_load_dwordx4 v35, s[4:7], s24 offen offset:3072 lds
  v_mfma_f32_16x16x32_bf16 a[36:39], a[136:139], a[80:83], a[36:39]
  s_add_u32 s24, s24, 2097152
  ds_read_b64_tr_b16 a[188:189], v47 offset:40960
  v_mfma_f32_16x16x32_bf16 a[40:43], a[144:147], a[80:83], a[40:43]
  ds_read_b64_tr_b16 a[190:191], v47 offset:41984
  v_mfma_f32_16x16x32_bf16 a[40:43], a[148:151], a[84:87], a[40:43]
  v_mfma_f32_16x16x32_bf16 a[44:47], a[156:159], a[84:87], a[44:47]
  s_add_u32 m0, s27, 16384
  v_mfma_f32_16x16x32_bf16 a[44:47], a[152:155], a[80:83], a[44:47]
  buffer_load_dwordx4 v36, s[8:11], s25 offen offset:0 lds
  v_mfma_f32_16x16x32_bf16 a[60:63], a[152:155], a[88:91], a[60:63]
  v_mfma_f32_16x16x32_bf16 a[60:63], a[156:159], a[92:95], a[60:63]
  v_mfma_f32_16x16x32_bf16 a[56:59], a[148:151], a[92:95], a[56:59]
  v_mfma_f32_16x16x32_bf16 a[56:59], a[144:147], a[88:91], a[56:59]
  v_mfma_f32_16x16x32_bf16 a[52:55], a[136:139], a[88:91], a[52:55]
  buffer_load_dwordx4 v37, s[8:11], s25 offen offset:1024 lds
  v_mfma_f32_16x16x32_bf16 a[52:55], a[140:143], a[92:95], a[52:55]
  v_mfma_f32_16x16x32_bf16 a[48:51], a[132:135], a[92:95], a[48:51]
  ds_read_b128 a[96:99], v40 offset:32768
  v_mfma_f32_16x16x32_bf16 a[48:51], a[128:131], a[88:91], a[48:51]
  s_waitcnt lgkmcnt(1)
  v_mfma_f32_16x16x32_bf16 v[64:67], a[160:163], a[64:67], v[64:67]
  ds_read_b128 a[100:103], v41 offset:32768
  v_mfma_f32_16x16x32_bf16 v[64:67], a[164:167], a[68:71], v[64:67]
  buffer_load_dwordx4 v38, s[8:11], s25 offen offset:2048 lds
  v_mfma_f32_16x16x32_bf16 v[68:71], a[172:175], a[68:71], v[68:71]
  ds_read_b128 a[104:107], v40 offset:34816
  v_mfma_f32_16x16x32_bf16 v[68:71], a[168:171], a[64:67], v[68:71]
  v_mfma_f32_16x16x32_bf16 v[72:75], a[176:179], a[64:67], v[72:75]
  ds_read_b128 a[108:111], v41 offset:34816
  v_mfma_f32_16x16x32_bf16 v[72:75], a[180:183], a[68:71], v[72:75]
  v_mfma_f32_16x16x32_bf16 v[76:79], a[188:191], a[68:71], v[76:79]
  buffer_load_dwordx4 v39, s[8:11], s25 offen offset:3072 lds
  v_mfma_f32_16x16x32_bf16 v[76:79], a[184:187], a[64:67], v[76:79]
  s_add_u32 s25, s25, 128
  ds_read_b128 a[112:115], v40 offset:36864
  v_mfma_f32_16x16x32_bf16 v[92:95], a[184:187], a[72:75], v[92:95]
  v_mfma_f32_16x16x32_bf16 v[92:95], a[188:191], a[76:79], v[92:95]
  s_cmp_eq_u32 s26, 1
  ds_read_b128 a[116:119], v41 offset:36864
  v_mfma_f32_16x16x32_bf16 v[88:91], a[180:183], a[76:79], v[88:91]
  s_cselect_b32 s60, 0, 0x1000
  v_mfma_f32_16x16x32_bf16 v[88:91], a[176:179], a[72:75], v[88:91]
  ds_read_b128 a[120:123], v40 offset:38912
  v_mfma_f32_16x16x32_bf16 v[84:87], a[168:171], a[72:75], v[84:87]
  buffer_load_dword v25, v31, s[72:75], s60 offen sc1
  v_mfma_f32_16x16x32_bf16 v[84:87], a[172:175], a[76:79], v[84:87]
  ds_read_b128 a[124:127], v41 offset:38912
  v_mfma_f32_16x16x32_bf16 v[80:83], a[164:167], a[76:79], v[80:83]
  v_mfma_f32_16x16x32_bf16 v[80:83], a[160:163], a[72:75], v[80:83]
  v_mfma_f32_16x16x32_bf16 v[96:99], a[160:163], a[80:83], v[96:99]
  v_mfma_f32_16x16x32_bf16 v[96:99], a[164:167], a[84:87], v[96:99]
  v_mfma_f32_16x16x32_bf16 v[100:103], a[172:175], a[84:87], v[100:103]
  v_mfma_f32_16x16x32_bf16 v[100:103], a[168:171], a[80:83], v[100:103]
  v_mfma_f32_16x16x32_bf16 v[104:107], a[176:179], a[80:83], v[104:107]
  v_mfma_f32_16x16x32_bf16 v[104:107], a[180:183], a[84:87], v[104:107]
  v_mfma_f32_16x16x32_bf16 v[108:111], a[188:191], a[84:87], v[108:111]
  v_mfma_f32_16x16x32_bf16 v[108:111], a[184:187], a[80:83], v[108:111]
  v_mfma_f32_16x16x32_bf16 v[124:127], a[184:187], a[88:91], v[124:127]
  v_mfma_f32_16x16x32_bf16 v[124:127], a[188:191], a[92:95], v[124:127]
  v_mfma_f32_16x16x32_bf16 v[120:123], a[180:183], a[92:95], v[120:123]
  v_mfma_f32_16x16x32_bf16 v[120:123], a[176:179], a[88:91], v[120:123]
  v_mfma_f32_16x16x32_bf16 v[116:119], a[168:171], a[88:91], v[116:119]
  v_mfma_f32_16x16x32_bf16 v[116:119], a[172:175], a[92:95], v[116:119]
  v_mfma_f32_16x16x32_bf16 v[112:115], a[164:167], a[92:95], v[112:115]
  v_mfma_f32_16x16x32_bf16 v[112:115], a[160:163], a[88:91], v[112:115]
  s_waitcnt vmcnt(18) lgkmcnt(0)
  v_mfma_f32_16x16x32_bf16 v[128:131], a[160:163], a[96:99], v[128:131]
  s_barrier
  v_mfma_f32_16x16x32_bf16 v[128:131], a[164:167], a[100:103], v[128:131]
  ds_read_b128 a[64:67], v42 offset:0
  v_mfma_f32_16x16x32_bf16 v[132:135], a[172:175], a[100:103], v[132:135]
  s_add_u32 m0, s27, 32768
  v_mfma_f32_16x16x32_bf16 v[132:135], a[168:171], a[96:99], v[132:135]
  buffer_load_dwordx4 v32, s[4:7], s24 offen offset:0 lds
  v_mfma_f32_16x16x32_bf16 v[136:139], a[176:179], a[96:99], v[136:139]
  ds_read_b128 a[68:71], v43 offset:0
  v_mfma_f32_16x16x32_bf16 v[136:139], a[180:183], a[100:103], v[136:139]
  v_mfma_f32_16x16x32_bf16 v[140:143], a[188:191], a[100:103], v[140:143]
  ds_read_b128 a[72:75], v42 offset:2048
  v_mfma_f32_16x16x32_bf16 v[140:143], a[184:187], a[96:99], v[140:143]
  v_mfma_f32_16x16x32_bf16 v[156:159], a[184:187], a[104:107], v[156:159]
  buffer_load_dwordx4 v33, s[4:7], s24 offen offset:1024 lds
  v_mfma_f32_16x16x32_bf16 v[156:159], a[188:191], a[108:111], v[156:159]
  ds_read_b128 a[76:79], v43 offset:2048
  v_mfma_f32_16x16x32_bf16 v[152:155], a[180:183], a[108:111], v[152:155]
  v_mfma_f32_16x16x32_bf16 v[152:155], a[176:179], a[104:107], v[152:155]
  ds_read_b128 a[80:83], v42 offset:4096
  v_mfma_f32_16x16x32_bf16 v[148:151], a[168:171], a[104:107], v[148:151]
  v_mfma_f32_16x16x32_bf16 v[148:151], a[172:175], a[108:111], v[148:151]
  buffer_load_dwordx4 v34, s[4:7], s24 offen offset:2048 lds
  v_mfma_f32_16x16x32_bf16 v[144:147], a[164:167], a[108:111], v[144:147]
  ds_read_b128 a[84:87], v43 offset:4096
  v_mfma_f32_16x16x32_bf16 v[144:147], a[160:163], a[104:107], v[144:147]
  v_mfma_f32_16x16x32_bf16 v[160:163], a[160:163], a[112:115], v[160:163]
  ds_read_b128 a[88:91], v42 offset:6144
  v_mfma_f32_16x16x32_bf16 v[160:163], a[164:167], a[116:119], v[160:163]
  v_mfma_f32_16x16x32_bf16 v[164:167], a[172:175], a[116:119], v[164:167]
  buffer_load_dwordx4 v35, s[4:7], s24 offen offset:3072 lds
  v_mfma_f32_16x16x32_bf16 v[164:167], a[168:171], a[112:115], v[164:167]
  s_add_u32 s24, s24, 4292870272
  ds_read_b128 a[92:95], v43 offset:6144
  v_mfma_f32_16x16x32_bf16 v[168:171], a[176:179], a[112:115], v[168:171]
  v_mfma_f32_16x16x32_bf16 v[168:171], a[180:183], a[116:119], v[168:171]
  v_mfma_f32_16x16x32_bf16 v[172:175], a[188:191], a[116:119], v[172:175]
  s_add_u32 m0, s27, 49152
  v_mfma_f32_16x16x32_bf16 v[172:175], a[184:187], a[112:115], v[172:175]
  buffer_load_dwordx4 v36, s[8:11], s25 offen offset:0 lds
  v_mfma_f32_16x16x32_bf16 v[188:191], a[184:187], a[120:123], v[188:191]
  v_mfma_f32_16x16x32_bf16 v[188:191], a[188:191], a[124:127], v[188:191]
  v_mfma_f32_16x16x32_bf16 v[184:187], a[180:183], a[124:127], v[184:187]
  v_mfma_f32_16x16x32_bf16 v[184:187], a[176:179], a[120:123], v[184:187]
  v_mfma_f32_16x16x32_bf16 v[180:183], a[168:171], a[120:123], v[180:183]
  buffer_load_dwordx4 v37, s[8:11], s25 offen offset:1024 lds
  v_mfma_f32_16x16x32_bf16 v[180:183], a[172:175], a[124:127], v[180:183]
  v_mfma_f32_16x16x32_bf16 v[176:179], a[164:167], a[124:127], v[176:179]
  v_mfma_f32_16x16x32_bf16 v[176:179], a[160:163], a[120:123], v[176:179]
  v_mfma_f32_16x16x32_bf16 v[192:195], a[128:131], a[96:99], v[192:195]
  ds_read_b64_tr_b16 a[160:161], v48 offset:0
  v_mfma_f32_16x16x32_bf16 v[192:195], a[132:135], a[100:103], v[192:195]
  buffer_load_dwordx4 v38, s[8:11], s25 offen offset:2048 lds
  v_mfma_f32_16x16x32_bf16 v[196:199], a[140:143], a[100:103], v[196:199]
  ds_read_b64_tr_b16 a[162:163], v48 offset:1024
  v_mfma_f32_16x16x32_bf16 v[196:199], a[136:139], a[96:99], v[196:199]
  ds_read_b64_tr_b16 a[164:165], v48 offset:8192
  v_mfma_f32_16x16x32_bf16 v[200:203], a[144:147], a[96:99], v[200:203]
  ds_read_b64_tr_b16 a[166:167], v48 offset:9216
  v_mfma_f32_16x16x32_bf16 v[200:203], a[148:151], a[100:103], v[200:203]
  ds_read_b64_tr_b16 a[168:169], v49 offset:0
  v_mfma_f32_16x16x32_bf16 v[204:207], a[156:159], a[100:103], v[204:207]
  buffer_load_dwordx4 v39, s[8:11], s25 offen offset:3072 lds
  v_mfma_f32_16x16x32_bf16 v[204:207], a[152:155], a[96:99], v[204:207]
  s_add_u32 s25, s25, 524160
  ds_read_b64_tr_b16 a[170:171], v49 offset:1024
  v_mfma_f32_16x16x32_bf16 v[220:223], a[152:155], a[104:107], v[220:223]
  ds_read_b64_tr_b16 a[172:173], v49 offset:8192
  v_mfma_f32_16x16x32_bf16 v[220:223], a[156:159], a[108:111], v[220:223]
  s_cmp_eq_u32 s26, 1
  ds_read_b64_tr_b16 a[174:175], v49 offset:9216
  v_mfma_f32_16x16x32_bf16 v[216:219], a[148:151], a[108:111], v[216:219]
  s_cselect_b32 s60, s16, 0x100000
  ds_read_b64_tr_b16 a[176:177], v50 offset:0
  v_mfma_f32_16x16x32_bf16 v[216:219], a[144:147], a[104:107], v[216:219]
  ds_read_b64_tr_b16 a[178:179], v50 offset:1024
  v_mfma_f32_16x16x32_bf16 v[212:215], a[136:139], a[104:107], v[212:215]
  buffer_load_dword v27, v0, s[96:99], s60 offen
  v_mfma_f32_16x16x32_bf16 v[212:215], a[140:143], a[108:111], v[212:215]
  ds_read_b64_tr_b16 a[180:181], v50 offset:8192
  v_mfma_f32_16x16x32_bf16 v[208:211], a[132:135], a[108:111], v[208:211]
  ds_read_b64_tr_b16 a[182:183], v50 offset:9216
  v_mfma_f32_16x16x32_bf16 v[208:211], a[128:131], a[104:107], v[208:211]
  ds_read_b64_tr_b16 a[184:185], v51 offset:0
  v_mfma_f32_16x16x32_bf16 v[224:227], a[128:131], a[112:115], v[224:227]
  ds_read_b64_tr_b16 a[186:187], v51 offset:1024
  v_mfma_f32_16x16x32_bf16 v[224:227], a[132:135], a[116:119], v[224:227]
  ds_read_b64_tr_b16 a[188:189], v51 offset:8192
  v_mfma_f32_16x16x32_bf16 v[228:231], a[140:143], a[116:119], v[228:231]
  ds_read_b64_tr_b16 a[190:191], v51 offset:9216
  v_mfma_f32_16x16x32_bf16 v[228:231], a[136:139], a[112:115], v[228:231]
  v_mfma_f32_16x16x32_bf16 v[232:235], a[144:147], a[112:115], v[232:235]
  v_mfma_f32_16x16x32_bf16 v[232:235], a[148:151], a[116:119], v[232:235]
  v_mfma_f32_16x16x32_bf16 v[236:239], a[156:159], a[116:119], v[236:239]
  v_mfma_f32_16x16x32_bf16 v[236:239], a[152:155], a[112:115], v[236:239]
  v_mfma_f32_16x16x32_bf16 v[252:255], a[152:155], a[120:123], v[252:255]
  v_mfma_f32_16x16x32_bf16 v[252:255], a[156:159], a[124:127], v[252:255]
  v_mfma_f32_16x16x32_bf16 v[248:251], a[148:151], a[124:127], v[248:251]
  v_mfma_f32_16x16x32_bf16 v[248:251], a[144:147], a[120:123], v[248:251]
  v_mfma_f32_16x16x32_bf16 v[244:247], a[136:139], a[120:123], v[244:247]
  v_mfma_f32_16x16x32_bf16 v[244:247], a[140:143], a[124:127], v[244:247]
  v_mfma_f32_16x16x32_bf16 v[240:243], a[132:135], a[124:127], v[240:243]
  v_mfma_f32_16x16x32_bf16 v[240:243], a[128:131], a[120:123], v[240:243]
  s_waitcnt vmcnt(18) lgkmcnt(0)
  v_mfma_f32_16x16x32_bf16 a[0:3], a[160:163], a[64:67], a[0:3]
  s_barrier
  v_mfma_f32_16x16x32_bf16 a[0:3], a[164:167], a[68:71], a[0:3]
  ds_read_b64_tr_b16 a[128:129], v48 offset:32768
  v_mfma_f32_16x16x32_bf16 a[4:7], a[172:175], a[68:71], a[4:7]
  s_add_u32 m0, s27, 65536
  ds_read_b64_tr_b16 a[130:131], v48 offset:33792
  v_mfma_f32_16x16x32_bf16 a[4:7], a[168:171], a[64:67], a[4:7]
  buffer_load_dwordx4 v32, s[4:7], s24 offen offset:0 lds
  v_mfma_f32_16x16x32_bf16 a[8:11], a[176:179], a[64:67], a[8:11]
  ds_read_b64_tr_b16 a[132:133], v48 offset:40960
  v_mfma_f32_16x16x32_bf16 a[8:11], a[180:183], a[68:71], a[8:11]
  ds_read_b64_tr_b16 a[134:135], v48 offset:41984
  v_mfma_f32_16x16x32_bf16 a[12:15], a[188:191], a[68:71], a[12:15]
  ds_read_b64_tr_b16 a[136:137], v49 offset:32768
  v_mfma_f32_16x16x32_bf16 a[12:15], a[184:187], a[64:67], a[12:15]
  ds_read_b64_tr_b16 a[138:139], v49 offset:33792
  v_mfma_f32_16x16x32_bf16 a[28:31], a[184:187], a[72:75], a[28:31]
  buffer_load_dwordx4 v33, s[4:7], s24 offen offset:1024 lds
  v_mfma_f32_16x16x32_bf16 a[28:31], a[188:191], a[76:79], a[28:31]
  ds_read_b64_tr_b16 a[140:141], v49 offset:40960
  v_mfma_f32_16x16x32_bf16 a[24:27], a[180:183], a[76:79], a[24:27]
  ds_read_b64_tr_b16 a[142:143], v49 offset:41984
  v_mfma_f32_16x16x32_bf16 a[24:27], a[176:179], a[72:75], a[24:27]
  ds_read_b64_tr_b16 a[144:145], v50 offset:32768
  v_mfma_f32_16x16x32_bf16 a[20:23], a[168:171], a[72:75], a[20:23]
  ds_read_b64_tr_b16 a[146:147], v50 offset:33792
  v_mfma_f32_16x16x32_bf16 a[20:23], a[172:175], a[76:79], a[20:23]
  buffer_load_dwordx4 v34, s[4:7], s24 offen offset:2048 lds
  v_mfma_f32_16x16x32_bf16 a[16:19], a[164:167], a[76:79], a[16:19]
  ds_read_b64_tr_b16 a[148:149], v50 offset:40960
  v_mfma_f32_16x16x32_bf16 a[16:19], a[160:163], a[72:75], a[16:19]
  ds_read_b64_tr_b16 a[150:151], v50 offset:41984
  v_mfma_f32_16x16x32_bf16 a[32:35], a[160:163], a[80:83], a[32:35]
  ds_read_b64_tr_b16 a[152:153], v51 offset:32768
  v_mfma_f32_16x16x32_bf16 a[32:35], a[164:167], a[84:87], a[32:35]
  ds_read_b64_tr_b16 a[154:155], v51 offset:33792
  v_mfma_f32_16x16x32_bf16 a[36:39], a[172:175], a[84:87], a[36:39]
  buffer_load_dwordx4 v35, s[4:7], s24 offen offset:3072 lds
  v_mfma_f32_16x16x32_bf16 a[36:39], a[168:171], a[80:83], a[36:39]
  s_add_u32 s24, s24, 2097152
  ds_read_b64_tr_b16 a[156:157], v51 offset:40960
  v_mfma_f32_16x16x32_bf16 a[40:43], a[176:179], a[80:83], a[40:43]
  ds_read_b64_tr_b16 a[158:159], v51 offset:41984
  v_mfma_f32_16x16x32_bf16 a[40:43], a[180:183], a[84:87], a[40:43]
  v_mfma_f32_16x16x32_bf16 a[44:47], a[188:191], a[84:87], a[44:47]
  s_add_u32 m0, s27, 81920
  v_mfma_f32_16x16x32_bf16 a[44:47], a[184:187], a[80:83], a[44:47]
  buffer_load_dwordx4 v36, s[8:11], s25 offen offset:0 lds
  v_mfma_f32_16x16x32_bf16 a[60:63], a[184:187], a[88:91], a[60:63]
  v_mfma_f32_16x16x32_bf16 a[60:63], a[188:191], a[92:95], a[60:63]
  v_mfma_f32_16x16x32_bf16 a[56:59], a[180:183], a[92:95], a[56:59]
  v_mfma_f32_16x16x32_bf16 a[56:59], a[176:179], a[88:91], a[56:59]
  v_mfma_f32_16x16x32_bf16 a[52:55], a[168:171], a[88:91], a[52:55]
  buffer_load_dwordx4 v37, s[8:11], s25 offen offset:1024 lds
  v_mfma_f32_16x16x32_bf16 a[52:55], a[172:175], a[92:95], a[52:55]
  v_mfma_f32_16x16x32_bf16 a[48:51], a[164:167], a[92:95], a[48:51]
  ds_read_b128 a[96:99], v42 offset:32768
  v_mfma_f32_16x16x32_bf16 a[48:51], a[160:163], a[88:91], a[48:51]
  s_waitcnt lgkmcnt(1)
  v_mfma_f32_16x16x32_bf16 v[64:67], a[128:131], a[64:67], v[64:67]
  ds_read_b128 a[100:103], v43 offset:32768
  v_mfma_f32_16x16x32_bf16 v[64:67], a[132:135], a[68:71], v[64:67]
  buffer_load_dwordx4 v38, s[8:11], s25 offen offset:2048 lds
  v_mfma_f32_16x16x32_bf16 v[68:71], a[140:143], a[68:71], v[68:71]
  ds_read_b128 a[104:107], v42 offset:34816
  v_mfma_f32_16x16x32_bf16 v[68:71], a[136:139], a[64:67], v[68:71]
  v_mfma_f32_16x16x32_bf16 v[72:75], a[144:147], a[64:67], v[72:75]
  ds_read_b128 a[108:111], v43 offset:34816
  v_mfma_f32_16x16x32_bf16 v[72:75], a[148:151], a[68:71], v[72:75]
  v_mfma_f32_16x16x32_bf16 v[76:79], a[156:159], a[68:71], v[76:79]
  buffer_load_dwordx4 v39, s[8:11], s25 offen offset:3072 lds
  v_mfma_f32_16x16x32_bf16 v[76:79], a[152:155], a[64:67], v[76:79]
  s_add_u32 s25, s25, 128
  ds_read_b128 a[112:115], v42 offset:36864
  v_mfma_f32_16x16x32_bf16 v[92:95], a[152:155], a[72:75], v[92:95]
  v_mfma_f32_16x16x32_bf16 v[92:95], a[156:159], a[76:79], v[92:95]
  s_cmp_eq_u32 s26, s33
  ds_read_b128 a[116:119], v43 offset:36864
  v_mfma_f32_16x16x32_bf16 v[88:91], a[148:151], a[76:79], v[88:91]
  s_cselect_b32 s82, 8192, 0
  v_mfma_f32_16x16x32_bf16 v[88:91], a[144:147], a[72:75], v[88:91]
  ds_read_b128 a[120:123], v42 offset:38912
  v_mfma_f32_16x16x32_bf16 v[84:87], a[136:139], a[72:75], v[84:87]
  buffer_load_dword v27, v0, s[80:83], 0 offen
  v_mfma_f32_16x16x32_bf16 v[84:87], a[140:143], a[76:79], v[84:87]
  ds_read_b128 a[124:127], v43 offset:38912
  v_mfma_f32_16x16x32_bf16 v[80:83], a[132:135], a[76:79], v[80:83]
  v_mfma_f32_16x16x32_bf16 v[80:83], a[128:131], a[72:75], v[80:83]
  v_mfma_f32_16x16x32_bf16 v[96:99], a[128:131], a[80:83], v[96:99]
  v_mfma_f32_16x16x32_bf16 v[96:99], a[132:135], a[84:87], v[96:99]
  v_mfma_f32_16x16x32_bf16 v[100:103], a[140:143], a[84:87], v[100:103]
  v_mfma_f32_16x16x32_bf16 v[100:103], a[136:139], a[80:83], v[100:103]
  v_mfma_f32_16x16x32_bf16 v[104:107], a[144:147], a[80:83], v[104:107]
  v_mfma_f32_16x16x32_bf16 v[104:107], a[148:151], a[84:87], v[104:107]
  v_mfma_f32_16x16x32_bf16 v[108:111], a[156:159], a[84:87], v[108:111]
  v_mfma_f32_16x16x32_bf16 v[108:111], a[152:155], a[80:83], v[108:111]
  v_mfma_f32_16x16x32_bf16 v[124:127], a[152:155], a[88:91], v[124:127]
  v_mfma_f32_16x16x32_bf16 v[124:127], a[156:159], a[92:95], v[124:127]
  v_mfma_f32_16x16x32_bf16 v[120:123], a[148:151], a[92:95], v[120:123]
  v_mfma_f32_16x16x32_bf16 v[120:123], a[144:147], a[88:91], v[120:123]
  v_mfma_f32_16x16x32_bf16 v[116:119], a[136:139], a[88:91], v[116:119]
  v_mfma_f32_16x16x32_bf16 v[116:119], a[140:143], a[92:95], v[116:119]
  v_mfma_f32_16x16x32_bf16 v[112:115], a[132:135], a[92:95], v[112:115]
  v_mfma_f32_16x16x32_bf16 v[112:115], a[128:131], a[88:91], v[112:115]
  s_waitcnt vmcnt(19) lgkmcnt(0)
  v_mfma_f32_16x16x32_bf16 v[128:131], a[128:131], a[96:99], v[128:131]
  s_barrier
  v_mfma_f32_16x16x32_bf16 v[128:131], a[132:135], a[100:103], v[128:131]
  ds_read_b128 a[64:67], v40 offset:0
  v_mfma_f32_16x16x32_bf16 v[132:135], a[140:143], a[100:103], v[132:135]
  s_add_u32 m0, s27, 98304
  v_mfma_f32_16x16x32_bf16 v[132:135], a[136:139], a[96:99], v[132:135]
  buffer_load_dwordx4 v32, s[4:7], s24 offen offset:0 lds
  v_mfma_f32_16x16x32_bf16 v[136:139], a[144:147], a[96:99], v[136:139]
  ds_read_b128 a[68:71], v41 offset:0
  v_mfma_f32_16x16x32_bf16 v[136:139], a[148:151], a[100:103], v[136:139]
  v_mfma_f32_16x16x32_bf16 v[140:143], a[156:159], a[100:103], v[140:143]
  ds_read_b128 a[72:75], v40 offset:2048
  v_mfma_f32_16x16x32_bf16 v[140:143], a[152:155], a[96:99], v[140:143]
  v_mfma_f32_16x16x32_bf16 v[156:159], a[152:155], a[104:107], v[156:159]
  buffer_load_dwordx4 v33, s[4:7], s24 offen offset:1024 lds
  v_mfma_f32_16x16x32_bf16 v[156:159], a[156:159], a[108:111], v[156:159]
  ds_read_b128 a[76:79], v41 offset:2048
  v_mfma_f32_16x16x32_bf16 v[152:155], a[148:151], a[108:111], v[152:155]
  v_mfma_f32_16x16x32_bf16 v[152:155], a[144:147], a[104:107], v[152:155]
  ds_read_b128 a[80:83], v40 offset:4096
  v_mfma_f32_16x16x32_bf16 v[148:151], a[136:139], a[104:107], v[148:151]
  v_mfma_f32_16x16x32_bf16 v[148:151], a[140:143], a[108:111], v[148:151]
  buffer_load_dwordx4 v34, s[4:7], s24 offen offset:2048 lds
  v_mfma_f32_16x16x32_bf16 v[144:147], a[132:135], a[108:111], v[144:147]
  ds_read_b128 a[84:87], v41 offset:4096
  v_mfma_f32_16x16x32_bf16 v[144:147], a[128:131], a[104:107], v[144:147]
  v_mfma_f32_16x16x32_bf16 v[160:163], a[128:131], a[112:115], v[160:163]
  ds_read_b128 a[88:91], v40 offset:6144
  v_mfma_f32_16x16x32_bf16 v[160:163], a[132:135], a[116:119], v[160:163]
  v_mfma_f32_16x16x32_bf16 v[164:167], a[140:143], a[116:119], v[164:167]
  buffer_load_dwordx4 v35, s[4:7], s24 offen offset:3072 lds
  v_mfma_f32_16x16x32_bf16 v[164:167], a[136:139], a[112:115], v[164:167]
  s_add_u32 s24, s24, 4292870272
  ds_read_b128 a[92:95], v41 offset:6144
  v_mfma_f32_16x16x32_bf16 v[168:171], a[144:147], a[112:115], v[168:171]
  v_mfma_f32_16x16x32_bf16 v[168:171], a[148:151], a[116:119], v[168:171]
  v_mfma_f32_16x16x32_bf16 v[172:175], a[156:159], a[116:119], v[172:175]
  s_add_u32 m0, s27, 114688
  v_mfma_f32_16x16x32_bf16 v[172:175], a[152:155], a[112:115], v[172:175]
  buffer_load_dwordx4 v36, s[8:11], s25 offen offset:0 lds
  v_mfma_f32_16x16x32_bf16 v[188:191], a[152:155], a[120:123], v[188:191]
  v_mfma_f32_16x16x32_bf16 v[188:191], a[156:159], a[124:127], v[188:191]
  v_mfma_f32_16x16x32_bf16 v[184:187], a[148:151], a[124:127], v[184:187]
  v_mfma_f32_16x16x32_bf16 v[184:187], a[144:147], a[120:123], v[184:187]
  v_mfma_f32_16x16x32_bf16 v[180:183], a[136:139], a[120:123], v[180:183]
  buffer_load_dwordx4 v37, s[8:11], s25 offen offset:1024 lds
  v_mfma_f32_16x16x32_bf16 v[180:183], a[140:143], a[124:127], v[180:183]
  v_mfma_f32_16x16x32_bf16 v[176:179], a[132:135], a[124:127], v[176:179]
  v_mfma_f32_16x16x32_bf16 v[176:179], a[128:131], a[120:123], v[176:179]
  v_mfma_f32_16x16x32_bf16 v[192:195], a[160:163], a[96:99], v[192:195]
  ds_read_b64_tr_b16 a[128:129], v44 offset:0
  v_mfma_f32_16x16x32_bf16 v[192:195], a[164:167], a[100:103], v[192:195]
  buffer_load_dwordx4 v38, s[8:11], s25 offen offset:2048 lds
  v_mfma_f32_16x16x32_bf16 v[196:199], a[172:175], a[100:103], v[196:199]
  ds_read_b64_tr_b16 a[130:131], v44 offset:1024
  v_mfma_f32_16x16x32_bf16 v[196:199], a[168:171], a[96:99], v[196:199]
  ds_read_b64_tr_b16 a[132:133], v44 offset:8192
  v_mfma_f32_16x16x32_bf16 v[200:203], a[176:179], a[96:99], v[200:203]
  ds_read_b64_tr_b16 a[134:135], v44 offset:9216
  v_mfma_f32_16x16x32_bf16 v[200:203], a[180:183], a[100:103], v[200:203]
  ds_read_b64_tr_b16 a[136:137], v45 offset:0
  v_mfma_f32_16x16x32_bf16 v[204:207], a[188:191], a[100:103], v[204:207]
  buffer_load_dwordx4 v39, s[8:11], s25 offen offset:3072 lds
  v_mfma_f32_16x16x32_bf16 v[204:207], a[184:187], a[96:99], v[204:207]
  s_add_u32 s25, s25, 524160
  ds_read_b64_tr_b16 a[138:139], v45 offset:1024
  v_mfma_f32_16x16x32_bf16 v[220:223], a[184:187], a[104:107], v[220:223]
  ds_read_b64_tr_b16 a[140:141], v45 offset:8192
  v_mfma_f32_16x16x32_bf16 v[220:223], a[188:191], a[108:111], v[220:223]
  ds_read_b64_tr_b16 a[142:143], v45 offset:9216
  v_mfma_f32_16x16x32_bf16 v[216:219], a[180:183], a[108:111], v[216:219]
  ds_read_b64_tr_b16 a[144:145], v46 offset:0
  v_mfma_f32_16x16x32_bf16 v[216:219], a[176:179], a[104:107], v[216:219]
  ds_read_b64_tr_b16 a[146:147], v46 offset:1024
  v_mfma_f32_16x16x32_bf16 v[212:215], a[168:171], a[104:107], v[212:215]
  v_mfma_f32_16x16x32_bf16 v[212:215], a[172:175], a[108:111], v[212:215]
  ds_read_b64_tr_b16 a[148:149], v46 offset:8192
  v_mfma_f32_16x16x32_bf16 v[208:211], a[164:167], a[108:111], v[208:211]
  ds_read_b64_tr_b16 a[150:151], v46 offset:9216
  v_mfma_f32_16x16x32_bf16 v[208:211], a[160:163], a[104:107], v[208:211]
  ds_read_b64_tr_b16 a[152:153], v47 offset:0
  v_mfma_f32_16x16x32_bf16 v[224:227], a[160:163], a[112:115], v[224:227]
  ds_read_b64_tr_b16 a[154:155], v47 offset:1024
  v_mfma_f32_16x16x32_bf16 v[224:227], a[164:167], a[116:119], v[224:227]
  ds_read_b64_tr_b16 a[156:157], v47 offset:8192
  v_mfma_f32_16x16x32_bf16 v[228:231], a[172:175], a[116:119], v[228:231]
  ds_read_b64_tr_b16 a[158:159], v47 offset:9216
  v_mfma_f32_16x16x32_bf16 v[228:231], a[168:171], a[112:115], v[228:231]
  v_mfma_f32_16x16x32_bf16 v[232:235], a[176:179], a[112:115], v[232:235]
  v_mfma_f32_16x16x32_bf16 v[232:235], a[180:183], a[116:119], v[232:235]
  v_mfma_f32_16x16x32_bf16 v[236:239], a[188:191], a[116:119], v[236:239]
  s_sub_u32 s26, s26, 1
  v_mfma_f32_16x16x32_bf16 v[236:239], a[184:187], a[112:115], v[236:239]
  s_cmp_eq_u32 s26, s64
  v_mfma_f32_16x16x32_bf16 v[252:255], a[184:187], a[120:123], v[252:255]
  s_cbranch_scc1 KV_SS_1
KV_SB_2:
  v_mfma_f32_16x16x32_bf16 v[252:255], a[188:191], a[124:127], v[252:255]
  v_mfma_f32_16x16x32_bf16 v[248:251], a[180:183], a[124:127], v[248:251]
  v_mfma_f32_16x16x32_bf16 v[248:251], a[176:179], a[120:123], v[248:251]
  s_cmp_lg_u32 s26, 0
  v_mfma_f32_16x16x32_bf16 v[244:247], a[168:171], a[120:123], v[244:247]
  v_mfma_f32_16x16x32_bf16 v[244:247], a[172:175], a[124:127], v[244:247]
  v_mfma_f32_16x16x32_bf16 v[240:243], a[164:167], a[124:127], v[240:243]
  v_mfma_f32_16x16x32_bf16 v[240:243], a[160:163], a[120:123], v[240:243]
  s_waitcnt vmcnt(18) lgkmcnt(0)
  s_cbranch_scc1 KV_LOOP0
  v_mfma_f32_16x16x32_bf16 a[0:3], a[128:131], a[64:67], a[0:3]
  s_barrier
  v_mfma_f32_16x16x32_bf16 a[0:3], a[132:135], a[68:71], a[0:3]
  ds_read_b64_tr_b16 a[160:161], v44 offset:32768
  v_cmp_le_u32 vcc, 16, v25
  v_mfma_f32_16x16x32_bf16 a[4:7], a[140:143], a[68:71], a[4:7]
  s_mov_b32 s24, 0
  ds_read_b64_tr_b16 a[162:163], v44 offset:33792
  v_mfma_f32_16x16x32_bf16 a[4:7], a[136:139], a[64:67], a[4:7]
  s_add_u32 m0, s31, 0
  ds_read_b64_tr_b16 a[164:165], v44 offset:40960
  v_mfma_f32_16x16x32_bf16 a[8:11], a[144:147], a[64:67], a[8:11]
  buffer_load_dwordx4 v4, s[68:71], s24 offen lds
  v_mfma_f32_16x16x32_bf16 a[8:11], a[148:151], a[68:71], a[8:11]
  s_add_u32 m0, m0, 4096
  ds_read_b64_tr_b16 a[166:167], v44 offset:41984
  v_mfma_f32_16x16x32_bf16 a[12:15], a[156:159], a[68:71], a[12:15]
  s_add_u32 s24, s24, s30
  ds_read_b64_tr_b16 a[168:169], v45 offset:32768
  v_mfma_f32_16x16x32_bf16 a[12:15], a[152:155], a[64:67], a[12:15]
  s_cmp_eq_u32 vcc_lo, 0xffff
  s_cbranch_scc0 KV_X0
KV_X0_B:
  ds_read_b64_tr_b16 a[170:171], v45 offset:33792
  v_mfma_f32_16x16x32_bf16 a[28:31], a[152:155], a[72:75], a[28:31]
  buffer_load_dwordx4 v4, s[68:71], s24 offen lds
  v_mfma_f32_16x16x32_bf16 a[28:31], a[156:159], a[76:79], a[28:31]
  s_add_u32 m0, m0, 4096
  ds_read_b64_tr_b16 a[172:173], v45 offset:40960
  v_mfma_f32_16x16x32_bf16 a[24:27], a[148:151], a[76:79], a[24:27]
  s_add_u32 s24, s24, s30
  ds_read_b64_tr_b16 a[174:175], v45 offset:41984
  v_mfma_f32_16x16x32_bf16 a[24:27], a[144:147], a[72:75], a[24:27]
  s_lshl_b32 s60, s23, 1
  ds_read_b64_tr_b16 a[176:177], v46 offset:32768
  v_mfma_f32_16x16x32_bf16 a[20:23], a[136:139], a[72:75], a[20:23]
  buffer_load_dwordx4 v4, s[68:71], s24 offen lds
  v_mfma_f32_16x16x32_bf16 a[20:23], a[140:143], a[76:79], a[20:23]
  s_add_u32 m0, m0, 4096
  ds_read_b64_tr_b16 a[178:179], v46 offset:33792
  v_mfma_f32_16x16x32_bf16 a[16:19], a[132:135], a[76:79], a[16:19]
  s_add_u32 s24, s24, s30
  ds_read_b64_tr_b16 a[180:181], v46 offset:40960
  v_mfma_f32_16x16x32_bf16 a[16:19], a[128:131], a[72:75], a[16:19]
  s_lshl_b32 s61, s23, 2
  ds_read_b64_tr_b16 a[182:183], v46 offset:41984
  v_mfma_f32_16x16x32_bf16 a[32:35], a[128:131], a[80:83], a[32:35]
  buffer_load_dwordx4 v4, s[68:71], s24 offen lds
  v_mfma_f32_16x16x32_bf16 a[32:35], a[132:135], a[84:87], a[32:35]
  s_add_u32 m0, m0, 4096
  ds_read_b64_tr_b16 a[184:185], v47 offset:32768
  v_mfma_f32_16x16x32_bf16 a[36:39], a[140:143], a[84:87], a[36:39]
  s_add_u32 s24, s24, s30
  ds_read_b64_tr_b16 a[186:187], v47 offset:33792
  v_mfma_f32_16x16x32_bf16 a[36:39], a[136:139], a[80:83], a[36:39]
  s_mov_b32 s62, 0x2468ace
  ds_read_b64_tr_b16 a[188:189], v47 offset:40960
  v_mfma_f32_16x16x32_bf16 a[40:43], a[144:147], a[80:83], a[40:43]
  buffer_load_dwordx4 v4, s[68:71], s24 offen lds
  v_mfma_f32_16x16x32_bf16 a[40:43], a[148:151], a[84:87], a[40:43]
  s_add_u32 m0, m0, 4096
  ds_read_b64_tr_b16 a[190:191], v47 offset:41984
  v_mfma_f32_16x16x32_bf16 a[44:47], a[156:159], a[84:87], a[44:47]
  s_add_u32 s24, s24, s30
  v_mfma_f32_16x16x32_bf16 a[44:47], a[152:155], a[80:83], a[44:47]
  s_bitcmp1_b32 s17, 1
  s_cmov_b32 s62, 0x2468ace
  v_mfma_f32_16x16x32_bf16 a[60:63], a[152:155], a[88:91], a[60:63]
  buffer_load_dwordx4 v4, s[68:71], s24 offen lds
  v_mfma_f32_16x16x32_bf16 a[60:63], a[156:159], a[92:95], a[60:63]
  s_add_u32 m0, m0, 4096
  v_mfma_f32_16x16x32_bf16 a[56:59], a[148:151], a[92:95], a[56:59]
  s_add_u32 s24, s24, s30
  v_mfma_f32_16x16x32_bf16 a[56:59], a[144:147], a[88:91], a[56:59]
  s_lshr_b32 s50, s62, s61
  v_mfma_f32_16x16x32_bf16 a[52:55], a[136:139], a[88:91], a[52:55]
  buffer_load_dwordx4 v4, s[68:71], s24 offen lds
  v_mfma_f32_16x16x32_bf16 a[52:55], a[140:143], a[92:95], a[52:55]
  s_and_b32 s50, s50, 15
  v_mfma_f32_16x16x32_bf16 a[48:51], a[132:135], a[92:95], a[48:51]
  s_sub_u32 s61, 32, s60
  ds_read_b128 a[96:99], v40 offset:32768
  v_mfma_f32_16x16x32_bf16 a[48:51], a[128:131], a[88:91], a[48:51]
  s_waitcnt lgkmcnt(1)
  v_mfma_f32_16x16x32_bf16 v[64:67], a[160:163], a[64:67], v[64:67]
  buffer_load_dwordx4 a[192:195], v9, s[12:15], s48 offen offset:0 sc1
  v_mfma_f32_16x16x32_bf16 v[64:67], a[164:167], a[68:71], v[64:67]
  s_sub_u32 s61, s61, s50
  ds_read_b128 a[100:103], v41 offset:32768
  v_mfma_f32_16x16x32_bf16 v[68:71], a[172:175], a[68:71], v[68:71]
  s_add_u32 s60, s60, 2
  v_mfma_f32_16x16x32_bf16 v[68:71], a[168:171], a[64:67], v[68:71]
  s_cmp_eq_u32 s22, 0
  s_cselect_b32 s42, s60, s61
  s_cselect_b32 s46, 3, 2
  ds_read_b128 a[104:107], v40 offset:34816
  v_mfma_f32_16x16x32_bf16 v[72:75], a[176:179], a[64:67], v[72:75]
  buffer_load_dwordx4 a[196:199], v9, s[12:15], s49 offen offset:0 sc1
  v_mfma_f32_16x16x32_bf16 v[72:75], a[180:183], a[68:71], v[72:75]
  s_cmp_eq_u32 s22, 0
  s_cselect_b32 s62, s50, 0
  s_cselect_b32 s63, 0, s50
  ds_read_b128 a[108:111], v41 offset:34816
  v_mfma_f32_16x16x32_bf16 v[76:79], a[188:191], a[68:71], v[76:79]
  s_cmp_eq_u32 s50, 0
  s_cmov_b32 s46, 0
  v_mfma_f32_16x16x32_bf16 v[76:79], a[184:187], a[64:67], v[76:79]
  s_lshl_b32 s60, s42, 1
  ds_read_b128 a[112:115], v40 offset:36864
  v_mfma_f32_16x16x32_bf16 v[92:95], a[184:187], a[72:75], v[92:95]
  buffer_load_dwordx4 a[200:203], v9, s[12:15], s48 offen offset:1024 sc1
  v_mfma_f32_16x16x32_bf16 v[92:95], a[188:191], a[76:79], v[92:95]
  s_lshl_b32 s62, s62, 1
  ds_read_b128 a[116:119], v41 offset:36864
  v_mfma_f32_16x16x32_bf16 v[88:91], a[180:183], a[76:79], v[88:91]
  s_add_u32 s52, s60, s62
  v_mfma_f32_16x16x32_bf16 v[88:91], a[176:179], a[72:75], v[88:91]
  s_add_u32 s61, s23, 9
  ds_read_b128 a[120:123], v40 offset:38912
  v_cmp_le_u32 vcc, s60, v1
  v_mfma_f32_16x16x32_bf16 v[84:87], a[168:171], a[72:75], v[84:87]
  buffer_load_dwordx4 a[204:207], v9, s[12:15], s49 offen offset:1024 sc1
  v_mfma_f32_16x16x32_bf16 v[84:87], a[172:175], a[76:79], v[84:87]
  ds_read_b128 a[124:127], v41 offset:38912
  v_subrev_u32 v2, s60, v1
  v_mfma_f32_16x16x32_bf16 v[80:83], a[164:167], a[76:79], v[80:83]
  v_mov_b32 v3, s60
  v_mov_b32 v16, s62
  v_mfma_f32_16x16x32_bf16 v[80:83], a[160:163], a[72:75], v[80:83]
  s_sub_u32 s62, s17, s21
  v_mfma_f32_16x16x32_bf16 v[96:99], a[160:163], a[80:83], v[96:99]
  buffer_load_dwordx4 a[208:211], v9, s[12:15], s48 offen offset:2048 sc1
  v_mfma_f32_16x16x32_bf16 v[96:99], a[164:167], a[84:87], v[96:99]
  s_lshl_b32 s62, s62, 5
  v_mfma_f32_16x16x32_bf16 v[100:103], a[172:175], a[84:87], v[100:103]
  s_add_u32 s62, s62, s61
  v_mov_b32 v17, s62
  v_cndmask_b32 v2, v1, v2, vcc
  v_mfma_f32_16x16x32_bf16 v[100:103], a[168:171], a[80:83], v[100:103]
  v_cndmask_b32 v3, v3, v16, vcc
  v_cndmask_b32 v17, 0, v17, vcc
  v_mfma_f32_16x16x32_bf16 v[104:107], a[176:179], a[80:83], v[104:107]
  buffer_load_dwordx4 a[212:215], v9, s[12:15], s49 offen offset:2048 sc1
  v_mfma_f32_16x16x32_bf16 v[104:107], a[180:183], a[84:87], v[104:107]
  v_add_u32 v16, 1, v2
  v_cmp_eq_u32 vcc, v16, v3
  v_mfma_f32_16x16x32_bf16 v[108:111], a[188:191], a[84:87], v[108:111]
  v_and_b32 v18, 1, v16
  v_min_u32 v18, v18, v2
  v_mfma_f32_16x16x32_bf16 v[108:111], a[184:187], a[80:83], v[108:111]
  v_cndmask_b32 v18, v18, 1, vcc
  v_lshrrev_b32 v16, 1, v16
  v_mfma_f32_16x16x32_bf16 v[124:127], a[184:187], a[88:91], v[124:127]
  buffer_load_dwordx4 a[216:219], v9, s[12:15], s48 offen offset:3072 sc1
  v_mfma_f32_16x16x32_bf16 v[124:127], a[188:191], a[92:95], v[124:127]
  v_sub_u32 v16, v16, v18
  v_cmp_le_u32 vcc, s61, v16
  v_mfma_f32_16x16x32_bf16 v[120:123], a[180:183], a[92:95], v[120:123]
  v_add_u32 v17, v17, v16
  v_add_u32 v16, s63, v17
  v_mfma_f32_16x16x32_bf16 v[120:123], a[176:179], a[88:91], v[120:123]
  s_mul_i32 s60, s21, 2097152
  v_cndmask_b32 v17, v17, v16, vcc
  v_mfma_f32_16x16x32_bf16 v[116:119], a[168:171], a[88:91], v[116:119]
  buffer_load_dwordx4 a[220:223], v9, s[12:15], s49 offen offset:3072 sc1
  v_mfma_f32_16x16x32_bf16 v[116:119], a[172:175], a[92:95], v[116:119]
  s_add_u32 s48, s48, 4096
  v_mfma_f32_16x16x32_bf16 v[112:115], a[164:167], a[92:95], v[112:115]
  s_add_u32 s49, s49, 4096
  v_mfma_f32_16x16x32_bf16 v[112:115], a[160:163], a[88:91], v[112:115]
  s_waitcnt vmcnt(23) lgkmcnt(0)
  v_mfma_f32_16x16x32_bf16 v[128:131], a[160:163], a[96:99], v[128:131]
  s_barrier
  v_mfma_f32_16x16x32_bf16 v[128:131], a[164:167], a[100:103], v[128:131]
  s_add_u32 s60, s60, 100663296
  ds_read_b128 a[64:67], v42 offset:0
  v_lshlrev_b32 v17, 16, v17
  v_mfma_f32_16x16x32_bf16 v[132:135], a[172:175], a[100:103], v[132:135]
  s_mov_b32 s24, 128
  v_lshl_add_u32 v17, v18, 15, v17
  v_add_u32 v17, s60, v17
  v_mfma_f32_16x16x32_bf16 v[132:135], a[168:171], a[96:99], v[132:135]
  s_add_u32 m0, s31, 32768
  ds_read_b128 a[68:71], v43 offset:0
  v_cmp_le_u32 vcc, s52, v1
  v_mfma_f32_16x16x32_bf16 v[136:139], a[176:179], a[96:99], v[136:139]
  buffer_load_dwordx4 v4, s[68:71], s24 offen lds
  v_mfma_f32_16x16x32_bf16 v[136:139], a[180:183], a[100:103], v[136:139]
  s_add_u32 m0, m0, 4096
  ds_read_b128 a[72:75], v42 offset:2048
  v_subrev_u32 v16, s52, v1
  v_mfma_f32_16x16x32_bf16 v[140:143], a[188:191], a[100:103], v[140:143]
  s_add_u32 s24, s24, s30
  v_lshlrev_b32 v16, 7, v16
  v_cndmask_b32 v5, v17, v16, vcc
  v_mfma_f32_16x16x32_bf16 v[140:143], a[184:187], a[96:99], v[140:143]
  s_lshl_b32 s61, s23, 17
  ds_read_b128 a[76:79], v43 offset:2048
  v_mfma_f32_16x16x32_bf16 v[156:159], a[184:187], a[104:107], v[156:159]
  buffer_load_dwordx4 v4, s[68:71], s24 offen lds
  v_mfma_f32_16x16x32_bf16 v[156:159], a[188:191], a[108:111], v[156:159]
  s_add_u32 m0, m0, 4096
  ds_read_b128 a[80:83], v42 offset:4096
  v_mfma_f32_16x16x32_bf16 v[152:155], a[180:183], a[108:111], v[152:155]
  s_add_u32 s24, s24, s30
  v_mfma_f32_16x16x32_bf16 v[152:155], a[176:179], a[104:107], v[152:155]
  s_add_u32 s60, s60, s61
  ds_read_b128 a[84:87], v43 offset:4096
  v_mfma_f32_16x16x32_bf16 v[148:151], a[168:171], a[104:107], v[148:151]
  buffer_load_dwordx4 v4, s[68:71], s24 offen lds
  v_mfma_f32_16x16x32_bf16 v[148:151], a[172:175], a[108:111], v[148:151]
  s_add_u32 m0, m0, 4096
  ds_read_b128 a[88:91], v42 offset:6144
  v_mfma_f32_16x16x32_bf16 v[144:147], a[164:167], a[108:111], v[144:147]
  s_add_u32 s24, s24, s30
  v_mfma_f32_16x16x32_bf16 v[144:147], a[160:163], a[104:107], v[144:147]
  s_lshr_b32 s61, s20, 1
  ds_read_b128 a[92:95], v43 offset:6144
  v_mfma_f32_16x16x32_bf16 v[160:163], a[160:163], a[112:115], v[160:163]
  buffer_load_dwordx4 v4, s[68:71], s24 offen lds
  v_mfma_f32_16x16x32_bf16 v[160:163], a[164:167], a[116:119], v[160:163]
  s_add_u32 m0, m0, 4096
  v_mfma_f32_16x16x32_bf16 v[164:167], a[172:175], a[116:119], v[164:167]
  s_add_u32 s24, s24, s30
  v_mfma_f32_16x16x32_bf16 v[164:167], a[168:171], a[112:115], v[164:167]
  s_lshl_b32 s61, s61, 16
  v_mfma_f32_16x16x32_bf16 v[168:171], a[176:179], a[112:115], v[168:171]
  buffer_load_dwordx4 v4, s[68:71], s24 offen lds
  v_mfma_f32_16x16x32_bf16 v[168:171], a[180:183], a[116:119], v[168:171]
  s_add_u32 m0, m0, 4096
  v_mfma_f32_16x16x32_bf16 v[172:175], a[188:191], a[116:119], v[172:175]
  s_add_u32 s24, s24, s30
  v_mfma_f32_16x16x32_bf16 v[172:175], a[184:187], a[112:115], v[172:175]
  s_add_u32 s60, s60, s61
  v_mfma_f32_16x16x32_bf16 v[188:191], a[184:187], a[120:123], v[188:191]
  buffer_load_dwordx4 v4, s[68:71], s24 offen lds
  v_mfma_f32_16x16x32_bf16 v[188:191], a[188:191], a[124:127], v[188:191]
  s_add_u32 m0, m0, 4096
  v_mfma_f32_16x16x32_bf16 v[184:187], a[180:183], a[124:127], v[184:187]
  s_add_u32 s24, s24, s30
  v_mfma_f32_16x16x32_bf16 v[184:187], a[176:179], a[120:123], v[184:187]
  s_lshl_b32 s62, s22, 1
  v_mfma_f32_16x16x32_bf16 v[180:183], a[168:171], a[120:123], v[180:183]
  buffer_load_dwordx4 v4, s[68:71], s24 offen lds
  v_mfma_f32_16x16x32_bf16 v[180:183], a[172:175], a[124:127], v[180:183]
  s_lshl_b32 s39, 2048, s62
  v_mfma_f32_16x16x32_bf16 v[176:179], a[164:167], a[124:127], v[176:179]
  s_lshr_b32 s47, 8192, s62
  v_mfma_f32_16x16x32_bf16 v[176:179], a[160:163], a[120:123], v[176:179]
  s_and_b32 s61, s20, 1
  v_mfma_f32_16x16x32_bf16 v[192:195], a[128:131], a[96:99], v[192:195]
  buffer_load_dwordx4 a[224:227], v9, s[12:15], s48 offen offset:0 sc1
  v_mfma_f32_16x16x32_bf16 v[192:195], a[132:135], a[100:103], v[192:195]
  s_mul_i32 s61, s61, s39
  ds_read_b64_tr_b16 a[160:161], v48 offset:0
  v_mfma_f32_16x16x32_bf16 v[196:199], a[140:143], a[100:103], v[196:199]
  s_lshl_b32 s61, s61, 1
  ds_read_b64_tr_b16 a[162:163], v48 offset:1024
  v_mfma_f32_16x16x32_bf16 v[196:199], a[136:139], a[96:99], v[196:199]
  s_add_u32 s60, s60, s61
  ds_read_b64_tr_b16 a[164:165], v48 offset:8192
  v_mfma_f32_16x16x32_bf16 v[200:203], a[144:147], a[96:99], v[200:203]
  buffer_load_dwordx4 a[228:231], v9, s[12:15], s49 offen offset:0 sc1
  v_mfma_f32_16x16x32_bf16 v[200:203], a[148:151], a[100:103], v[200:203]
  s_lshl_b32 s61, s22, 15
  ds_read_b64_tr_b16 a[166:167], v48 offset:9216
  v_mfma_f32_16x16x32_bf16 v[204:207], a[156:159], a[100:103], v[204:207]
  s_add_u32 s41, s60, s61
  ds_read_b64_tr_b16 a[168:169], v49 offset:0
  v_lshrrev_b32 v2, 2, v1
  v_mfma_f32_16x16x32_bf16 v[204:207], a[152:155], a[96:99], v[204:207]
  ds_read_b64_tr_b16 a[170:171], v49 offset:1024
  v_bfe_u32 v3, v2, 1, 2
  v_mfma_f32_16x16x32_bf16 v[220:223], a[152:155], a[104:107], v[220:223]
  buffer_load_dwordx4 a[232:235], v9, s[12:15], s48 offen offset:1024 sc1
  v_mfma_f32_16x16x32_bf16 v[220:223], a[156:159], a[108:111], v[220:223]
  ds_read_b64_tr_b16 a[172:173], v49 offset:8192
  v_lshlrev_b32 v2, 7, v2
  v_mfma_f32_16x16x32_bf16 v[216:219], a[148:151], a[108:111], v[216:219]
  ds_read_b64_tr_b16 a[174:175], v49 offset:9216
  v_and_b32 v16, 3, v1
  v_mfma_f32_16x16x32_bf16 v[216:219], a[144:147], a[104:107], v[216:219]
  ds_read_b64_tr_b16 a[176:177], v50 offset:0
  v_lshl_add_u32 v2, v16, 3, v2
  v_mfma_f32_16x16x32_bf16 v[212:215], a[136:139], a[104:107], v[212:215]
  buffer_load_dwordx4 a[236:239], v9, s[12:15], s49 offen offset:1024 sc1
  v_mfma_f32_16x16x32_bf16 v[212:215], a[140:143], a[108:111], v[212:215]
  ds_read_b64_tr_b16 a[178:179], v50 offset:1024
  v_lshl_add_u32 v28, v3, 5, v2
  v_mfma_f32_16x16x32_bf16 v[208:211], a[132:135], a[108:111], v[208:211]
  ds_read_b64_tr_b16 a[180:181], v50 offset:8192
  v_xor_b32 v29, 32, v28
  v_mfma_f32_16x16x32_bf16 v[208:211], a[128:131], a[104:107], v[208:211]
  ds_read_b64_tr_b16 a[182:183], v50 offset:9216
  v_xor_b32 v30, 64, v28
  v_mfma_f32_16x16x32_bf16 v[224:227], a[128:131], a[112:115], v[224:227]
  buffer_load_dwordx4 a[240:243], v9, s[12:15], s48 offen offset:2048 sc1
  v_mfma_f32_16x16x32_bf16 v[224:227], a[132:135], a[116:119], v[224:227]
  ds_read_b64_tr_b16 a[184:185], v51 offset:0
  v_xor_b32 v31, 96, v28
  v_mfma_f32_16x16x32_bf16 v[228:231], a[140:143], a[116:119], v[228:231]
  ds_read_b64_tr_b16 a[186:187], v51 offset:1024
  v_and_b32 v2, 15, v1
  v_mfma_f32_16x16x32_bf16 v[228:231], a[136:139], a[112:115], v[228:231]
  s_lshl_b32 s60, s20, 4
  ds_read_b64_tr_b16 a[188:189], v51 offset:8192
  v_add_u32 v2, s60, v2
  v_mfma_f32_16x16x32_bf16 v[232:235], a[144:147], a[112:115], v[232:235]
  buffer_load_dwordx4 a[244:247], v9, s[12:15], s49 offen offset:2048 sc1
  v_mfma_f32_16x16x32_bf16 v[232:235], a[148:151], a[116:119], v[232:235]
  ds_read_b64_tr_b16 a[190:191], v51 offset:9216
  v_lshrrev_b32 v3, 4, v1
  v_mfma_f32_16x16x32_bf16 v[236:239], a[156:159], a[116:119], v[236:239]
  v_lshlrev_b32 v3, 2, v3
  v_sub_u32 v2, v2, v3
  v_mfma_f32_16x16x32_bf16 v[236:239], a[152:155], a[112:115], v[236:239]
  s_add_u32 m0, s3, 128000
  v_cvt_f32_i32 v2, v2
  v_add_f32 v2, 0.5, v2
  v_mfma_f32_16x16x32_bf16 v[252:255], a[152:155], a[120:123], v[252:255]
  buffer_load_dwordx4 v9, s[12:15], s48 offen offset:3072 sc1 lds
  v_mfma_f32_16x16x32_bf16 v[252:255], a[156:159], a[124:127], v[252:255]
  v_mul_f32 v24, 0x71800000, v2
  v_mfma_f32_16x16x32_bf16 v[248:251], a[148:151], a[124:127], v[248:251]
  v_mfma_f32_16x16x32_bf16 v[248:251], a[144:147], a[120:123], v[248:251]
  s_add_u32 m0, s3, 129024
  v_mfma_f32_16x16x32_bf16 v[244:247], a[136:139], a[120:123], v[244:247]
  buffer_load_dwordx4 v9, s[12:15], s49 offen offset:3072 sc1 lds
  v_mfma_f32_16x16x32_bf16 v[244:247], a[140:143], a[124:127], v[244:247]
  v_mfma_f32_16x16x32_bf16 v[240:243], a[132:135], a[124:127], v[240:243]
  v_mfma_f32_16x16x32_bf16 v[240:243], a[128:131], a[120:123], v[240:243]
  s_waitcnt vmcnt(30) lgkmcnt(0)
  v_mfma_f32_16x16x32_bf16 a[0:3], a[160:163], a[64:67], a[0:3]
  s_barrier
  v_mfma_f32_16x16x32_bf16 a[0:3], a[164:167], a[68:71], a[0:3]
  ds_read_b64_tr_b16 a[128:129], v48 offset:32768
  v_mfma_f32_16x16x32_bf16 a[4:7], a[172:175], a[68:71], a[4:7]
  s_add_u32 s48, s48, 4096
  ds_read_b64_tr_b16 a[130:131], v48 offset:33792
  v_mfma_f32_16x16x32_bf16 a[4:7], a[168:171], a[64:67], a[4:7]
  s_add_u32 m0, s3, 133120
  ds_read_b64_tr_b16 a[132:133], v48 offset:40960
  v_mfma_f32_16x16x32_bf16 a[8:11], a[176:179], a[64:67], a[8:11]
  buffer_load_dwordx4 v9, s[12:15], s48 offen offset:0 sc1 lds
  v_mfma_f32_16x16x32_bf16 a[8:11], a[180:183], a[68:71], a[8:11]
  ds_read_b64_tr_b16 a[134:135], v48 offset:41984
  v_mfma_f32_16x16x32_bf16 a[12:15], a[188:191], a[68:71], a[12:15]
  s_add_u32 s49, s49, 4096
  ds_read_b64_tr_b16 a[136:137], v49 offset:32768
  v_mfma_f32_16x16x32_bf16 a[12:15], a[184:187], a[64:67], a[12:15]
  s_add_u32 m0, s3, 134144
  ds_read_b64_tr_b16 a[138:139], v49 offset:33792
  v_mfma_f32_16x16x32_bf16 a[28:31], a[184:187], a[72:75], a[28:31]
  buffer_load_dwordx4 v9, s[12:15], s49 offen offset:0 sc1 lds
  v_mfma_f32_16x16x32_bf16 a[28:31], a[188:191], a[76:79], a[28:31]
  ds_read_b64_tr_b16 a[140:141], v49 offset:40960
  v_mfma_f32_16x16x32_bf16 a[24:27], a[180:183], a[76:79], a[24:27]
  ds_read_b64_tr_b16 a[142:143], v49 offset:41984
  v_mfma_f32_16x16x32_bf16 a[24:27], a[176:179], a[72:75], a[24:27]
  s_add_u32 m0, s3, 134144
  ds_read_b64_tr_b16 a[144:145], v50 offset:32768
  v_mfma_f32_16x16x32_bf16 a[20:23], a[168:171], a[72:75], a[20:23]
  buffer_load_dwordx4 v9, s[12:15], s48 offen offset:1024 sc1 lds
  v_mfma_f32_16x16x32_bf16 a[20:23], a[172:175], a[76:79], a[20:23]
  ds_read_b64_tr_b16 a[146:147], v50 offset:33792
  v_mfma_f32_16x16x32_bf16 a[16:19], a[164:167], a[76:79], a[16:19]
  ds_read_b64_tr_b16 a[148:149], v50 offset:40960
  v_mfma_f32_16x16x32_bf16 a[16:19], a[160:163], a[72:75], a[16:19]
  s_add_u32 m0, s3, 135168
  ds_read_b64_tr_b16 a[150:151], v50 offset:41984
  v_mfma_f32_16x16x32_bf16 a[32:35], a[160:163], a[80:83], a[32:35]
  buffer_load_dwordx4 v9, s[12:15], s49 offen offset:1024 sc1 lds
  v_mfma_f32_16x16x32_bf16 a[32:35], a[164:167], a[84:87], a[32:35]
  ds_read_b64_tr_b16 a[152:153], v51 offset:32768
  v_mfma_f32_16x16x32_bf16 a[36:39], a[172:175], a[84:87], a[36:39]
  ds_read_b64_tr_b16 a[154:155], v51 offset:33792
  v_mfma_f32_16x16x32_bf16 a[36:39], a[168:171], a[80:83], a[36:39]
  s_add_u32 m0, s3, 135168
  ds_read_b64_tr_b16 a[156:157], v51 offset:40960
  v_mfma_f32_16x16x32_bf16 a[40:43], a[176:179], a[80:83], a[40:43]
  buffer_load_dwordx4 v9, s[12:15], s48 offen offset:2048 sc1 lds
  v_mfma_f32_16x16x32_bf16 a[40:43], a[180:183], a[84:87], a[40:43]
  ds_read_b64_tr_b16 a[158:159], v51 offset:41984
  v_mfma_f32_16x16x32_bf16 a[44:47], a[188:191], a[84:87], a[44:47]
  v_mfma_f32_16x16x32_bf16 a[44:47], a[184:187], a[80:83], a[44:47]
  s_add_u32 m0, s3, 136192
  v_mfma_f32_16x16x32_bf16 a[60:63], a[184:187], a[88:91], a[60:63]
  buffer_load_dwordx4 v9, s[12:15], s49 offen offset:2048 sc1 lds
  v_mfma_f32_16x16x32_bf16 a[60:63], a[188:191], a[92:95], a[60:63]
  v_mfma_f32_16x16x32_bf16 a[56:59], a[180:183], a[92:95], a[56:59]
  v_mfma_f32_16x16x32_bf16 a[56:59], a[176:179], a[88:91], a[56:59]
  v_mfma_f32_16x16x32_bf16 a[52:55], a[168:171], a[88:91], a[52:55]
  v_mfma_f32_16x16x32_bf16 a[52:55], a[172:175], a[92:95], a[52:55]
  v_mfma_f32_16x16x32_bf16 a[48:51], a[164:167], a[92:95], a[48:51]
  ds_read_b128 a[96:99], v42 offset:32768
  v_mfma_f32_16x16x32_bf16 a[48:51], a[160:163], a[88:91], a[48:51]
  s_waitcnt lgkmcnt(1)
  v_mfma_f32_16x16x32_bf16 v[64:67], a[128:131], a[64:67], v[64:67]
  ds_read_b128 a[100:103], v43 offset:32768
  v_mfma_f32_16x16x32_bf16 v[64:67], a[132:135], a[68:71], v[64:67]
  s_mov_b32 s38, s41
  v_mfma_f32_16x16x32_bf16 v[68:71], a[140:143], a[68:71], v[68:71]
  ds_read_b128 a[104:107], v42 offset:34816
  v_mfma_f32_16x16x32_bf16 v[68:71], a[136:139], a[64:67], v[68:71]
  v_mfma_f32_16x16x32_bf16 v[72:75], a[144:147], a[64:67], v[72:75]
  ds_read_b128 a[108:111], v43 offset:34816
  v_mfma_f32_16x16x32_bf16 v[72:75], a[148:151], a[68:71], v[72:75]
  v_mfma_f32_16x16x32_bf16 v[76:79], a[156:159], a[68:71], v[76:79]
  ds_read_b128 a[112:115], v42 offset:36864
  v_mfma_f32_16x16x32_bf16 v[76:79], a[152:155], a[64:67], v[76:79]
  v_mfma_f32_16x16x32_bf16 v[92:95], a[152:155], a[72:75], v[92:95]
  ds_read_b128 a[116:119], v43 offset:36864
  v_accvgpr_read_b32 v52, a0
  v_mfma_f32_16x16x32_bf16 v[92:95], a[156:159], a[76:79], v[92:95]
  v_accvgpr_read_b32 v53, a1
  v_accvgpr_read_b32 v54, a2
  v_mfma_f32_16x16x32_bf16 v[88:91], a[148:151], a[76:79], v[88:91]
  ds_read_b128 a[120:123], v42 offset:38912
  v_accvgpr_read_b32 v55, a3
  v_mfma_f32_16x16x32_bf16 v[88:91], a[144:147], a[72:75], v[88:91]
  v_cvt_pk_bf16_f32 v32, v52, v53
  v_cvt_pk_bf16_f32 v33, v54, v55
  v_mfma_f32_16x16x32_bf16 v[84:87], a[136:139], a[72:75], v[84:87]
  ds_read_b128 a[124:127], v43 offset:38912
  v_accvgpr_read_b32 v56, a4
  v_mfma_f32_16x16x32_bf16 v[84:87], a[140:143], a[76:79], v[84:87]
  v_accvgpr_read_b32 v57, a5
  v_accvgpr_read_b32 v58, a6
  v_mfma_f32_16x16x32_bf16 v[80:83], a[132:135], a[76:79], v[80:83]
  v_accvgpr_read_b32 v59, a7
  v_cvt_pk_bf16_f32 v34, v56, v57
  v_mfma_f32_16x16x32_bf16 v[80:83], a[128:131], a[72:75], v[80:83]
  v_cvt_pk_bf16_f32 v35, v58, v59
  v_mfma_f32_16x16x32_bf16 v[96:99], a[128:131], a[80:83], v[96:99]
  buffer_store_dwordx4 v[32:35], v9, s[12:15], s38 offen offset:0 sc1
  v_accvgpr_read_b32 v52, a8
  v_accvgpr_read_b32 v53, a9
  v_accvgpr_read_b32 v54, a10
  v_mfma_f32_16x16x32_bf16 v[96:99], a[132:135], a[84:87], v[96:99]
  v_accvgpr_read_b32 v55, a11
  v_cvt_pk_bf16_f32 v36, v52, v53
  v_mfma_f32_16x16x32_bf16 v[100:103], a[140:143], a[84:87], v[100:103]
  v_cvt_pk_bf16_f32 v37, v54, v55
  v_accvgpr_read_b32 v56, a12
  v_mfma_f32_16x16x32_bf16 v[100:103], a[136:139], a[80:83], v[100:103]
  v_accvgpr_read_b32 v57, a13
  v_accvgpr_read_b32 v58, a14
  v_mfma_f32_16x16x32_bf16 v[104:107], a[144:147], a[80:83], v[104:107]
  v_accvgpr_read_b32 v59, a15
  v_cvt_pk_bf16_f32 v38, v56, v57
  v_mfma_f32_16x16x32_bf16 v[104:107], a[148:151], a[84:87], v[104:107]
  v_cvt_pk_bf16_f32 v39, v58, v59
  v_mfma_f32_16x16x32_bf16 v[108:111], a[156:159], a[84:87], v[108:111]
  buffer_store_dwordx4 v[36:39], v9, s[12:15], s38 offen offset:1024 sc1
  s_add_u32 s38, s38, s47
  v_accvgpr_read_b32 v52, a16
  v_accvgpr_read_b32 v53, a17
  v_mfma_f32_16x16x32_bf16 v[108:111], a[152:155], a[80:83], v[108:111]
  v_accvgpr_read_b32 v54, a18
  v_accvgpr_read_b32 v55, a19
  v_mfma_f32_16x16x32_bf16 v[124:127], a[152:155], a[88:91], v[124:127]
  v_cvt_pk_bf16_f32 v60, v52, v53
  v_cvt_pk_bf16_f32 v61, v54, v55
  v_mfma_f32_16x16x32_bf16 v[124:127], a[156:159], a[92:95], v[124:127]
  v_accvgpr_read_b32 v56, a20
  v_accvgpr_read_b32 v57, a21
  v_mfma_f32_16x16x32_bf16 v[120:123], a[148:151], a[92:95], v[120:123]
  v_accvgpr_read_b32 v58, a22
  v_accvgpr_read_b32 v59, a23
  v_mfma_f32_16x16x32_bf16 v[120:123], a[144:147], a[88:91], v[120:123]
  v_cvt_pk_bf16_f32 v62, v56, v57
  v_cvt_pk_bf16_f32 v63, v58, v59
  v_mfma_f32_16x16x32_bf16 v[116:119], a[136:139], a[88:91], v[116:119]
  buffer_store_dwordx4 v[60:63], v9, s[12:15], s38 offen offset:0 sc1
  v_accvgpr_read_b32 v52, a24
  v_accvgpr_read_b32 v53, a25
  v_accvgpr_read_b32 v54, a26
  v_mfma_f32_16x16x32_bf16 v[116:119], a[140:143], a[92:95], v[116:119]
  v_accvgpr_read_b32 v55, a27
  v_cvt_pk_bf16_f32 v32, v52, v53
  v_mfma_f32_16x16x32_bf16 v[112:115], a[132:135], a[92:95], v[112:115]
  v_cvt_pk_bf16_f32 v33, v54, v55
  v_accvgpr_read_b32 v56, a28
  v_mfma_f32_16x16x32_bf16 v[112:115], a[128:131], a[88:91], v[112:115]
  s_waitcnt vmcnt(17) lgkmcnt(0)
  v_mfma_f32_16x16x32_bf16 v[128:131], a[128:131], a[96:99], v[128:131]
  s_barrier
  v_mfma_f32_16x16x32_bf16 v[128:131], a[132:135], a[100:103], v[128:131]
  v_accvgpr_read_b32 v57, a29
  v_accvgpr_read_b32 v58, a30
  v_mfma_f32_16x16x32_bf16 v[132:135], a[140:143], a[100:103], v[132:135]
  s_mov_b32 s24, 256
  v_accvgpr_read_b32 v59, a31
  v_cvt_pk_bf16_f32 v34, v56, v57
  v_mfma_f32_16x16x32_bf16 v[132:135], a[136:139], a[96:99], v[132:135]
  s_add_u32 m0, s31, 65536
  v_cvt_pk_bf16_f32 v35, v58, v59
  v_mfma_f32_16x16x32_bf16 v[136:139], a[144:147], a[96:99], v[136:139]
  buffer_load_dwordx4 v4, s[68:71], s24 offen lds
  v_mfma_f32_16x16x32_bf16 v[136:139], a[148:151], a[100:103], v[136:139]
  s_add_u32 m0, m0, 4096
  v_mfma_f32_16x16x32_bf16 v[140:143], a[156:159], a[100:103], v[140:143]
  s_add_u32 s24, s24, s30
  v_mfma_f32_16x16x32_bf16 v[140:143], a[152:155], a[96:99], v[140:143]
  buffer_store_dwordx4 v[32:35], v9, s[12:15], s38 offen offset:1024 sc1
  s_add_u32 s38, s38, s47
  v_accvgpr_read_b32 v52, a32
  v_accvgpr_read_b32 v53, a33
  v_mfma_f32_16x16x32_bf16 v[156:159], a[152:155], a[104:107], v[156:159]
  buffer_load_dwordx4 v4, s[68:71], s24 offen lds
  v_mfma_f32_16x16x32_bf16 v[156:159], a[156:159], a[108:111], v[156:159]
  s_add_u32 m0, m0, 4096
  v_accvgpr_read_b32 v54, a34
  v_accvgpr_read_b32 v55, a35
  v_mfma_f32_16x16x32_bf16 v[152:155], a[148:151], a[108:111], v[152:155]
  s_add_u32 s24, s24, s30
  v_cvt_pk_bf16_f32 v36, v52, v53
  v_cvt_pk_bf16_f32 v37, v54, v55
  v_mfma_f32_16x16x32_bf16 v[152:155], a[144:147], a[104:107], v[152:155]
  v_accvgpr_read_b32 v56, a36
  v_accvgpr_read_b32 v57, a37
  v_mfma_f32_16x16x32_bf16 v[148:151], a[136:139], a[104:107], v[148:151]
  buffer_load_dwordx4 v4, s[68:71], s24 offen lds
  v_mfma_f32_16x16x32_bf16 v[148:151], a[140:143], a[108:111], v[148:151]
  s_add_u32 m0, m0, 4096
  v_accvgpr_read_b32 v58, a38
  v_accvgpr_read_b32 v59, a39
  v_mfma_f32_16x16x32_bf16 v[144:147], a[132:135], a[108:111], v[144:147]
  s_add_u32 s24, s24, s30
  v_cvt_pk_bf16_f32 v38, v56, v57
  v_cvt_pk_bf16_f32 v39, v58, v59
  v_mfma_f32_16x16x32_bf16 v[144:147], a[128:131], a[104:107], v[144:147]
  v_cvt_pk_bf16_f32 v64, v64, v65
  v_cvt_pk_bf16_f32 v65, v66, v67
  v_mfma_f32_16x16x32_bf16 v[160:163], a[128:131], a[112:115], v[160:163]
  buffer_load_dwordx4 v4, s[68:71], s24 offen lds
  v_mfma_f32_16x16x32_bf16 v[160:163], a[132:135], a[116:119], v[160:163]
  s_add_u32 m0, m0, 4096
  v_cvt_pk_bf16_f32 v66, v68, v69
  v_cvt_pk_bf16_f32 v67, v70, v71
  v_mfma_f32_16x16x32_bf16 v[164:167], a[140:143], a[116:119], v[164:167]
  s_add_u32 s24, s24, s30
  v_cvt_pk_bf16_f32 v68, v72, v73
  v_cvt_pk_bf16_f32 v69, v74, v75
  v_mfma_f32_16x16x32_bf16 v[164:167], a[136:139], a[112:115], v[164:167]
  buffer_store_dwordx4 v[36:39], v9, s[12:15], s38 offen offset:0 sc1
  v_accvgpr_read_b32 v52, a40
  v_accvgpr_read_b32 v53, a41
  v_accvgpr_read_b32 v54, a42
  v_mfma_f32_16x16x32_bf16 v[168:171], a[144:147], a[112:115], v[168:171]
  buffer_load_dwordx4 v4, s[68:71], s24 offen lds
  v_mfma_f32_16x16x32_bf16 v[168:171], a[148:151], a[116:119], v[168:171]
  s_add_u32 m0, m0, 4096
  v_accvgpr_read_b32 v55, a43
  v_cvt_pk_bf16_f32 v60, v52, v53
  v_mfma_f32_16x16x32_bf16 v[172:175], a[156:159], a[116:119], v[172:175]
  s_add_u32 s24, s24, s30
  v_cvt_pk_bf16_f32 v61, v54, v55
  v_accvgpr_read_b32 v56, a44
  v_mfma_f32_16x16x32_bf16 v[172:175], a[152:155], a[112:115], v[172:175]
  v_accvgpr_read_b32 v57, a45
  v_accvgpr_read_b32 v58, a46
  v_mfma_f32_16x16x32_bf16 v[188:191], a[152:155], a[120:123], v[188:191]
  buffer_load_dwordx4 v4, s[68:71], s24 offen lds
  v_mfma_f32_16x16x32_bf16 v[188:191], a[156:159], a[124:127], v[188:191]
  s_add_u32 m0, m0, 4096
  v_accvgpr_read_b32 v59, a47
  v_cvt_pk_bf16_f32 v62, v56, v57
  v_mfma_f32_16x16x32_bf16 v[184:187], a[148:151], a[124:127], v[184:187]
  s_add_u32 s24, s24, s30
  v_cvt_pk_bf16_f32 v63, v58, v59
  v_cvt_pk_bf16_f32 v70, v76, v77
  v_mfma_f32_16x16x32_bf16 v[184:187], a[144:147], a[120:123], v[184:187]
  buffer_store_dwordx4 v[60:63], v9, s[12:15], s38 offen offset:1024 sc1
  s_add_u32 s38, s38, s47
  v_accvgpr_read_b32 v52, a48
  v_accvgpr_read_b32 v53, a49
  v_mfma_f32_16x16x32_bf16 v[180:183], a[136:139], a[120:123], v[180:183]
  buffer_load_dwordx4 v4, s[68:71], s24 offen lds
  v_mfma_f32_16x16x32_bf16 v[180:183], a[140:143], a[124:127], v[180:183]
  v_accvgpr_read_b32 v54, a50
  v_accvgpr_read_b32 v55, a51
  v_mfma_f32_16x16x32_bf16 v[176:179], a[132:135], a[124:127], v[176:179]
  v_cvt_pk_bf16_f32 v32, v52, v53
  v_cvt_pk_bf16_f32 v33, v54, v55
  v_mfma_f32_16x16x32_bf16 v[176:179], a[128:131], a[120:123], v[176:179]
  v_accvgpr_read_b32 v56, a52
  v_accvgpr_read_b32 v57, a53
  v_mfma_f32_16x16x32_bf16 v[192:195], a[160:163], a[96:99], v[192:195]
  v_accvgpr_read_b32 v58, a54
  v_accvgpr_read_b32 v59, a55
  v_mfma_f32_16x16x32_bf16 v[192:195], a[164:167], a[100:103], v[192:195]
  v_cvt_pk_bf16_f32 v34, v56, v57
  v_cvt_pk_bf16_f32 v35, v58, v59
  v_mfma_f32_16x16x32_bf16 v[196:199], a[172:175], a[100:103], v[196:199]
  v_cvt_pk_bf16_f32 v71, v78, v79
  v_cvt_pk_bf16_f32 v72, v80, v81
  v_mfma_f32_16x16x32_bf16 v[196:199], a[168:171], a[96:99], v[196:199]
  v_cvt_pk_bf16_f32 v73, v82, v83
  v_cvt_pk_bf16_f32 v74, v84, v85
  v_mfma_f32_16x16x32_bf16 v[200:203], a[176:179], a[96:99], v[200:203]
  buffer_store_dwordx4 v[32:35], v9, s[12:15], s38 offen offset:0 sc1
  v_accvgpr_read_b32 v52, a56
  v_accvgpr_read_b32 v53, a57
  v_accvgpr_read_b32 v54, a58
  v_mfma_f32_16x16x32_bf16 v[200:203], a[180:183], a[100:103], v[200:203]
  v_accvgpr_read_b32 v55, a59
  v_cvt_pk_bf16_f32 v36, v52, v53
  v_mfma_f32_16x16x32_bf16 v[204:207], a[188:191], a[100:103], v[204:207]
  v_cvt_pk_bf16_f32 v37, v54, v55
  v_accvgpr_read_b32 v56, a60
  v_mfma_f32_16x16x32_bf16 v[204:207], a[184:187], a[96:99], v[204:207]
  v_accvgpr_read_b32 v57, a61
  v_accvgpr_read_b32 v58, a62
  v_mfma_f32_16x16x32_bf16 v[220:223], a[184:187], a[104:107], v[220:223]
  v_accvgpr_read_b32 v59, a63
  v_cvt_pk_bf16_f32 v38, v56, v57
  v_mfma_f32_16x16x32_bf16 v[220:223], a[188:191], a[108:111], v[220:223]
  v_cvt_pk_bf16_f32 v39, v58, v59
  v_cvt_pk_bf16_f32 v75, v86, v87
  v_mfma_f32_16x16x32_bf16 v[216:219], a[180:183], a[108:111], v[216:219]
  v_cvt_pk_bf16_f32 v76, v88, v89
  v_cvt_pk_bf16_f32 v77, v90, v91
  v_mfma_f32_16x16x32_bf16 v[216:219], a[176:179], a[104:107], v[216:219]
  v_cvt_pk_bf16_f32 v78, v92, v93
  v_cvt_pk_bf16_f32 v79, v94, v95
  v_mfma_f32_16x16x32_bf16 v[212:215], a[168:171], a[104:107], v[212:215]
  v_cvt_pk_bf16_f32 v80, v96, v97
  v_cvt_pk_bf16_f32 v81, v98, v99
  v_mfma_f32_16x16x32_bf16 v[212:215], a[172:175], a[108:111], v[212:215]
  v_cvt_pk_bf16_f32 v82, v100, v101
  v_cvt_pk_bf16_f32 v83, v102, v103
  v_mfma_f32_16x16x32_bf16 v[208:211], a[164:167], a[108:111], v[208:211]
  buffer_store_dwordx4 v[36:39], v9, s[12:15], s38 offen offset:1024 sc1
  s_add_u32 s38, s38, s47
  v_cvt_pk_bf16_f32 v84, v104, v105
  v_cvt_pk_bf16_f32 v85, v106, v107
  v_mfma_f32_16x16x32_bf16 v[208:211], a[160:163], a[104:107], v[208:211]
  v_cvt_pk_bf16_f32 v86, v108, v109
  v_cvt_pk_bf16_f32 v87, v110, v111
  v_mfma_f32_16x16x32_bf16 v[224:227], a[160:163], a[112:115], v[224:227]
  v_cvt_pk_bf16_f32 v88, v112, v113
  v_cvt_pk_bf16_f32 v89, v114, v115
  v_mfma_f32_16x16x32_bf16 v[224:227], a[164:167], a[116:119], v[224:227]
  v_cvt_pk_bf16_f32 v90, v116, v117
  v_cvt_pk_bf16_f32 v91, v118, v119
  v_mfma_f32_16x16x32_bf16 v[228:231], a[172:175], a[116:119], v[228:231]
  s_nop 0
  ds_read_b64_tr_b16 a[0:1], v28 offset:0
  ds_read_b64_tr_b16 a[2:3], v28 offset:2048
  v_mfma_f32_16x16x32_bf16 v[228:231], a[168:171], a[112:115], v[228:231]
  s_nop 0
  ds_read_b64_tr_b16 a[4:5], v28 offset:4096
  ds_read_b64_tr_b16 a[6:7], v28 offset:6144
  v_mfma_f32_16x16x32_bf16 v[232:235], a[176:179], a[112:115], v[232:235]
  ds_read_b64_tr_b16 a[8:9], v28 offset:8192
  v_cvt_pk_bf16_f32 v92, v120, v121
  v_mfma_f32_16x16x32_bf16 v[232:235], a[180:183], a[116:119], v[232:235]
  s_nop 0
  ds_read_b64_tr_b16 a[10:11], v28 offset:10240
  ds_read_b64_tr_b16 a[12:13], v28 offset:12288
  v_mfma_f32_16x16x32_bf16 v[236:239], a[188:191], a[116:119], v[236:239]
  ds_read_b64_tr_b16 a[14:15], v28 offset:14336
  v_cvt_pk_bf16_f32 v93, v122, v123
  v_mfma_f32_16x16x32_bf16 v[236:239], a[184:187], a[112:115], v[236:239]
  s_nop 0
  ds_read_b64_tr_b16 a[16:17], v28 offset:16384
  ds_read_b64_tr_b16 a[18:19], v28 offset:18432
  v_mfma_f32_16x16x32_bf16 v[252:255], a[184:187], a[120:123], v[252:255]
  ds_read_b64_tr_b16 a[20:21], v28 offset:20480
  v_cvt_pk_bf16_f32 v94, v124, v125
  v_mfma_f32_16x16x32_bf16 v[252:255], a[188:191], a[124:127], v[252:255]
  s_nop 0
  ds_read_b64_tr_b16 a[22:23], v28 offset:22528
  ds_read_b64_tr_b16 a[24:25], v28 offset:24576
  v_mfma_f32_16x16x32_bf16 v[248:251], a[180:183], a[124:127], v[248:251]
  s_nop 0
  ds_read_b64_tr_b16 a[26:27], v28 offset:26624
  ds_read_b64_tr_b16 a[28:29], v29 offset:0
  v_mfma_f32_16x16x32_bf16 v[248:251], a[176:179], a[120:123], v[248:251]
  ds_read_b64_tr_b16 a[30:31], v29 offset:2048
  v_cvt_pk_bf16_f32 v95, v126, v127
  v_mfma_f32_16x16x32_bf16 v[244:247], a[168:171], a[120:123], v[244:247]
  s_nop 0
  ds_read_b64_tr_b16 a[32:33], v29 offset:4096
  ds_read_b64_tr_b16 a[34:35], v29 offset:6144
  v_mfma_f32_16x16x32_bf16 v[244:247], a[172:175], a[124:127], v[244:247]
  ds_read_b64_tr_b16 a[36:37], v29 offset:8192
  v_cvt_pk_bf16_f32 v96, v128, v129
  v_mfma_f32_16x16x32_bf16 v[240:243], a[164:167], a[124:127], v[240:243]
  s_nop 0
  ds_read_b64_tr_b16 a[38:39], v29 offset:10240
  ds_read_b64_tr_b16 a[40:41], v29 offset:12288
  v_mfma_f32_16x16x32_bf16 v[240:243], a[160:163], a[120:123], v[240:243]
  s_waitcnt vmcnt(15)
  ds_read_b64_tr_b16 a[42:43], v29 offset:14336
  v_cvt_pk_bf16_f32 v97, v130, v131
  v_cvt_pk_bf16_f32 v98, v132, v133
  v_cvt_pk_bf16_f32 v99, v134, v135
  v_cvt_pk_bf16_f32 v100, v136, v137
  v_cvt_pk_bf16_f32 v101, v138, v139
  v_cvt_pk_bf16_f32 v102, v140, v141
  v_cvt_pk_bf16_f32 v103, v142, v143
  v_cvt_pk_bf16_f32 v104, v144, v145
  v_cvt_pk_bf16_f32 v105, v146, v147
  v_cvt_pk_bf16_f32 v106, v148, v149
  v_cvt_pk_bf16_f32 v107, v150, v151
  v_cvt_pk_bf16_f32 v108, v152, v153
  v_cvt_pk_bf16_f32 v109, v154, v155
  v_cvt_pk_bf16_f32 v110, v156, v157
  v_cvt_pk_bf16_f32 v111, v158, v159
  s_branch KV_J
KV_V:
  v_mfma_f32_16x16x32_bf16 a[0:3], a[64:67], a[128:131], 0
  s_barrier
  v_mfma_f32_16x16x32_bf16 a[0:3], a[68:71], a[132:135], a[0:3]
  s_add_u32 m0, s27, 98304
  ds_read_b64_tr_b16 a[160:161], v44 offset:32768
  v_lshlrev_b32 v10, 16, v52
  v_mfma_f32_16x16x32_bf16 a[16:19], a[68:71], a[140:143], 0
  buffer_load_dwordx4 v32, s[4:7], s24 offen offset:0 lds
  v_mfma_f32_16x16x32_bf16 a[16:19], a[64:67], a[136:139], a[16:19]
  s_mov_b64 s[72:73], s[16:17]
  ds_read_b64_tr_b16 a[162:163], v44 offset:33792
  v_and_b32 v11, 0xffff0000, v52
  v_mfma_f32_16x16x32_bf16 a[32:35], a[64:67], a[144:147], 0
  s_mov_b32 s74, 256
  ds_read_b64_tr_b16 a[164:165], v44 offset:40960
  v_lshlrev_b32 v12, 16, v53
  v_mfma_f32_16x16x32_bf16 a[32:35], a[68:71], a[148:151], a[32:35]
  s_mov_b32 s75, 0x20000
  ds_read_b64_tr_b16 a[166:167], v44 offset:41984
  v_and_b32 v13, 0xffff0000, v53
  v_mfma_f32_16x16x32_bf16 a[48:51], a[68:71], a[156:159], 0
  buffer_load_dwordx4 v33, s[4:7], s24 offen offset:1024 lds
  v_mfma_f32_16x16x32_bf16 a[48:51], a[64:67], a[152:155], a[48:51]
  s_mov_b32 s70, 3670016
  ds_read_b64_tr_b16 a[168:169], v45 offset:32768
  v_lshlrev_b32 v14, 16, v54
  v_mfma_f32_16x16x32_bf16 a[52:55], a[72:75], a[152:155], 0
  s_mov_b32 s71, 0x20000
  ds_read_b64_tr_b16 a[170:171], v45 offset:33792
  v_and_b32 v15, 0xffff0000, v54
  v_mfma_f32_16x16x32_bf16 a[52:55], a[76:79], a[156:159], a[52:55]
  s_sub_u32 s61, 15, s23
  ds_read_b64_tr_b16 a[172:173], v45 offset:40960
  v_lshlrev_b32 v16, 16, v55
  v_mfma_f32_16x16x32_bf16 a[36:39], a[76:79], a[148:151], 0
  buffer_load_dwordx4 v34, s[4:7], s24 offen offset:2048 lds
  v_mfma_f32_16x16x32_bf16 a[36:39], a[72:75], a[144:147], a[36:39]
  s_cmp_eq_u32 s22, 0
  s_cselect_b32 s40, s23, s61
  s_cselect_b32 s62, 0, 0
  ds_read_b64_tr_b16 a[174:175], v45 offset:41984
  v_and_b32 v17, 0xffff0000, v55
  v_mfma_f32_16x16x32_bf16 a[20:23], a[72:75], a[136:139], 0
  s_xor_b32 s17, s21, s62
  ds_read_b64_tr_b16 a[176:177], v46 offset:32768
  v_lshlrev_b32 v18, 16, v56
  v_mfma_f32_16x16x32_bf16 a[20:23], a[76:79], a[140:143], a[20:23]
  s_lshl_b32 s62, s62, 14
  ds_read_b64_tr_b16 a[178:179], v46 offset:33792
  v_and_b32 v19, 0xffff0000, v56
  v_mfma_f32_16x16x32_bf16 a[4:7], a[76:79], a[132:135], 0
  buffer_load_dwordx4 v35, s[4:7], s24 offen offset:3072 lds
  v_mfma_f32_16x16x32_bf16 a[4:7], a[72:75], a[128:131], a[4:7]
  s_add_u32 s24, s24, 4292870272
  ds_read_b64_tr_b16 a[180:181], v46 offset:40960
  v_lshlrev_b32 v20, 16, v57
  v_mfma_f32_16x16x32_bf16 a[8:11], a[80:83], a[128:131], 0
  s_lshl_b32 s56, s21, 14
  ds_read_b64_tr_b16 a[182:183], v46 offset:41984
  v_and_b32 v21, 0xffff0000, v57
  v_mfma_f32_16x16x32_bf16 a[8:11], a[84:87], a[132:135], a[8:11]
  s_add_u32 m0, s27, 114688
  ds_read_b64_tr_b16 a[184:185], v47 offset:32768
  v_lshlrev_b32 v22, 16, v58
  v_mfma_f32_16x16x32_bf16 a[24:27], a[84:87], a[140:143], 0
  buffer_load_dwordx4 v36, s[8:11], s25 offen offset:0 lds
  v_mfma_f32_16x16x32_bf16 a[24:27], a[80:83], a[136:139], a[24:27]
  s_add_u32 s56, s56, 44564480
  ds_read_b64_tr_b16 a[186:187], v47 offset:33792
  v_and_b32 v23, 0xffff0000, v58
  v_mfma_f32_16x16x32_bf16 a[40:43], a[80:83], a[144:147], 0
  s_lshr_b32 s60, s2, 4
  ds_read_b64_tr_b16 a[188:189], v47 offset:40960
  v_lshlrev_b32 v24, 16, v59
  v_mfma_f32_16x16x32_bf16 a[40:43], a[84:87], a[148:151], a[40:43]
  s_lshl_b32 s60, s60, 7
  ds_read_b64_tr_b16 a[190:191], v47 offset:41984
  v_and_b32 v25, 0xffff0000, v59
  v_mfma_f32_16x16x32_bf16 a[56:59], a[84:87], a[156:159], 0
  buffer_load_dwordx4 v37, s[8:11], s25 offen offset:1024 lds
  v_mfma_f32_16x16x32_bf16 a[56:59], a[80:83], a[152:155], a[56:59]
  s_lshl_b32 s61, s20, 7
  v_add_f32 v60, v10, v11
  v_mul_f32 v62, v10, v10
  v_mfma_f32_16x16x32_bf16 a[60:63], a[88:91], a[152:155], 0
  s_add_u32 s66, s60, s56
  v_fmac_f32 v62, v11, v11
  v_add_f32 v60, v60, v12
  v_mfma_f32_16x16x32_bf16 a[60:63], a[92:95], a[156:159], a[60:63]
  s_cmp_eq_u32 s20, 0
  s_cselect_b32 s66, s66, 268435456
  v_fmac_f32 v62, v12, v12
  v_add_f32 v60, v60, v13
  v_mfma_f32_16x16x32_bf16 a[44:47], a[92:95], a[148:151], 0
  buffer_load_dwordx4 v38, s[8:11], s25 offen offset:2048 lds
  v_mfma_f32_16x16x32_bf16 a[44:47], a[88:91], a[144:147], a[44:47]
  s_lshl_b32 s60, s23, 9
  v_fmac_f32 v62, v13, v13
  v_add_f32 v60, v60, v14
  v_mfma_f32_16x16x32_bf16 a[28:31], a[88:91], a[136:139], 0
  s_add_u32 s60, s60, s61
  v_fmac_f32 v62, v14, v14
  v_add_f32 v60, v60, v15
  v_mfma_f32_16x16x32_bf16 a[28:31], a[92:95], a[140:143], a[28:31]
  s_add_u32 s60, s60, s56
  v_fmac_f32 v62, v15, v15
  v_add_f32 v60, v60, v16
  v_mfma_f32_16x16x32_bf16 a[12:15], a[92:95], a[132:135], 0
  buffer_load_dwordx4 v39, s[8:11], s25 offen offset:3072 lds
  v_mfma_f32_16x16x32_bf16 a[12:15], a[88:91], a[128:131], a[12:15]
  s_waitcnt lgkmcnt(0)
  s_add_u32 s25, s25, 524160
  ds_read_b128 a[96:99], v40 offset:32768
  v_mfma_f32_16x16x32_bf16 v[64:67], a[64:67], a[160:163], 0
  s_xor_b32 s60, s60, s62
  v_fmac_f32 v62, v16, v16
  v_add_f32 v60, v60, v17
  v_mfma_f32_16x16x32_bf16 v[64:67], a[68:71], a[164:167], v[64:67]
  s_add_u32 m0, s27, 0
  ds_read_b128 a[100:103], v41 offset:32768
  v_fmac_f32 v62, v17, v17
  v_mfma_f32_16x16x32_bf16 v[80:83], a[68:71], a[172:175], 0
  buffer_load_dwordx4 v32, s[4:7], s24 offen offset:0 lds
  v_mfma_f32_16x16x32_bf16 v[80:83], a[64:67], a[168:171], v[80:83]
  s_add_u32 s60, s60, 8192
  ds_read_b128 a[104:107], v40 offset:34816
  v_add_f32 v61, v18, v19
  v_mfma_f32_16x16x32_bf16 v[96:99], a[64:67], a[176:179], 0
  s_add_u32 s61, s60, 4096
  v_mul_f32 v63, v18, v18
  v_fmac_f32 v63, v19, v19
  v_mfma_f32_16x16x32_bf16 v[96:99], a[68:71], a[180:183], v[96:99]
  s_cmp_eq_u32 s22, 0
  s_cselect_b32 s67, s61, s60
  s_cselect_b32 s51, s60, s61
  ds_read_b128 a[108:111], v41 offset:34816
  v_add_f32 v61, v61, v20
  v_mfma_f32_16x16x32_bf16 v[112:115], a[68:71], a[188:191], 0
  buffer_load_dwordx4 v33, s[4:7], s24 offen offset:1024 lds
  v_mfma_f32_16x16x32_bf16 v[112:115], a[64:67], a[184:187], v[112:115]
  s_lshl_b32 s61, s20, 9
  ds_read_b128 a[112:115], v40 offset:36864
  v_fmac_f32 v63, v20, v20
  v_mfma_f32_16x16x32_bf16 v[116:119], a[72:75], a[184:187], 0
  s_add_u32 s56, s56, s61
  v_add_f32 v61, v61, v21
  v_fmac_f32 v63, v21, v21
  v_mfma_f32_16x16x32_bf16 v[116:119], a[76:79], a[188:191], v[116:119]
  ds_read_b128 a[116:119], v41 offset:36864
  v_add_f32 v61, v61, v22
  v_mfma_f32_16x16x32_bf16 v[100:103], a[76:79], a[180:183], 0
  buffer_load_dwordx4 v34, s[4:7], s24 offen offset:2048 lds
  v_mfma_f32_16x16x32_bf16 v[100:103], a[72:75], a[176:179], v[100:103]
  ds_read_b128 a[120:123], v40 offset:38912
  v_fmac_f32 v63, v22, v22
  v_mfma_f32_16x16x32_bf16 v[84:87], a[72:75], a[168:171], 0
  v_add_f32 v61, v61, v23
  v_fmac_f32 v63, v23, v23
  v_mfma_f32_16x16x32_bf16 v[84:87], a[76:79], a[172:175], v[84:87]
  ds_read_b128 a[124:127], v41 offset:38912
  v_add_f32 v61, v61, v24
  v_mfma_f32_16x16x32_bf16 v[68:71], a[76:79], a[164:167], 0
  buffer_load_dwordx4 v35, s[4:7], s24 offen offset:3072 lds
  v_mfma_f32_16x16x32_bf16 v[68:71], a[72:75], a[160:163], v[68:71]
  s_add_u32 s24, s24, 2097152
  v_fmac_f32 v63, v24, v24
  v_add_f32 v61, v61, v25
  v_mfma_f32_16x16x32_bf16 v[72:75], a[80:83], a[160:163], 0
  v_fmac_f32 v63, v25, v25
  v_mov_b32 v5, 0x7fff0000
  v_mfma_f32_16x16x32_bf16 v[72:75], a[84:87], a[164:167], v[72:75]
  s_add_u32 m0, s27, 16384
  v_mfma_f32_16x16x32_bf16 v[88:91], a[84:87], a[172:175], 0
  buffer_load_dwordx4 v36, s[8:11], s25 offen offset:0 lds
  v_mfma_f32_16x16x32_bf16 v[88:91], a[80:83], a[168:171], v[88:91]
  s_lshl_b64 exec, 0xff, 0
  v_mov_b32 v5, s66
  s_mov_b64 exec, -1
  v_add_f32_dpp v60, v60, v60 quad_perm:[1,0,3,2] row_mask:0xf bank_mask:0xf
  v_add_f32_dpp v61, v61, v61 quad_perm:[1,0,3,2] row_mask:0xf bank_mask:0xf
  v_mfma_f32_16x16x32_bf16 v[104:107], a[80:83], a[176:179], 0
  s_lshl_b64 exec, 0xff, 8
  v_mov_b32 v5, s67
  s_mov_b64 exec, -1
  v_add_f32_dpp v62, v62, v62 quad_perm:[1,0,3,2] row_mask:0xf bank_mask:0xf
  v_add_f32_dpp v63, v63, v63 quad_perm:[1,0,3,2] row_mask:0xf bank_mask:0xf
  v_mfma_f32_16x16x32_bf16 v[104:107], a[84:87], a[180:183], v[104:107]
  s_add_u32 s60, s66, 2048
  v_add_f32_dpp v60, v60, v60 quad_perm:[2,3,0,1] row_mask:0xf bank_mask:0xf
  v_add_f32_dpp v61, v61, v61 quad_perm:[2,3,0,1] row_mask:0xf bank_mask:0xf
  v_mfma_f32_16x16x32_bf16 v[120:123], a[84:87], a[188:191], 0
  buffer_load_dwordx4 v37, s[8:11], s25 offen offset:1024 lds
  v_mfma_f32_16x16x32_bf16 v[120:123], a[80:83], a[184:187], v[120:123]
  s_lshl_b64 exec, 0xff, 32
  v_mov_b32 v5, s60
  s_mov_b64 exec, -1
  v_add_f32_dpp v62, v62, v62 quad_perm:[2,3,0,1] row_mask:0xf bank_mask:0xf
  v_add_f32_dpp v63, v63, v63 quad_perm:[2,3,0,1] row_mask:0xf bank_mask:0xf
  v_mfma_f32_16x16x32_bf16 v[124:127], a[88:91], a[184:187], 0
  s_lshl_b32 s60, s40, 2
  v_add_f32_dpp v60, v60, v60 row_half_mirror row_mask:0xf bank_mask:0xf
  v_add_f32_dpp v61, v61, v61 row_half_mirror row_mask:0xf bank_mask:0xf
  v_mfma_f32_16x16x32_bf16 v[124:127], a[92:95], a[188:191], v[124:127]
  s_add_u32 s60, s60, s20
  v_add_f32_dpp v62, v62, v62 row_half_mirror row_mask:0xf bank_mask:0xf
  v_add_f32_dpp v63, v63, v63 row_half_mirror row_mask:0xf bank_mask:0xf
  v_mfma_f32_16x16x32_bf16 v[108:111], a[92:95], a[180:183], 0
  buffer_load_dwordx4 v38, s[8:11], s25 offen offset:2048 lds
  v_mfma_f32_16x16x32_bf16 v[108:111], a[88:91], a[176:179], v[108:111]
  s_lshl_b32 s60, s60, 4
  v_add_f32_dpp v60, v60, v60 row_mirror row_mask:0xf bank_mask:0xf
  v_add_f32_dpp v61, v61, v61 row_mirror row_mask:0xf bank_mask:0xf
  v_mfma_f32_16x16x32_bf16 v[92:95], a[88:91], a[168:171], 0
  s_add_u32 s60, s60, s21
  v_add_f32_dpp v62, v62, v62 row_mirror row_mask:0xf bank_mask:0xf
  v_add_f32_dpp v63, v63, v63 row_mirror row_mask:0xf bank_mask:0xf
  v_mfma_f32_16x16x32_bf16 v[92:95], a[92:95], a[172:175], v[92:95]
  s_lshl_b32 s60, s60, 7
  v_mov_b32 v26, v60
  v_mov_b32 v28, v61
  v_mfma_f32_16x16x32_bf16 v[76:79], a[92:95], a[164:167], 0
  buffer_load_dwordx4 v39, s[8:11], s25 offen offset:3072 lds
  v_mfma_f32_16x16x32_bf16 v[76:79], a[88:91], a[160:163], v[76:79]
  s_add_u32 s25, s25, 128
  s_waitcnt vmcnt(16) lgkmcnt(0)
  v_mfma_f32_16x16x32_bf16 v[128:131], a[96:99], a[160:163], 0
  s_barrier
  v_mfma_f32_16x16x32_bf16 v[128:131], a[100:103], a[164:167], v[128:131]
  s_add_u32 s60, s60, 94371840
  ds_read_b128 a[64:67], v42 offset:0
  v_mov_b32 v29, v62
  v_mfma_f32_16x16x32_bf16 v[144:147], a[100:103], a[172:175], 0
  s_add_u32 m0, s27, 32768
  v_mov_b32 v30, v63
  v_mfma_f32_16x16x32_bf16 v[144:147], a[96:99], a[168:171], v[144:147]
  buffer_load_dwordx4 v32, s[4:7], s24 offen offset:0 lds
  v_mfma_f32_16x16x32_bf16 v[160:163], a[96:99], a[176:179], 0
  s_lshl_b64 exec, 0xff, 16
  v_mov_b32 v5, s60
  s_mov_b64 exec, -1
  ds_read_b128 a[68:71], v43 offset:0
  v_mfma_f32_16x16x32_bf16 v[160:163], a[100:103], a[180:183], v[160:163]
  s_lshl_b32 s60, s20, 8
  v_permlane16_swap_b32 v60, v26
  v_mfma_f32_16x16x32_bf16 v[176:179], a[100:103], a[188:191], 0
  s_add_u32 s60, s60, s2
  ds_read_b128 a[72:75], v42 offset:2048
  v_mfma_f32_16x16x32_bf16 v[176:179], a[96:99], a[184:187], v[176:179]
  s_lshl_b32 s61, s60, 7
  v_permlane16_swap_b32 v61, v28
  v_mfma_f32_16x16x32_bf16 v[180:183], a[104:107], a[184:187], 0
  buffer_load_dwordx4 v33, s[4:7], s24 offen offset:1024 lds
  v_mfma_f32_16x16x32_bf16 v[180:183], a[108:111], a[188:191], v[180:183]
  s_add_u32 s61, s61, 94502912
  ds_read_b128 a[76:79], v43 offset:2048
  v_mfma_f32_16x16x32_bf16 v[164:167], a[108:111], a[180:183], 0
  s_cmp_lt_u32 s60, 480
  s_cselect_b32 s61, s61, 0x7fff0000
  v_permlane16_swap_b32 v62, v29
  v_mfma_f32_16x16x32_bf16 v[164:167], a[104:107], a[176:179], v[164:167]
  s_lshl_b64 exec, 0xff, 24
  v_mov_b32 v5, s61
  s_mov_b64 exec, -1
  ds_read_b128 a[80:83], v42 offset:4096
  v_mfma_f32_16x16x32_bf16 v[148:151], a[104:107], a[168:171], 0
  s_lshl_b32 s61, s60, 13
  v_permlane16_swap_b32 v63, v30
  v_mfma_f32_16x16x32_bf16 v[148:151], a[108:111], a[172:175], v[148:151]
  buffer_load_dwordx4 v34, s[4:7], s24 offen offset:2048 lds
  v_mfma_f32_16x16x32_bf16 v[132:135], a[108:111], a[164:167], 0
  s_add_u32 s80, s68, s61
  s_addc_u32 s81, s69, 0
  ds_read_b128 a[84:87], v43 offset:4096
  v_add_f32 v60, v60, v26
  v_mfma_f32_16x16x32_bf16 v[132:135], a[104:107], a[160:163], v[132:135]
  s_mov_b32 s83, 0x20000
  v_add_f32 v61, v61, v28
  v_add_f32 v62, v62, v29
  v_mfma_f32_16x16x32_bf16 v[136:139], a[112:115], a[160:163], 0
  s_mul_i32 s33, s60, 11
  ds_read_b128 a[88:91], v42 offset:6144
  v_add_f32 v63, v63, v30
  v_mfma_f32_16x16x32_bf16 v[136:139], a[116:119], a[164:167], v[136:139]
  s_lshr_b32 s33, s33, 10
  v_mov_b32 v26, v60
  v_mov_b32 v28, v61
  v_mfma_f32_16x16x32_bf16 v[152:155], a[116:119], a[172:175], 0
  buffer_load_dwordx4 v35, s[4:7], s24 offen offset:3072 lds
  v_mfma_f32_16x16x32_bf16 v[152:155], a[112:115], a[168:171], v[152:155]
  s_add_u32 s24, s24, 4292870272
  ds_read_b128 a[92:95], v43 offset:6144
  v_mov_b32 v29, v62
  v_mfma_f32_16x16x32_bf16 v[168:171], a[112:115], a[176:179], 0
  s_sub_u32 s33, 6, s33
  v_mov_b32 v30, v63
  v_mfma_f32_16x16x32_bf16 v[168:171], a[116:119], a[180:183], v[168:171]
  s_cmp_ge_u32 s60, 448
  s_cmov_b32 s33, 99
  v_permlane32_swap_b32 v60, v26
  v_mfma_f32_16x16x32_bf16 v[184:187], a[116:119], a[188:191], 0
  s_add_u32 m0, s27, 49152
  v_permlane32_swap_b32 v61, v28
  v_mfma_f32_16x16x32_bf16 v[184:187], a[112:115], a[184:187], v[184:187]
  buffer_load_dwordx4 v36, s[8:11], s25 offen offset:0 lds
  v_mfma_f32_16x16x32_bf16 v[188:191], a[120:123], a[184:187], 0
  s_bfe_u32 s64, s2, 0x20003
  v_permlane32_swap_b32 v62, v29
  v_mfma_f32_16x16x32_bf16 v[188:191], a[124:127], a[188:191], v[188:191]
  s_sub_u32 s64, 5, s64
  v_permlane32_swap_b32 v63, v30
  v_mfma_f32_16x16x32_bf16 v[172:175], a[124:127], a[180:183], 0
  s_cmp_eq_u32 s20, 0
  s_cselect_b32 s64, s64, 99
  v_add_f32 v60, v60, v26
  v_add_f32 v61, v61, v28
  v_mfma_f32_16x16x32_bf16 v[172:175], a[120:123], a[176:179], v[172:175]
  s_lshl_b32 s65, s21, 2
  v_add_f32 v62, v62, v29
  v_add_f32 v63, v63, v30
  v_mfma_f32_16x16x32_bf16 v[156:159], a[120:123], a[168:171], 0
  buffer_load_dwordx4 v37, s[8:11], s25 offen offset:1024 lds
  v_mfma_f32_16x16x32_bf16 v[156:159], a[124:127], a[172:175], v[156:159]
  s_lshr_b32 s63, s2, 1
  v_mul_f32 v60, 0x3b124925, v60
  v_mul_f32 v62, 0x3b124925, v62
  v_mfma_f32_16x16x32_bf16 v[140:143], a[124:127], a[164:167], 0
  s_mul_i32 s63, s63, 14336
  v_fma_f32 v62, -v60, v60, v62
  v_max_f32 v62, 0, v62
  v_mfma_f32_16x16x32_bf16 v[140:143], a[120:123], a[160:163], v[140:143]
  s_and_b32 s60, s2, 1
  v_add_f32 v62, 0x3727c5ac, v62
  v_mfma_f32_16x16x32_bf16 v[192:195], a[96:99], a[128:131], 0
  s_lshl_b32 s60, s60, 7
  ds_read_b64_tr_b16 a[160:161], v48 offset:0
  v_mfma_f32_16x16x32_bf16 v[192:195], a[100:103], a[132:135], v[192:195]
  buffer_load_dwordx4 v38, s[8:11], s25 offen offset:2048 lds
  v_mfma_f32_16x16x32_bf16 v[208:211], a[100:103], a[140:143], 0
  s_add_u32 s63, s63, s60
  ds_read_b64_tr_b16 a[162:163], v48 offset:1024
  v_mfma_f32_16x16x32_bf16 v[208:211], a[96:99], a[136:139], v[208:211]
  s_add_u32 s63, s63, 33554432
  ds_read_b64_tr_b16 a[164:165], v48 offset:8192
  v_mfma_f32_16x16x32_bf16 v[224:227], a[96:99], a[144:147], 0
  s_mov_b32 s26, 6
  ds_read_b64_tr_b16 a[166:167], v48 offset:9216
  v_and_b32 v6, 7, v1
  v_mfma_f32_16x16x32_bf16 v[224:227], a[100:103], a[148:151], v[224:227]
  ds_read_b64_tr_b16 a[168:169], v49 offset:0
  v_lshl_add_u32 v5, v6, 4, v5
  v_mfma_f32_16x16x32_bf16 v[240:243], a[100:103], a[156:159], 0
  buffer_load_dwordx4 v39, s[8:11], s25 offen offset:3072 lds
  v_mfma_f32_16x16x32_bf16 v[240:243], a[96:99], a[152:155], v[240:243]
  s_add_u32 s25, s25, 524160
  ds_read_b64_tr_b16 a[170:171], v49 offset:1024
  v_mfma_f32_16x16x32_bf16 v[244:247], a[104:107], a[152:155], 0
  ds_read_b64_tr_b16 a[172:173], v49 offset:8192
  v_mfma_f32_16x16x32_bf16 v[244:247], a[108:111], a[156:159], v[244:247]
  ds_read_b64_tr_b16 a[174:175], v49 offset:9216
  v_mfma_f32_16x16x32_bf16 v[228:231], a[108:111], a[148:151], 0
  ds_read_b64_tr_b16 a[176:177], v50 offset:0
  v_mfma_f32_16x16x32_bf16 v[228:231], a[104:107], a[144:147], v[228:231]
  ds_read_b64_tr_b16 a[178:179], v50 offset:1024
  v_mfma_f32_16x16x32_bf16 v[212:215], a[104:107], a[136:139], 0
  ds_read_b64_tr_b16 a[180:181], v50 offset:8192
  v_mfma_f32_16x16x32_bf16 v[212:215], a[108:111], a[140:143], v[212:215]
  ds_read_b64_tr_b16 a[182:183], v50 offset:9216
  v_mfma_f32_16x16x32_bf16 v[196:199], a[108:111], a[132:135], 0
  ds_read_b64_tr_b16 a[184:185], v51 offset:0
  v_mfma_f32_16x16x32_bf16 v[196:199], a[104:107], a[128:131], v[196:199]
  ds_read_b64_tr_b16 a[186:187], v51 offset:1024
  v_mfma_f32_16x16x32_bf16 v[200:203], a[112:115], a[128:131], 0
  ds_read_b64_tr_b16 a[188:189], v51 offset:8192
  v_mfma_f32_16x16x32_bf16 v[200:203], a[116:119], a[132:135], v[200:203]
  ds_read_b64_tr_b16 a[190:191], v51 offset:9216
  v_mfma_f32_16x16x32_bf16 v[216:219], a[116:119], a[140:143], 0
  v_rsq_f32 v62, v62
  v_mfma_f32_16x16x32_bf16 v[216:219], a[112:115], a[136:139], v[216:219]
  v_mul_f32 v62, 0x3db8aa3b, v62
  v_sub_f32 v10, v10, v60
  v_mfma_f32_16x16x32_bf16 v[232:235], a[112:115], a[144:147], 0
  v_mul_f32 v10, v10, v62
  v_sub_f32 v11, v11, v60
  v_mfma_f32_16x16x32_bf16 v[232:235], a[116:119], a[148:151], v[232:235]
  v_mul_f32 v11, v11, v62
  v_sub_f32 v12, v12, v60
  v_mfma_f32_16x16x32_bf16 v[248:251], a[116:119], a[156:159], 0
  v_mul_f32 v12, v12, v62
  v_sub_f32 v13, v13, v60
  v_mfma_f32_16x16x32_bf16 v[248:251], a[112:115], a[152:155], v[248:251]
  v_mul_f32 v13, v13, v62
  v_sub_f32 v14, v14, v60
  v_mfma_f32_16x16x32_bf16 v[252:255], a[120:123], a[152:155], 0
  v_mul_f32 v14, v14, v62
  v_sub_f32 v15, v15, v60
  v_mfma_f32_16x16x32_bf16 v[252:255], a[124:127], a[156:159], v[252:255]
  v_mul_f32 v15, v15, v62
  v_sub_f32 v16, v16, v60
  v_mfma_f32_16x16x32_bf16 v[236:239], a[124:127], a[148:151], 0
  v_mul_f32 v16, v16, v62
  v_sub_f32 v17, v17, v60
  v_mfma_f32_16x16x32_bf16 v[236:239], a[120:123], a[144:147], v[236:239]
  v_mul_f32 v17, v17, v62
  v_cvt_pk_bf16_f32 v52, v10, v11
  v_mfma_f32_16x16x32_bf16 v[220:223], a[120:123], a[136:139], 0
  v_cvt_pk_bf16_f32 v53, v12, v13
  v_cvt_pk_bf16_f32 v54, v14, v15
  v_mfma_f32_16x16x32_bf16 v[220:223], a[124:127], a[140:143], v[220:223]
  v_cvt_pk_bf16_f32 v55, v16, v17
  v_mul_f32 v61, 0x3b124925, v61
  v_mfma_f32_16x16x32_bf16 v[204:207], a[124:127], a[132:135], 0
  v_mul_f32 v63, 0x3b124925, v63
  v_fma_f32 v63, -v61, v61, v63
  v_mfma_f32_16x16x32_bf16 v[204:207], a[120:123], a[128:131], v[204:207]
  s_waitcnt vmcnt(16) lgkmcnt(0)
  v_mfma_f32_16x16x32_bf16 a[0:3], a[64:67], a[160:163], a[0:3]
  s_barrier
  v_mfma_f32_16x16x32_bf16 a[0:3], a[68:71], a[164:167], a[0:3]
  ds_read_b64_tr_b16 a[128:129], v48 offset:32768
  v_max_f32 v63, 0, v63
  v_mfma_f32_16x16x32_bf16 a[16:19], a[68:71], a[172:175], a[16:19]
  s_add_u32 m0, s27, 65536
  ds_read_b64_tr_b16 a[130:131], v48 offset:33792
  v_add_f32 v63, 0x3727c5ac, v63
  v_mfma_f32_16x16x32_bf16 a[16:19], a[64:67], a[168:171], a[16:19]
  buffer_load_dwordx4 v32, s[4:7], s24 offen offset:0 lds
  v_mfma_f32_16x16x32_bf16 a[32:35], a[64:67], a[176:179], a[32:35]
  ds_read_b64_tr_b16 a[132:133], v48 offset:40960
  v_mfma_f32_16x16x32_bf16 a[32:35], a[68:71], a[180:183], a[32:35]
  ds_read_b64_tr_b16 a[134:135], v48 offset:41984
  v_mfma_f32_16x16x32_bf16 a[48:51], a[68:71], a[188:191], a[48:51]
  ds_read_b64_tr_b16 a[136:137], v49 offset:32768
  v_mfma_f32_16x16x32_bf16 a[48:51], a[64:67], a[184:187], a[48:51]
  ds_read_b64_tr_b16 a[138:139], v49 offset:33792
  v_mfma_f32_16x16x32_bf16 a[52:55], a[72:75], a[184:187], a[52:55]
  buffer_load_dwordx4 v33, s[4:7], s24 offen offset:1024 lds
  v_mfma_f32_16x16x32_bf16 a[52:55], a[76:79], a[188:191], a[52:55]
  ds_read_b64_tr_b16 a[140:141], v49 offset:40960
  v_mfma_f32_16x16x32_bf16 a[36:39], a[76:79], a[180:183], a[36:39]
  ds_read_b64_tr_b16 a[142:143], v49 offset:41984
  v_mfma_f32_16x16x32_bf16 a[36:39], a[72:75], a[176:179], a[36:39]
  ds_read_b64_tr_b16 a[144:145], v50 offset:32768
  v_mfma_f32_16x16x32_bf16 a[20:23], a[72:75], a[168:171], a[20:23]
  ds_read_b64_tr_b16 a[146:147], v50 offset:33792
  v_mfma_f32_16x16x32_bf16 a[20:23], a[76:79], a[172:175], a[20:23]
  buffer_load_dwordx4 v34, s[4:7], s24 offen offset:2048 lds
  v_mfma_f32_16x16x32_bf16 a[4:7], a[76:79], a[164:167], a[4:7]
  ds_read_b64_tr_b16 a[148:149], v50 offset:40960
  v_mfma_f32_16x16x32_bf16 a[4:7], a[72:75], a[160:163], a[4:7]
  ds_read_b64_tr_b16 a[150:151], v50 offset:41984
  v_mfma_f32_16x16x32_bf16 a[8:11], a[80:83], a[160:163], a[8:11]
  ds_read_b64_tr_b16 a[152:153], v51 offset:32768
  v_mfma_f32_16x16x32_bf16 a[8:11], a[84:87], a[164:167], a[8:11]
  ds_read_b64_tr_b16 a[154:155], v51 offset:33792
  v_mfma_f32_16x16x32_bf16 a[24:27], a[84:87], a[172:175], a[24:27]
  buffer_load_dwordx4 v35, s[4:7], s24 offen offset:3072 lds
  v_mfma_f32_16x16x32_bf16 a[24:27], a[80:83], a[168:171], a[24:27]
  s_add_u32 s24, s24, 2097152
  ds_read_b64_tr_b16 a[156:157], v51 offset:40960
  v_mfma_f32_16x16x32_bf16 a[40:43], a[80:83], a[176:179], a[40:43]
  ds_read_b64_tr_b16 a[158:159], v51 offset:41984
  v_mfma_f32_16x16x32_bf16 a[40:43], a[84:87], a[180:183], a[40:43]
  v_rsq_f32 v63, v63
  v_mfma_f32_16x16x32_bf16 a[56:59], a[84:87], a[188:191], a[56:59]
  s_add_u32 m0, s27, 81920
  v_mul_f32 v63, 0x3db8aa3b, v63
  v_sub_f32 v18, v18, v61
  v_mfma_f32_16x16x32_bf16 a[56:59], a[80:83], a[184:187], a[56:59]
  buffer_load_dwordx4 v36, s[8:11], s25 offen offset:0 lds
  v_mfma_f32_16x16x32_bf16 a[60:63], a[88:91], a[184:187], a[60:63]
  v_mul_f32 v18, v18, v63
  v_sub_f32 v19, v19, v61
  v_mfma_f32_16x16x32_bf16 a[60:63], a[92:95], a[188:191], a[60:63]
  v_mul_f32 v19, v19, v63
  v_sub_f32 v20, v20, v61
  v_mfma_f32_16x16x32_bf16 a[44:47], a[92:95], a[180:183], a[44:47]
  v_mul_f32 v20, v20, v63
  v_sub_f32 v21, v21, v61
  v_mfma_f32_16x16x32_bf16 a[44:47], a[88:91], a[176:179], a[44:47]
  v_mul_f32 v21, v21, v63
  v_sub_f32 v22, v22, v61
  v_mfma_f32_16x16x32_bf16 a[28:31], a[88:91], a[168:171], a[28:31]
  buffer_load_dwordx4 v37, s[8:11], s25 offen offset:1024 lds
  v_mfma_f32_16x16x32_bf16 a[28:31], a[92:95], a[172:175], a[28:31]
  v_mul_f32 v22, v22, v63
  v_sub_f32 v23, v23, v61
  v_mfma_f32_16x16x32_bf16 a[12:15], a[92:95], a[164:167], a[12:15]
  ds_read_b128 a[96:99], v42 offset:32768
  v_mul_f32 v23, v23, v63
  v_mfma_f32_16x16x32_bf16 a[12:15], a[88:91], a[160:163], a[12:15]
  s_waitcnt lgkmcnt(1)
  v_sub_f32 v24, v24, v61
  v_mul_f32 v24, v24, v63
  v_mfma_f32_16x16x32_bf16 v[64:67], a[64:67], a[128:131], v[64:67]
  ds_read_b128 a[100:103], v43 offset:32768
  v_sub_f32 v25, v25, v61
  v_mfma_f32_16x16x32_bf16 v[64:67], a[68:71], a[132:135], v[64:67]
  buffer_load_dwordx4 v38, s[8:11], s25 offen offset:2048 lds
  v_mfma_f32_16x16x32_bf16 v[80:83], a[68:71], a[140:143], v[80:83]
  ds_read_b128 a[104:107], v42 offset:34816
  v_mul_f32 v25, v25, v63
  v_mfma_f32_16x16x32_bf16 v[80:83], a[64:67], a[136:139], v[80:83]
  v_cvt_pk_bf16_f32 v56, v18, v19
  v_cvt_pk_bf16_f32 v57, v20, v21
  v_mfma_f32_16x16x32_bf16 v[96:99], a[64:67], a[144:147], v[96:99]
  ds_read_b128 a[108:111], v43 offset:34816
  v_cvt_pk_bf16_f32 v58, v22, v23
  v_mfma_f32_16x16x32_bf16 v[96:99], a[68:71], a[148:151], v[96:99]
  v_cvt_pk_bf16_f32 v59, v24, v25
  v_mul_u32_u24 v22, 144, v1
  v_mfma_f32_16x16x32_bf16 v[112:115], a[68:71], a[156:159], v[112:115]
  buffer_load_dwordx4 v39, s[8:11], s25 offen offset:3072 lds
  v_mfma_f32_16x16x32_bf16 v[112:115], a[64:67], a[152:155], v[112:115]
  s_add_u32 s25, s25, 128
  ds_read_b128 a[112:115], v42 offset:36864
  v_lshl_add_u32 v22, s20, 5, v22
  v_mfma_f32_16x16x32_bf16 v[116:119], a[72:75], a[152:155], v[116:119]
  v_add_u32 v22, 0x20000, v22
  v_lshrrev_b32 v18, 3, v0
  v_mfma_f32_16x16x32_bf16 v[116:119], a[76:79], a[156:159], v[116:119]
  ds_read_b128 a[116:119], v43 offset:36864
  v_add_u32 v18, v18, v0
  v_mfma_f32_16x16x32_bf16 v[100:103], a[76:79], a[148:151], v[100:103]
  v_lshlrev_b32 v18, 4, v18
  v_add_u32 v18, 0x20000, v18
  v_mfma_f32_16x16x32_bf16 v[100:103], a[72:75], a[144:147], v[100:103]
  ds_read_b128 a[120:123], v42 offset:38912
  v_lshrrev_b32 v19, 3, v0
  v_mfma_f32_16x16x32_bf16 v[84:87], a[72:75], a[136:139], v[84:87]
  v_lshlrev_b32 v19, 8, v19
  v_and_b32 v20, 7, v0
  v_mfma_f32_16x16x32_bf16 v[84:87], a[76:79], a[140:143], v[84:87]
  ds_read_b128 a[124:127], v43 offset:38912
  v_lshl_add_u32 v19, v20, 4, v19
  v_mfma_f32_16x16x32_bf16 v[68:71], a[76:79], a[132:135], v[68:71]
  v_cmp_gt_u32 vcc, 192, v0
  v_add_u32 v20, 8192, v19
  v_mfma_f32_16x16x32_bf16 v[68:71], a[72:75], a[128:131], v[68:71]
  v_mov_b32 v21, 0x7fff0000
  v_cndmask_b32 v20, v21, v20, vcc
  v_mfma_f32_16x16x32_bf16 v[72:75], a[80:83], a[128:131], v[72:75]
  v_mov_b64 v[60:61], 0
  v_mov_b64 v[62:63], 0
  v_mfma_f32_16x16x32_bf16 v[72:75], a[84:87], a[132:135], v[72:75]
  v_lshlrev_b32 v0, 7, v1
  v_lshlrev_b32 v9, 4, v1
  v_mfma_f32_16x16x32_bf16 v[88:91], a[84:87], a[140:143], v[88:91]
  v_lshlrev_b32 v31, 2, v1
  v_mfma_f32_16x16x32_bf16 v[88:91], a[80:83], a[136:139], v[88:91]
  v_mfma_f32_16x16x32_bf16 v[104:107], a[80:83], a[144:147], v[104:107]
  ds_write_b128 v22, v[52:55] offset:0
  v_mfma_f32_16x16x32_bf16 v[104:107], a[84:87], a[148:151], v[104:107]
  v_mfma_f32_16x16x32_bf16 v[120:123], a[84:87], a[156:159], v[120:123]
  v_mfma_f32_16x16x32_bf16 v[120:123], a[80:83], a[152:155], v[120:123]
  v_mfma_f32_16x16x32_bf16 v[124:127], a[88:91], a[152:155], v[124:127]
  ds_write_b128 v22, v[56:59] offset:16
  v_mfma_f32_16x16x32_bf16 v[124:127], a[92:95], a[156:159], v[124:127]
  v_mfma_f32_16x16x32_bf16 v[108:111], a[92:95], a[148:151], v[108:111]
  v_mfma_f32_16x16x32_bf16 v[108:111], a[88:91], a[144:147], v[108:111]
  v_mfma_f32_16x16x32_bf16 v[92:95], a[88:91], a[136:139], v[92:95]
  v_mfma_f32_16x16x32_bf16 v[92:95], a[92:95], a[140:143], v[92:95]
  v_mfma_f32_16x16x32_bf16 v[76:79], a[92:95], a[132:135], v[76:79]
  v_mfma_f32_16x16x32_bf16 v[76:79], a[88:91], a[128:131], v[76:79]
  s_waitcnt vmcnt(16) lgkmcnt(0)
  v_mfma_f32_16x16x32_bf16 v[128:131], a[96:99], a[128:131], v[128:131]
  s_barrier
  v_mfma_f32_16x16x32_bf16 v[128:131], a[100:103], a[132:135], v[128:131]
  ds_read_b128 a[64:67], v40 offset:0
  v_lshrrev_b32 v2, 3, v1
  v_mfma_f32_16x16x32_bf16 v[144:147], a[100:103], a[140:143], v[144:147]
  s_add_u32 m0, s27, 98304
  ds_read_b128 v[52:55], v18 offset:0
  v_mfma_f32_16x16x32_bf16 v[144:147], a[96:99], a[136:139], v[144:147]
  buffer_load_dwordx4 v32, s[4:7], s24 offen offset:0 lds
  v_mfma_f32_16x16x32_bf16 v[160:163], a[96:99], a[144:147], v[160:163]
  s_lshl_b32 s61, s20, 3
  ds_read_b128 v[56:59], v18 offset:4608
  v_add_u32 v2, s61, v2
  v_mfma_f32_16x16x32_bf16 v[160:163], a[100:103], a[148:151], v[160:163]
  ds_read_b128 a[68:71], v41 offset:0
  v_bfe_u32 v3, v1, 1, 2
  v_mfma_f32_16x16x32_bf16 v[176:179], a[100:103], a[156:159], v[176:179]
  v_lshrrev_b32 v16, 4, v1
  v_xor_b32 v3, v3, v16
  v_mfma_f32_16x16x32_bf16 v[176:179], a[96:99], a[152:155], v[176:179]
  ds_read_b128 a[72:75], v40 offset:2048
  v_lshlrev_b32 v3, 5, v3
  v_mfma_f32_16x16x32_bf16 v[180:183], a[104:107], a[152:155], v[180:183]
  buffer_load_dwordx4 v33, s[4:7], s24 offen offset:1024 lds
  v_mfma_f32_16x16x32_bf16 v[180:183], a[108:111], a[156:159], v[180:183]
  ds_read_b128 a[76:79], v41 offset:2048
  v_and_b32 v16, 1, v1
  v_mfma_f32_16x16x32_bf16 v[164:167], a[108:111], a[148:151], v[164:167]
  v_lshl_add_u32 v3, v16, 4, v3
  v_lshl_add_u32 v4, v2, 13, v3
  v_mfma_f32_16x16x32_bf16 v[164:167], a[104:107], a[144:147], v[164:167]
  s_lshl_b32 s61, s21, 9
  ds_read_b128 a[80:83], v40 offset:4096
  v_add_u32 v4, s61, v4
  v_mfma_f32_16x16x32_bf16 v[148:151], a[104:107], a[136:139], v[148:151]
  s_lshl_b32 s61, s21, 8
  v_add_u32 v2, s61, v2
  v_mul_u32_u24 v7, 896, v2
  v_mfma_f32_16x16x32_bf16 v[148:151], a[108:111], a[140:143], v[148:151]
  buffer_load_dwordx4 v34, s[4:7], s24 offen offset:2048 lds
  v_mfma_f32_16x16x32_bf16 v[132:135], a[108:111], a[132:135], v[132:135]
  ds_read_b128 a[84:87], v41 offset:4096
  v_add_u32 v7, v7, v3
  v_mfma_f32_16x16x32_bf16 v[132:135], a[104:107], a[128:131], v[132:135]
  s_mov_b32 s30, 262144
  v_mfma_f32_16x16x32_bf16 v[136:139], a[112:115], a[128:131], v[136:139]
  s_lshl_b32 s31, s20, 10
  ds_read_b128 a[88:91], v40 offset:6144
  v_mfma_f32_16x16x32_bf16 v[136:139], a[116:119], a[132:135], v[136:139]
  s_lshl_b32 s3, s20, 13
  v_mfma_f32_16x16x32_bf16 v[152:155], a[116:119], a[140:143], v[152:155]
  buffer_load_dwordx4 v35, s[4:7], s24 offen offset:3072 lds
  v_mfma_f32_16x16x32_bf16 v[152:155], a[112:115], a[136:139], v[152:155]
  s_add_u32 s24, s24, 4292870272
  ds_read_b128 a[92:95], v41 offset:6144
  v_mfma_f32_16x16x32_bf16 v[168:171], a[112:115], a[144:147], v[168:171]
  s_lshl_b32 s48, s40, 3
  v_mfma_f32_16x16x32_bf16 v[168:171], a[116:119], a[148:151], v[168:171]
  s_add_u32 s48, s48, s20
  v_mfma_f32_16x16x32_bf16 v[184:187], a[116:119], a[156:159], v[184:187]
  s_add_u32 m0, s27, 114688
  v_mfma_f32_16x16x32_bf16 v[184:187], a[112:115], a[152:155], v[184:187]
  buffer_load_dwordx4 v36, s[8:11], s25 offen offset:0 lds
  v_mfma_f32_16x16x32_bf16 v[188:191], a[120:123], a[152:155], v[188:191]
  s_mul_i32 s48, s48, 14336
  v_mfma_f32_16x16x32_bf16 v[188:191], a[124:127], a[156:159], v[188:191]
  s_add_u32 s48, s48, 33554432
  v_mfma_f32_16x16x32_bf16 v[172:175], a[124:127], a[148:151], v[172:175]
  s_add_u32 s49, s48, 57344
  v_mfma_f32_16x16x32_bf16 v[172:175], a[120:123], a[144:147], v[172:175]
  s_lshr_b32 s16, s2, 3
  v_mfma_f32_16x16x32_bf16 v[156:159], a[120:123], a[136:139], v[156:159]
  buffer_load_dwordx4 v37, s[8:11], s25 offen offset:1024 lds
  v_mfma_f32_16x16x32_bf16 v[156:159], a[124:127], a[140:143], v[156:159]
  s_lshl_b32 s61, s20, 5
  v_mfma_f32_16x16x32_bf16 v[140:143], a[124:127], a[132:135], v[140:143]
  s_waitcnt lgkmcnt(0)
  v_mfma_f32_16x16x32_bf16 v[140:143], a[120:123], a[128:131], v[140:143]
  s_add_u32 s16, s16, s61
  v_mfma_f32_16x16x32_bf16 v[192:195], a[96:99], a[160:163], v[192:195]
  s_lshl_b32 s16, s16, 13
  ds_read_b64_tr_b16 a[128:129], v44 offset:0
  v_mfma_f32_16x16x32_bf16 v[192:195], a[100:103], a[164:167], v[192:195]
  buffer_load_dwordx4 v38, s[8:11], s25 offen offset:2048 lds
  v_mfma_f32_16x16x32_bf16 v[208:211], a[100:103], a[172:175], v[208:211]
  ds_read_b64_tr_b16 a[130:131], v44 offset:1024
  v_mfma_f32_16x16x32_bf16 v[208:211], a[96:99], a[168:171], v[208:211]
  ds_read_b64_tr_b16 a[132:133], v44 offset:8192
  v_mfma_f32_16x16x32_bf16 v[224:227], a[96:99], a[176:179], v[224:227]
  ds_read_b64_tr_b16 a[134:135], v44 offset:9216
  v_mfma_f32_16x16x32_bf16 v[224:227], a[100:103], a[180:183], v[224:227]
  ds_read_b64_tr_b16 a[136:137], v45 offset:0
  v_mfma_f32_16x16x32_bf16 v[240:243], a[100:103], a[188:191], v[240:243]
  buffer_load_dwordx4 v39, s[8:11], s25 offen offset:3072 lds
  v_mfma_f32_16x16x32_bf16 v[240:243], a[96:99], a[184:187], v[240:243]
  s_add_u32 s25, s25, 524160
  ds_read_b64_tr_b16 a[138:139], v45 offset:1024
  v_mfma_f32_16x16x32_bf16 v[244:247], a[104:107], a[184:187], v[244:247]
  ds_read_b64_tr_b16 a[140:141], v45 offset:8192
  v_mfma_f32_16x16x32_bf16 v[244:247], a[108:111], a[188:191], v[244:247]
  ds_read_b64_tr_b16 a[142:143], v45 offset:9216
  v_mfma_f32_16x16x32_bf16 v[228:231], a[108:111], a[180:183], v[228:231]
  ds_read_b64_tr_b16 a[144:145], v46 offset:0
  v_mfma_f32_16x16x32_bf16 v[228:231], a[104:107], a[176:179], v[228:231]
  ds_read_b64_tr_b16 a[146:147], v46 offset:1024
  v_mfma_f32_16x16x32_bf16 v[212:215], a[104:107], a[168:171], v[212:215]
  buffer_store_dwordx4 v[52:55], v19, s[12:15], s63 offen sc1
  v_mfma_f32_16x16x32_bf16 v[212:215], a[108:111], a[172:175], v[212:215]
  ds_read_b64_tr_b16 a[148:149], v46 offset:8192
  v_mfma_f32_16x16x32_bf16 v[196:199], a[108:111], a[164:167], v[196:199]
  ds_read_b64_tr_b16 a[150:151], v46 offset:9216
  v_mfma_f32_16x16x32_bf16 v[196:199], a[104:107], a[160:163], v[196:199]
  ds_read_b64_tr_b16 a[152:153], v47 offset:0
  v_mfma_f32_16x16x32_bf16 v[200:203], a[112:115], a[160:163], v[200:203]
  ds_read_b64_tr_b16 a[154:155], v47 offset:1024
  v_mfma_f32_16x16x32_bf16 v[200:203], a[116:119], a[164:167], v[200:203]
  buffer_store_dwordx4 v[56:59], v20, s[12:15], s63 offen sc1
  v_mfma_f32_16x16x32_bf16 v[216:219], a[116:119], a[172:175], v[216:219]
  ds_read_b64_tr_b16 a[156:157], v47 offset:8192
  v_mfma_f32_16x16x32_bf16 v[216:219], a[112:115], a[168:171], v[216:219]
  ds_read_b64_tr_b16 a[158:159], v47 offset:9216
  v_mfma_f32_16x16x32_bf16 v[232:235], a[112:115], a[176:179], v[232:235]
  v_mfma_f32_16x16x32_bf16 v[232:235], a[116:119], a[180:183], v[232:235]
  v_mfma_f32_16x16x32_bf16 v[248:251], a[116:119], a[188:191], v[248:251]
  buffer_store_dwordx4 v[60:63], v5, s[12:15], 0 offen sc1
  v_mfma_f32_16x16x32_bf16 v[248:251], a[112:115], a[184:187], v[248:251]
  v_mfma_f32_16x16x32_bf16 v[252:255], a[120:123], a[184:187], v[252:255]
  v_mfma_f32_16x16x32_bf16 v[252:255], a[124:127], a[188:191], v[252:255]
  v_mfma_f32_16x16x32_bf16 v[236:239], a[124:127], a[180:183], v[236:239]
  v_mfma_f32_16x16x32_bf16 v[236:239], a[120:123], a[176:179], v[236:239]
  v_mfma_f32_16x16x32_bf16 v[220:223], a[120:123], a[168:171], v[220:223]
  v_mfma_f32_16x16x32_bf16 v[220:223], a[124:127], a[172:175], v[220:223]
  v_mfma_f32_16x16x32_bf16 v[204:207], a[124:127], a[164:167], v[204:207]
  v_mfma_f32_16x16x32_bf16 v[204:207], a[120:123], a[160:163], v[204:207]
  s_waitcnt vmcnt(19) lgkmcnt(0)
.p2align 6
KV_LOOP1:
  v_mfma_f32_16x16x32_bf16 a[0:3], a[64:67], a[128:131], a[0:3]
  s_barrier
  v_mfma_f32_16x16x32_bf16 a[0:3], a[68:71], a[132:135], a[0:3]
  ds_read_b64_tr_b16 a[160:161], v44 offset:32768
  v_mfma_f32_16x16x32_bf16 a[16:19], a[68:71], a[140:143], a[16:19]
  s_add_u32 m0, s27, 0
  ds_read_b64_tr_b16 a[162:163], v44 offset:33792
  v_mfma_f32_16x16x32_bf16 a[16:19], a[64:67], a[136:139], a[16:19]
  buffer_load_dwordx4 v32, s[4:7], s24 offen offset:0 lds
  v_mfma_f32_16x16x32_bf16 a[32:35], a[64:67], a[144:147], a[32:35]
  ds_read_b64_tr_b16 a[164:165], v44 offset:40960
  v_mfma_f32_16x16x32_bf16 a[32:35], a[68:71], a[148:151], a[32:35]
  ds_read_b64_tr_b16 a[166:167], v44 offset:41984
  v_mfma_f32_16x16x32_bf16 a[48:51], a[68:71], a[156:159], a[48:51]
  ds_read_b64_tr_b16 a[168:169], v45 offset:32768
  v_mfma_f32_16x16x32_bf16 a[48:51], a[64:67], a[152:155], a[48:51]
  ds_read_b64_tr_b16 a[170:171], v45 offset:33792
  v_mfma_f32_16x16x32_bf16 a[52:55], a[72:75], a[152:155], a[52:55]
  buffer_load_dwordx4 v33, s[4:7], s24 offen offset:1024 lds
  v_mfma_f32_16x16x32_bf16 a[52:55], a[76:79], a[156:159], a[52:55]
  ds_read_b64_tr_b16 a[172:173], v45 offset:40960
  v_mfma_f32_16x16x32_bf16 a[36:39], a[76:79], a[148:151], a[36:39]
  ds_read_b64_tr_b16 a[174:175], v45 offset:41984
  v_mfma_f32_16x16x32_bf16 a[36:39], a[72:75], a[144:147], a[36:39]
  ds_read_b64_tr_b16 a[176:177], v46 offset:32768
  v_mfma_f32_16x16x32_bf16 a[20:23], a[72:75], a[136:139], a[20:23]
  ds_read_b64_tr_b16 a[178:179], v46 offset:33792
  v_mfma_f32_16x16x32_bf16 a[20:23], a[76:79], a[140:143], a[20:23]
  buffer_load_dwordx4 v34, s[4:7], s24 offen offset:2048 lds
  v_mfma_f32_16x16x32_bf16 a[4:7], a[76:79], a[132:135], a[4:7]
  ds_read_b64_tr_b16 a[180:181], v46 offset:40960
  v_mfma_f32_16x16x32_bf16 a[4:7], a[72:75], a[128:131], a[4:7]
  ds_read_b64_tr_b16 a[182:183], v46 offset:41984
  v_mfma_f32_16x16x32_bf16 a[8:11], a[80:83], a[128:131], a[8:11]
  ds_read_b64_tr_b16 a[184:185], v47 offset:32768
  v_mfma_f32_16x16x32_bf16 a[8:11], a[84:87], a[132:135], a[8:11]
  ds_read_b64_tr_b16 a[186:187], v47 offset:33792
  v_mfma_f32_16x16x32_bf16 a[24:27], a[84:87], a[140:143], a[24:27]
  buffer_load_dwordx4 v35, s[4:7], s24 offen offset:3072 lds
  v_mfma_f32_16x16x32_bf16 a[24:27], a[80:83], a[136:139], a[24:27]
  s_add_u32 s24, s24, 2097152
  ds_read_b64_tr_b16 a[188:189], v47 offset:40960
  v_mfma_f32_16x16x32_bf16 a[40:43], a[80:83], a[144:147], a[40:43]
  ds_read_b64_tr_b16 a[190:191], v47 offset:41984
  v_mfma_f32_16x16x32_bf16 a[40:43], a[84:87], a[148:151], a[40:43]
  v_mfma_f32_16x16x32_bf16 a[56:59], a[84:87], a[156:159], a[56:59]
  s_add_u32 m0, s27, 16384
  v_mfma_f32_16x16x32_bf16 a[56:59], a[80:83], a[152:155], a[56:59]
  buffer_load_dwordx4 v36, s[8:11], s25 offen offset:0 lds
  v_mfma_f32_16x16x32_bf16 a[60:63], a[88:91], a[152:155], a[60:63]
  v_mfma_f32_16x16x32_bf16 a[60:63], a[92:95], a[156:159], a[60:63]
  v_mfma_f32_16x16x32_bf16 a[44:47], a[92:95], a[148:151], a[44:47]
  v_mfma_f32_16x16x32_bf16 a[44:47], a[88:91], a[144:147], a[44:47]
  v_mfma_f32_16x16x32_bf16 a[28:31], a[88:91], a[136:139], a[28:31]
  buffer_load_dwordx4 v37, s[8:11], s25 offen offset:1024 lds
  v_mfma_f32_16x16x32_bf16 a[28:31], a[92:95], a[140:143], a[28:31]
  v_mfma_f32_16x16x32_bf16 a[12:15], a[92:95], a[132:135], a[12:15]
  ds_read_b128 a[96:99], v40 offset:32768
  v_mfma_f32_16x16x32_bf16 a[12:15], a[88:91], a[128:131], a[12:15]
  s_waitcnt lgkmcnt(1)
  v_mfma_f32_16x16x32_bf16 v[64:67], a[64:67], a[160:163], v[64:67]
  ds_read_b128 a[100:103], v41 offset:32768
  v_mfma_f32_16x16x32_bf16 v[64:67], a[68:71], a[164:167], v[64:67]
  buffer_load_dwordx4 v38, s[8:11], s25 offen offset:2048 lds
  v_mfma_f32_16x16x32_bf16 v[80:83], a[68:71], a[172:175], v[80:83]
  ds_read_b128 a[104:107], v40 offset:34816
  v_mfma_f32_16x16x32_bf16 v[80:83], a[64:67], a[168:171], v[80:83]
  v_mfma_f32_16x16x32_bf16 v[96:99], a[64:67], a[176:179], v[96:99]
  ds_read_b128 a[108:111], v41 offset:34816
  v_mfma_f32_16x16x32_bf16 v[96:99], a[68:71], a[180:183], v[96:99]
  v_mfma_f32_16x16x32_bf16 v[112:115], a[68:71], a[188:191], v[112:115]
  buffer_load_dwordx4 v39, s[8:11], s25 offen offset:3072 lds
  v_mfma_f32_16x16x32_bf16 v[112:115], a[64:67], a[184:187], v[112:115]
  s_add_u32 s25, s25, 128
  ds_read_b128 a[112:115], v40 offset:36864
  v_mfma_f32_16x16x32_bf16 v[116:119], a[72:75], a[184:187], v[116:119]
  v_mfma_f32_16x16x32_bf16 v[116:119], a[76:79], a[188:191], v[116:119]
  s_cmp_eq_u32 s26, 1
  ds_read_b128 a[116:119], v41 offset:36864
  v_mfma_f32_16x16x32_bf16 v[100:103], a[76:79], a[180:183], v[100:103]
  s_cselect_b32 s60, 0, 0x1000
  v_mfma_f32_16x16x32_bf16 v[100:103], a[72:75], a[176:179], v[100:103]
  ds_read_b128 a[120:123], v40 offset:38912
  v_mfma_f32_16x16x32_bf16 v[84:87], a[72:75], a[168:171], v[84:87]
  buffer_load_dword v25, v31, s[72:75], s60 offen sc1
  v_mfma_f32_16x16x32_bf16 v[84:87], a[76:79], a[172:175], v[84:87]
  ds_read_b128 a[124:127], v41 offset:38912
  v_mfma_f32_16x16x32_bf16 v[68:71], a[76:79], a[164:167], v[68:71]
  v_mfma_f32_16x16x32_bf16 v[68:71], a[72:75], a[160:163], v[68:71]
  v_mfma_f32_16x16x32_bf16 v[72:75], a[80:83], a[160:163], v[72:75]
  v_mfma_f32_16x16x32_bf16 v[72:75], a[84:87], a[164:167], v[72:75]
  v_mfma_f32_16x16x32_bf16 v[88:91], a[84:87], a[172:175], v[88:91]
  v_mfma_f32_16x16x32_bf16 v[88:91], a[80:83], a[168:171], v[88:91]
  v_mfma_f32_16x16x32_bf16 v[104:107], a[80:83], a[176:179], v[104:107]
  v_mfma_f32_16x16x32_bf16 v[104:107], a[84:87], a[180:183], v[104:107]
  v_mfma_f32_16x16x32_bf16 v[120:123], a[84:87], a[188:191], v[120:123]
  v_mfma_f32_16x16x32_bf16 v[120:123], a[80:83], a[184:187], v[120:123]
  v_mfma_f32_16x16x32_bf16 v[124:127], a[88:91], a[184:187], v[124:127]
  v_mfma_f32_16x16x32_bf16 v[124:127], a[92:95], a[188:191], v[124:127]
  v_mfma_f32_16x16x32_bf16 v[108:111], a[92:95], a[180:183], v[108:111]
  v_mfma_f32_16x16x32_bf16 v[108:111], a[88:91], a[176:179], v[108:111]
  v_mfma_f32_16x16x32_bf16 v[92:95], a[88:91], a[168:171], v[92:95]
  v_mfma_f32_16x16x32_bf16 v[92:95], a[92:95], a[172:175], v[92:95]
  v_mfma_f32_16x16x32_bf16 v[76:79], a[92:95], a[164:167], v[76:79]
  v_mfma_f32_16x16x32_bf16 v[76:79], a[88:91], a[160:163], v[76:79]
  s_waitcnt vmcnt(18) lgkmcnt(0)
  v_mfma_f32_16x16x32_bf16 v[128:131], a[96:99], a[160:163], v[128:131]
  s_barrier
  v_mfma_f32_16x16x32_bf16 v[128:131], a[100:103], a[164:167], v[128:131]
  ds_read_b128 a[64:67], v42 offset:0
  v_mfma_f32_16x16x32_bf16 v[144:147], a[100:103], a[172:175], v[144:147]
  s_add_u32 m0, s27, 32768
  v_mfma_f32_16x16x32_bf16 v[144:147], a[96:99], a[168:171], v[144:147]
  buffer_load_dwordx4 v32, s[4:7], s24 offen offset:0 lds
  v_mfma_f32_16x16x32_bf16 v[160:163], a[96:99], a[176:179], v[160:163]
  ds_read_b128 a[68:71], v43 offset:0
  v_mfma_f32_16x16x32_bf16 v[160:163], a[100:103], a[180:183], v[160:163]
  v_mfma_f32_16x16x32_bf16 v[176:179], a[100:103], a[188:191], v[176:179]
  ds_read_b128 a[72:75], v42 offset:2048
  v_mfma_f32_16x16x32_bf16 v[176:179], a[96:99], a[184:187], v[176:179]
  v_mfma_f32_16x16x32_bf16 v[180:183], a[104:107], a[184:187], v[180:183]
  buffer_load_dwordx4 v33, s[4:7], s24 offen offset:1024 lds
  v_mfma_f32_16x16x32_bf16 v[180:183], a[108:111], a[188:191], v[180:183]
  ds_read_b128 a[76:79], v43 offset:2048
  v_mfma_f32_16x16x32_bf16 v[164:167], a[108:111], a[180:183], v[164:167]
  v_mfma_f32_16x16x32_bf16 v[164:167], a[104:107], a[176:179], v[164:167]
  ds_read_b128 a[80:83], v42 offset:4096
  v_mfma_f32_16x16x32_bf16 v[148:151], a[104:107], a[168:171], v[148:151]
  v_mfma_f32_16x16x32_bf16 v[148:151], a[108:111], a[172:175], v[148:151]
  buffer_load_dwordx4 v34, s[4:7], s24 offen offset:2048 lds
  v_mfma_f32_16x16x32_bf16 v[132:135], a[108:111], a[164:167], v[132:135]
  ds_read_b128 a[84:87], v43 offset:4096
  v_mfma_f32_16x16x32_bf16 v[132:135], a[104:107], a[160:163], v[132:135]
  v_mfma_f32_16x16x32_bf16 v[136:139], a[112:115], a[160:163], v[136:139]
  ds_read_b128 a[88:91], v42 offset:6144
  v_mfma_f32_16x16x32_bf16 v[136:139], a[116:119], a[164:167], v[136:139]
  v_mfma_f32_16x16x32_bf16 v[152:155], a[116:119], a[172:175], v[152:155]
  buffer_load_dwordx4 v35, s[4:7], s24 offen offset:3072 lds
  v_mfma_f32_16x16x32_bf16 v[152:155], a[112:115], a[168:171], v[152:155]
  s_add_u32 s24, s24, 4292870272
  ds_read_b128 a[92:95], v43 offset:6144
  v_mfma_f32_16x16x32_bf16 v[168:171], a[112:115], a[176:179], v[168:171]
  v_mfma_f32_16x16x32_bf16 v[168:171], a[116:119], a[180:183], v[168:171]
  v_mfma_f32_16x16x32_bf16 v[184:187], a[116:119], a[188:191], v[184:187]
  s_add_u32 m0, s27, 49152
  v_mfma_f32_16x16x32_bf16 v[184:187], a[112:115], a[184:187], v[184:187]
  buffer_load_dwordx4 v36, s[8:11], s25 offen offset:0 lds
  v_mfma_f32_16x16x32_bf16 v[188:191], a[120:123], a[184:187], v[188:191]
  v_mfma_f32_16x16x32_bf16 v[188:191], a[124:127], a[188:191], v[188:191]
  v_mfma_f32_16x16x32_bf16 v[172:175], a[124:127], a[180:183], v[172:175]
  v_mfma_f32_16x16x32_bf16 v[172:175], a[120:123], a[176:179], v[172:175]
  v_mfma_f32_16x16x32_bf16 v[156:159], a[120:123], a[168:171], v[156:159]
  buffer_load_dwordx4 v37, s[8:11], s25 offen offset:1024 lds
  v_mfma_f32_16x16x32_bf16 v[156:159], a[124:127], a[172:175], v[156:159]
  v_mfma_f32_16x16x32_bf16 v[140:143], a[124:127], a[164:167], v[140:143]
  v_mfma_f32_16x16x32_bf16 v[140:143], a[120:123], a[160:163], v[140:143]
  v_mfma_f32_16x16x32_bf16 v[192:195], a[96:99], a[128:131], v[192:195]
  ds_read_b64_tr_b16 a[160:161], v48 offset:0
  v_mfma_f32_16x16x32_bf16 v[192:195], a[100:103], a[132:135], v[192:195]
  buffer_load_dwordx4 v38, s[8:11], s25 offen offset:2048 lds
  v_mfma_f32_16x16x32_bf16 v[208:211], a[100:103], a[140:143], v[208:211]
  ds_read_b64_tr_b16 a[162:163], v48 offset:1024
  v_mfma_f32_16x16x32_bf16 v[208:211], a[96:99], a[136:139], v[208:211]
  ds_read_b64_tr_b16 a[164:165], v48 offset:8192
  v_mfma_f32_16x16x32_bf16 v[224:227], a[96:99], a[144:147], v[224:227]
  ds_read_b64_tr_b16 a[166:167], v48 offset:9216
  v_mfma_f32_16x16x32_bf16 v[224:227], a[100:103], a[148:151], v[224:227]
  ds_read_b64_tr_b16 a[168:169], v49 offset:0
  v_mfma_f32_16x16x32_bf16 v[240:243], a[100:103], a[156:159], v[240:243]
  buffer_load_dwordx4 v39, s[8:11], s25 offen offset:3072 lds
  v_mfma_f32_16x16x32_bf16 v[240:243], a[96:99], a[152:155], v[240:243]
  s_add_u32 s25, s25, 524160
  ds_read_b64_tr_b16 a[170:171], v49 offset:1024
  v_mfma_f32_16x16x32_bf16 v[244:247], a[104:107], a[152:155], v[244:247]
  ds_read_b64_tr_b16 a[172:173], v49 offset:8192
  v_mfma_f32_16x16x32_bf16 v[244:247], a[108:111], a[156:159], v[244:247]
  s_cmp_eq_u32 s26, 1
  ds_read_b64_tr_b16 a[174:175], v49 offset:9216
  v_mfma_f32_16x16x32_bf16 v[228:231], a[108:111], a[148:151], v[228:231]
  s_cselect_b32 s60, s16, 0x100000
  ds_read_b64_tr_b16 a[176:177], v50 offset:0
  v_mfma_f32_16x16x32_bf16 v[228:231], a[104:107], a[144:147], v[228:231]
  ds_read_b64_tr_b16 a[178:179], v50 offset:1024
  v_mfma_f32_16x16x32_bf16 v[212:215], a[104:107], a[136:139], v[212:215]
  buffer_load_dword v27, v0, s[96:99], s60 offen
  v_mfma_f32_16x16x32_bf16 v[212:215], a[108:111], a[140:143], v[212:215]
  ds_read_b64_tr_b16 a[180:181], v50 offset:8192
  v_mfma_f32_16x16x32_bf16 v[196:199], a[108:111], a[132:135], v[196:199]
  ds_read_b64_tr_b16 a[182:183], v50 offset:9216
  v_mfma_f32_16x16x32_bf16 v[196:199], a[104:107], a[128:131], v[196:199]
  ds_read_b64_tr_b16 a[184:185], v51 offset:0
  v_mfma_f32_16x16x32_bf16 v[200:203], a[112:115], a[128:131], v[200:203]
  ds_read_b64_tr_b16 a[186:187], v51 offset:1024
  v_mfma_f32_16x16x32_bf16 v[200:203], a[116:119], a[132:135], v[200:203]
  ds_read_b64_tr_b16 a[188:189], v51 offset:8192
  v_mfma_f32_16x16x32_bf16 v[216:219], a[116:119], a[140:143], v[216:219]
  ds_read_b64_tr_b16 a[190:191], v51 offset:9216
  v_mfma_f32_16x16x32_bf16 v[216:219], a[112:115], a[136:139], v[216:219]
  v_mfma_f32_16x16x32_bf16 v[232:235], a[112:115], a[144:147], v[232:235]
  v_mfma_f32_16x16x32_bf16 v[232:235], a[116:119], a[148:151], v[232:235]
  v_mfma_f32_16x16x32_bf16 v[248:251], a[116:119], a[156:159], v[248:251]
  v_mfma_f32_16x16x32_bf16 v[248:251], a[112:115], a[152:155], v[248:251]
  v_mfma_f32_16x16x32_bf16 v[252:255], a[120:123], a[152:155], v[252:255]
  v_mfma_f32_16x16x32_bf16 v[252:255], a[124:127], a[156:159], v[252:255]
  v_mfma_f32_16x16x32_bf16 v[236:239], a[124:127], a[148:151], v[236:239]
  v_mfma_f32_16x16x32_bf16 v[236:239], a[120:123], a[144:147], v[236:239]
  v_mfma_f32_16x16x32_bf16 v[220:223], a[120:123], a[136:139], v[220:223]
  v_mfma_f32_16x16x32_bf16 v[220:223], a[124:127], a[140:143], v[220:223]
  v_mfma_f32_16x16x32_bf16 v[204:207], a[124:127], a[132:135], v[204:207]
  v_mfma_f32_16x16x32_bf16 v[204:207], a[120:123], a[128:131], v[204:207]
  s_waitcnt vmcnt(18) lgkmcnt(0)
  v_mfma_f32_16x16x32_bf16 a[0:3], a[64:67], a[160:163], a[0:3]
  s_barrier
  v_mfma_f32_16x16x32_bf16 a[0:3], a[68:71], a[164:167], a[0:3]
  ds_read_b64_tr_b16 a[128:129], v48 offset:32768
  v_mfma_f32_16x16x32_bf16 a[16:19], a[68:71], a[172:175], a[16:19]
  s_add_u32 m0, s27, 65536
  ds_read_b64_tr_b16 a[130:131], v48 offset:33792
  v_mfma_f32_16x16x32_bf16 a[16:19], a[64:67], a[168:171], a[16:19]
  buffer_load_dwordx4 v32, s[4:7], s24 offen offset:0 lds
  v_mfma_f32_16x16x32_bf16 a[32:35], a[64:67], a[176:179], a[32:35]
  ds_read_b64_tr_b16 a[132:133], v48 offset:40960
  v_mfma_f32_16x16x32_bf16 a[32:35], a[68:71], a[180:183], a[32:35]
  ds_read_b64_tr_b16 a[134:135], v48 offset:41984
  v_mfma_f32_16x16x32_bf16 a[48:51], a[68:71], a[188:191], a[48:51]
  ds_read_b64_tr_b16 a[136:137], v49 offset:32768
  v_mfma_f32_16x16x32_bf16 a[48:51], a[64:67], a[184:187], a[48:51]
  ds_read_b64_tr_b16 a[138:139], v49 offset:33792
  v_mfma_f32_16x16x32_bf16 a[52:55], a[72:75], a[184:187], a[52:55]
  buffer_load_dwordx4 v33, s[4:7], s24 offen offset:1024 lds
  v_mfma_f32_16x16x32_bf16 a[52:55], a[76:79], a[188:191], a[52:55]
  ds_read_b64_tr_b16 a[140:141], v49 offset:40960
  v_mfma_f32_16x16x32_bf16 a[36:39], a[76:79], a[180:183], a[36:39]
  ds_read_b64_tr_b16 a[142:143], v49 offset:41984
  v_mfma_f32_16x16x32_bf16 a[36:39], a[72:75], a[176:179], a[36:39]
  ds_read_b64_tr_b16 a[144:145], v50 offset:32768
  v_mfma_f32_16x16x32_bf16 a[20:23], a[72:75], a[168:171], a[20:23]
  ds_read_b64_tr_b16 a[146:147], v50 offset:33792
  v_mfma_f32_16x16x32_bf16 a[20:23], a[76:79], a[172:175], a[20:23]
  buffer_load_dwordx4 v34, s[4:7], s24 offen offset:2048 lds
  v_mfma_f32_16x16x32_bf16 a[4:7], a[76:79], a[164:167], a[4:7]
  ds_read_b64_tr_b16 a[148:149], v50 offset:40960
  v_mfma_f32_16x16x32_bf16 a[4:7], a[72:75], a[160:163], a[4:7]
  ds_read_b64_tr_b16 a[150:151], v50 offset:41984
  v_mfma_f32_16x16x32_bf16 a[8:11], a[80:83], a[160:163], a[8:11]
  ds_read_b64_tr_b16 a[152:153], v51 offset:32768
  v_mfma_f32_16x16x32_bf16 a[8:11], a[84:87], a[164:167], a[8:11]
  ds_read_b64_tr_b16 a[154:155], v51 offset:33792
  v_mfma_f32_16x16x32_bf16 a[24:27], a[84:87], a[172:175], a[24:27]
  buffer_load_dwordx4 v35, s[4:7], s24 offen offset:3072 lds
  v_mfma_f32_16x16x32_bf16 a[24:27], a[80:83], a[168:171], a[24:27]
  s_add_u32 s24, s24, 2097152
  ds_read_b64_tr_b16 a[156:157], v51 offset:40960
  v_mfma_f32_16x16x32_bf16 a[40:43], a[80:83], a[176:179], a[40:43]
  ds_read_b64_tr_b16 a[158:159], v51 offset:41984
  v_mfma_f32_16x16x32_bf16 a[40:43], a[84:87], a[180:183], a[40:43]
  v_mfma_f32_16x16x32_bf16 a[56:59], a[84:87], a[188:191], a[56:59]
  s_add_u32 m0, s27, 81920
  v_mfma_f32_16x16x32_bf16 a[56:59], a[80:83], a[184:187], a[56:59]
  buffer_load_dwordx4 v36, s[8:11], s25 offen offset:0 lds
  v_mfma_f32_16x16x32_bf16 a[60:63], a[88:91], a[184:187], a[60:63]
  v_mfma_f32_16x16x32_bf16 a[60:63], a[92:95], a[188:191], a[60:63]
  v_mfma_f32_16x16x32_bf16 a[44:47], a[92:95], a[180:183], a[44:47]
  v_mfma_f32_16x16x32_bf16 a[44:47], a[88:91], a[176:179], a[44:47]
  v_mfma_f32_16x16x32_bf16 a[28:31], a[88:91], a[168:171], a[28:31]
  buffer_load_dwordx4 v37, s[8:11], s25 offen offset:1024 lds
  v_mfma_f32_16x16x32_bf16 a[28:31], a[92:95], a[172:175], a[28:31]
  v_mfma_f32_16x16x32_bf16 a[12:15], a[92:95], a[164:167], a[12:15]
  ds_read_b128 a[96:99], v42 offset:32768
  v_mfma_f32_16x16x32_bf16 a[12:15], a[88:91], a[160:163], a[12:15]
  s_waitcnt lgkmcnt(1)
  v_mfma_f32_16x16x32_bf16 v[64:67], a[64:67], a[128:131], v[64:67]
  ds_read_b128 a[100:103], v43 offset:32768
  v_mfma_f32_16x16x32_bf16 v[64:67], a[68:71], a[132:135], v[64:67]
  buffer_load_dwordx4 v38, s[8:11], s25 offen offset:2048 lds
  v_mfma_f32_16x16x32_bf16 v[80:83], a[68:71], a[140:143], v[80:83]
  ds_read_b128 a[104:107], v42 offset:34816
  v_mfma_f32_16x16x32_bf16 v[80:83], a[64:67], a[136:139], v[80:83]
  v_mfma_f32_16x16x32_bf16 v[96:99], a[64:67], a[144:147], v[96:99]
  ds_read_b128 a[108:111], v43 offset:34816
  v_mfma_f32_16x16x32_bf16 v[96:99], a[68:71], a[148:151], v[96:99]
  v_mfma_f32_16x16x32_bf16 v[112:115], a[68:71], a[156:159], v[112:115]
  buffer_load_dwordx4 v39, s[8:11], s25 offen offset:3072 lds
  v_mfma_f32_16x16x32_bf16 v[112:115], a[64:67], a[152:155], v[112:115]
  s_add_u32 s25, s25, 128
  ds_read_b128 a[112:115], v42 offset:36864
  v_mfma_f32_16x16x32_bf16 v[116:119], a[72:75], a[152:155], v[116:119]
  v_mfma_f32_16x16x32_bf16 v[116:119], a[76:79], a[156:159], v[116:119]
  s_cmp_eq_u32 s26, s33
  ds_read_b128 a[116:119], v43 offset:36864
  v_mfma_f32_16x16x32_bf16 v[100:103], a[76:79], a[148:151], v[100:103]
  s_cselect_b32 s82, 8192, 0
  v_mfma_f32_16x16x32_bf16 v[100:103], a[72:75], a[144:147], v[100:103]
  ds_read_b128 a[120:123], v42 offset:38912
  v_mfma_f32_16x16x32_bf16 v[84:87], a[72:75], a[136:139], v[84:87]
  buffer_load_dword v27, v0, s[80:83], 0 offen
  v_mfma_f32_16x16x32_bf16 v[84:87], a[76:79], a[140:143], v[84:87]
  ds_read_b128 a[124:127], v43 offset:38912
  v_mfma_f32_16x16x32_bf16 v[68:71], a[76:79], a[132:135], v[68:71]
  v_mfma_f32_16x16x32_bf16 v[68:71], a[72:75], a[128:131], v[68:71]
  v_mfma_f32_16x16x32_bf16 v[72:75], a[80:83], a[128:131], v[72:75]
  v_mfma_f32_16x16x32_bf16 v[72:75], a[84:87], a[132:135], v[72:75]
  v_mfma_f32_16x16x32_bf16 v[88:91], a[84:87], a[140:143], v[88:91]
  v_mfma_f32_16x16x32_bf16 v[88:91], a[80:83], a[136:139], v[88:91]
  v_mfma_f32_16x16x32_bf16 v[104:107], a[80:83], a[144:147], v[104:107]
  v_mfma_f32_16x16x32_bf16 v[104:107], a[84:87], a[148:151], v[104:107]
  v_mfma_f32_16x16x32_bf16 v[120:123], a[84:87], a[156:159], v[120:123]
  v_mfma_f32_16x16x32_bf16 v[120:123], a[80:83], a[152:155], v[120:123]
  v_mfma_f32_16x16x32_bf16 v[124:127], a[88:91], a[152:155], v[124:127]
  v_mfma_f32_16x16x32_bf16 v[124:127], a[92:95], a[156:159], v[124:127]
  v_mfma_f32_16x16x32_bf16 v[108:111], a[92:95], a[148:151], v[108:111]
  v_mfma_f32_16x16x32_bf16 v[108:111], a[88:91], a[144:147], v[108:111]
  v_mfma_f32_16x16x32_bf16 v[92:95], a[88:91], a[136:139], v[92:95]
  v_mfma_f32_16x16x32_bf16 v[92:95], a[92:95], a[140:143], v[92:95]
  v_mfma_f32_16x16x32_bf16 v[76:79], a[92:95], a[132:135], v[76:79]
  v_mfma_f32_16x16x32_bf16 v[76:79], a[88:91], a[128:131], v[76:79]
  s_waitcnt vmcnt(19) lgkmcnt(0)
  v_mfma_f32_16x16x32_bf16 v[128:131], a[96:99], a[128:131], v[128:131]
  s_barrier
  v_mfma_f32_16x16x32_bf16 v[128:131], a[100:103], a[132:135], v[128:131]
  ds_read_b128 a[64:67], v40 offset:0
  v_mfma_f32_16x16x32_bf16 v[144:147], a[100:103], a[140:143], v[144:147]
  s_add_u32 m0, s27, 98304
  v_mfma_f32_16x16x32_bf16 v[144:147], a[96:99], a[136:139], v[144:147]
  buffer_load_dwordx4 v32, s[4:7], s24 offen offset:0 lds
  v_mfma_f32_16x16x32_bf16 v[160:163], a[96:99], a[144:147], v[160:163]
  ds_read_b128 a[68:71], v41 offset:0
  v_mfma_f32_16x16x32_bf16 v[160:163], a[100:103], a[148:151], v[160:163]
  v_mfma_f32_16x16x32_bf16 v[176:179], a[100:103], a[156:159], v[176:179]
  ds_read_b128 a[72:75], v40 offset:2048
  v_mfma_f32_16x16x32_bf16 v[176:179], a[96:99], a[152:155], v[176:179]
  v_mfma_f32_16x16x32_bf16 v[180:183], a[104:107], a[152:155], v[180:183]
  buffer_load_dwordx4 v33, s[4:7], s24 offen offset:1024 lds
  v_mfma_f32_16x16x32_bf16 v[180:183], a[108:111], a[156:159], v[180:183]
  ds_read_b128 a[76:79], v41 offset:2048
  v_mfma_f32_16x16x32_bf16 v[164:167], a[108:111], a[148:151], v[164:167]
  v_mfma_f32_16x16x32_bf16 v[164:167], a[104:107], a[144:147], v[164:167]
  ds_read_b128 a[80:83], v40 offset:4096
  v_mfma_f32_16x16x32_bf16 v[148:151], a[104:107], a[136:139], v[148:151]
  v_mfma_f32_16x16x32_bf16 v[148:151], a[108:111], a[140:143], v[148:151]
  buffer_load_dwordx4 v34, s[4:7], s24 offen offset:2048 lds
  v_mfma_f32_16x16x32_bf16 v[132:135], a[108:111], a[132:135], v[132:135]
  ds_read_b128 a[84:87], v41 offset:4096
  v_mfma_f32_16x16x32_bf16 v[132:135], a[104:107], a[128:131], v[132:135]
  v_mfma_f32_16x16x32_bf16 v[136:139], a[112:115], a[128:131], v[136:139]
  ds_read_b128 a[88:91], v40 offset:6144
  v_mfma_f32_16x16x32_bf16 v[136:139], a[116:119], a[132:135], v[136:139]
  v_mfma_f32_16x16x32_bf16 v[152:155], a[116:119], a[140:143], v[152:155]
  buffer_load_dwordx4 v35, s[4:7], s24 offen offset:3072 lds
  v_mfma_f32_16x16x32_bf16 v[152:155], a[112:115], a[136:139], v[152:155]
  s_add_u32 s24, s24, 4292870272
  ds_read_b128 a[92:95], v41 offset:6144
  v_mfma_f32_16x16x32_bf16 v[168:171], a[112:115], a[144:147], v[168:171]
  v_mfma_f32_16x16x32_bf16 v[168:171], a[116:119], a[148:151], v[168:171]
  v_mfma_f32_16x16x32_bf16 v[184:187], a[116:119], a[156:159], v[184:187]
  s_add_u32 m0, s27, 114688
  v_mfma_f32_16x16x32_bf16 v[184:187], a[112:115], a[152:155], v[184:187]
  buffer_load_dwordx4 v36, s[8:11], s25 offen offset:0 lds
  v_mfma_f32_16x16x32_bf16 v[188:191], a[120:123], a[152:155], v[188:191]
  v_mfma_f32_16x16x32_bf16 v[188:191], a[124:127], a[156:159], v[188:191]
  v_mfma_f32_16x16x32_bf16 v[172:175], a[124:127], a[148:151], v[172:175]
  v_mfma_f32_16x16x32_bf16 v[172:175], a[120:123], a[144:147], v[172:175]
  v_mfma_f32_16x16x32_bf16 v[156:159], a[120:123], a[136:139], v[156:159]
  buffer_load_dwordx4 v37, s[8:11], s25 offen offset:1024 lds
  v_mfma_f32_16x16x32_bf16 v[156:159], a[124:127], a[140:143], v[156:159]
  v_mfma_f32_16x16x32_bf16 v[140:143], a[124:127], a[132:135], v[140:143]
  v_mfma_f32_16x16x32_bf16 v[140:143], a[120:123], a[128:131], v[140:143]
  v_mfma_f32_16x16x32_bf16 v[192:195], a[96:99], a[160:163], v[192:195]
  ds_read_b64_tr_b16 a[128:129], v44 offset:0
  v_mfma_f32_16x16x32_bf16 v[192:195], a[100:103], a[164:167], v[192:195]
  buffer_load_dwordx4 v38, s[8:11], s25 offen offset:2048 lds
  v_mfma_f32_16x16x32_bf16 v[208:211], a[100:103], a[172:175], v[208:211]
  ds_read_b64_tr_b16 a[130:131], v44 offset:1024
  v_mfma_f32_16x16x32_bf16 v[208:211], a[96:99], a[168:171], v[208:211]
  ds_read_b64_tr_b16 a[132:133], v44 offset:8192
  v_mfma_f32_16x16x32_bf16 v[224:227], a[96:99], a[176:179], v[224:227]
  ds_read_b64_tr_b16 a[134:135], v44 offset:9216
  v_mfma_f32_16x16x32_bf16 v[224:227], a[100:103], a[180:183], v[224:227]
  ds_read_b64_tr_b16 a[136:137], v45 offset:0
  v_mfma_f32_16x16x32_bf16 v[240:243], a[100:103], a[188:191], v[240:243]
  buffer_load_dwordx4 v39, s[8:11], s25 offen offset:3072 lds
  v_mfma_f32_16x16x32_bf16 v[240:243], a[96:99], a[184:187], v[240:243]
  s_add_u32 s25, s25, 524160
  ds_read_b64_tr_b16 a[138:139], v45 offset:1024
  v_mfma_f32_16x16x32_bf16 v[244:247], a[104:107], a[184:187], v[244:247]
  ds_read_b64_tr_b16 a[140:141], v45 offset:8192
  v_mfma_f32_16x16x32_bf16 v[244:247], a[108:111], a[188:191], v[244:247]
  ds_read_b64_tr_b16 a[142:143], v45 offset:9216
  v_mfma_f32_16x16x32_bf16 v[228:231], a[108:111], a[180:183], v[228:231]
  ds_read_b64_tr_b16 a[144:145], v46 offset:0
  v_mfma_f32_16x16x32_bf16 v[228:231], a[104:107], a[176:179], v[228:231]
  ds_read_b64_tr_b16 a[146:147], v46 offset:1024
  v_mfma_f32_16x16x32_bf16 v[212:215], a[104:107], a[168:171], v[212:215]
  v_mfma_f32_16x16x32_bf16 v[212:215], a[108:111], a[172:175], v[212:215]
  ds_read_b64_tr_b16 a[148:149], v46 offset:8192
  v_mfma_f32_16x16x32_bf16 v[196:199], a[108:111], a[164:167], v[196:199]
  ds_read_b64_tr_b16 a[150:151], v46 offset:9216
  v_mfma_f32_16x16x32_bf16 v[196:199], a[104:107], a[160:163], v[196:199]
  ds_read_b64_tr_b16 a[152:153], v47 offset:0
  v_mfma_f32_16x16x32_bf16 v[200:203], a[112:115], a[160:163], v[200:203]
  ds_read_b64_tr_b16 a[154:155], v47 offset:1024
  v_mfma_f32_16x16x32_bf16 v[200:203], a[116:119], a[164:167], v[200:203]
  ds_read_b64_tr_b16 a[156:157], v47 offset:8192
  v_mfma_f32_16x16x32_bf16 v[216:219], a[116:119], a[172:175], v[216:219]
  ds_read_b64_tr_b16 a[158:159], v47 offset:9216
  v_mfma_f32_16x16x32_bf16 v[216:219], a[112:115], a[168:171], v[216:219]
  v_mfma_f32_16x16x32_bf16 v[232:235], a[112:115], a[176:179], v[232:235]
  v_mfma_f32_16x16x32_bf16 v[232:235], a[116:119], a[180:183], v[232:235]
  v_mfma_f32_16x16x32_bf16 v[248:251], a[116:119], a[188:191], v[248:251]
  s_sub_u32 s26, s26, 1
  v_mfma_f32_16x16x32_bf16 v[248:251], a[112:115], a[184:187], v[248:251]
  s_cmp_eq_u32 s26, s64
  v_mfma_f32_16x16x32_bf16 v[252:255], a[120:123], a[184:187], v[252:255]
  s_cbranch_scc1 KV_SS_3
KV_SB_4:
  v_mfma_f32_16x16x32_bf16 v[252:255], a[124:127], a[188:191], v[252:255]
  v_mfma_f32_16x16x32_bf16 v[236:239], a[124:127], a[180:183], v[236:239]
  v_mfma_f32_16x16x32_bf16 v[236:239], a[120:123], a[176:179], v[236:239]
  s_cmp_lg_u32 s26, 0
  v_mfma_f32_16x16x32_bf16 v[220:223], a[120:123], a[168:171], v[220:223]
  v_mfma_f32_16x16x32_bf16 v[220:223], a[124:127], a[172:175], v[220:223]
  v_mfma_f32_16x16x32_bf16 v[204:207], a[124:127], a[164:167], v[204:207]
  v_mfma_f32_16x16x32_bf16 v[204:207], a[120:123], a[160:163], v[204:207]
  s_waitcnt vmcnt(18) lgkmcnt(0)
  s_cbranch_scc1 KV_LOOP1
  v_mfma_f32_16x16x32_bf16 a[0:3], a[64:67], a[128:131], a[0:3]
  s_barrier
  v_mfma_f32_16x16x32_bf16 a[0:3], a[68:71], a[132:135], a[0:3]
  ds_read_b64_tr_b16 a[160:161], v44 offset:32768
  v_cmp_le_u32 vcc, 16, v25
  v_mfma_f32_16x16x32_bf16 a[16:19], a[68:71], a[140:143], a[16:19]
  s_mov_b32 s24, 0
  ds_read_b64_tr_b16 a[162:163], v44 offset:33792
  v_mfma_f32_16x16x32_bf16 a[16:19], a[64:67], a[136:139], a[16:19]
  s_add_u32 m0, s31, 0
  ds_read_b64_tr_b16 a[164:165], v44 offset:40960
  v_mfma_f32_16x16x32_bf16 a[32:35], a[64:67], a[144:147], a[32:35]
  buffer_load_dwordx4 v4, s[68:71], s24 offen lds
  v_mfma_f32_16x16x32_bf16 a[32:35], a[68:71], a[148:151], a[32:35]
  s_add_u32 m0, m0, 4096
  ds_read_b64_tr_b16 a[166:167], v44 offset:41984
  v_mfma_f32_16x16x32_bf16 a[48:51], a[68:71], a[156:159], a[48:51]
  s_add_u32 s24, s24, s30
  ds_read_b64_tr_b16 a[168:169], v45 offset:32768
  v_mfma_f32_16x16x32_bf16 a[48:51], a[64:67], a[152:155], a[48:51]
  s_cmp_eq_u32 vcc_lo, 0xffff
  s_cbranch_scc0 KV_X1
KV_X1_B:
  ds_read_b64_tr_b16 a[170:171], v45 offset:33792
  v_mfma_f32_16x16x32_bf16 a[52:55], a[72:75], a[152:155], a[52:55]
  buffer_load_dwordx4 v4, s[68:71], s24 offen lds
  v_mfma_f32_16x16x32_bf16 a[52:55], a[76:79], a[156:159], a[52:55]
  s_add_u32 m0, m0, 4096
  ds_read_b64_tr_b16 a[172:173], v45 offset:40960
  v_mfma_f32_16x16x32_bf16 a[36:39], a[76:79], a[148:151], a[36:39]
  s_add_u32 s24, s24, s30
  ds_read_b64_tr_b16 a[174:175], v45 offset:41984
  v_mfma_f32_16x16x32_bf16 a[36:39], a[72:75], a[144:147], a[36:39]
  s_lshl_b32 s60, s23, 1
  ds_read_b64_tr_b16 a[176:177], v46 offset:32768
  v_mfma_f32_16x16x32_bf16 a[20:23], a[72:75], a[136:139], a[20:23]
  buffer_load_dwordx4 v4, s[68:71], s24 offen lds
  v_mfma_f32_16x16x32_bf16 a[20:23], a[76:79], a[140:143], a[20:23]
  s_add_u32 m0, m0, 4096
  ds_read_b64_tr_b16 a[178:179], v46 offset:33792
  v_mfma_f32_16x16x32_bf16 a[4:7], a[76:79], a[132:135], a[4:7]
  s_add_u32 s24, s24, s30
  ds_read_b64_tr_b16 a[180:181], v46 offset:40960
  v_mfma_f32_16x16x32_bf16 a[4:7], a[72:75], a[128:131], a[4:7]
  s_lshl_b32 s61, s23, 2
  ds_read_b64_tr_b16 a[182:183], v46 offset:41984
  v_mfma_f32_16x16x32_bf16 a[8:11], a[80:83], a[128:131], a[8:11]
  buffer_load_dwordx4 v4, s[68:71], s24 offen lds
  v_mfma_f32_16x16x32_bf16 a[8:11], a[84:87], a[132:135], a[8:11]
  s_add_u32 m0, m0, 4096
  ds_read_b64_tr_b16 a[184:185], v47 offset:32768
  v_mfma_f32_16x16x32_bf16 a[24:27], a[84:87], a[140:143], a[24:27]
  s_add_u32 s24, s24, s30
  ds_read_b64_tr_b16 a[186:187], v47 offset:33792
  v_mfma_f32_16x16x32_bf16 a[24:27], a[80:83], a[136:139], a[24:27]
  s_mov_b32 s62, 0x2468ace
  ds_read_b64_tr_b16 a[188:189], v47 offset:40960
  v_mfma_f32_16x16x32_bf16 a[40:43], a[80:83], a[144:147], a[40:43]
  buffer_load_dwordx4 v4, s[68:71], s24 offen lds
  v_mfma_f32_16x16x32_bf16 a[40:43], a[84:87], a[148:151], a[40:43]
  s_add_u32 m0, m0, 4096
  ds_read_b64_tr_b16 a[190:191], v47 offset:41984
  v_mfma_f32_16x16x32_bf16 a[56:59], a[84:87], a[156:159], a[56:59]
  s_add_u32 s24, s24, s30
  v_mfma_f32_16x16x32_bf16 a[56:59], a[80:83], a[152:155], a[56:59]
  s_bitcmp1_b32 s17, 1
  s_cmov_b32 s62, 0x2468ace
  v_mfma_f32_16x16x32_bf16 a[60:63], a[88:91], a[152:155], a[60:63]
  buffer_load_dwordx4 v4, s[68:71], s24 offen lds
  v_mfma_f32_16x16x32_bf16 a[60:63], a[92:95], a[156:159], a[60:63]
  s_add_u32 m0, m0, 4096
  v_mfma_f32_16x16x32_bf16 a[44:47], a[92:95], a[148:151], a[44:47]
  s_add_u32 s24, s24, s30
  v_mfma_f32_16x16x32_bf16 a[44:47], a[88:91], a[144:147], a[44:47]
  s_lshr_b32 s50, s62, s61
  v_mfma_f32_16x16x32_bf16 a[28:31], a[88:91], a[136:139], a[28:31]
  buffer_load_dwordx4 v4, s[68:71], s24 offen lds
  v_mfma_f32_16x16x32_bf16 a[28:31], a[92:95], a[140:143], a[28:31]
  s_and_b32 s50, s50, 15
  v_mfma_f32_16x16x32_bf16 a[12:15], a[92:95], a[132:135], a[12:15]
  s_sub_u32 s61, 32, s60
  ds_read_b128 a[96:99], v40 offset:32768
  v_mfma_f32_16x16x32_bf16 a[12:15], a[88:91], a[128:131], a[12:15]
  s_waitcnt lgkmcnt(1)
  v_mfma_f32_16x16x32_bf16 v[64:67], a[64:67], a[160:163], v[64:67]
  buffer_load_dwordx4 a[192:195], v9, s[12:15], s48 offen offset:0 sc1
  v_mfma_f32_16x16x32_bf16 v[64:67], a[68:71], a[164:167], v[64:67]
  s_sub_u32 s61, s61, s50
  ds_read_b128 a[100:103], v41 offset:32768
  v_mfma_f32_16x16x32_bf16 v[80:83], a[68:71], a[172:175], v[80:83]
  s_add_u32 s60, s60, 2
  v_mfma_f32_16x16x32_bf16 v[80:83], a[64:67], a[168:171], v[80:83]
  s_cmp_eq_u32 s22, 0
  s_cselect_b32 s42, s60, s61
  s_cselect_b32 s46, 3, 2
  ds_read_b128 a[104:107], v40 offset:34816
  v_mfma_f32_16x16x32_bf16 v[96:99], a[64:67], a[176:179], v[96:99]
  buffer_load_dwordx4 a[196:199], v9, s[12:15], s49 offen offset:0 sc1
  v_mfma_f32_16x16x32_bf16 v[96:99], a[68:71], a[180:183], v[96:99]
  s_cmp_eq_u32 s22, 0
  s_cselect_b32 s62, s50, 0
  s_cselect_b32 s63, 0, s50
  ds_read_b128 a[108:111], v41 offset:34816
  v_mfma_f32_16x16x32_bf16 v[112:115], a[68:71], a[188:191], v[112:115]
  s_cmp_eq_u32 s50, 0
  s_cmov_b32 s46, 0
  v_mfma_f32_16x16x32_bf16 v[112:115], a[64:67], a[184:187], v[112:115]
  s_lshl_b32 s60, s42, 1
  ds_read_b128 a[112:115], v40 offset:36864
  v_mfma_f32_16x16x32_bf16 v[116:119], a[72:75], a[184:187], v[116:119]
  buffer_load_dwordx4 a[200:203], v9, s[12:15], s48 offen offset:1024 sc1
  v_mfma_f32_16x16x32_bf16 v[116:119], a[76:79], a[188:191], v[116:119]
  s_lshl_b32 s62, s62, 1
  ds_read_b128 a[116:119], v41 offset:36864
  v_mfma_f32_16x16x32_bf16 v[100:103], a[76:79], a[180:183], v[100:103]
  s_add_u32 s52, s60, s62
  v_mfma_f32_16x16x32_bf16 v[100:103], a[72:75], a[176:179], v[100:103]
  s_add_u32 s61, s23, 9
  ds_read_b128 a[120:123], v40 offset:38912
  v_cmp_le_u32 vcc, s60, v1
  v_mfma_f32_16x16x32_bf16 v[84:87], a[72:75], a[168:171], v[84:87]
  buffer_load_dwordx4 a[204:207], v9, s[12:15], s49 offen offset:1024 sc1
  v_mfma_f32_16x16x32_bf16 v[84:87], a[76:79], a[172:175], v[84:87]
  ds_read_b128 a[124:127], v41 offset:38912
  v_subrev_u32 v2, s60, v1
  v_mfma_f32_16x16x32_bf16 v[68:71], a[76:79], a[164:167], v[68:71]
  v_mov_b32 v3, s60
  v_mov_b32 v16, s62
  v_mfma_f32_16x16x32_bf16 v[68:71], a[72:75], a[160:163], v[68:71]
  s_sub_u32 s62, s17, s21
  v_mfma_f32_16x16x32_bf16 v[72:75], a[80:83], a[160:163], v[72:75]
  buffer_load_dwordx4 a[208:211], v9, s[12:15], s48 offen offset:2048 sc1
  v_mfma_f32_16x16x32_bf16 v[72:75], a[84:87], a[164:167], v[72:75]
  s_lshl_b32 s62, s62, 5
  v_mfma_f32_16x16x32_bf16 v[88:91], a[84:87], a[172:175], v[88:91]
  s_add_u32 s62, s62, s61
  v_mov_b32 v17, s62
  v_cndmask_b32 v2, v1, v2, vcc
  v_mfma_f32_16x16x32_bf16 v[88:91], a[80:83], a[168:171], v[88:91]
  v_cndmask_b32 v3, v3, v16, vcc
  v_cndmask_b32 v17, 0, v17, vcc
  v_mfma_f32_16x16x32_bf16 v[104:107], a[80:83], a[176:179], v[104:107]
  buffer_load_dwordx4 a[212:215], v9, s[12:15], s49 offen offset:2048 sc1
  v_mfma_f32_16x16x32_bf16 v[104:107], a[84:87], a[180:183], v[104:107]
  v_add_u32 v16, 1, v2
  v_cmp_eq_u32 vcc, v16, v3
  v_mfma_f32_16x16x32_bf16 v[120:123], a[84:87], a[188:191], v[120:123]
  v_and_b32 v18, 1, v16
  v_min_u32 v18, v18, v2
  v_mfma_f32_16x16x32_bf16 v[120:123], a[80:83], a[184:187], v[120:123]
  v_cndmask_b32 v18, v18, 1, vcc
  v_lshrrev_b32 v16, 1, v16
  v_mfma_f32_16x16x32_bf16 v[124:127], a[88:91], a[184:187], v[124:127]
  buffer_load_dwordx4 a[216:219], v9, s[12:15], s48 offen offset:3072 sc1
  v_mfma_f32_16x16x32_bf16 v[124:127], a[92:95], a[188:191], v[124:127]
  v_sub_u32 v16, v16, v18
  v_cmp_le_u32 vcc, s61, v16
  v_mfma_f32_16x16x32_bf16 v[108:111], a[92:95], a[180:183], v[108:111]
  v_add_u32 v17, v17, v16
  v_add_u32 v16, s63, v17
  v_mfma_f32_16x16x32_bf16 v[108:111], a[88:91], a[176:179], v[108:111]
  s_mul_i32 s60, s21, 2097152
  v_cndmask_b32 v17, v17, v16, vcc
  v_mfma_f32_16x16x32_bf16 v[92:95], a[88:91], a[168:171], v[92:95]
  buffer_load_dwordx4 a[220:223], v9, s[12:15], s49 offen offset:3072 sc1
  v_mfma_f32_16x16x32_bf16 v[92:95], a[92:95], a[172:175], v[92:95]
  s_add_u32 s48, s48, 4096
  v_mfma_f32_16x16x32_bf16 v[76:79], a[92:95], a[164:167], v[76:79]
  s_add_u32 s49, s49, 4096
  v_mfma_f32_16x16x32_bf16 v[76:79], a[88:91], a[160:163], v[76:79]
  s_waitcnt vmcnt(23) lgkmcnt(0)
  v_mfma_f32_16x16x32_bf16 v[128:131], a[96:99], a[160:163], v[128:131]
  s_barrier
  v_mfma_f32_16x16x32_bf16 v[128:131], a[100:103], a[164:167], v[128:131]
  s_add_u32 s60, s60, 100663296
  ds_read_b128 a[64:67], v42 offset:0
  v_lshlrev_b32 v17, 16, v17
  v_mfma_f32_16x16x32_bf16 v[144:147], a[100:103], a[172:175], v[144:147]
  s_mov_b32 s24, 128
  v_lshl_add_u32 v17, v18, 15, v17
  v_add_u32 v17, s60, v17
  v_mfma_f32_16x16x32_bf16 v[144:147], a[96:99], a[168:171], v[144:147]
  s_add_u32 m0, s31, 32768
  ds_read_b128 a[68:71], v43 offset:0
  v_cmp_le_u32 vcc, s52, v1
  v_mfma_f32_16x16x32_bf16 v[160:163], a[96:99], a[176:179], v[160:163]
  buffer_load_dwordx4 v4, s[68:71], s24 offen lds
  v_mfma_f32_16x16x32_bf16 v[160:163], a[100:103], a[180:183], v[160:163]
  s_add_u32 m0, m0, 4096
  ds_read_b128 a[72:75], v42 offset:2048
  v_subrev_u32 v16, s52, v1
  v_mfma_f32_16x16x32_bf16 v[176:179], a[100:103], a[188:191], v[176:179]
  s_add_u32 s24, s24, s30
  v_lshlrev_b32 v16, 7, v16
  v_cndmask_b32 v5, v17, v16, vcc
  v_mfma_f32_16x16x32_bf16 v[176:179], a[96:99], a[184:187], v[176:179]
  s_lshl_b32 s61, s23, 17
  ds_read_b128 a[76:79], v43 offset:2048
  v_mfma_f32_16x16x32_bf16 v[180:183], a[104:107], a[184:187], v[180:183]
  buffer_load_dwordx4 v4, s[68:71], s24 offen lds
  v_mfma_f32_16x16x32_bf16 v[180:183], a[108:111], a[188:191], v[180:183]
  s_add_u32 m0, m0, 4096
  ds_read_b128 a[80:83], v42 offset:4096
  v_mfma_f32_16x16x32_bf16 v[164:167], a[108:111], a[180:183], v[164:167]
  s_add_u32 s24, s24, s30
  v_mfma_f32_16x16x32_bf16 v[164:167], a[104:107], a[176:179], v[164:167]
  s_add_u32 s60, s60, s61
  ds_read_b128 a[84:87], v43 offset:4096
  v_mfma_f32_16x16x32_bf16 v[148:151], a[104:107], a[168:171], v[148:151]
  buffer_load_dwordx4 v4, s[68:71], s24 offen lds
  v_mfma_f32_16x16x32_bf16 v[148:151], a[108:111], a[172:175], v[148:151]
  s_add_u32 m0, m0, 4096
  ds_read_b128 a[88:91], v42 offset:6144
  v_mfma_f32_16x16x32_bf16 v[132:135], a[108:111], a[164:167], v[132:135]
  s_add_u32 s24, s24, s30
  v_mfma_f32_16x16x32_bf16 v[132:135], a[104:107], a[160:163], v[132:135]
  s_lshr_b32 s61, s20, 1
  ds_read_b128 a[92:95], v43 offset:6144
  v_mfma_f32_16x16x32_bf16 v[136:139], a[112:115], a[160:163], v[136:139]
  buffer_load_dwordx4 v4, s[68:71], s24 offen lds
  v_mfma_f32_16x16x32_bf16 v[136:139], a[116:119], a[164:167], v[136:139]
  s_add_u32 m0, m0, 4096
  v_mfma_f32_16x16x32_bf16 v[152:155], a[116:119], a[172:175], v[152:155]
  s_add_u32 s24, s24, s30
  v_mfma_f32_16x16x32_bf16 v[152:155], a[112:115], a[168:171], v[152:155]
  s_lshl_b32 s61, s61, 16
  v_mfma_f32_16x16x32_bf16 v[168:171], a[112:115], a[176:179], v[168:171]
  buffer_load_dwordx4 v4, s[68:71], s24 offen lds
  v_mfma_f32_16x16x32_bf16 v[168:171], a[116:119], a[180:183], v[168:171]
  s_add_u32 m0, m0, 4096
  v_mfma_f32_16x16x32_bf16 v[184:187], a[116:119], a[188:191], v[184:187]
  s_add_u32 s24, s24, s30
  v_mfma_f32_16x16x32_bf16 v[184:187], a[112:115], a[184:187], v[184:187]
  s_add_u32 s60, s60, s61
  v_mfma_f32_16x16x32_bf16 v[188:191], a[120:123], a[184:187], v[188:191]
  buffer_load_dwordx4 v4, s[68:71], s24 offen lds
  v_mfma_f32_16x16x32_bf16 v[188:191], a[124:127], a[188:191], v[188:191]
  s_add_u32 m0, m0, 4096
  v_mfma_f32_16x16x32_bf16 v[172:175], a[124:127], a[180:183], v[172:175]
  s_add_u32 s24, s24, s30
  v_mfma_f32_16x16x32_bf16 v[172:175], a[120:123], a[176:179], v[172:175]
  s_lshl_b32 s62, s22, 1
  v_mfma_f32_16x16x32_bf16 v[156:159], a[120:123], a[168:171], v[156:159]
  buffer_load_dwordx4 v4, s[68:71], s24 offen lds
  v_mfma_f32_16x16x32_bf16 v[156:159], a[124:127], a[172:175], v[156:159]
  s_lshl_b32 s39, 2048, s62
  v_mfma_f32_16x16x32_bf16 v[140:143], a[124:127], a[164:167], v[140:143]
  s_lshr_b32 s47, 8192, s62
  v_mfma_f32_16x16x32_bf16 v[140:143], a[120:123], a[160:163], v[140:143]
  s_and_b32 s61, s20, 1
  v_mfma_f32_16x16x32_bf16 v[192:195], a[96:99], a[128:131], v[192:195]
  buffer_load_dwordx4 a[224:227], v9, s[12:15], s48 offen offset:0 sc1
  v_mfma_f32_16x16x32_bf16 v[192:195], a[100:103], a[132:135], v[192:195]
  s_mul_i32 s61, s61, s39
  ds_read_b64_tr_b16 a[160:161], v48 offset:0
  v_mfma_f32_16x16x32_bf16 v[208:211], a[100:103], a[140:143], v[208:211]
  s_lshl_b32 s61, s61, 1
  ds_read_b64_tr_b16 a[162:163], v48 offset:1024
  v_mfma_f32_16x16x32_bf16 v[208:211], a[96:99], a[136:139], v[208:211]
  s_add_u32 s60, s60, s61
  ds_read_b64_tr_b16 a[164:165], v48 offset:8192
  v_mfma_f32_16x16x32_bf16 v[224:227], a[96:99], a[144:147], v[224:227]
  buffer_load_dwordx4 a[228:231], v9, s[12:15], s49 offen offset:0 sc1
  v_mfma_f32_16x16x32_bf16 v[224:227], a[100:103], a[148:151], v[224:227]
  s_lshl_b32 s61, s22, 15
  ds_read_b64_tr_b16 a[166:167], v48 offset:9216
  v_mfma_f32_16x16x32_bf16 v[240:243], a[100:103], a[156:159], v[240:243]
  s_add_u32 s41, s60, s61
  ds_read_b64_tr_b16 a[168:169], v49 offset:0
  v_lshrrev_b32 v2, 2, v1
  v_mfma_f32_16x16x32_bf16 v[240:243], a[96:99], a[152:155], v[240:243]
  ds_read_b64_tr_b16 a[170:171], v49 offset:1024
  v_bfe_u32 v3, v2, 1, 2
  v_mfma_f32_16x16x32_bf16 v[244:247], a[104:107], a[152:155], v[244:247]
  buffer_load_dwordx4 a[232:235], v9, s[12:15], s48 offen offset:1024 sc1
  v_mfma_f32_16x16x32_bf16 v[244:247], a[108:111], a[156:159], v[244:247]
  ds_read_b64_tr_b16 a[172:173], v49 offset:8192
  v_lshlrev_b32 v2, 7, v2
  v_mfma_f32_16x16x32_bf16 v[228:231], a[108:111], a[148:151], v[228:231]
  ds_read_b64_tr_b16 a[174:175], v49 offset:9216
  v_and_b32 v16, 3, v1
  v_mfma_f32_16x16x32_bf16 v[228:231], a[104:107], a[144:147], v[228:231]
  ds_read_b64_tr_b16 a[176:177], v50 offset:0
  v_lshl_add_u32 v2, v16, 3, v2
  v_mfma_f32_16x16x32_bf16 v[212:215], a[104:107], a[136:139], v[212:215]
  buffer_load_dwordx4 a[236:239], v9, s[12:15], s49 offen offset:1024 sc1
  v_mfma_f32_16x16x32_bf16 v[212:215], a[108:111], a[140:143], v[212:215]
  ds_read_b64_tr_b16 a[178:179], v50 offset:1024
  v_lshl_add_u32 v28, v3, 5, v2
  v_mfma_f32_16x16x32_bf16 v[196:199], a[108:111], a[132:135], v[196:199]
  ds_read_b64_tr_b16 a[180:181], v50 offset:8192
  v_xor_b32 v29, 32, v28
  v_mfma_f32_16x16x32_bf16 v[196:199], a[104:107], a[128:131], v[196:199]
  ds_read_b64_tr_b16 a[182:183], v50 offset:9216
  v_xor_b32 v30, 64, v28
  v_mfma_f32_16x16x32_bf16 v[200:203], a[112:115], a[128:131], v[200:203]
  buffer_load_dwordx4 a[240:243], v9, s[12:15], s48 offen offset:2048 sc1
  v_mfma_f32_16x16x32_bf16 v[200:203], a[116:119], a[132:135], v[200:203]
  ds_read_b64_tr_b16 a[184:185], v51 offset:0
  v_xor_b32 v31, 96, v28
  v_mfma_f32_16x16x32_bf16 v[216:219], a[116:119], a[140:143], v[216:219]
  ds_read_b64_tr_b16 a[186:187], v51 offset:1024
  v_and_b32 v2, 15, v1
  v_mfma_f32_16x16x32_bf16 v[216:219], a[112:115], a[136:139], v[216:219]
  s_lshl_b32 s60, s20, 4
  ds_read_b64_tr_b16 a[188:189], v51 offset:8192
  v_add_u32 v2, s60, v2
  v_mfma_f32_16x16x32_bf16 v[232:235], a[112:115], a[144:147], v[232:235]
  buffer_load_dwordx4 a[244:247], v9, s[12:15], s49 offen offset:2048 sc1
  v_mfma_f32_16x16x32_bf16 v[232:235], a[116:119], a[148:151], v[232:235]
  ds_read_b64_tr_b16 a[190:191], v51 offset:9216
  v_lshrrev_b32 v3, 4, v1
  v_mfma_f32_16x16x32_bf16 v[248:251], a[116:119], a[156:159], v[248:251]
  v_lshlrev_b32 v3, 2, v3
  v_sub_u32 v2, v2, v3
  v_mfma_f32_16x16x32_bf16 v[248:251], a[112:115], a[152:155], v[248:251]
  s_add_u32 m0, s3, 128000
  v_cvt_f32_i32 v2, v2
  v_add_f32 v2, 0.5, v2
  v_mfma_f32_16x16x32_bf16 v[252:255], a[120:123], a[152:155], v[252:255]
  buffer_load_dwordx4 v9, s[12:15], s48 offen offset:3072 sc1 lds
  v_mfma_f32_16x16x32_bf16 v[252:255], a[124:127], a[156:159], v[252:255]
  v_mul_f32 v24, 0x71800000, v2
  v_mfma_f32_16x16x32_bf16 v[236:239], a[124:127], a[148:151], v[236:239]
  v_mfma_f32_16x16x32_bf16 v[236:239], a[120:123], a[144:147], v[236:239]
  s_add_u32 m0, s3, 129024
  v_mfma_f32_16x16x32_bf16 v[220:223], a[120:123], a[136:139], v[220:223]
  buffer_load_dwordx4 v9, s[12:15], s49 offen offset:3072 sc1 lds
  v_mfma_f32_16x16x32_bf16 v[220:223], a[124:127], a[140:143], v[220:223]
  v_mfma_f32_16x16x32_bf16 v[204:207], a[124:127], a[132:135], v[204:207]
  v_mfma_f32_16x16x32_bf16 v[204:207], a[120:123], a[128:131], v[204:207]
  s_waitcnt vmcnt(30) lgkmcnt(0)
  v_mfma_f32_16x16x32_bf16 a[0:3], a[64:67], a[160:163], a[0:3]
  s_barrier
  v_mfma_f32_16x16x32_bf16 a[0:3], a[68:71], a[164:167], a[0:3]
  ds_read_b64_tr_b16 a[128:129], v48 offset:32768
  v_mfma_f32_16x16x32_bf16 a[16:19], a[68:71], a[172:175], a[16:19]
  s_add_u32 s48, s48, 4096
  ds_read_b64_tr_b16 a[130:131], v48 offset:33792
  v_mfma_f32_16x16x32_bf16 a[16:19], a[64:67], a[168:171], a[16:19]
  s_add_u32 m0, s3, 133120
  ds_read_b64_tr_b16 a[132:133], v48 offset:40960
  v_mfma_f32_16x16x32_bf16 a[32:35], a[64:67], a[176:179], a[32:35]
  buffer_load_dwordx4 v9, s[12:15], s48 offen offset:0 sc1 lds
  v_mfma_f32_16x16x32_bf16 a[32:35], a[68:71], a[180:183], a[32:35]
  ds_read_b64_tr_b16 a[134:135], v48 offset:41984
  v_mfma_f32_16x16x32_bf16 a[48:51], a[68:71], a[188:191], a[48:51]
  s_add_u32 s49, s49, 4096
  ds_read_b64_tr_b16 a[136:137], v49 offset:32768
  v_mfma_f32_16x16x32_bf16 a[48:51], a[64:67], a[184:187], a[48:51]
  s_add_u32 m0, s3, 134144
  ds_read_b64_tr_b16 a[138:139], v49 offset:33792
  v_mfma_f32_16x16x32_bf16 a[52:55], a[72:75], a[184:187], a[52:55]
  buffer_load_dwordx4 v9, s[12:15], s49 offen offset:0 sc1 lds
  v_mfma_f32_16x16x32_bf16 a[52:55], a[76:79], a[188:191], a[52:55]
  ds_read_b64_tr_b16 a[140:141], v49 offset:40960
  v_mfma_f32_16x16x32_bf16 a[36:39], a[76:79], a[180:183], a[36:39]
  ds_read_b64_tr_b16 a[142:143], v49 offset:41984
  v_mfma_f32_16x16x32_bf16 a[36:39], a[72:75], a[176:179], a[36:39]
  s_add_u32 m0, s3, 134144
  ds_read_b64_tr_b16 a[144:145], v50 offset:32768
  v_mfma_f32_16x16x32_bf16 a[20:23], a[72:75], a[168:171], a[20:23]
  buffer_load_dwordx4 v9, s[12:15], s48 offen offset:1024 sc1 lds
  v_mfma_f32_16x16x32_bf16 a[20:23], a[76:79], a[172:175], a[20:23]
  ds_read_b64_tr_b16 a[146:147], v50 offset:33792
  v_mfma_f32_16x16x32_bf16 a[4:7], a[76:79], a[164:167], a[4:7]
  ds_read_b64_tr_b16 a[148:149], v50 offset:40960
  v_mfma_f32_16x16x32_bf16 a[4:7], a[72:75], a[160:163], a[4:7]
  s_add_u32 m0, s3, 135168
  ds_read_b64_tr_b16 a[150:151], v50 offset:41984
  v_mfma_f32_16x16x32_bf16 a[8:11], a[80:83], a[160:163], a[8:11]
  buffer_load_dwordx4 v9, s[12:15], s49 offen offset:1024 sc1 lds
  v_mfma_f32_16x16x32_bf16 a[8:11], a[84:87], a[164:167], a[8:11]
  ds_read_b64_tr_b16 a[152:153], v51 offset:32768
  v_mfma_f32_16x16x32_bf16 a[24:27], a[84:87], a[172:175], a[24:27]
  ds_read_b64_tr_b16 a[154:155], v51 offset:33792
  v_mfma_f32_16x16x32_bf16 a[24:27], a[80:83], a[168:171], a[24:27]
  s_add_u32 m0, s3, 135168
  ds_read_b64_tr_b16 a[156:157], v51 offset:40960
  v_mfma_f32_16x16x32_bf16 a[40:43], a[80:83], a[176:179], a[40:43]
  buffer_load_dwordx4 v9, s[12:15], s48 offen offset:2048 sc1 lds
  v_mfma_f32_16x16x32_bf16 a[40:43], a[84:87], a[180:183], a[40:43]
  ds_read_b64_tr_b16 a[158:159], v51 offset:41984
  v_mfma_f32_16x16x32_bf16 a[56:59], a[84:87], a[188:191], a[56:59]
  v_mfma_f32_16x16x32_bf16 a[56:59], a[80:83], a[184:187], a[56:59]
  s_add_u32 m0, s3, 136192
  v_mfma_f32_16x16x32_bf16 a[60:63], a[88:91], a[184:187], a[60:63]
  buffer_load_dwordx4 v9, s[12:15], s49 offen offset:2048 sc1 lds
  v_mfma_f32_16x16x32_bf16 a[60:63], a[92:95], a[188:191], a[60:63]
  v_mfma_f32_16x16x32_bf16 a[44:47], a[92:95], a[180:183], a[44:47]
  v_mfma_f32_16x16x32_bf16 a[44:47], a[88:91], a[176:179], a[44:47]
  v_mfma_f32_16x16x32_bf16 a[28:31], a[88:91], a[168:171], a[28:31]
  v_mfma_f32_16x16x32_bf16 a[28:31], a[92:95], a[172:175], a[28:31]
  v_mfma_f32_16x16x32_bf16 a[12:15], a[92:95], a[164:167], a[12:15]
  ds_read_b128 a[96:99], v42 offset:32768
  v_mfma_f32_16x16x32_bf16 a[12:15], a[88:91], a[160:163], a[12:15]
  s_waitcnt lgkmcnt(1)
  v_mfma_f32_16x16x32_bf16 v[64:67], a[64:67], a[128:131], v[64:67]
  ds_read_b128 a[100:103], v43 offset:32768
  v_mfma_f32_16x16x32_bf16 v[64:67], a[68:71], a[132:135], v[64:67]
  s_mov_b32 s38, s41
  v_mfma_f32_16x16x32_bf16 v[80:83], a[68:71], a[140:143], v[80:83]
  ds_read_b128 a[104:107], v42 offset:34816
  v_mfma_f32_16x16x32_bf16 v[80:83], a[64:67], a[136:139], v[80:83]
  v_mfma_f32_16x16x32_bf16 v[96:99], a[64:67], a[144:147], v[96:99]
  ds_read_b128 a[108:111], v43 offset:34816
  v_mfma_f32_16x16x32_bf16 v[96:99], a[68:71], a[148:151], v[96:99]
  v_mfma_f32_16x16x32_bf16 v[112:115], a[68:71], a[156:159], v[112:115]
  ds_read_b128 a[112:115], v42 offset:36864
  v_mfma_f32_16x16x32_bf16 v[112:115], a[64:67], a[152:155], v[112:115]
  v_mfma_f32_16x16x32_bf16 v[116:119], a[72:75], a[152:155], v[116:119]
  ds_read_b128 a[116:119], v43 offset:36864
  v_accvgpr_read_b32 v52, a0
  v_mfma_f32_16x16x32_bf16 v[116:119], a[76:79], a[156:159], v[116:119]
  v_accvgpr_read_b32 v53, a1
  v_accvgpr_read_b32 v54, a2
  v_mfma_f32_16x16x32_bf16 v[100:103], a[76:79], a[148:151], v[100:103]
  ds_read_b128 a[120:123], v42 offset:38912
  v_accvgpr_read_b32 v55, a3
  v_mfma_f32_16x16x32_bf16 v[100:103], a[72:75], a[144:147], v[100:103]
  v_cvt_pk_bf16_f32 v32, v52, v53
  v_cvt_pk_bf16_f32 v33, v54, v55
  v_mfma_f32_16x16x32_bf16 v[84:87], a[72:75], a[136:139], v[84:87]
  ds_read_b128 a[124:127], v43 offset:38912
  v_accvgpr_read_b32 v56, a4
  v_mfma_f32_16x16x32_bf16 v[84:87], a[76:79], a[140:143], v[84:87]
  v_accvgpr_read_b32 v57, a5
  v_accvgpr_read_b32 v58, a6
  v_mfma_f32_16x16x32_bf16 v[68:71], a[76:79], a[132:135], v[68:71]
  v_accvgpr_read_b32 v59, a7
  v_cvt_pk_bf16_f32 v34, v56, v57
  v_mfma_f32_16x16x32_bf16 v[68:71], a[72:75], a[128:131], v[68:71]
  v_cvt_pk_bf16_f32 v35, v58, v59
  v_mfma_f32_16x16x32_bf16 v[72:75], a[80:83], a[128:131], v[72:75]
  buffer_store_dwordx4 v[32:35], v9, s[12:15], s38 offen offset:0 sc1
  v_accvgpr_read_b32 v52, a8
  v_accvgpr_read_b32 v53, a9
  v_accvgpr_read_b32 v54, a10
  v_mfma_f32_16x16x32_bf16 v[72:75], a[84:87], a[132:135], v[72:75]
  v_accvgpr_read_b32 v55, a11
  v_cvt_pk_bf16_f32 v36, v52, v53
  v_mfma_f32_16x16x32_bf16 v[88:91], a[84:87], a[140:143], v[88:91]
  v_cvt_pk_bf16_f32 v37, v54, v55
  v_accvgpr_read_b32 v56, a12
  v_mfma_f32_16x16x32_bf16 v[88:91], a[80:83], a[136:139], v[88:91]
  v_accvgpr_read_b32 v57, a13
  v_accvgpr_read_b32 v58, a14
  v_mfma_f32_16x16x32_bf16 v[104:107], a[80:83], a[144:147], v[104:107]
  v_accvgpr_read_b32 v59, a15
  v_cvt_pk_bf16_f32 v38, v56, v57
  v_mfma_f32_16x16x32_bf16 v[104:107], a[84:87], a[148:151], v[104:107]
  v_cvt_pk_bf16_f32 v39, v58, v59
  v_mfma_f32_16x16x32_bf16 v[120:123], a[84:87], a[156:159], v[120:123]
  buffer_store_dwordx4 v[36:39], v9, s[12:15], s38 offen offset:1024 sc1
  s_add_u32 s38, s38, s47
  v_accvgpr_read_b32 v52, a16
  v_accvgpr_read_b32 v53, a17
  v_mfma_f32_16x16x32_bf16 v[120:123], a[80:83], a[152:155], v[120:123]
  v_accvgpr_read_b32 v54, a18
  v_accvgpr_read_b32 v55, a19
  v_mfma_f32_16x16x32_bf16 v[124:127], a[88:91], a[152:155], v[124:127]
  v_cvt_pk_bf16_f32 v60, v52, v53
  v_cvt_pk_bf16_f32 v61, v54, v55
  v_mfma_f32_16x16x32_bf16 v[124:127], a[92:95], a[156:159], v[124:127]
  v_accvgpr_read_b32 v56, a20
  v_accvgpr_read_b32 v57, a21
  v_mfma_f32_16x16x32_bf16 v[108:111], a[92:95], a[148:151], v[108:111]
  v_accvgpr_read_b32 v58, a22
  v_accvgpr_read_b32 v59, a23
  v_mfma_f32_16x16x32_bf16 v[108:111], a[88:91], a[144:147], v[108:111]
  v_cvt_pk_bf16_f32 v62, v56, v57
  v_cvt_pk_bf16_f32 v63, v58, v59
  v_mfma_f32_16x16x32_bf16 v[92:95], a[88:91], a[136:139], v[92:95]
  buffer_store_dwordx4 v[60:63], v9, s[12:15], s38 offen offset:0 sc1
  v_accvgpr_read_b32 v52, a24
  v_accvgpr_read_b32 v53, a25
  v_accvgpr_read_b32 v54, a26
  v_mfma_f32_16x16x32_bf16 v[92:95], a[92:95], a[140:143], v[92:95]
  v_accvgpr_read_b32 v55, a27
  v_cvt_pk_bf16_f32 v32, v52, v53
  v_mfma_f32_16x16x32_bf16 v[76:79], a[92:95], a[132:135], v[76:79]
  v_cvt_pk_bf16_f32 v33, v54, v55
  v_accvgpr_read_b32 v56, a28
  v_mfma_f32_16x16x32_bf16 v[76:79], a[88:91], a[128:131], v[76:79]
  s_waitcnt vmcnt(17) lgkmcnt(0)
  v_mfma_f32_16x16x32_bf16 v[128:131], a[96:99], a[128:131], v[128:131]
  s_barrier
  v_mfma_f32_16x16x32_bf16 v[128:131], a[100:103], a[132:135], v[128:131]
  v_accvgpr_read_b32 v57, a29
  v_accvgpr_read_b32 v58, a30
  v_mfma_f32_16x16x32_bf16 v[144:147], a[100:103], a[140:143], v[144:147]
  s_mov_b32 s24, 256
  v_accvgpr_read_b32 v59, a31
  v_cvt_pk_bf16_f32 v34, v56, v57
  v_mfma_f32_16x16x32_bf16 v[144:147], a[96:99], a[136:139], v[144:147]
  s_add_u32 m0, s31, 65536
  v_cvt_pk_bf16_f32 v35, v58, v59
  v_mfma_f32_16x16x32_bf16 v[160:163], a[96:99], a[144:147], v[160:163]
  buffer_load_dwordx4 v4, s[68:71], s24 offen lds
  v_mfma_f32_16x16x32_bf16 v[160:163], a[100:103], a[148:151], v[160:163]
  s_add_u32 m0, m0, 4096
  v_mfma_f32_16x16x32_bf16 v[176:179], a[100:103], a[156:159], v[176:179]
  s_add_u32 s24, s24, s30
  v_mfma_f32_16x16x32_bf16 v[176:179], a[96:99], a[152:155], v[176:179]
  buffer_store_dwordx4 v[32:35], v9, s[12:15], s38 offen offset:1024 sc1
  s_add_u32 s38, s38, s47
  v_accvgpr_read_b32 v52, a32
  v_accvgpr_read_b32 v53, a33
  v_mfma_f32_16x16x32_bf16 v[180:183], a[104:107], a[152:155], v[180:183]
  buffer_load_dwordx4 v4, s[68:71], s24 offen lds
  v_mfma_f32_16x16x32_bf16 v[180:183], a[108:111], a[156:159], v[180:183]
  s_add_u32 m0, m0, 4096
  v_accvgpr_read_b32 v54, a34
  v_accvgpr_read_b32 v55, a35
  v_mfma_f32_16x16x32_bf16 v[164:167], a[108:111], a[148:151], v[164:167]
  s_add_u32 s24, s24, s30
  v_cvt_pk_bf16_f32 v36, v52, v53
  v_cvt_pk_bf16_f32 v37, v54, v55
  v_mfma_f32_16x16x32_bf16 v[164:167], a[104:107], a[144:147], v[164:167]
  v_accvgpr_read_b32 v56, a36
  v_accvgpr_read_b32 v57, a37
  v_mfma_f32_16x16x32_bf16 v[148:151], a[104:107], a[136:139], v[148:151]
  buffer_load_dwordx4 v4, s[68:71], s24 offen lds
  v_mfma_f32_16x16x32_bf16 v[148:151], a[108:111], a[140:143], v[148:151]
  s_add_u32 m0, m0, 4096
  v_accvgpr_read_b32 v58, a38
  v_accvgpr_read_b32 v59, a39
  v_mfma_f32_16x16x32_bf16 v[132:135], a[108:111], a[132:135], v[132:135]
  s_add_u32 s24, s24, s30
  v_cvt_pk_bf16_f32 v38, v56, v57
  v_cvt_pk_bf16_f32 v39, v58, v59
  v_mfma_f32_16x16x32_bf16 v[132:135], a[104:107], a[128:131], v[132:135]
  v_cvt_pk_bf16_f32 v64, v64, v65
  v_cvt_pk_bf16_f32 v65, v66, v67
  v_mfma_f32_16x16x32_bf16 v[136:139], a[112:115], a[128:131], v[136:139]
  buffer_load_dwordx4 v4, s[68:71], s24 offen lds
  v_mfma_f32_16x16x32_bf16 v[136:139], a[116:119], a[132:135], v[136:139]
  s_add_u32 m0, m0, 4096
  v_cvt_pk_bf16_f32 v66, v68, v69
  v_cvt_pk_bf16_f32 v67, v70, v71
  v_mfma_f32_16x16x32_bf16 v[152:155], a[116:119], a[140:143], v[152:155]
  s_add_u32 s24, s24, s30
  v_cvt_pk_bf16_f32 v68, v72, v73
  v_cvt_pk_bf16_f32 v69, v74, v75
  v_mfma_f32_16x16x32_bf16 v[152:155], a[112:115], a[136:139], v[152:155]
  buffer_store_dwordx4 v[36:39], v9, s[12:15], s38 offen offset:0 sc1
  v_accvgpr_read_b32 v52, a40
  v_accvgpr_read_b32 v53, a41
  v_accvgpr_read_b32 v54, a42
  v_mfma_f32_16x16x32_bf16 v[168:171], a[112:115], a[144:147], v[168:171]
  buffer_load_dwordx4 v4, s[68:71], s24 offen lds
  v_mfma_f32_16x16x32_bf16 v[168:171], a[116:119], a[148:151], v[168:171]
  s_add_u32 m0, m0, 4096
  v_accvgpr_read_b32 v55, a43
  v_cvt_pk_bf16_f32 v60, v52, v53
  v_mfma_f32_16x16x32_bf16 v[184:187], a[116:119], a[156:159], v[184:187]
  s_add_u32 s24, s24, s30
  v_cvt_pk_bf16_f32 v61, v54, v55
  v_accvgpr_read_b32 v56, a44
  v_mfma_f32_16x16x32_bf16 v[184:187], a[112:115], a[152:155], v[184:187]
  v_accvgpr_read_b32 v57, a45
  v_accvgpr_read_b32 v58, a46
  v_mfma_f32_16x16x32_bf16 v[188:191], a[120:123], a[152:155], v[188:191]
  buffer_load_dwordx4 v4, s[68:71], s24 offen lds
  v_mfma_f32_16x16x32_bf16 v[188:191], a[124:127], a[156:159], v[188:191]
  s_add_u32 m0, m0, 4096
  v_accvgpr_read_b32 v59, a47
  v_cvt_pk_bf16_f32 v62, v56, v57
  v_mfma_f32_16x16x32_bf16 v[172:175], a[124:127], a[148:151], v[172:175]
  s_add_u32 s24, s24, s30
  v_cvt_pk_bf16_f32 v63, v58, v59
  v_cvt_pk_bf16_f32 v70, v76, v77
  v_mfma_f32_16x16x32_bf16 v[172:175], a[120:123], a[144:147], v[172:175]
  buffer_store_dwordx4 v[60:63], v9, s[12:15], s38 offen offset:1024 sc1
  s_add_u32 s38, s38, s47
  v_accvgpr_read_b32 v52, a48
  v_accvgpr_read_b32 v53, a49
  v_mfma_f32_16x16x32_bf16 v[156:159], a[120:123], a[136:139], v[156:159]
  buffer_load_dwordx4 v4, s[68:71], s24 offen lds
  v_mfma_f32_16x16x32_bf16 v[156:159], a[124:127], a[140:143], v[156:159]
  v_accvgpr_read_b32 v54, a50
  v_accvgpr_read_b32 v55, a51
  v_mfma_f32_16x16x32_bf16 v[140:143], a[124:127], a[132:135], v[140:143]
  v_cvt_pk_bf16_f32 v32, v52, v53
  v_cvt_pk_bf16_f32 v33, v54, v55
  v_mfma_f32_16x16x32_bf16 v[140:143], a[120:123], a[128:131], v[140:143]
  v_accvgpr_read_b32 v56, a52
  v_accvgpr_read_b32 v57, a53
  v_mfma_f32_16x16x32_bf16 v[192:195], a[96:99], a[160:163], v[192:195]
  v_accvgpr_read_b32 v58, a54
  v_accvgpr_read_b32 v59, a55
  v_mfma_f32_16x16x32_bf16 v[192:195], a[100:103], a[164:167], v[192:195]
  v_cvt_pk_bf16_f32 v34, v56, v57
  v_cvt_pk_bf16_f32 v35, v58, v59
  v_mfma_f32_16x16x32_bf16 v[208:211], a[100:103], a[172:175], v[208:211]
  v_cvt_pk_bf16_f32 v71, v78, v79
  v_cvt_pk_bf16_f32 v72, v80, v81
  v_mfma_f32_16x16x32_bf16 v[208:211], a[96:99], a[168:171], v[208:211]
  v_cvt_pk_bf16_f32 v73, v82, v83
  v_cvt_pk_bf16_f32 v74, v84, v85
  v_mfma_f32_16x16x32_bf16 v[224:227], a[96:99], a[176:179], v[224:227]
  buffer_store_dwordx4 v[32:35], v9, s[12:15], s38 offen offset:0 sc1
  v_accvgpr_read_b32 v52, a56
  v_accvgpr_read_b32 v53, a57
  v_accvgpr_read_b32 v54, a58
  v_mfma_f32_16x16x32_bf16 v[224:227], a[100:103], a[180:183], v[224:227]
  v_accvgpr_read_b32 v55, a59
  v_cvt_pk_bf16_f32 v36, v52, v53
  v_mfma_f32_16x16x32_bf16 v[240:243], a[100:103], a[188:191], v[240:243]
  v_cvt_pk_bf16_f32 v37, v54, v55
  v_accvgpr_read_b32 v56, a60
  v_mfma_f32_16x16x32_bf16 v[240:243], a[96:99], a[184:187], v[240:243]
  v_accvgpr_read_b32 v57, a61
  v_accvgpr_read_b32 v58, a62
  v_mfma_f32_16x16x32_bf16 v[244:247], a[104:107], a[184:187], v[244:247]
  v_accvgpr_read_b32 v59, a63
  v_cvt_pk_bf16_f32 v38, v56, v57
  v_mfma_f32_16x16x32_bf16 v[244:247], a[108:111], a[188:191], v[244:247]
  v_cvt_pk_bf16_f32 v39, v58, v59
  v_cvt_pk_bf16_f32 v75, v86, v87
  v_mfma_f32_16x16x32_bf16 v[228:231], a[108:111], a[180:183], v[228:231]
  v_cvt_pk_bf16_f32 v76, v88, v89
  v_cvt_pk_bf16_f32 v77, v90, v91
  v_mfma_f32_16x16x32_bf16 v[228:231], a[104:107], a[176:179], v[228:231]
  v_cvt_pk_bf16_f32 v78, v92, v93
  v_cvt_pk_bf16_f32 v79, v94, v95
  v_mfma_f32_16x16x32_bf16 v[212:215], a[104:107], a[168:171], v[212:215]
  v_cvt_pk_bf16_f32 v80, v96, v97
  v_cvt_pk_bf16_f32 v81, v98, v99
  v_mfma_f32_16x16x32_bf16 v[212:215], a[108:111], a[172:175], v[212:215]
  v_cvt_pk_bf16_f32 v82, v100, v101
  v_cvt_pk_bf16_f32 v83, v102, v103
  v_mfma_f32_16x16x32_bf16 v[196:199], a[108:111], a[164:167], v[196:199]
  buffer_store_dwordx4 v[36:39], v9, s[12:15], s38 offen offset:1024 sc1
  s_add_u32 s38, s38, s47
  v_cvt_pk_bf16_f32 v84, v104, v105
  v_cvt_pk_bf16_f32 v85, v106, v107
  v_mfma_f32_16x16x32_bf16 v[196:199], a[104:107], a[160:163], v[196:199]
  v_cvt_pk_bf16_f32 v86, v108, v109
  v_cvt_pk_bf16_f32 v87, v110, v111
  v_mfma_f32_16x16x32_bf16 v[200:203], a[112:115], a[160:163], v[200:203]
  v_cvt_pk_bf16_f32 v88, v112, v113
  v_cvt_pk_bf16_f32 v89, v114, v115
  v_mfma_f32_16x16x32_bf16 v[200:203], a[116:119], a[164:167], v[200:203]
  v_cvt_pk_bf16_f32 v90, v116, v117
  v_cvt_pk_bf16_f32 v91, v118, v119
  v_mfma_f32_16x16x32_bf16 v[216:219], a[116:119], a[172:175], v[216:219]
  s_nop 0
  ds_read_b64_tr_b16 a[0:1], v28 offset:0
  ds_read_b64_tr_b16 a[2:3], v28 offset:2048
  v_mfma_f32_16x16x32_bf16 v[216:219], a[112:115], a[168:171], v[216:219]
  s_nop 0
  ds_read_b64_tr_b16 a[4:5], v28 offset:4096
  ds_read_b64_tr_b16 a[6:7], v28 offset:6144
  v_mfma_f32_16x16x32_bf16 v[232:235], a[112:115], a[176:179], v[232:235]
  ds_read_b64_tr_b16 a[8:9], v28 offset:8192
  v_cvt_pk_bf16_f32 v92, v120, v121
  v_mfma_f32_16x16x32_bf16 v[232:235], a[116:119], a[180:183], v[232:235]
  s_nop 0
  ds_read_b64_tr_b16 a[10:11], v28 offset:10240
  ds_read_b64_tr_b16 a[12:13], v28 offset:12288
  v_mfma_f32_16x16x32_bf16 v[248:251], a[116:119], a[188:191], v[248:251]
  ds_read_b64_tr_b16 a[14:15], v28 offset:14336
  v_cvt_pk_bf16_f32 v93, v122, v123
  v_mfma_f32_16x16x32_bf16 v[248:251], a[112:115], a[184:187], v[248:251]
  s_nop 0
  ds_read_b64_tr_b16 a[16:17], v28 offset:16384
  ds_read_b64_tr_b16 a[18:19], v28 offset:18432
  v_mfma_f32_16x16x32_bf16 v[252:255], a[120:123], a[184:187], v[252:255]
  ds_read_b64_tr_b16 a[20:21], v28 offset:20480
  v_cvt_pk_bf16_f32 v94, v124, v125
  v_mfma_f32_16x16x32_bf16 v[252:255], a[124:127], a[188:191], v[252:255]
  s_nop 0
  ds_read_b64_tr_b16 a[22:23], v28 offset:22528
  ds_read_b64_tr_b16 a[24:25], v28 offset:24576
  v_mfma_f32_16x16x32_bf16 v[236:239], a[124:127], a[180:183], v[236:239]
  s_nop 0
  ds_read_b64_tr_b16 a[26:27], v28 offset:26624
  ds_read_b64_tr_b16 a[28:29], v29 offset:0
  v_mfma_f32_16x16x32_bf16 v[236:239], a[120:123], a[176:179], v[236:239]
  ds_read_b64_tr_b16 a[30:31], v29 offset:2048
  v_cvt_pk_bf16_f32 v95, v126, v127
  v_mfma_f32_16x16x32_bf16 v[220:223], a[120:123], a[168:171], v[220:223]
  s_nop 0
  ds_read_b64_tr_b16 a[32:33], v29 offset:4096
  ds_read_b64_tr_b16 a[34:35], v29 offset:6144
  v_mfma_f32_16x16x32_bf16 v[220:223], a[124:127], a[172:175], v[220:223]
  ds_read_b64_tr_b16 a[36:37], v29 offset:8192
  v_cvt_pk_bf16_f32 v96, v128, v129
  v_mfma_f32_16x16x32_bf16 v[204:207], a[124:127], a[164:167], v[204:207]
  s_nop 0
  ds_read_b64_tr_b16 a[38:39], v29 offset:10240
  ds_read_b64_tr_b16 a[40:41], v29 offset:12288
  v_mfma_f32_16x16x32_bf16 v[204:207], a[120:123], a[160:163], v[204:207]
  s_waitcnt vmcnt(15)
  ds_read_b64_tr_b16 a[42:43], v29 offset:14336
  v_cvt_pk_bf16_f32 v97, v130, v131
  v_cvt_pk_bf16_f32 v98, v132, v133
  v_cvt_pk_bf16_f32 v99, v134, v135
  v_cvt_pk_bf16_f32 v100, v136, v137
  v_cvt_pk_bf16_f32 v101, v138, v139
  v_cvt_pk_bf16_f32 v102, v140, v141
  v_cvt_pk_bf16_f32 v103, v142, v143
  v_cvt_pk_bf16_f32 v104, v144, v145
  v_cvt_pk_bf16_f32 v105, v146, v147
  v_cvt_pk_bf16_f32 v106, v148, v149
  v_cvt_pk_bf16_f32 v107, v150, v151
  v_cvt_pk_bf16_f32 v108, v152, v153
  v_cvt_pk_bf16_f32 v109, v154, v155
  v_cvt_pk_bf16_f32 v110, v156, v157
  v_cvt_pk_bf16_f32 v111, v158, v159
KV_J:
  s_add_u32 s38, s41, s39
  s_waitcnt lgkmcnt(11)
  v_mfma_f32_16x16x32_bf16 v[128:131], a[0:3], a[192:195], 0
  s_mov_b32 s24, 384
  ds_read_b64_tr_b16 a[44:45], v29 offset:16384
  ds_read_b64_tr_b16 a[46:47], v29 offset:18432
  v_mfma_f32_16x16x32_bf16 v[128:131], a[4:7], a[200:203], v[128:131]
  s_add_u32 m0, s31, 98304
  ds_read_b64_tr_b16 a[48:49], v29 offset:20480
  ds_read_b64_tr_b16 a[50:51], v29 offset:22528
  v_mfma_f32_16x16x32_bf16 v[128:131], a[8:11], a[208:211], v[128:131]
  buffer_load_dwordx4 v4, s[68:71], s24 offen lds
  v_mfma_f32_16x16x32_bf16 v[128:131], a[12:15], a[216:219], v[128:131]
  s_add_u32 m0, m0, 4096
  ds_read_b64_tr_b16 a[52:53], v29 offset:24576
  ds_read_b64_tr_b16 a[54:55], v29 offset:26624
  v_mfma_f32_16x16x32_bf16 v[128:131], a[16:19], a[224:227], v[128:131]
  s_waitcnt lgkmcnt(9)
  s_add_u32 s24, s24, s30
  ds_read_b64_tr_b16 a[56:57], v30 offset:0
  v_mfma_f32_16x16x32_bf16 v[128:131], a[20:23], a[232:235], v[128:131]
  buffer_store_dwordx4 v[64:67], v9, s[12:15], s38 offen offset:0 sc1
  v_mov_b32 v2, 1
  v_add_u32 v26, s3, v9
  v_add_u32 v26, 0x20000, v26
  v_mfma_f32_16x16x32_bf16 v[128:131], a[24:27], a[240:243], v[128:131]
  buffer_load_dwordx4 v4, s[68:71], s24 offen lds
  v_mfma_f32_16x16x32_bf16 v[132:135], a[0:3], a[196:199], 0
  s_add_u32 m0, m0, 4096
  ds_read_b64_tr_b16 a[58:59], v30 offset:2048
  ds_read_b64_tr_b16 a[60:61], v30 offset:4096
  v_mfma_f32_16x16x32_bf16 v[132:135], a[4:7], a[204:207], v[132:135]
  s_add_u32 s24, s24, s30
  ds_read_b64_tr_b16 a[62:63], v30 offset:6144
  ds_read_b64_tr_b16 a[0:1], v30 offset:8192
  v_mfma_f32_16x16x32_bf16 v[132:135], a[8:11], a[212:215], v[132:135]
  s_add_u32 s54, s41, 1048576
  ds_read_b64_tr_b16 a[2:3], v30 offset:10240
  v_cvt_pk_bf16_f32 v112, v160, v161
  v_mfma_f32_16x16x32_bf16 v[132:135], a[12:15], a[220:223], v[132:135]
  s_lshl_b32 s55, s17, 3
  ds_read_b64_tr_b16 a[4:5], v30 offset:12288
  v_cvt_pk_bf16_f32 v113, v162, v163
  v_mfma_f32_16x16x32_bf16 v[132:135], a[16:19], a[228:231], v[132:135]
  buffer_load_dwordx4 v4, s[68:71], s24 offen lds
  v_mfma_f32_16x16x32_bf16 v[132:135], a[20:23], a[236:239], v[132:135]
  s_add_u32 m0, m0, 4096
  ds_read_b64_tr_b16 a[6:7], v30 offset:14336
  ds_read_b64_tr_b16 a[8:9], v30 offset:16384
  v_mfma_f32_16x16x32_bf16 v[132:135], a[24:27], a[244:247], v[132:135]
  s_add_u32 s24, s24, s30
  ds_read_b64_tr_b16 a[10:11], v30 offset:18432
  v_cvt_pk_bf16_f32 v114, v164, v165
  v_mfma_f32_16x16x32_bf16 v[136:139], a[28:31], a[192:195], 0
  s_waitcnt lgkmcnt(7)
  ds_read_b64_tr_b16 a[12:13], v30 offset:20480
  v_cvt_pk_bf16_f32 v115, v166, v167
  v_mfma_f32_16x16x32_bf16 v[136:139], a[32:35], a[200:203], v[136:139]
  buffer_load_dwordx4 v4, s[68:71], s24 offen lds
  v_mfma_f32_16x16x32_bf16 v[136:139], a[36:39], a[208:211], v[136:139]
  s_add_u32 m0, m0, 4096
  ds_read_b64_tr_b16 a[14:15], v30 offset:22528
  ds_read_b64_tr_b16 a[16:17], v30 offset:24576
  v_mfma_f32_16x16x32_bf16 v[136:139], a[40:43], a[216:219], v[136:139]
  s_add_u32 s24, s24, s30
  ds_read_b64_tr_b16 a[18:19], v30 offset:26624
  v_cvt_pk_bf16_f32 v116, v168, v169
  v_mfma_f32_16x16x32_bf16 v[136:139], a[44:47], a[224:227], v[136:139]
  s_add_u32 s55, s55, s23
  ds_read_b64_tr_b16 a[20:21], v31 offset:0
  v_cvt_pk_bf16_f32 v117, v170, v171
  v_mfma_f32_16x16x32_bf16 v[136:139], a[48:51], a[232:235], v[136:139]
  s_lshl_b32 s55, s55, 2
  ds_read_b64_tr_b16 a[22:23], v31 offset:2048
  v_cvt_pk_bf16_f32 v118, v172, v173
  v_mfma_f32_16x16x32_bf16 v[136:139], a[52:55], a[240:243], v[136:139]
  buffer_load_dwordx4 v4, s[68:71], s24 offen lds
  v_mfma_f32_16x16x32_bf16 v[140:143], a[28:31], a[196:199], 0
  s_add_u32 m0, m0, 4096
  ds_read_b64_tr_b16 a[24:25], v31 offset:4096
  ds_read_b64_tr_b16 a[26:27], v31 offset:6144
  v_mfma_f32_16x16x32_bf16 v[140:143], a[32:35], a[204:207], v[140:143]
  s_add_u32 s24, s24, s30
  ds_read_b64_tr_b16 a[28:29], v31 offset:8192
  v_cvt_pk_bf16_f32 v119, v174, v175
  v_mfma_f32_16x16x32_bf16 v[140:143], a[36:39], a[212:215], v[140:143]
  buffer_store_dwordx4 v[68:71], v9, s[12:15], s38 offen offset:1024 sc1
  s_add_u32 s38, s38, s47
  v_cvt_pk_bf16_f32 v120, v176, v177
  v_cvt_pk_bf16_f32 v121, v178, v179
  v_mfma_f32_16x16x32_bf16 v[140:143], a[40:43], a[220:223], v[140:143]
  buffer_load_dwordx4 v4, s[68:71], s24 offen lds
  v_mfma_f32_16x16x32_bf16 v[140:143], a[44:47], a[228:231], v[140:143]
  s_add_u32 m0, m0, 4096
  ds_read_b64_tr_b16 a[30:31], v31 offset:10240
  ds_read_b64_tr_b16 a[32:33], v31 offset:12288
  v_mfma_f32_16x16x32_bf16 v[140:143], a[48:51], a[236:239], v[140:143]
  s_add_u32 s24, s24, s30
  ds_read_b64_tr_b16 a[34:35], v31 offset:14336
  ds_read_b64_tr_b16 a[36:37], v31 offset:16384
  v_mfma_f32_16x16x32_bf16 v[140:143], a[52:55], a[244:247], v[140:143]
  s_waitcnt lgkmcnt(7)
  ds_read_b64_tr_b16 a[38:39], v31 offset:18432
  v_cvt_pk_bf16_f32 v122, v180, v181
  v_mfma_f32_16x16x32_bf16 v[144:147], a[56:59], a[192:195], 0
  buffer_load_dwordx4 v4, s[68:71], s24 offen lds
  v_mfma_f32_16x16x32_bf16 v[144:147], a[60:63], a[200:203], v[144:147]
  s_add_u32 s55, s55, s20
  ds_read_b64_tr_b16 a[40:41], v31 offset:20480
  ds_read_b64_tr_b16 a[42:43], v31 offset:22528
  v_mfma_f32_16x16x32_bf16 v[144:147], a[0:3], a[208:211], v[144:147]
  s_mul_i32 s55, s55, 17408
  ds_read_b64_tr_b16 a[44:45], v31 offset:24576
  v_cvt_pk_bf16_f32 v123, v182, v183
  v_mfma_f32_16x16x32_bf16 v[144:147], a[4:7], a[216:219], v[144:147]
  s_mov_b64 s[4:5], s[18:19]
  ds_read_b64_tr_b16 a[46:47], v31 offset:26624
  v_cvt_pk_bf16_f32 v124, v184, v185
  v_mfma_f32_16x16x32_bf16 v[144:147], a[8:11], a[224:227], v[144:147]
  s_cmp_eq_u32 s46, 2
  s_cselect_b32 s6, 268435456, 0
  s_cselect_b32 s53, s67, 268435456
  v_mfma_f32_16x16x32_bf16 v[144:147], a[12:15], a[232:235], v[144:147]
  s_barrier
  v_mfma_f32_16x16x32_bf16 v[144:147], a[16:19], a[240:243], v[144:147]
  s_mov_b32 s28, 5
  ds_read_b64_tr_b16 a[48:49], v28 offset:32768
  ds_read_b64_tr_b16 a[50:51], v28 offset:34816
  v_mfma_f32_16x16x32_bf16 v[148:151], a[56:59], a[196:199], 0
  s_mov_b32 s29, 0
  ds_read_b64_tr_b16 a[52:53], v28 offset:36864
  ds_read_b64_tr_b16 a[54:55], v28 offset:38912
  v_mfma_f32_16x16x32_bf16 v[148:151], a[60:63], a[204:207], v[148:151]
  buffer_load_dwordx4 a[128:131], v9, s[12:15], s48 offen offset:3072 sc1
  v_mfma_f32_16x16x32_bf16 v[148:151], a[0:3], a[212:215], v[148:151]
  s_mov_b32 s7, 0x20000
  ds_read_b64_tr_b16 a[56:57], v28 offset:40960
  ds_read_b64_tr_b16 a[58:59], v28 offset:43008
  v_mfma_f32_16x16x32_bf16 v[148:151], a[4:7], a[220:223], v[148:151]
  s_mov_b32 s44, 0
  ds_read_b64_tr_b16 a[60:61], v28 offset:45056
  v_cvt_pk_bf16_f32 v125, v186, v187
  v_mfma_f32_16x16x32_bf16 v[148:151], a[8:11], a[228:231], v[148:151]
  s_sub_u32 s43, s42, 1
  ds_read_b64_tr_b16 a[62:63], v28 offset:47104
  v_cvt_pk_bf16_f32 v126, v188, v189
  v_mfma_f32_16x16x32_bf16 v[148:151], a[12:15], a[236:239], v[148:151]
  buffer_store_dwordx4 v[72:75], v9, s[12:15], s38 offen offset:0 sc1
  v_cvt_pk_bf16_f32 v127, v190, v191
  v_cvt_pk_bf16_f32 v48, v192, v193
  v_cvt_pk_bf16_f32 v49, v194, v195
  v_mfma_f32_16x16x32_bf16 v[148:151], a[16:19], a[244:247], v[148:151]
  s_waitcnt lgkmcnt(6)
  ds_read_b64_tr_b16 a[0:1], v28 offset:49152
  ds_read_b64_tr_b16 a[2:3], v28 offset:51200
  v_mfma_f32_16x16x32_bf16 v[152:155], a[20:23], a[192:195], 0
  buffer_load_dwordx4 a[132:135], v9, s[12:15], s49 offen offset:3072 sc1
  v_mfma_f32_16x16x32_bf16 v[152:155], a[24:27], a[200:203], v[152:155]
  s_mov_b32 s45, 2
  ds_read_b64_tr_b16 a[4:5], v28 offset:53248
  ds_read_b64_tr_b16 a[6:7], v28 offset:55296
  v_mfma_f32_16x16x32_bf16 v[152:155], a[28:31], a[208:211], v[152:155]
  s_mov_b32 s32, 0
  ds_read_b64_tr_b16 a[8:9], v28 offset:57344
  v_cvt_pk_bf16_f32 v50, v196, v197
  v_mfma_f32_16x16x32_bf16 v[152:155], a[32:35], a[216:219], v[152:155]
  s_mov_b32 s25, 0
  ds_read_b64_tr_b16 a[10:11], v28 offset:59392
  v_xor_b32 v28, 0x10000, v28
  v_mfma_f32_16x16x32_bf16 v[152:155], a[36:39], a[224:227], v[152:155]
  s_add_u32 s26, s55, 0
  ds_read_b64_tr_b16 a[12:13], v29 offset:32768
  v_cvt_pk_bf16_f32 v51, v198, v199
  v_mfma_f32_16x16x32_bf16 v[152:155], a[40:43], a[232:235], v[152:155]
  s_add_u32 s48, s48, 4096
  ds_read_b64_tr_b16 a[14:15], v29 offset:34816
  v_cvt_pk_bf16_f32 v52, v200, v201
  v_mfma_f32_16x16x32_bf16 v[152:155], a[44:47], a[240:243], v[152:155]
  buffer_load_dwordx4 a[136:139], v9, s[12:15], s48 offen offset:0 sc1
  v_mfma_f32_16x16x32_bf16 v[156:159], a[20:23], a[196:199], 0
  s_lshl_b32 s60, s20, 8
  ds_read_b64_tr_b16 a[16:17], v29 offset:36864
  ds_read_b64_tr_b16 a[18:19], v29 offset:38912
  v_mfma_f32_16x16x32_bf16 v[156:159], a[24:27], a[204:207], v[156:159]
  s_add_u32 s60, s60, s2
  ds_read_b64_tr_b16 a[20:21], v29 offset:40960
  v_cvt_pk_bf16_f32 v53, v202, v203
  v_mfma_f32_16x16x32_bf16 v[156:159], a[28:31], a[212:215], v[156:159]
  s_lshl_b32 s61, s60, 13
  ds_read_b64_tr_b16 a[22:23], v29 offset:43008
  v_cvt_pk_bf16_f32 v54, v204, v205
  v_mfma_f32_16x16x32_bf16 v[156:159], a[32:35], a[220:223], v[156:159]
  s_add_u32 s76, s100, s61
  s_addc_u32 s77, s101, 0
  ds_read_b64_tr_b16 a[24:25], v29 offset:45056
  v_cvt_pk_bf16_f32 v55, v206, v207
  v_mfma_f32_16x16x32_bf16 v[156:159], a[36:39], a[228:231], v[156:159]
  s_add_u32 s84, s84, s61
  s_addc_u32 s85, s85, 0
  ds_read_b64_tr_b16 a[26:27], v29 offset:47104
  v_cvt_pk_bf16_f32 v56, v208, v209
  v_mfma_f32_16x16x32_bf16 v[156:159], a[40:43], a[236:239], v[156:159]
  s_add_u32 s86, s86, s61
  s_addc_u32 s87, s87, 0
  ds_read_b64_tr_b16 a[28:29], v29 offset:49152
  v_cvt_pk_bf16_f32 v57, v210, v211
  v_mfma_f32_16x16x32_bf16 v[156:159], a[44:47], a[244:247], v[156:159]
  s_getpc_b64 s[62:63]
PC_5:
  ds_read_b64_tr_b16 a[30:31], v29 offset:51200
  v_cvt_pk_bf16_f32 v58, v212, v213
  v_mfma_f32_16x16x32_bf16 v[160:163], a[48:51], a[192:195], 0
  s_waitcnt lgkmcnt(6)
  s_mov_b32 s24, 1835008
  ds_read_b64_tr_b16 a[32:33], v29 offset:53248
  v_mfma_f32_16x16x32_bf16 v[160:163], a[52:55], a[200:203], v[160:163]
  s_add_u32 m0, s31, 0
  ds_read_b64_tr_b16 a[34:35], v29 offset:55296
  v_cvt_pk_bf16_f32 v59, v214, v215
  v_mfma_f32_16x16x32_bf16 v[160:163], a[56:59], a[208:211], v[160:163]
  buffer_load_dwordx4 v4, s[68:71], s24 offen lds
  v_mfma_f32_16x16x32_bf16 v[160:163], a[60:63], a[216:219], v[160:163]
  s_add_u32 m0, m0, 4096
  ds_read_b64_tr_b16 a[36:37], v29 offset:57344
  ds_read_b64_tr_b16 a[38:39], v29 offset:59392
  v_mfma_f32_16x16x32_bf16 v[160:163], a[0:3], a[224:227], v[160:163]
  s_add_u32 s24, s24, s30
  ds_read_b64_tr_b16 a[40:41], v30 offset:32768
  v_xor_b32 v29, 0x10000, v29
  v_mfma_f32_16x16x32_bf16 v[160:163], a[4:7], a[232:235], v[160:163]
  buffer_store_dwordx4 v[76:79], v9, s[12:15], s38 offen offset:1024 sc1
  s_add_u32 s38, s38, s47
  v_cvt_pk_bf16_f32 v60, v216, v217
  v_cvt_pk_bf16_f32 v61, v218, v219
  v_mfma_f32_16x16x32_bf16 v[160:163], a[8:11], a[240:243], v[160:163]
  buffer_load_dwordx4 v4, s[68:71], s24 offen lds
  v_mfma_f32_16x16x32_bf16 v[164:167], a[48:51], a[196:199], 0
  s_add_u32 m0, m0, 4096
  ds_read_b64_tr_b16 a[42:43], v30 offset:34816
  ds_read_b64_tr_b16 a[44:45], v30 offset:36864
  v_mfma_f32_16x16x32_bf16 v[164:167], a[52:55], a[204:207], v[164:167]
  s_add_u32 s24, s24, s30
  ds_read_b64_tr_b16 a[46:47], v30 offset:38912
  ds_read_b64_tr_b16 a[48:49], v30 offset:40960
  v_mfma_f32_16x16x32_bf16 v[164:167], a[56:59], a[212:215], v[164:167]
  s_sub_u32 s61, s61, 3670016-(TL_BEGIN-PC_5)
  ds_read_b64_tr_b16 a[50:51], v30 offset:43008
  v_cvt_pk_bf16_f32 v62, v220, v221
  v_mfma_f32_16x16x32_bf16 v[164:167], a[60:63], a[220:223], v[164:167]
  s_add_u32 s62, s62, s61
  s_addc_u32 s63, s63, 0
  ds_read_b64_tr_b16 a[52:53], v30 offset:45056
  v_cvt_pk_bf16_f32 v63, v222, v223
  v_mfma_f32_16x16x32_bf16 v[164:167], a[0:3], a[228:231], v[164:167]
  buffer_load_dwordx4 v4, s[68:71], s24 offen lds
  v_mfma_f32_16x16x32_bf16 v[164:167], a[4:7], a[236:239], v[164:167]
  s_add_u32 m0, m0, 4096
  ds_read_b64_tr_b16 a[54:55], v30 offset:47104
  ds_read_b64_tr_b16 a[56:57], v30 offset:49152
  v_mfma_f32_16x16x32_bf16 v[164:167], a[8:11], a[244:247], v[164:167]
  s_add_u32 s24, s24, s30
  ds_read_b64_tr_b16 a[58:59], v30 offset:51200
  v_cvt_pk_bf16_f32 v32, v224, v225
  v_mfma_f32_16x16x32_bf16 v[168:171], a[12:15], a[192:195], 0
  s_waitcnt lgkmcnt(7)
  ds_read_b64_tr_b16 a[60:61], v30 offset:53248
  v_cvt_pk_bf16_f32 v33, v226, v227
  v_mfma_f32_16x16x32_bf16 v[168:171], a[16:19], a[200:203], v[168:171]
  buffer_load_dwordx4 v4, s[68:71], s24 offen lds
  v_mfma_f32_16x16x32_bf16 v[168:171], a[20:23], a[208:211], v[168:171]
  s_add_u32 m0, m0, 4096
  ds_read_b64_tr_b16 a[62:63], v30 offset:55296
  ds_read_b64_tr_b16 a[0:1], v30 offset:57344
  v_mfma_f32_16x16x32_bf16 v[168:171], a[24:27], a[216:219], v[168:171]
  s_add_u32 s24, s24, s30
  ds_read_b64_tr_b16 a[2:3], v30 offset:59392
  v_xor_b32 v30, 0x10000, v30
  v_mfma_f32_16x16x32_bf16 v[168:171], a[28:31], a[224:227], v[168:171]
  s_mul_i32 s9, s60, 5
  ds_read_b64_tr_b16 a[4:5], v31 offset:32768
  v_cvt_pk_bf16_f32 v34, v228, v229
  v_mfma_f32_16x16x32_bf16 v[168:171], a[32:35], a[232:235], v[168:171]
  s_lshr_b32 s9, s9, 10
  ds_read_b64_tr_b16 a[6:7], v31 offset:34816
  v_cvt_pk_bf16_f32 v35, v230, v231
  v_mfma_f32_16x16x32_bf16 v[168:171], a[36:39], a[240:243], v[168:171]
  buffer_load_dwordx4 v4, s[68:71], s24 offen lds
  v_mfma_f32_16x16x32_bf16 v[172:175], a[12:15], a[196:199], 0
  s_add_u32 m0, m0, 4096
  ds_read_b64_tr_b16 a[8:9], v31 offset:36864
  ds_read_b64_tr_b16 a[10:11], v31 offset:38912
  v_mfma_f32_16x16x32_bf16 v[172:175], a[16:19], a[204:207], v[172:175]
  s_add_u32 s24, s24, s30
  ds_read_b64_tr_b16 a[12:13], v31 offset:40960
  v_cvt_pk_bf16_f32 v36, v232, v233
  v_mfma_f32_16x16x32_bf16 v[172:175], a[20:23], a[212:215], v[172:175]
  buffer_store_dwordx4 v[80:83], v9, s[12:15], s38 offen offset:0 sc1
  v_cvt_pk_bf16_f32 v37, v234, v235
  v_cvt_pk_bf16_f32 v38, v236, v237
  v_cvt_pk_bf16_f32 v39, v238, v239
  v_mfma_f32_16x16x32_bf16 v[172:175], a[24:27], a[220:223], v[172:175]
  buffer_load_dwordx4 v4, s[68:71], s24 offen lds
  v_mfma_f32_16x16x32_bf16 v[172:175], a[28:31], a[228:231], v[172:175]
  s_add_u32 m0, m0, 4096
  ds_read_b64_tr_b16 a[14:15], v31 offset:43008
  ds_read_b64_tr_b16 a[16:17], v31 offset:45056
  v_mfma_f32_16x16x32_bf16 v[172:175], a[32:35], a[236:239], v[172:175]
  s_add_u32 s24, s24, s30
  ds_read_b64_tr_b16 a[18:19], v31 offset:47104
  ds_read_b64_tr_b16 a[20:21], v31 offset:49152
  v_mfma_f32_16x16x32_bf16 v[172:175], a[36:39], a[244:247], v[172:175]
  s_waitcnt lgkmcnt(7)
  ds_read_b64_tr_b16 a[22:23], v31 offset:51200
  v_cvt_pk_bf16_f32 v40, v240, v241
  v_mfma_f32_16x16x32_bf16 v[176:179], a[40:43], a[192:195], 0
  buffer_load_dwordx4 v4, s[68:71], s24 offen lds
  v_mfma_f32_16x16x32_bf16 v[176:179], a[44:47], a[200:203], v[176:179]
  s_add_u32 s10, s9, 2
  ds_read_b64_tr_b16 a[24:25], v31 offset:53248
  ds_read_b64_tr_b16 a[26:27], v31 offset:55296
  v_mfma_f32_16x16x32_bf16 v[176:179], a[48:51], a[208:211], v[176:179]
  s_add_u32 s11, s9, 6
  ds_read_b64_tr_b16 a[28:29], v31 offset:57344
  v_cvt_pk_bf16_f32 v41, v242, v243
  v_mfma_f32_16x16x32_bf16 v[176:179], a[52:55], a[216:219], v[176:179]
  s_cmp_ge_u32 s60, 448
  s_cmov_b64 s[76:77], s[62:63]
  ds_read_b64_tr_b16 a[30:31], v31 offset:59392
  v_xor_b32 v31, 0x10000, v31
  v_mfma_f32_16x16x32_bf16 v[176:179], a[56:59], a[224:227], v[176:179]
  s_waitcnt vmcnt(24)
  v_mfma_f32_16x16x32_bf16 v[176:179], a[60:63], a[232:235], v[176:179]
  s_barrier
  v_mfma_f32_16x16x32_bf16 v[176:179], a[0:3], a[240:243], v[176:179]
  s_cmp_ge_u32 s60, 896
  s_cmov_b32 s10, 99
  s_cmov_b32 s11, 99
  ds_read_b64_tr_b16 a[32:33], v28 offset:0
  ds_read_b64_tr_b16 a[34:35], v28 offset:2048
  v_mfma_f32_16x16x32_bf16 v[180:183], a[40:43], a[196:199], 0
  s_add_u32 s49, s49, 4096
  ds_read_b64_tr_b16 a[36:37], v28 offset:4096
  ds_read_b64_tr_b16 a[38:39], v28 offset:6144
  v_mfma_f32_16x16x32_bf16 v[180:183], a[44:47], a[204:207], v[180:183]
  buffer_load_dwordx4 a[140:143], v9, s[12:15], s49 offen offset:0 sc1
  v_mfma_f32_16x16x32_bf16 v[180:183], a[48:51], a[212:215], v[180:183]
  s_cmp_ge_u32 s60, 448+(ALL_END-TL_BEGIN)/8192
  s_cmov_b64 s[76:77], s[84:85]
  s_cmov_b64 s[84:85], s[86:87]
  s_cmov_b32 s9, s10
  s_cmov_b32 s10, s11
  ds_read_b64_tr_b16 a[40:41], v28 offset:8192
  ds_read_b64_tr_b16 a[42:43], v28 offset:10240
  v_mfma_f32_16x16x32_bf16 v[180:183], a[52:55], a[220:223], v[180:183]
  buffer_store_dwordx4 v[84:87], v9, s[12:15], s38 offen offset:1024 sc1
  s_add_u32 s38, s38, s47
  v_cvt_pk_bf16_f32 v42, v244, v245
  v_cvt_pk_bf16_f32 v43, v246, v247
  v_mfma_f32_16x16x32_bf16 v[180:183], a[56:59], a[228:231], v[180:183]
  s_mov_b32 s8, 0
  ds_read_b64_tr_b16 a[44:45], v28 offset:12288
  ds_read_b64_tr_b16 a[46:47], v28 offset:14336
  v_mfma_f32_16x16x32_bf16 v[180:183], a[60:63], a[236:239], v[180:183]
  s_bfe_u32 s16, s2, 0x10003
  ds_read_b64_tr_b16 a[48:49], v28 offset:16384
  v_cvt_pk_bf16_f32 v44, v248, v249
  v_mfma_f32_16x16x32_bf16 v[180:183], a[0:3], a[244:247], v[180:183]
  s_waitcnt lgkmcnt(7)
  ds_read_b64_tr_b16 a[50:51], v28 offset:18432
  v_cvt_pk_bf16_f32 v45, v250, v251
  v_mfma_f32_16x16x32_bf16 v[184:187], a[4:7], a[192:195], 0
  buffer_load_dwordx4 a[144:147], v9, s[12:15], s48 offen offset:1024 sc1
  v_mfma_f32_16x16x32_bf16 v[184:187], a[8:11], a[200:203], v[184:187]
  s_lshl_b32 s16, s16, 2
  ds_read_b64_tr_b16 a[52:53], v28 offset:20480
  ds_read_b64_tr_b16 a[54:55], v28 offset:22528
  v_mfma_f32_16x16x32_bf16 v[184:187], a[12:15], a[208:211], v[184:187]
  s_add_u32 s16, s16, s20
  ds_read_b64_tr_b16 a[56:57], v28 offset:24576
  v_cvt_pk_bf16_f32 v46, v252, v253
  v_mfma_f32_16x16x32_bf16 v[184:187], a[16:19], a[216:219], v[184:187]
  s_lshl_b32 s16, s16, 13
  ds_read_b64_tr_b16 a[58:59], v28 offset:26624
  v_cvt_pk_bf16_f32 v47, v254, v255
  v_mfma_f32_16x16x32_bf16 v[184:187], a[20:23], a[224:227], v[184:187]
  s_add_u32 s16, s16, AT_LAST1-PC_1
  ds_read_b64_tr_b16 a[60:61], v29 offset:0
  v_accvgpr_write_b32 a152, v32
  v_mfma_f32_16x16x32_bf16 v[184:187], a[24:27], a[232:235], v[184:187]
  s_cmp_eq_u32 s40, 7
  s_cselect_b32 s16, s16, 0x100000
  ds_read_b64_tr_b16 a[62:63], v29 offset:2048
  v_accvgpr_write_b32 a153, v33
  v_mfma_f32_16x16x32_bf16 v[184:187], a[28:31], a[240:243], v[184:187]
  buffer_load_dwordx4 a[148:151], v9, s[12:15], s49 offen offset:1024 sc1
  v_mfma_f32_16x16x32_bf16 v[188:191], a[4:7], a[196:199], 0
  s_nop 0
  ds_read_b64_tr_b16 a[0:1], v29 offset:4096
  ds_read_b64_tr_b16 a[2:3], v29 offset:6144
  v_mfma_f32_16x16x32_bf16 v[188:191], a[8:11], a[204:207], v[188:191]
  ds_read_b64_tr_b16 a[4:5], v29 offset:8192
  v_accvgpr_write_b32 a154, v34
  v_mfma_f32_16x16x32_bf16 v[188:191], a[12:15], a[212:215], v[188:191]
  ds_read_b64_tr_b16 a[6:7], v29 offset:10240
  v_accvgpr_write_b32 a155, v35
  v_mfma_f32_16x16x32_bf16 v[188:191], a[16:19], a[220:223], v[188:191]
  ds_read_b64_tr_b16 a[8:9], v29 offset:12288
  v_accvgpr_write_b32 a156, v36
  v_mfma_f32_16x16x32_bf16 v[188:191], a[20:23], a[228:231], v[188:191]
  ds_read_b64_tr_b16 a[10:11], v29 offset:14336
  v_accvgpr_write_b32 a157, v37
  v_mfma_f32_16x16x32_bf16 v[188:191], a[24:27], a[236:239], v[188:191]
  ds_read_b64_tr_b16 a[12:13], v29 offset:16384
  v_accvgpr_write_b32 a158, v38
  v_mfma_f32_16x16x32_bf16 v[188:191], a[28:31], a[244:247], v[188:191]
  ds_read_b64_tr_b16 a[14:15], v29 offset:18432
  v_accvgpr_write_b32 a159, v39
  v_mfma_f32_16x16x32_bf16 v[192:195], a[32:35], a[192:195], 0
  s_waitcnt lgkmcnt(6)
  s_mov_b32 s24, 1835136
  ds_read_b64_tr_b16 a[16:17], v29 offset:20480
  v_mfma_f32_16x16x32_bf16 v[192:195], a[36:39], a[200:203], v[192:195]
  s_add_u32 m0, s31, 32768
  ds_read_b64_tr_b16 a[18:19], v29 offset:22528
  v_accvgpr_write_b32 a248, v40
  v_mfma_f32_16x16x32_bf16 v[192:195], a[40:43], a[208:211], v[192:195]
  buffer_load_dwordx4 v4, s[68:71], s24 offen lds
  v_mfma_f32_16x16x32_bf16 v[192:195], a[44:47], a[216:219], v[192:195]
  s_add_u32 m0, m0, 4096
  ds_read_b64_tr_b16 a[20:21], v29 offset:24576
  ds_read_b64_tr_b16 a[22:23], v29 offset:26624
  v_mfma_f32_16x16x32_bf16 v[192:195], a[48:51], a[224:227], v[192:195]
  s_add_u32 s24, s24, s30
  ds_read_b64_tr_b16 a[24:25], v30 offset:0
  v_accvgpr_write_b32 a249, v41
  v_mfma_f32_16x16x32_bf16 v[192:195], a[52:55], a[232:235], v[192:195]
  buffer_store_dwordx4 v[88:91], v9, s[12:15], s38 offen offset:0 sc1
  v_accvgpr_write_b32 a250, v42
  v_accvgpr_write_b32 a251, v43
  v_accvgpr_write_b32 a252, v44
  v_mfma_f32_16x16x32_bf16 v[192:195], a[56:59], a[240:243], v[192:195]
  buffer_load_dwordx4 v4, s[68:71], s24 offen lds
  v_mfma_f32_16x16x32_bf16 v[196:199], a[32:35], a[196:199], 0
  s_add_u32 m0, m0, 4096
  ds_read_b64_tr_b16 a[26:27], v30 offset:2048
  ds_read_b64_tr_b16 a[28:29], v30 offset:4096
  v_mfma_f32_16x16x32_bf16 v[196:199], a[36:39], a[204:207], v[196:199]
  s_add_u32 s24, s24, s30
  ds_read_b64_tr_b16 a[30:31], v30 offset:6144
  ds_read_b64_tr_b16 a[32:33], v30 offset:8192
  v_mfma_f32_16x16x32_bf16 v[196:199], a[40:43], a[212:215], v[196:199]
  ds_read_b64_tr_b16 a[34:35], v30 offset:10240
  v_accvgpr_write_b32 a253, v45
  v_mfma_f32_16x16x32_bf16 v[196:199], a[44:47], a[220:223], v[196:199]
  ds_read_b64_tr_b16 a[36:37], v30 offset:12288
  v_accvgpr_write_b32 a254, v46
  v_mfma_f32_16x16x32_bf16 v[196:199], a[48:51], a[228:231], v[196:199]
  buffer_load_dwordx4 v4, s[68:71], s24 offen lds
  v_mfma_f32_16x16x32_bf16 v[196:199], a[52:55], a[236:239], v[196:199]
  s_add_u32 m0, m0, 4096
  ds_read_b64_tr_b16 a[38:39], v30 offset:14336
  ds_read_b64_tr_b16 a[40:41], v30 offset:16384
  v_mfma_f32_16x16x32_bf16 v[196:199], a[56:59], a[244:247], v[196:199]
  s_add_u32 s24, s24, s30
  ds_read_b64_tr_b16 a[42:43], v30 offset:18432
  v_accvgpr_write_b32 a255, v47
  v_mfma_f32_16x16x32_bf16 v[200:203], a[60:63], a[192:195], 0
  s_waitcnt lgkmcnt(7)
  ds_read_b64_tr_b16 a[44:45], v30 offset:20480
  v_mov_b64 v[32:33], 0
  v_mfma_f32_16x16x32_bf16 v[200:203], a[0:3], a[200:203], v[200:203]
  buffer_load_dwordx4 v4, s[68:71], s24 offen lds
  v_mfma_f32_16x16x32_bf16 v[200:203], a[4:7], a[208:211], v[200:203]
  s_add_u32 m0, m0, 4096
  ds_read_b64_tr_b16 a[46:47], v30 offset:22528
  ds_read_b64_tr_b16 a[48:49], v30 offset:24576
  v_mfma_f32_16x16x32_bf16 v[200:203], a[8:11], a[216:219], v[200:203]
  s_add_u32 s24, s24, s30
  ds_read_b64_tr_b16 a[50:51], v30 offset:26624
  v_mov_b64 v[34:35], 0
  v_mfma_f32_16x16x32_bf16 v[200:203], a[12:15], a[224:227], v[200:203]
  buffer_store_dwordx4 v[92:95], v9, s[12:15], s38 offen offset:1024 sc1
  s_add_u32 s38, s54, s39
  v_mov_b64 v[36:37], 0
  v_mov_b64 v[38:39], 0
  v_mfma_f32_16x16x32_bf16 v[200:203], a[16:19], a[232:235], v[200:203]
  s_nop 0
  ds_read_b64_tr_b16 a[52:53], v31 offset:0
  ds_read_b64_tr_b16 a[54:55], v31 offset:2048
  v_mfma_f32_16x16x32_bf16 v[200:203], a[20:23], a[240:243], v[200:203]
  buffer_load_dwordx4 v4, s[68:71], s24 offen lds
  v_mfma_f32_16x16x32_bf16 v[204:207], a[60:63], a[196:199], 0
  s_add_u32 m0, m0, 4096
  ds_read_b64_tr_b16 a[56:57], v31 offset:4096
  ds_read_b64_tr_b16 a[58:59], v31 offset:6144
  v_mfma_f32_16x16x32_bf16 v[204:207], a[0:3], a[204:207], v[204:207]
  s_add_u32 s24, s24, s30
  ds_read_b64_tr_b16 a[60:61], v31 offset:8192
  v_mov_b64 v[40:41], 0
  v_mfma_f32_16x16x32_bf16 v[204:207], a[4:7], a[212:215], v[204:207]
  ds_read_b64_tr_b16 a[62:63], v31 offset:10240
  v_mov_b64 v[42:43], 0
  v_mfma_f32_16x16x32_bf16 v[204:207], a[8:11], a[220:223], v[204:207]
  buffer_load_dwordx4 v4, s[68:71], s24 offen lds
  v_mfma_f32_16x16x32_bf16 v[204:207], a[12:15], a[228:231], v[204:207]
  s_add_u32 m0, m0, 4096
  ds_read_b64_tr_b16 a[0:1], v31 offset:12288
  ds_read_b64_tr_b16 a[2:3], v31 offset:14336
  v_mfma_f32_16x16x32_bf16 v[204:207], a[16:19], a[236:239], v[204:207]
  s_add_u32 s24, s24, s30
  ds_read_b64_tr_b16 a[4:5], v31 offset:16384
  v_mov_b64 v[44:45], 0
  v_mfma_f32_16x16x32_bf16 v[204:207], a[20:23], a[244:247], v[204:207]
  s_waitcnt lgkmcnt(7)
  ds_read_b64_tr_b16 a[6:7], v31 offset:18432
  v_mov_b64 v[46:47], 0
  v_mfma_f32_16x16x32_bf16 v[208:211], a[24:27], a[192:195], 0
  buffer_load_dwordx4 v4, s[68:71], s24 offen lds
  v_mfma_f32_16x16x32_bf16 v[208:211], a[28:31], a[200:203], v[208:211]
  s_cmp_eq_u32 s40, 0
  s_cbranch_scc1 AT_BLK0
AT_BLK0_B:
  ds_read_b64_tr_b16 a[8:9], v31 offset:20480
  ds_read_b64_tr_b16 a[10:11], v31 offset:22528
  v_mfma_f32_16x16x32_bf16 v[208:211], a[32:35], a[208:211], v[208:211]
  ds_read_b64_tr_b16 a[12:13], v31 offset:24576
  v_mfma_f32_16x16x32_bf16 v[208:211], a[36:39], a[216:219], v[208:211]
  ds_read_b64_tr_b16 a[14:15], v31 offset:26624
  v_mfma_f32_16x16x32_bf16 v[208:211], a[40:43], a[224:227], v[208:211]
  s_waitcnt vmcnt(26)
  v_mfma_f32_16x16x32_bf16 v[208:211], a[44:47], a[232:235], v[208:211]
  s_barrier
  v_mfma_f32_16x16x32_bf16 v[208:211], a[48:51], a[240:243], v[208:211]
  s_nop 0
  ds_read_b64_tr_b16 a[16:17], v28 offset:32768
  ds_read_b64_tr_b16 a[18:19], v28 offset:34816
  v_mfma_f32_16x16x32_bf16 v[212:215], a[24:27], a[196:199], 0
  s_nop 0
  ds_read_b64_tr_b16 a[20:21], v28 offset:36864
  ds_read_b64_tr_b16 a[22:23], v28 offset:38912
  v_mfma_f32_16x16x32_bf16 v[212:215], a[28:31], a[204:207], v[212:215]
  ds_read_b64_tr_b16 a[24:25], v28 offset:40960
  v_mfma_f32_16x16x32_bf16 v[212:215], a[32:35], a[212:215], v[212:215]
  ds_read_b64_tr_b16 a[26:27], v28 offset:43008
  v_mfma_f32_16x16x32_bf16 v[212:215], a[36:39], a[220:223], v[212:215]
  s_nop 0
  ds_read_b128 a[64:67], v26 offset:0
  ds_read_b64_tr_b16 a[28:29], v28 offset:45056
  v_mfma_f32_16x16x32_bf16 v[212:215], a[40:43], a[228:231], v[212:215]
  ds_read_b64_tr_b16 a[30:31], v28 offset:47104
  v_mfma_f32_16x16x32_bf16 v[212:215], a[44:47], a[236:239], v[212:215]
  ds_read_b64_tr_b16 a[32:33], v28 offset:49152
  v_mfma_f32_16x16x32_bf16 v[212:215], a[48:51], a[244:247], v[212:215]
  ds_read_b64_tr_b16 a[34:35], v28 offset:51200
  v_mfma_f32_16x16x32_bf16 v[216:219], a[52:55], a[192:195], 0
  s_waitcnt lgkmcnt(7)
  ds_read_b64_tr_b16 a[36:37], v28 offset:53248
  v_mfma_f32_16x16x32_bf16 v[216:219], a[56:59], a[200:203], v[216:219]
  ds_read_b64_tr_b16 a[38:39], v28 offset:55296
  v_mfma_f32_16x16x32_bf16 v[216:219], a[60:63], a[208:211], v[216:219]
  s_nop 0
  ds_read_b128 a[68:71], v26 offset:1024
  ds_read_b64_tr_b16 a[40:41], v28 offset:57344
  v_mfma_f32_16x16x32_bf16 v[216:219], a[0:3], a[216:219], v[216:219]
  ds_read_b64_tr_b16 a[42:43], v28 offset:59392
  v_xor_b32 v28, 0x10000, v28
  v_mfma_f32_16x16x32_bf16 v[216:219], a[4:7], a[224:227], v[216:219]
  ds_read_b64_tr_b16 a[44:45], v29 offset:32768
  v_mfma_f32_16x16x32_bf16 v[216:219], a[8:11], a[232:235], v[216:219]
  ds_read_b64_tr_b16 a[46:47], v29 offset:34816
  v_mfma_f32_16x16x32_bf16 v[216:219], a[12:15], a[240:243], v[216:219]
  ds_read_b64_tr_b16 a[48:49], v29 offset:36864
  v_mfma_f32_16x16x32_bf16 v[220:223], a[52:55], a[196:199], 0
  ds_read_b64_tr_b16 a[50:51], v29 offset:38912
  v_mfma_f32_16x16x32_bf16 v[220:223], a[56:59], a[204:207], v[220:223]
  s_nop 0
  ds_read_b128 a[72:75], v26 offset:2048
  ds_read_b64_tr_b16 a[52:53], v29 offset:40960
  v_mfma_f32_16x16x32_bf16 v[220:223], a[60:63], a[212:215], v[220:223]
  ds_read_b64_tr_b16 a[54:55], v29 offset:43008
  v_mfma_f32_16x16x32_bf16 v[220:223], a[0:3], a[220:223], v[220:223]
  ds_read_b64_tr_b16 a[56:57], v29 offset:45056
  v_mfma_f32_16x16x32_bf16 v[220:223], a[4:7], a[228:231], v[220:223]
  ds_read_b64_tr_b16 a[58:59], v29 offset:47104
  v_mfma_f32_16x16x32_bf16 v[220:223], a[8:11], a[236:239], v[220:223]
  ds_read_b64_tr_b16 a[60:61], v29 offset:49152
  v_mfma_f32_16x16x32_bf16 v[220:223], a[12:15], a[244:247], v[220:223]
  ds_read_b64_tr_b16 a[62:63], v29 offset:51200
  v_mfma_f32_16x16x32_bf16 v[224:227], a[16:19], a[192:195], 0
  s_mov_b32 s24, 1835264
  ds_read_b128 a[76:79], v26 offset:3072
  ds_read_b64_tr_b16 a[0:1], v29 offset:53248
  v_mfma_f32_16x16x32_bf16 v[224:227], a[20:23], a[200:203], v[224:227]
  s_waitcnt lgkmcnt(7)
  s_add_u32 m0, s31, 65536
  ds_read_b64_tr_b16 a[2:3], v29 offset:55296
  v_mfma_f32_16x16x32_bf16 v[224:227], a[24:27], a[208:211], v[224:227]
  buffer_load_dwordx4 v4, s[68:71], s24 offen lds
  v_mfma_f32_16x16x32_bf16 v[224:227], a[28:31], a[216:219], v[224:227]
  s_add_u32 m0, m0, 4096
  ds_read_b64_tr_b16 a[4:5], v29 offset:57344
  ds_read_b64_tr_b16 a[6:7], v29 offset:59392
  v_mfma_f32_16x16x32_bf16 v[224:227], a[32:35], a[224:227], v[224:227]
  s_add_u32 s24, s24, s30
  ds_read_b64_tr_b16 a[8:9], v30 offset:32768
  v_xor_b32 v29, 0x10000, v29
  v_mfma_f32_16x16x32_bf16 v[224:227], a[36:39], a[232:235], v[224:227]
  ds_read_b64_tr_b16 a[10:11], v30 offset:34816
  v_mfma_f32_16x16x32_bf16 v[224:227], a[40:43], a[240:243], v[224:227]
  buffer_load_dwordx4 v4, s[68:71], s24 offen lds
  v_mfma_f32_16x16x32_bf16 v[228:231], a[16:19], a[196:199], 0
  s_add_u32 m0, m0, 4096
  ds_read_b128 a[80:83], v26 offset:4096
  ds_read_b64_tr_b16 a[12:13], v30 offset:36864
  v_mfma_f32_16x16x32_bf16 v[228:231], a[20:23], a[204:207], v[228:231]
  s_add_u32 s24, s24, s30
  ds_read_b64_tr_b16 a[14:15], v30 offset:38912
  ds_read_b64_tr_b16 a[16:17], v30 offset:40960
  v_mfma_f32_16x16x32_bf16 v[228:231], a[24:27], a[212:215], v[228:231]
  ds_read_b64_tr_b16 a[18:19], v30 offset:43008
  v_mfma_f32_16x16x32_bf16 v[228:231], a[28:31], a[220:223], v[228:231]
  ds_read_b64_tr_b16 a[20:21], v30 offset:45056
  v_mfma_f32_16x16x32_bf16 v[228:231], a[32:35], a[228:231], v[228:231]
  buffer_load_dwordx4 v4, s[68:71], s24 offen lds
  v_mfma_f32_16x16x32_bf16 v[228:231], a[36:39], a[236:239], v[228:231]
  s_add_u32 m0, m0, 4096
  ds_read_b128 a[84:87], v26 offset:5120
  ds_read_b64_tr_b16 a[22:23], v30 offset:47104
  v_mfma_f32_16x16x32_bf16 v[228:231], a[40:43], a[244:247], v[228:231]
  s_add_u32 s24, s24, s30
  ds_read_b64_tr_b16 a[24:25], v30 offset:49152
  ds_read_b64_tr_b16 a[26:27], v30 offset:51200
  v_mfma_f32_16x16x32_bf16 v[232:235], a[44:47], a[192:195], 0
  s_waitcnt lgkmcnt(8)
  ds_read_b64_tr_b16 a[28:29], v30 offset:53248
  v_mfma_f32_16x16x32_bf16 v[232:235], a[48:51], a[200:203], v[232:235]
  buffer_load_dwordx4 v4, s[68:71], s24 offen lds
  v_mfma_f32_16x16x32_bf16 v[232:235], a[52:55], a[208:211], v[232:235]
  s_add_u32 m0, m0, 4096
  ds_read_b64_tr_b16 a[30:31], v30 offset:55296
  ds_read_b64_tr_b16 a[32:33], v30 offset:57344
  v_mfma_f32_16x16x32_bf16 v[232:235], a[56:59], a[216:219], v[232:235]
  s_add_u32 s24, s24, s30
  ds_read_b64_tr_b16 a[34:35], v30 offset:59392
  v_xor_b32 v30, 0x10000, v30
  v_mfma_f32_16x16x32_bf16 v[232:235], a[60:63], a[224:227], v[232:235]
  s_nop 0
  ds_read_b128 a[88:91], v26 offset:6144
  ds_read_b64_tr_b16 a[36:37], v31 offset:32768
  v_mfma_f32_16x16x32_bf16 v[232:235], a[0:3], a[232:235], v[232:235]
  ds_read_b64_tr_b16 a[38:39], v31 offset:34816
  v_mfma_f32_16x16x32_bf16 v[232:235], a[4:7], a[240:243], v[232:235]
  buffer_load_dwordx4 v4, s[68:71], s24 offen lds
  v_mfma_f32_16x16x32_bf16 v[236:239], a[44:47], a[196:199], 0
  s_add_u32 m0, m0, 4096
  ds_read_b64_tr_b16 a[40:41], v31 offset:36864
  ds_read_b64_tr_b16 a[42:43], v31 offset:38912
  v_mfma_f32_16x16x32_bf16 v[236:239], a[48:51], a[204:207], v[236:239]
  s_add_u32 s24, s24, s30
  ds_read_b64_tr_b16 a[44:45], v31 offset:40960
  v_mfma_f32_16x16x32_bf16 v[236:239], a[52:55], a[212:215], v[236:239]
  ds_read_b64_tr_b16 a[46:47], v31 offset:43008
  v_mfma_f32_16x16x32_bf16 v[236:239], a[56:59], a[220:223], v[236:239]
  buffer_load_dwordx4 v4, s[68:71], s24 offen lds
  v_mfma_f32_16x16x32_bf16 v[236:239], a[60:63], a[228:231], v[236:239]
  s_add_u32 m0, m0, 4096
  ds_read_b128 a[92:95], v26 offset:7168
  ds_read_b64_tr_b16 a[48:49], v31 offset:45056
  v_mfma_f32_16x16x32_bf16 v[236:239], a[0:3], a[236:239], v[236:239]
  s_add_u32 s24, s24, s30
  ds_read_b64_tr_b16 a[50:51], v31 offset:47104
  ds_read_b64_tr_b16 a[52:53], v31 offset:49152
  v_mfma_f32_16x16x32_bf16 v[236:239], a[4:7], a[244:247], v[236:239]
  s_waitcnt lgkmcnt(8)
  ds_read_b64_tr_b16 a[54:55], v31 offset:51200
  v_mfma_f32_16x16x32_bf16 v[240:243], a[8:11], a[192:195], 0
  buffer_load_dwordx4 v4, s[68:71], s24 offen lds
  v_mfma_f32_16x16x32_bf16 v[240:243], a[12:15], a[200:203], v[240:243]
  s_nop 0
  ds_read_b64_tr_b16 a[56:57], v31 offset:53248
  ds_read_b64_tr_b16 a[58:59], v31 offset:55296
  v_mfma_f32_16x16x32_bf16 v[240:243], a[16:19], a[208:211], v[240:243]
  ds_read_b64_tr_b16 a[60:61], v31 offset:57344
  v_mfma_f32_16x16x32_bf16 v[240:243], a[20:23], a[216:219], v[240:243]
  s_waitcnt vmcnt(10)
  ds_read_b64_tr_b16 a[62:63], v31 offset:59392
  v_xor_b32 v31, 0x10000, v31
  v_mfma_f32_16x16x32_bf16 v[240:243], a[24:27], a[224:227], v[240:243]
  s_waitcnt vmcnt(14)
  v_mfma_f32_16x16x32_bf16 v[240:243], a[28:31], a[232:235], v[240:243]
  s_barrier
  v_mfma_f32_16x16x32_bf16 v[240:243], a[32:35], a[240:243], v[240:243]
  s_mov_b64 exec, 1
  buffer_store_dword v2, off, s[12:15], s66 sc1
  s_mov_b64 exec, -1
  v_mfma_f32_16x16x32_bf16 v[244:247], a[8:11], a[196:199], 0
  s_nop 0
  ds_read_b64_tr_b16 a[0:1], v28 offset:0
  ds_read_b64_tr_b16 a[2:3], v28 offset:2048
  v_mfma_f32_16x16x32_bf16 v[244:247], a[12:15], a[204:207], v[244:247]
  s_nop 0
  ds_read_b64_tr_b16 a[4:5], v28 offset:4096
  ds_read_b64_tr_b16 a[6:7], v28 offset:6144
  v_mfma_f32_16x16x32_bf16 v[244:247], a[16:19], a[212:215], v[244:247]
  buffer_store_dwordx4 v[96:99], v9, s[12:15], s38 offen offset:0 sc1
  v_mfma_f32_16x16x32_bf16 v[244:247], a[20:23], a[220:223], v[244:247]
  s_nop 0
  ds_read_b64_tr_b16 a[8:9], v28 offset:8192
  ds_read_b64_tr_b16 a[10:11], v28 offset:10240
  v_mfma_f32_16x16x32_bf16 v[244:247], a[24:27], a[228:231], v[244:247]
  s_nop 0
  ds_read_b64_tr_b16 a[12:13], v28 offset:12288
  ds_read_b64_tr_b16 a[14:15], v28 offset:14336
  v_mfma_f32_16x16x32_bf16 v[244:247], a[28:31], a[236:239], v[244:247]
  ds_read_b64_tr_b16 a[16:17], v28 offset:16384
  v_mfma_f32_16x16x32_bf16 v[244:247], a[32:35], a[244:247], v[244:247]
  ds_read_b64_tr_b16 a[18:19], v28 offset:18432
  v_mfma_f32_16x16x32_bf16 v[248:251], a[36:39], a[192:195], 0
  s_waitcnt lgkmcnt(8)
  ds_read_b64_tr_b16 a[20:21], v28 offset:20480
  v_mfma_f32_16x16x32_bf16 v[248:251], a[40:43], a[200:203], v[248:251]
  ds_read_b64_tr_b16 a[22:23], v28 offset:22528
  v_mfma_f32_16x16x32_bf16 v[248:251], a[44:47], a[208:211], v[248:251]
  ds_read_b64_tr_b16 a[24:25], v28 offset:24576
  v_mfma_f32_16x16x32_bf16 v[248:251], a[48:51], a[216:219], v[248:251]
  ds_read_b64_tr_b16 a[26:27], v28 offset:26624
  v_mfma_f32_16x16x32_bf16 v[248:251], a[52:55], a[224:227], v[248:251]
  ds_read_b64_tr_b16 a[28:29], v29 offset:0
  v_mfma_f32_16x16x32_bf16 v[248:251], a[56:59], a[232:235], v[248:251]
  ds_read_b64_tr_b16 a[30:31], v29 offset:2048
  v_mfma_f32_16x16x32_bf16 v[248:251], a[60:63], a[240:243], v[248:251]
  ds_read_b64_tr_b16 a[32:33], v29 offset:4096
  v_mfma_f32_16x16x32_bf16 v[252:255], a[36:39], a[196:199], 0
  ds_read_b64_tr_b16 a[34:35], v29 offset:6144
  v_mfma_f32_16x16x32_bf16 v[252:255], a[40:43], a[204:207], v[252:255]
  ds_read_b64_tr_b16 a[36:37], v29 offset:8192
  v_mfma_f32_16x16x32_bf16 v[252:255], a[44:47], a[212:215], v[252:255]
  ds_read_b64_tr_b16 a[38:39], v29 offset:10240
  v_mfma_f32_16x16x32_bf16 v[252:255], a[48:51], a[220:223], v[252:255]
  ds_read_b64_tr_b16 a[40:41], v29 offset:12288
  v_mfma_f32_16x16x32_bf16 v[252:255], a[52:55], a[228:231], v[252:255]
  ds_read_b64_tr_b16 a[42:43], v29 offset:14336
  v_mfma_f32_16x16x32_bf16 v[252:255], a[56:59], a[236:239], v[252:255]
  ds_read_b64_tr_b16 a[44:45], v29 offset:16384
  v_mfma_f32_16x16x32_bf16 v[252:255], a[60:63], a[244:247], v[252:255]
  ds_read_b64_tr_b16 a[46:47], v29 offset:18432
  v_mfma_f32_16x16x32_bf16 v[128:131], a[0:3], a[64:67], v[128:131]
  s_waitcnt lgkmcnt(6)
  s_mov_b32 s24, 1835392
  ds_read_b64_tr_b16 a[48:49], v29 offset:20480
  v_mfma_f32_16x16x32_bf16 v[128:131], a[4:7], a[72:75], v[128:131]
  s_add_u32 m0, s31, 98304
  ds_read_b64_tr_b16 a[50:51], v29 offset:22528
  v_mfma_f32_16x16x32_bf16 v[128:131], a[8:11], a[80:83], v[128:131]
  buffer_load_dwordx4 v4, s[68:71], s24 offen lds
  v_mfma_f32_16x16x32_bf16 v[128:131], a[12:15], a[88:91], v[128:131]
  s_add_u32 m0, m0, 4096
  ds_read_b64_tr_b16 a[52:53], v29 offset:24576
  ds_read_b64_tr_b16 a[54:55], v29 offset:26624
  v_mfma_f32_16x16x32_bf16 v[128:131], a[16:19], a[128:131], v[128:131]
  s_add_u32 s24, s24, s30
  ds_read_b64_tr_b16 a[56:57], v30 offset:0
  v_mfma_f32_16x16x32_bf16 v[128:131], a[20:23], a[136:139], v[128:131]
  ds_read_b64_tr_b16 a[58:59], v30 offset:2048
  v_mfma_f32_16x16x32_bf16 v[128:131], a[24:27], a[144:147], v[128:131]
  buffer_load_dwordx4 v4, s[68:71], s24 offen lds
  v_mfma_f32_16x16x32_bf16 v[132:135], a[0:3], a[68:71], v[132:135]
  s_add_u32 m0, m0, 4096
  ds_read_b64_tr_b16 a[60:61], v30 offset:4096
  ds_read_b64_tr_b16 a[62:63], v30 offset:6144
  v_mfma_f32_16x16x32_bf16 v[132:135], a[4:7], a[76:79], v[132:135]
  s_add_u32 s24, s24, s30
  ds_read_b64_tr_b16 a[0:1], v30 offset:8192
  v_mfma_f32_16x16x32_bf16 v[132:135], a[8:11], a[84:87], v[132:135]
  buffer_store_dwordx4 v[100:103], v9, s[12:15], s38 offen offset:1024 sc1
  s_add_u32 s38, s38, s47
  v_mfma_f32_16x16x32_bf16 v[132:135], a[12:15], a[92:95], v[132:135]
  s_nop 0
  ds_read_b64_tr_b16 a[2:3], v30 offset:10240
  ds_read_b64_tr_b16 a[4:5], v30 offset:12288
  v_mfma_f32_16x16x32_bf16 v[132:135], a[16:19], a[132:135], v[132:135]
  buffer_load_dwordx4 v4, s[68:71], s24 offen lds
  v_mfma_f32_16x16x32_bf16 v[132:135], a[20:23], a[140:143], v[132:135]
  s_add_u32 m0, m0, 4096
  ds_read_b64_tr_b16 a[6:7], v30 offset:14336
  ds_read_b64_tr_b16 a[8:9], v30 offset:16384
  v_mfma_f32_16x16x32_bf16 v[132:135], a[24:27], a[148:151], v[132:135]
  s_add_u32 s24, s24, s30
  ds_read_b64_tr_b16 a[10:11], v30 offset:18432
  v_mfma_f32_16x16x32_bf16 v[136:139], a[28:31], a[64:67], v[136:139]
  s_waitcnt lgkmcnt(6)
  ds_read_b64_tr_b16 a[12:13], v30 offset:20480
  v_cvt_pk_bf16_f32 v16, v128, v129
  v_mfma_f32_16x16x32_bf16 v[136:139], a[32:35], a[72:75], v[136:139]
  buffer_load_dwordx4 v4, s[68:71], s24 offen lds
  v_mfma_f32_16x16x32_bf16 v[136:139], a[36:39], a[80:83], v[136:139]
  s_add_u32 m0, m0, 4096
  ds_read_b64_tr_b16 a[14:15], v30 offset:22528
  ds_read_b64_tr_b16 a[16:17], v30 offset:24576
  v_mfma_f32_16x16x32_bf16 v[136:139], a[40:43], a[88:91], v[136:139]
  s_add_u32 s24, s24, s30
  ds_read_b64_tr_b16 a[18:19], v30 offset:26624
  v_cvt_pk_bf16_f32 v17, v130, v131
  v_mfma_f32_16x16x32_bf16 v[136:139], a[44:47], a[128:131], v[136:139]
  ds_read_b64_tr_b16 a[20:21], v31 offset:0
  v_accvgpr_write_b32 a96, v16
  v_mfma_f32_16x16x32_bf16 v[136:139], a[48:51], a[136:139], v[136:139]
  ds_read_b64_tr_b16 a[22:23], v31 offset:2048
  v_accvgpr_write_b32 a97, v17
  v_mfma_f32_16x16x32_bf16 v[136:139], a[52:55], a[144:147], v[136:139]
  buffer_load_dwordx4 v4, s[68:71], s24 offen lds
  v_mfma_f32_16x16x32_bf16 v[140:143], a[28:31], a[68:71], v[140:143]
  s_add_u32 m0, m0, 4096
  ds_read_b64_tr_b16 a[24:25], v31 offset:4096
  ds_read_b64_tr_b16 a[26:27], v31 offset:6144
  v_mfma_f32_16x16x32_bf16 v[140:143], a[32:35], a[76:79], v[140:143]
  s_add_u32 s24, s24, s30
  ds_read_b64_tr_b16 a[28:29], v31 offset:8192
  v_cvt_pk_bf16_f32 v18, v132, v133
  v_mfma_f32_16x16x32_bf16 v[140:143], a[36:39], a[84:87], v[140:143]
  ds_read_b64_tr_b16 a[30:31], v31 offset:10240
  v_cvt_pk_bf16_f32 v19, v134, v135
  v_mfma_f32_16x16x32_bf16 v[140:143], a[40:43], a[92:95], v[140:143]
  buffer_load_dwordx4 v4, s[68:71], s24 offen lds
  v_mfma_f32_16x16x32_bf16 v[140:143], a[44:47], a[132:135], v[140:143]
  s_add_u32 m0, m0, 4096
  ds_read_b64_tr_b16 a[32:33], v31 offset:12288
  ds_read_b64_tr_b16 a[34:35], v31 offset:14336
  v_mfma_f32_16x16x32_bf16 v[140:143], a[48:51], a[140:143], v[140:143]
  s_add_u32 s24, s24, s30
  ds_read_b64_tr_b16 a[36:37], v31 offset:16384
  v_accvgpr_write_b32 a160, v18
  v_mfma_f32_16x16x32_bf16 v[140:143], a[52:55], a[148:151], v[140:143]
  ds_read_b64_tr_b16 a[38:39], v31 offset:18432
  v_accvgpr_write_b32 a161, v19
  v_mfma_f32_16x16x32_bf16 v[144:147], a[56:59], a[64:67], v[144:147]
  buffer_load_dwordx4 v4, s[68:71], s24 offen lds
  v_mfma_f32_16x16x32_bf16 v[144:147], a[60:63], a[72:75], v[144:147]
  s_waitcnt lgkmcnt(5)
  ds_read_b64_tr_b16 a[40:41], v31 offset:20480
  ds_read_b64_tr_b16 a[42:43], v31 offset:22528
  v_mfma_f32_16x16x32_bf16 v[144:147], a[0:3], a[80:83], v[144:147]
  s_mov_b64 s[68:69], s[18:19]
  ds_read_b64_tr_b16 a[44:45], v31 offset:24576
  v_cvt_pk_bf16_f32 v20, v136, v137
  v_mfma_f32_16x16x32_bf16 v[144:147], a[4:7], a[88:91], v[144:147]
  s_mov_b32 s70, 268435456
  ds_read_b64_tr_b16 a[46:47], v31 offset:26624
  v_cvt_pk_bf16_f32 v21, v138, v139
  v_mfma_f32_16x16x32_bf16 v[144:147], a[8:11], a[128:131], v[144:147]
  s_waitcnt vmcnt(17)
  v_mfma_f32_16x16x32_bf16 v[144:147], a[12:15], a[136:139], v[144:147]
  s_barrier
  v_mfma_f32_16x16x32_bf16 v[144:147], a[16:19], a[144:147], v[144:147]
  buffer_store_dwordx4 v[104:107], v9, s[12:15], s38 offen offset:0 sc1
  v_accvgpr_write_b32 a98, v20
  v_accvgpr_write_b32 a99, v21
  v_mfma_f32_16x16x32_bf16 v[148:151], a[56:59], a[68:71], v[148:151]
  s_mov_b32 s30, 4096
  ds_read_b64_tr_b16 a[48:49], v28 offset:32768
  ds_read_b64_tr_b16 a[50:51], v28 offset:34816
  v_mfma_f32_16x16x32_bf16 v[148:151], a[60:63], a[76:79], v[148:151]
  s_nop 0
  ds_read_b64_tr_b16 a[52:53], v28 offset:36864
  ds_read_b64_tr_b16 a[54:55], v28 offset:38912
  v_mfma_f32_16x16x32_bf16 v[148:151], a[0:3], a[84:87], v[148:151]
  s_nop 0
  ds_read_b64_tr_b16 a[56:57], v28 offset:40960
  ds_read_b64_tr_b16 a[58:59], v28 offset:43008
  v_mfma_f32_16x16x32_bf16 v[148:151], a[4:7], a[92:95], v[148:151]
  ds_read_b64_tr_b16 a[60:61], v28 offset:45056
  v_add_u32 v4, s31, v9
  v_mfma_f32_16x16x32_bf16 v[148:151], a[8:11], a[132:135], v[148:151]
  ds_read_b64_tr_b16 a[62:63], v28 offset:47104
  v_readlane_b32 s24, v5, 0
  v_mfma_f32_16x16x32_bf16 v[148:151], a[12:15], a[140:143], v[148:151]
  ds_read_b64_tr_b16 a[0:1], v28 offset:49152
  v_mov_b32 v8, v9
  v_mfma_f32_16x16x32_bf16 v[148:151], a[16:19], a[148:151], v[148:151]
  ds_read_b64_tr_b16 a[2:3], v28 offset:51200
  v_mov_b32 v12, 0
  v_mfma_f32_16x16x32_bf16 v[152:155], a[20:23], a[64:67], v[152:155]
  ds_read_b64_tr_b16 a[4:5], v28 offset:53248
  v_mov_b32 v13, 0
  v_mfma_f32_16x16x32_bf16 v[152:155], a[24:27], a[72:75], v[152:155]
  s_waitcnt lgkmcnt(7)
  ds_read_b64_tr_b16 a[6:7], v28 offset:55296
  v_cvt_pk_bf16_f32 v22, v140, v141
  v_mfma_f32_16x16x32_bf16 v[152:155], a[28:31], a[80:83], v[152:155]
  v_and_b32 v6, 0x180, v0
  buffer_load_dword v6, v6, s[12:15], s56 offen sc1
  v_mfma_f32_16x16x32_bf16 v[152:155], a[32:35], a[88:91], v[152:155]
  s_nop 0
  ds_read_b64_tr_b16 a[8:9], v28 offset:57344
  ds_read_b64_tr_b16 a[10:11], v28 offset:59392
  v_mfma_f32_16x16x32_bf16 v[152:155], a[36:39], a[128:131], v[152:155]
  ds_read_b64_tr_b16 a[12:13], v29 offset:32768
  v_xor_b32 v28, 0x10000, v28
  v_mfma_f32_16x16x32_bf16 v[152:155], a[40:43], a[136:139], v[152:155]
  ds_read_b64_tr_b16 a[14:15], v29 offset:34816
  v_cvt_pk_bf16_f32 v23, v142, v143
  v_mfma_f32_16x16x32_bf16 v[152:155], a[44:47], a[144:147], v[152:155]
  ds_read_b64_tr_b16 a[16:17], v29 offset:36864
  v_accvgpr_write_b32 a162, v22
  v_mfma_f32_16x16x32_bf16 v[156:159], a[20:23], a[68:71], v[156:159]
  ds_read_b64_tr_b16 a[18:19], v29 offset:38912
  v_accvgpr_write_b32 a163, v23
  v_mfma_f32_16x16x32_bf16 v[156:159], a[24:27], a[76:79], v[156:159]
  ds_read_b64_tr_b16 a[20:21], v29 offset:40960
  v_cvt_pk_bf16_f32 v16, v144, v145
  v_mfma_f32_16x16x32_bf16 v[156:159], a[28:31], a[84:87], v[156:159]
  ds_read_b64_tr_b16 a[22:23], v29 offset:43008
  v_cvt_pk_bf16_f32 v17, v146, v147
  v_mfma_f32_16x16x32_bf16 v[156:159], a[32:35], a[92:95], v[156:159]
  ds_read_b64_tr_b16 a[24:25], v29 offset:45056
  v_accvgpr_write_b32 a100, v16
  v_mfma_f32_16x16x32_bf16 v[156:159], a[36:39], a[132:135], v[156:159]
  ds_read_b64_tr_b16 a[26:27], v29 offset:47104
  v_accvgpr_write_b32 a101, v17
  v_mfma_f32_16x16x32_bf16 v[156:159], a[40:43], a[140:143], v[156:159]
  ds_read_b64_tr_b16 a[28:29], v29 offset:49152
  v_cvt_pk_bf16_f32 v18, v148, v149
  v_mfma_f32_16x16x32_bf16 v[156:159], a[44:47], a[148:151], v[156:159]
  ds_read_b64_tr_b16 a[30:31], v29 offset:51200
  v_cvt_pk_bf16_f32 v19, v150, v151
  v_mfma_f32_16x16x32_bf16 v[160:163], a[48:51], a[64:67], v[160:163]
  ds_read_b64_tr_b16 a[32:33], v29 offset:53248
  v_accvgpr_write_b32 a164, v18
  v_mfma_f32_16x16x32_bf16 v[160:163], a[52:55], a[72:75], v[160:163]
  s_waitcnt lgkmcnt(6)
  ds_read_b64_tr_b16 a[34:35], v29 offset:55296
  v_accvgpr_write_b32 a165, v19
  v_mfma_f32_16x16x32_bf16 v[160:163], a[56:59], a[80:83], v[160:163]
  ds_read_b64_tr_b16 a[36:37], v29 offset:57344
  v_cvt_pk_bf16_f32 v20, v152, v153
  v_mfma_f32_16x16x32_bf16 v[160:163], a[60:63], a[88:91], v[160:163]
  buffer_store_dwordx4 v[108:111], v9, s[12:15], s38 offen offset:1024 sc1
  s_add_u32 s38, s38, s47
  v_cvt_pk_bf16_f32 v21, v154, v155
  v_accvgpr_write_b32 a102, v20
  v_mfma_f32_16x16x32_bf16 v[160:163], a[0:3], a[128:131], v[160:163]
  s_nop 0
  ds_read_b64_tr_b16 a[38:39], v29 offset:59392
  ds_read_b64_tr_b16 a[40:41], v30 offset:32768
  v_mfma_f32_16x16x32_bf16 v[160:163], a[4:7], a[136:139], v[160:163]
  ds_read_b64_tr_b16 a[42:43], v30 offset:34816
  v_xor_b32 v29, 0x10000, v29
  v_mfma_f32_16x16x32_bf16 v[160:163], a[8:11], a[144:147], v[160:163]
  ds_read_b64_tr_b16 a[44:45], v30 offset:36864
  v_accvgpr_write_b32 a103, v21
  v_mfma_f32_16x16x32_bf16 v[164:167], a[48:51], a[68:71], v[164:167]
  ds_read_b64_tr_b16 a[46:47], v30 offset:38912
  v_cvt_pk_bf16_f32 v22, v156, v157
  v_mfma_f32_16x16x32_bf16 v[164:167], a[52:55], a[76:79], v[164:167]
  ds_read_b64_tr_b16 a[48:49], v30 offset:40960
  v_cvt_pk_bf16_f32 v23, v158, v159
  v_mfma_f32_16x16x32_bf16 v[164:167], a[56:59], a[84:87], v[164:167]
  ds_read_b64_tr_b16 a[50:51], v30 offset:43008
  v_accvgpr_write_b32 a166, v22
  v_mfma_f32_16x16x32_bf16 v[164:167], a[60:63], a[92:95], v[164:167]
  ds_read_b64_tr_b16 a[52:53], v30 offset:45056
  v_accvgpr_write_b32 a167, v23
  v_mfma_f32_16x16x32_bf16 v[164:167], a[0:3], a[132:135], v[164:167]
  ds_read_b64_tr_b16 a[54:55], v30 offset:47104
  v_mfma_f32_16x16x32_bf16 v[164:167], a[4:7], a[140:143], v[164:167]
  ds_read_b64_tr_b16 a[56:57], v30 offset:49152
  v_mfma_f32_16x16x32_bf16 v[164:167], a[8:11], a[148:151], v[164:167]
  ds_read_b64_tr_b16 a[58:59], v30 offset:51200
  v_mfma_f32_16x16x32_bf16 v[168:171], a[12:15], a[64:67], v[168:171]
  ds_read_b64_tr_b16 a[60:61], v30 offset:53248
  v_cvt_pk_bf16_f32 v16, v160, v161
  v_mfma_f32_16x16x32_bf16 v[168:171], a[16:19], a[72:75], v[168:171]
  s_waitcnt lgkmcnt(6)
  ds_read_b64_tr_b16 a[62:63], v30 offset:55296
  v_cvt_pk_bf16_f32 v17, v162, v163
  v_mfma_f32_16x16x32_bf16 v[168:171], a[20:23], a[80:83], v[168:171]
  ds_read_b64_tr_b16 a[0:1], v30 offset:57344
  v_accvgpr_write_b32 a104, v16
  v_mfma_f32_16x16x32_bf16 v[168:171], a[24:27], a[88:91], v[168:171]
  ds_read_b64_tr_b16 a[2:3], v30 offset:59392
  v_xor_b32 v30, 0x10000, v30
  v_mfma_f32_16x16x32_bf16 v[168:171], a[28:31], a[128:131], v[168:171]
  ds_read_b64_tr_b16 a[4:5], v31 offset:32768
  v_accvgpr_write_b32 a105, v17
  v_mfma_f32_16x16x32_bf16 v[168:171], a[32:35], a[136:139], v[168:171]
  ds_read_b64_tr_b16 a[6:7], v31 offset:34816
  v_mfma_f32_16x16x32_bf16 v[168:171], a[36:39], a[144:147], v[168:171]
  ds_read_b64_tr_b16 a[8:9], v31 offset:36864
  v_mfma_f32_16x16x32_bf16 v[172:175], a[12:15], a[68:71], v[172:175]
  ds_read_b64_tr_b16 a[10:11], v31 offset:38912
  v_cvt_pk_bf16_f32 v18, v164, v165
  v_mfma_f32_16x16x32_bf16 v[172:175], a[16:19], a[76:79], v[172:175]
  ds_read_b64_tr_b16 a[12:13], v31 offset:40960
  v_cvt_pk_bf16_f32 v19, v166, v167
  v_mfma_f32_16x16x32_bf16 v[172:175], a[20:23], a[84:87], v[172:175]
  ds_read_b64_tr_b16 a[14:15], v31 offset:43008
  v_accvgpr_write_b32 a168, v18
  v_mfma_f32_16x16x32_bf16 v[172:175], a[24:27], a[92:95], v[172:175]
  ds_read_b64_tr_b16 a[16:17], v31 offset:45056
  v_accvgpr_write_b32 a169, v19
  v_mfma_f32_16x16x32_bf16 v[172:175], a[28:31], a[132:135], v[172:175]
  ds_read_b64_tr_b16 a[18:19], v31 offset:47104
  v_mfma_f32_16x16x32_bf16 v[172:175], a[32:35], a[140:143], v[172:175]
  ds_read_b64_tr_b16 a[20:21], v31 offset:49152
  v_mfma_f32_16x16x32_bf16 v[172:175], a[36:39], a[148:151], v[172:175]
  ds_read_b64_tr_b16 a[22:23], v31 offset:51200
  v_mfma_f32_16x16x32_bf16 v[176:179], a[40:43], a[64:67], v[176:179]
  s_waitcnt lgkmcnt(6)
  s_waitcnt vmcnt(1)
  v_cmp_le_u32 vcc, 1, v6
  v_mfma_f32_16x16x32_bf16 v[176:179], a[44:47], a[72:75], v[176:179]
  buffer_store_dwordx4 v[112:115], v9, s[12:15], s38 offen offset:0 sc1
  v_cvt_pk_bf16_f32 v20, v168, v169
  v_cvt_pk_bf16_f32 v21, v170, v171
  v_accvgpr_write_b32 a106, v20
  v_mfma_f32_16x16x32_bf16 v[176:179], a[48:51], a[80:83], v[176:179]
  s_cmp_eq_u64 vcc, -1
  s_cbranch_scc0 AT_KVS
AT_KVS_B:
  ds_read_b64_tr_b16 a[24:25], v31 offset:53248
  ds_read_b64_tr_b16 a[26:27], v31 offset:55296
  v_mfma_f32_16x16x32_bf16 v[176:179], a[52:55], a[88:91], v[176:179]
  s_nop 0
  ds_read_b64_tr_b16 a[28:29], v31 offset:57344
  ds_read_b64_tr_b16 a[30:31], v31 offset:59392
  v_mfma_f32_16x16x32_bf16 v[176:179], a[56:59], a[128:131], v[176:179]
  s_waitcnt vmcnt(14)
  v_mfma_f32_16x16x32_bf16 v[176:179], a[60:63], a[136:139], v[176:179]
  s_barrier
  v_mfma_f32_16x16x32_bf16 v[176:179], a[0:3], a[144:147], v[176:179]
  s_xor_b32 s60, s17, s21
  ds_read_b64_tr_b16 a[32:33], v28 offset:0
  ds_read_b64_tr_b16 a[34:35], v28 offset:2048
  v_mfma_f32_16x16x32_bf16 v[180:183], a[40:43], a[68:71], v[180:183]
  s_lshl_b32 s60, s60, 14
  ds_read_b64_tr_b16 a[36:37], v28 offset:4096
  ds_read_b64_tr_b16 a[38:39], v28 offset:6144
  v_mfma_f32_16x16x32_bf16 v[180:183], a[44:47], a[76:79], v[180:183]
  s_xor_b32 s56, s56, s60
  ds_read_b64_tr_b16 a[40:41], v28 offset:8192
  v_xor_b32 v31, 0x10000, v31
  v_mfma_f32_16x16x32_bf16 v[180:183], a[48:51], a[84:87], v[180:183]
  ds_read_b64_tr_b16 a[42:43], v28 offset:10240
  v_accvgpr_write_b32 a107, v21
  v_mfma_f32_16x16x32_bf16 v[180:183], a[52:55], a[92:95], v[180:183]
  ds_read_b64_tr_b16 a[44:45], v28 offset:12288
  v_cvt_pk_bf16_f32 v22, v172, v173
  v_mfma_f32_16x16x32_bf16 v[180:183], a[56:59], a[132:135], v[180:183]
  ds_read_b64_tr_b16 a[46:47], v28 offset:14336
  v_cvt_pk_bf16_f32 v23, v174, v175
  v_mfma_f32_16x16x32_bf16 v[180:183], a[60:63], a[140:143], v[180:183]
  ds_read_b64_tr_b16 a[48:49], v28 offset:16384
  v_accvgpr_write_b32 a170, v22
  v_mfma_f32_16x16x32_bf16 v[180:183], a[0:3], a[148:151], v[180:183]
  ds_read_b64_tr_b16 a[50:51], v28 offset:18432
  v_accvgpr_write_b32 a171, v23
  v_mfma_f32_16x16x32_bf16 v[184:187], a[4:7], a[64:67], v[184:187]
  ds_read_b64_tr_b16 a[52:53], v28 offset:20480
  v_cvt_pk_bf16_f32 v16, v176, v177
  v_mfma_f32_16x16x32_bf16 v[184:187], a[8:11], a[72:75], v[184:187]
  s_waitcnt lgkmcnt(6)
  ds_read_b64_tr_b16 a[54:55], v28 offset:22528
  v_cvt_pk_bf16_f32 v17, v178, v179
  v_mfma_f32_16x16x32_bf16 v[184:187], a[12:15], a[80:83], v[184:187]
  ds_read_b64_tr_b16 a[56:57], v28 offset:24576
  v_accvgpr_write_b32 a108, v16
  v_mfma_f32_16x16x32_bf16 v[184:187], a[16:19], a[88:91], v[184:187]
  ds_read_b64_tr_b16 a[58:59], v28 offset:26624
  v_accvgpr_write_b32 a109, v17
  v_mfma_f32_16x16x32_bf16 v[184:187], a[20:23], a[128:131], v[184:187]
  ds_read_b64_tr_b16 a[60:61], v29 offset:0
  v_mfma_f32_16x16x32_bf16 v[184:187], a[24:27], a[136:139], v[184:187]
  ds_read_b64_tr_b16 a[62:63], v29 offset:2048
  v_mfma_f32_16x16x32_bf16 v[184:187], a[28:31], a[144:147], v[184:187]
  ds_read_b64_tr_b16 a[0:1], v29 offset:4096
  v_mfma_f32_16x16x32_bf16 v[188:191], a[4:7], a[68:71], v[188:191]
  ds_read_b64_tr_b16 a[2:3], v29 offset:6144
  v_cvt_pk_bf16_f32 v18, v180, v181
  v_mfma_f32_16x16x32_bf16 v[188:191], a[8:11], a[76:79], v[188:191]
  ds_read_b64_tr_b16 a[4:5], v29 offset:8192
  v_cvt_pk_bf16_f32 v19, v182, v183
  v_mfma_f32_16x16x32_bf16 v[188:191], a[12:15], a[84:87], v[188:191]
  ds_read_b64_tr_b16 a[6:7], v29 offset:10240
  v_accvgpr_write_b32 a172, v18
  v_mfma_f32_16x16x32_bf16 v[188:191], a[16:19], a[92:95], v[188:191]
  ds_read_b64_tr_b16 a[8:9], v29 offset:12288
  v_accvgpr_write_b32 a173, v19
  v_mfma_f32_16x16x32_bf16 v[188:191], a[20:23], a[132:135], v[188:191]
  ds_read_b64_tr_b16 a[10:11], v29 offset:14336
  v_mfma_f32_16x16x32_bf16 v[188:191], a[24:27], a[140:143], v[188:191]
  ds_read_b64_tr_b16 a[12:13], v29 offset:16384
  v_mfma_f32_16x16x32_bf16 v[188:191], a[28:31], a[148:151], v[188:191]
  buffer_store_dwordx4 v[116:119], v9, s[12:15], s38 offen offset:1024 sc1
  s_add_u32 s38, s38, s47
  v_mfma_f32_16x16x32_bf16 v[192:195], a[32:35], a[64:67], v[192:195]
  s_nop 0
  ds_read_b64_tr_b16 a[14:15], v29 offset:18432
  ds_read_b64_tr_b16 a[16:17], v29 offset:20480
  v_mfma_f32_16x16x32_bf16 v[192:195], a[36:39], a[72:75], v[192:195]
  s_waitcnt lgkmcnt(6)
  s_mov_b32 m0, s31
  ds_read_b64_tr_b16 a[18:19], v29 offset:22528
  v_mfma_f32_16x16x32_bf16 v[192:195], a[40:43], a[80:83], v[192:195]
  buffer_load_dwordx4 v4, s[68:71], s24 offen lds
  v_mfma_f32_16x16x32_bf16 v[192:195], a[44:47], a[88:91], v[192:195]
  s_add_u32 m0, m0, 4096
  ds_read_b64_tr_b16 a[20:21], v29 offset:24576
  ds_read_b64_tr_b16 a[22:23], v29 offset:26624
  v_mfma_f32_16x16x32_bf16 v[192:195], a[48:51], a[128:131], v[192:195]
  s_add_u32 s24, s24, s30
  ds_read_b64_tr_b16 a[24:25], v30 offset:0
  v_cvt_pk_bf16_f32 v20, v184, v185
  v_mfma_f32_16x16x32_bf16 v[192:195], a[52:55], a[136:139], v[192:195]
  ds_read_b64_tr_b16 a[26:27], v30 offset:2048
  v_cvt_pk_bf16_f32 v21, v186, v187
  v_mfma_f32_16x16x32_bf16 v[192:195], a[56:59], a[144:147], v[192:195]
  buffer_load_dwordx4 v4, s[68:71], s24 offen lds
  v_mfma_f32_16x16x32_bf16 v[196:199], a[32:35], a[68:71], v[196:199]
  s_add_u32 m0, m0, 4096
  ds_read_b64_tr_b16 a[28:29], v30 offset:4096
  ds_read_b64_tr_b16 a[30:31], v30 offset:6144
  v_mfma_f32_16x16x32_bf16 v[196:199], a[36:39], a[76:79], v[196:199]
  s_add_u32 s24, s24, s30
  ds_read_b64_tr_b16 a[32:33], v30 offset:8192
  v_accvgpr_write_b32 a110, v20
  v_mfma_f32_16x16x32_bf16 v[196:199], a[40:43], a[84:87], v[196:199]
  ds_read_b64_tr_b16 a[34:35], v30 offset:10240
  v_accvgpr_write_b32 a111, v21
  v_mfma_f32_16x16x32_bf16 v[196:199], a[44:47], a[92:95], v[196:199]
  buffer_load_dwordx4 v4, s[68:71], s24 offen lds
  v_mfma_f32_16x16x32_bf16 v[196:199], a[48:51], a[132:135], v[196:199]
  s_add_u32 m0, m0, 4096
  ds_read_b64_tr_b16 a[36:37], v30 offset:12288
  ds_read_b64_tr_b16 a[38:39], v30 offset:14336
  v_mfma_f32_16x16x32_bf16 v[196:199], a[52:55], a[140:143], v[196:199]
  s_add_u32 s24, s24, s30
  ds_read_b64_tr_b16 a[40:41], v30 offset:16384
  v_cvt_pk_bf16_f32 v22, v188, v189
  v_mfma_f32_16x16x32_bf16 v[196:199], a[56:59], a[148:151], v[196:199]
  s_waitcnt lgkmcnt(7)
  ds_read_b64_tr_b16 a[42:43], v30 offset:18432
  v_cvt_pk_bf16_f32 v23, v190, v191
  v_mfma_f32_16x16x32_bf16 v[200:203], a[60:63], a[64:67], v[200:203]
  buffer_load_dwordx4 v4, s[68:71], s24 offen lds
  v_mfma_f32_16x16x32_bf16 v[200:203], a[0:3], a[72:75], v[200:203]
  s_add_u32 m0, m0, 4096
  ds_read_b64_tr_b16 a[44:45], v30 offset:20480
  ds_read_b64_tr_b16 a[46:47], v30 offset:22528
  v_mfma_f32_16x16x32_bf16 v[200:203], a[4:7], a[80:83], v[200:203]
  s_add_u32 s24, s24, s30
  ds_read_b64_tr_b16 a[48:49], v30 offset:24576
  v_accvgpr_write_b32 a174, v22
  v_mfma_f32_16x16x32_bf16 v[200:203], a[8:11], a[88:91], v[200:203]
  ds_read_b64_tr_b16 a[50:51], v30 offset:26624
  v_accvgpr_write_b32 a175, v23
  v_mfma_f32_16x16x32_bf16 v[200:203], a[12:15], a[128:131], v[200:203]
  buffer_load_dwordx4 v4, s[68:71], s24 offen lds
  v_mfma_f32_16x16x32_bf16 v[200:203], a[16:19], a[136:139], v[200:203]
  s_add_u32 m0, m0, 4096
  ds_read_b64_tr_b16 a[52:53], v31 offset:0
  ds_read_b64_tr_b16 a[54:55], v31 offset:2048
  v_mfma_f32_16x16x32_bf16 v[200:203], a[20:23], a[144:147], v[200:203]
  s_add_u32 s24, s24, s30
  ds_read_b64_tr_b16 a[56:57], v31 offset:4096
  v_cvt_pk_bf16_f32 v16, v192, v193
  v_mfma_f32_16x16x32_bf16 v[204:207], a[60:63], a[68:71], v[204:207]
  ds_read_b64_tr_b16 a[58:59], v31 offset:6144
  v_cvt_pk_bf16_f32 v17, v194, v195
  v_mfma_f32_16x16x32_bf16 v[204:207], a[0:3], a[76:79], v[204:207]
  buffer_load_dwordx4 v4, s[68:71], s24 offen lds
  v_mfma_f32_16x16x32_bf16 v[204:207], a[4:7], a[84:87], v[204:207]
  s_add_u32 m0, m0, 4096
  ds_read_b64_tr_b16 a[60:61], v31 offset:8192
  ds_read_b64_tr_b16 a[62:63], v31 offset:10240
  v_mfma_f32_16x16x32_bf16 v[204:207], a[8:11], a[92:95], v[204:207]
  s_waitcnt lgkmcnt(6)
  s_add_u32 s24, s24, s30
  ds_read_b64_tr_b16 a[0:1], v31 offset:12288
  v_mfma_f32_16x16x32_bf16 v[204:207], a[12:15], a[132:135], v[204:207]
  buffer_store_dwordx4 v[120:123], v9, s[12:15], s38 offen offset:0 sc1
  v_accvgpr_write_b32 a112, v16
  v_accvgpr_write_b32 a113, v17
  v_cvt_pk_bf16_f32 v18, v196, v197
  v_mfma_f32_16x16x32_bf16 v[204:207], a[16:19], a[140:143], v[204:207]
  buffer_load_dwordx4 v4, s[68:71], s24 offen lds
  v_mfma_f32_16x16x32_bf16 v[204:207], a[20:23], a[148:151], v[204:207]
  s_add_u32 m0, m0, 4096
  ds_read_b64_tr_b16 a[2:3], v31 offset:14336
  ds_read_b64_tr_b16 a[4:5], v31 offset:16384
  v_mfma_f32_16x16x32_bf16 v[208:211], a[24:27], a[64:67], v[208:211]
  s_add_u32 s24, s24, s30
  ds_read_b64_tr_b16 a[6:7], v31 offset:18432
  ds_read_b64_tr_b16 a[8:9], v31 offset:20480
  v_mfma_f32_16x16x32_bf16 v[208:211], a[28:31], a[72:75], v[208:211]
  ds_read_b64_tr_b16 a[10:11], v31 offset:22528
  v_cvt_pk_bf16_f32 v19, v198, v199
  v_mfma_f32_16x16x32_bf16 v[208:211], a[32:35], a[80:83], v[208:211]
  buffer_load_dwordx4 v4, s[68:71], s24 offen lds
  v_mfma_f32_16x16x32_bf16 v[208:211], a[36:39], a[88:91], v[208:211]
  s_add_u32 s31, s31, 32768
  ds_read_b64_tr_b16 a[12:13], v31 offset:24576
  ds_read_b64_tr_b16 a[14:15], v31 offset:26624
  v_mfma_f32_16x16x32_bf16 v[208:211], a[40:43], a[128:131], v[208:211]
  s_waitcnt vmcnt(14)
  v_mfma_f32_16x16x32_bf16 v[208:211], a[44:47], a[136:139], v[208:211]
  s_barrier
  v_mfma_f32_16x16x32_bf16 v[208:211], a[48:51], a[144:147], v[208:211]
  s_and_b32 s31, s31, 0x1ffff
  ds_read_b64_tr_b16 a[16:17], v28 offset:32768
  ds_read_b64_tr_b16 a[18:19], v28 offset:34816
  v_mfma_f32_16x16x32_bf16 v[212:215], a[24:27], a[68:71], v[212:215]
  s_add_u32 s25, s25, 1
  ds_read_b64_tr_b16 a[20:21], v28 offset:36864
  ds_read_b64_tr_b16 a[22:23], v28 offset:38912
  v_mfma_f32_16x16x32_bf16 v[212:215], a[28:31], a[76:79], v[212:215]
  buffer_store_dwordx4 a[96:99], v9, s[4:7], s26 offen offset:0 sc1
  v_readlane_b32 s24, v5, s25
  v_accvgpr_write_b32 a176, v18
  v_accvgpr_write_b32 a177, v19
  v_mfma_f32_16x16x32_bf16 v[212:215], a[32:35], a[84:87], v[212:215]
  s_nop 0
  ds_read_b64_tr_b16 a[24:25], v28 offset:40960
  ds_read_b64_tr_b16 a[26:27], v28 offset:43008
  v_mfma_f32_16x16x32_bf16 v[212:215], a[36:39], a[92:95], v[212:215]
  ds_read_b64_tr_b16 a[28:29], v28 offset:45056
  v_cvt_pk_bf16_f32 v20, v200, v201
  v_mfma_f32_16x16x32_bf16 v[212:215], a[40:43], a[132:135], v[212:215]
  ds_read_b64_tr_b16 a[30:31], v28 offset:47104
  v_cvt_pk_bf16_f32 v21, v202, v203
  v_mfma_f32_16x16x32_bf16 v[212:215], a[44:47], a[140:143], v[212:215]
  s_waitcnt lgkmcnt(8)
  ds_read_b64_tr_b16 a[32:33], v28 offset:49152
  v_accvgpr_write_b32 a114, v20
  v_mfma_f32_16x16x32_bf16 v[212:215], a[48:51], a[148:151], v[212:215]
  buffer_store_dwordx4 a[160:163], v9, s[4:7], s26 offen offset:1024 sc1
  v_accvgpr_write_b32 a115, v21
  v_cvt_pk_bf16_f32 v22, v204, v205
  v_cvt_pk_bf16_f32 v23, v206, v207
  v_mfma_f32_16x16x32_bf16 v[216:219], a[52:55], a[64:67], v[216:219]
  s_nop 0
  ds_read_b64_tr_b16 a[34:35], v28 offset:51200
  ds_read_b64_tr_b16 a[36:37], v28 offset:53248
  v_mfma_f32_16x16x32_bf16 v[216:219], a[56:59], a[72:75], v[216:219]
  ds_read_b64_tr_b16 a[38:39], v28 offset:55296
  v_accvgpr_write_b32 a178, v22
  v_mfma_f32_16x16x32_bf16 v[216:219], a[60:63], a[80:83], v[216:219]
  ds_read_b64_tr_b16 a[40:41], v28 offset:57344
  v_accvgpr_write_b32 a179, v23
  v_mfma_f32_16x16x32_bf16 v[216:219], a[0:3], a[88:91], v[216:219]
  ds_read_b64_tr_b16 a[42:43], v28 offset:59392
  v_cvt_pk_bf16_f32 v16, v208, v209
  v_mfma_f32_16x16x32_bf16 v[216:219], a[4:7], a[128:131], v[216:219]
  buffer_store_dwordx4 a[100:103], v9, s[4:7], s26 offen offset:2048 sc1
  v_cvt_pk_bf16_f32 v17, v210, v211
  v_accvgpr_write_b32 a116, v16
  v_accvgpr_write_b32 a117, v17
  v_mfma_f32_16x16x32_bf16 v[216:219], a[8:11], a[136:139], v[216:219]
  s_nop 0
  ds_read_b64_tr_b16 a[44:45], v29 offset:32768
  ds_read_b64_tr_b16 a[46:47], v29 offset:34816
  v_mfma_f32_16x16x32_bf16 v[216:219], a[12:15], a[144:147], v[216:219]
  ds_read_b64_tr_b16 a[48:49], v29 offset:36864
  v_mfma_f32_16x16x32_bf16 v[220:223], a[52:55], a[68:71], v[220:223]
  ds_read_b64_tr_b16 a[50:51], v29 offset:38912
  v_cvt_pk_bf16_f32 v18, v212, v213
  v_mfma_f32_16x16x32_bf16 v[220:223], a[56:59], a[76:79], v[220:223]
  ds_read_b64_tr_b16 a[52:53], v29 offset:40960
  v_cvt_pk_bf16_f32 v19, v214, v215
  v_mfma_f32_16x16x32_bf16 v[220:223], a[60:63], a[84:87], v[220:223]
  buffer_store_dwordx4 v[124:127], v9, s[12:15], s38 offen offset:1024 sc1
  s_add_u32 s38, s38, s47
  v_accvgpr_write_b32 a180, v18
  v_accvgpr_write_b32 a181, v19
  v_mfma_f32_16x16x32_bf16 v[220:223], a[0:3], a[92:95], v[220:223]
  buffer_store_dwordx4 a[164:167], v9, s[4:7], s26 offen offset:3072 sc1
  s_add_u32 s26, s26, 4096
  v_mfma_f32_16x16x32_bf16 v[220:223], a[4:7], a[132:135], v[220:223]
  s_nop 0
  ds_read_b64_tr_b16 a[54:55], v29 offset:43008
  ds_read_b64_tr_b16 a[56:57], v29 offset:45056
  v_mfma_f32_16x16x32_bf16 v[220:223], a[8:11], a[140:143], v[220:223]
  s_nop 0
  ds_read_b64_tr_b16 a[58:59], v29 offset:47104
  ds_read_b64_tr_b16 a[60:61], v29 offset:49152
  v_mfma_f32_16x16x32_bf16 v[220:223], a[12:15], a[148:151], v[220:223]
  s_waitcnt lgkmcnt(6)
  ds_read_b64_tr_b16 a[62:63], v29 offset:51200
  v_mfma_f32_16x16x32_bf16 v[224:227], a[16:19], a[64:67], v[224:227]
  ds_read_b64_tr_b16 a[0:1], v29 offset:53248
  v_cvt_pk_bf16_f32 v20, v216, v217
  v_mfma_f32_16x16x32_bf16 v[224:227], a[20:23], a[72:75], v[224:227]
  s_mov_b32 m0, s31
  ds_read_b64_tr_b16 a[2:3], v29 offset:55296
  v_cvt_pk_bf16_f32 v21, v218, v219
  v_mfma_f32_16x16x32_bf16 v[224:227], a[24:27], a[80:83], v[224:227]
  buffer_load_dwordx4 v4, s[68:71], s24 offen lds
  v_mfma_f32_16x16x32_bf16 v[224:227], a[28:31], a[88:91], v[224:227]
  s_add_u32 m0, m0, 4096
  ds_read_b64_tr_b16 a[4:5], v29 offset:57344
  ds_read_b64_tr_b16 a[6:7], v29 offset:59392
  v_mfma_f32_16x16x32_bf16 v[224:227], a[32:35], a[128:131], v[224:227]
  s_add_u32 s24, s24, s30
  ds_read_b64_tr_b16 a[8:9], v30 offset:32768
  v_accvgpr_write_b32 a118, v20
  v_mfma_f32_16x16x32_bf16 v[224:227], a[36:39], a[136:139], v[224:227]
  ds_read_b64_tr_b16 a[10:11], v30 offset:34816
  v_accvgpr_write_b32 a119, v21
  v_mfma_f32_16x16x32_bf16 v[224:227], a[40:43], a[144:147], v[224:227]
  buffer_load_dwordx4 v4, s[68:71], s24 offen lds
  v_mfma_f32_16x16x32_bf16 v[228:231], a[16:19], a[68:71], v[228:231]
  s_add_u32 m0, m0, 4096
  ds_read_b64_tr_b16 a[12:13], v30 offset:36864
  ds_read_b64_tr_b16 a[14:15], v30 offset:38912
  v_mfma_f32_16x16x32_bf16 v[228:231], a[20:23], a[76:79], v[228:231]
  s_add_u32 s24, s24, s30
  ds_read_b64_tr_b16 a[16:17], v30 offset:40960
  v_cvt_pk_bf16_f32 v22, v220, v221
  v_mfma_f32_16x16x32_bf16 v[228:231], a[24:27], a[84:87], v[228:231]
  ds_read_b64_tr_b16 a[18:19], v30 offset:43008
  v_cvt_pk_bf16_f32 v23, v222, v223
  v_mfma_f32_16x16x32_bf16 v[228:231], a[28:31], a[92:95], v[228:231]
  buffer_load_dwordx4 v4, s[68:71], s24 offen lds
  v_mfma_f32_16x16x32_bf16 v[228:231], a[32:35], a[132:135], v[228:231]
  s_add_u32 m0, m0, 4096
  ds_read_b64_tr_b16 a[20:21], v30 offset:45056
  ds_read_b64_tr_b16 a[22:23], v30 offset:47104
  v_mfma_f32_16x16x32_bf16 v[228:231], a[36:39], a[140:143], v[228:231]
  s_add_u32 s24, s24, s30
  ds_read_b64_tr_b16 a[24:25], v30 offset:49152
  v_accvgpr_write_b32 a182, v22
  v_mfma_f32_16x16x32_bf16 v[228:231], a[40:43], a[148:151], v[228:231]
  s_waitcnt lgkmcnt(7)
  ds_read_b64_tr_b16 a[26:27], v30 offset:51200
  v_accvgpr_write_b32 a183, v23
  v_mfma_f32_16x16x32_bf16 v[232:235], a[44:47], a[64:67], v[232:235]
  buffer_load_dwordx4 v4, s[68:71], s24 offen lds
  v_mfma_f32_16x16x32_bf16 v[232:235], a[48:51], a[72:75], v[232:235]
  s_add_u32 m0, m0, 4096
  ds_read_b64_tr_b16 a[28:29], v30 offset:53248
  ds_read_b64_tr_b16 a[30:31], v30 offset:55296
  v_mfma_f32_16x16x32_bf16 v[232:235], a[52:55], a[80:83], v[232:235]
  s_add_u32 s24, s24, s30
  ds_read_b64_tr_b16 a[32:33], v30 offset:57344
  v_cvt_pk_bf16_f32 v16, v224, v225
  v_mfma_f32_16x16x32_bf16 v[232:235], a[56:59], a[88:91], v[232:235]
  ds_read_b64_tr_b16 a[34:35], v30 offset:59392
  v_cvt_pk_bf16_f32 v17, v226, v227
  v_mfma_f32_16x16x32_bf16 v[232:235], a[60:63], a[128:131], v[232:235]
  buffer_load_dwordx4 v4, s[68:71], s24 offen lds
  v_mfma_f32_16x16x32_bf16 v[232:235], a[0:3], a[136:139], v[232:235]
  s_add_u32 m0, m0, 4096
  ds_read_b64_tr_b16 a[36:37], v31 offset:32768
  ds_read_b64_tr_b16 a[38:39], v31 offset:34816
  v_mfma_f32_16x16x32_bf16 v[232:235], a[4:7], a[144:147], v[232:235]
  s_add_u32 s24, s24, s30
  ds_read_b64_tr_b16 a[40:41], v31 offset:36864
  v_accvgpr_write_b32 a120, v16
  v_mfma_f32_16x16x32_bf16 v[236:239], a[44:47], a[68:71], v[236:239]
  ds_read_b64_tr_b16 a[42:43], v31 offset:38912
  v_accvgpr_write_b32 a121, v17
  v_mfma_f32_16x16x32_bf16 v[236:239], a[48:51], a[76:79], v[236:239]
  buffer_load_dwordx4 v4, s[68:71], s24 offen lds
  v_mfma_f32_16x16x32_bf16 v[236:239], a[52:55], a[84:87], v[236:239]
  s_add_u32 m0, m0, 4096
  ds_read_b64_tr_b16 a[44:45], v31 offset:40960
  ds_read_b64_tr_b16 a[46:47], v31 offset:43008
  v_mfma_f32_16x16x32_bf16 v[236:239], a[56:59], a[92:95], v[236:239]
  s_add_u32 s24, s24, s30
  ds_read_b64_tr_b16 a[48:49], v31 offset:45056
  v_cvt_pk_bf16_f32 v18, v228, v229
  v_mfma_f32_16x16x32_bf16 v[236:239], a[60:63], a[132:135], v[236:239]
  ds_read_b64_tr_b16 a[50:51], v31 offset:47104
  v_cvt_pk_bf16_f32 v19, v230, v231
  v_mfma_f32_16x16x32_bf16 v[236:239], a[0:3], a[140:143], v[236:239]
  buffer_load_dwordx4 v4, s[68:71], s24 offen lds
  v_mfma_f32_16x16x32_bf16 v[236:239], a[4:7], a[148:151], v[236:239]
  s_add_u32 m0, m0, 4096
  ds_read_b64_tr_b16 a[52:53], v31 offset:49152
  ds_read_b64_tr_b16 a[54:55], v31 offset:51200
  v_mfma_f32_16x16x32_bf16 v[240:243], a[8:11], a[64:67], v[240:243]
  s_waitcnt lgkmcnt(6)
  s_add_u32 s24, s24, s30
  ds_read_b64_tr_b16 a[56:57], v31 offset:53248
  v_mfma_f32_16x16x32_bf16 v[240:243], a[12:15], a[72:75], v[240:243]
  ds_read_b64_tr_b16 a[58:59], v31 offset:55296
  v_accvgpr_write_b32 a184, v18
  v_mfma_f32_16x16x32_bf16 v[240:243], a[16:19], a[80:83], v[240:243]
  buffer_load_dwordx4 v4, s[68:71], s24 offen lds
  v_mfma_f32_16x16x32_bf16 v[240:243], a[20:23], a[88:91], v[240:243]
  s_add_u32 s31, s31, 32768
  ds_read_b64_tr_b16 a[60:61], v31 offset:57344
  ds_read_b64_tr_b16 a[62:63], v31 offset:59392
  v_mfma_f32_16x16x32_bf16 v[240:243], a[24:27], a[128:131], v[240:243]
  s_waitcnt vmcnt(13)
  v_mfma_f32_16x16x32_bf16 v[240:243], a[28:31], a[136:139], v[240:243]
  s_barrier
  v_mfma_f32_16x16x32_bf16 v[240:243], a[32:35], a[144:147], v[240:243]
  s_and_b32 s31, s31, 0x1ffff
  ds_read_b128 a[0:3], v8 offset:0
  v_accvgpr_write_b32 a185, v19
  v_mfma_f32_16x16x32_bf16 v[244:247], a[8:11], a[68:71], v[244:247]
  s_add_u32 s25, s25, 1
  v_readlane_b32 s24, v5, s25
  v_cvt_pk_bf16_f32 v20, v232, v233
  v_mfma_f32_16x16x32_bf16 v[244:247], a[12:15], a[76:79], v[244:247]
  ds_read_b128 a[4:7], v8 offset:1024
  v_cvt_pk_bf16_f32 v21, v234, v235
  v_mfma_f32_16x16x32_bf16 v[244:247], a[16:19], a[84:87], v[244:247]
  buffer_store_dwordx4 a[104:107], v9, s[4:7], s26 offen offset:0 sc1
  v_accvgpr_write_b32 a122, v20
  v_accvgpr_write_b32 a123, v21
  v_cvt_pk_bf16_f32 v22, v236, v237
  v_mfma_f32_16x16x32_bf16 v[244:247], a[20:23], a[92:95], v[244:247]
  ds_read_b128 a[8:11], v8 offset:2048
  v_cvt_pk_bf16_f32 v23, v238, v239
  v_mfma_f32_16x16x32_bf16 v[244:247], a[24:27], a[132:135], v[244:247]
  v_accvgpr_write_b32 a186, v22
  v_accvgpr_write_b32 a187, v23
  v_mfma_f32_16x16x32_bf16 v[244:247], a[28:31], a[140:143], v[244:247]
  ds_read_b128 a[12:15], v8 offset:3072
  v_mfma_f32_16x16x32_bf16 v[244:247], a[32:35], a[148:151], v[244:247]
  buffer_store_dwordx4 a[168:171], v9, s[4:7], s26 offen offset:1024 sc1
  v_mfma_f32_16x16x32_bf16 v[248:251], a[36:39], a[64:67], v[248:251]
  ds_read_b128 a[16:19], v8 offset:4096
  v_cvt_pk_bf16_f32 v16, v240, v241
  v_mfma_f32_16x16x32_bf16 v[248:251], a[40:43], a[72:75], v[248:251]
  s_waitcnt lgkmcnt(3)
  v_cvt_pk_bf16_f32 v17, v242, v243
  v_accvgpr_write_b32 a124, v16
  v_mfma_f32_16x16x32_bf16 v[248:251], a[44:47], a[80:83], v[248:251]
  ds_read_b128 a[20:23], v8 offset:5120
  v_accvgpr_write_b32 a125, v17
  v_mfma_f32_16x16x32_bf16 v[248:251], a[48:51], a[88:91], v[248:251]
  buffer_store_dwordx4 a[108:111], v9, s[4:7], s26 offen offset:2048 sc1
  v_mfma_f32_16x16x32_bf16 v[248:251], a[52:55], a[128:131], v[248:251]
  ds_read_b128 a[24:27], v8 offset:6144
  v_mfma_f32_16x16x32_bf16 v[248:251], a[56:59], a[136:139], v[248:251]
  v_mfma_f32_16x16x32_bf16 v[248:251], a[60:63], a[144:147], v[248:251]
  ds_read_b128 a[28:31], v8 offset:7168
  v_mfma_f32_16x16x32_bf16 v[252:255], a[36:39], a[68:71], v[252:255]
  buffer_store_dwordx4 a[172:175], v9, s[4:7], s26 offen offset:3072 sc1
  s_add_u32 s26, s26, 4096
  v_cvt_pk_bf16_f32 v18, v244, v245
  v_cvt_pk_bf16_f32 v19, v246, v247
  v_mfma_f32_16x16x32_bf16 v[252:255], a[40:43], a[76:79], v[252:255]
  ds_read_b128 a[32:35], v8 offset:8192
  v_accvgpr_write_b32 a188, v18
  v_accvgpr_write_b32 a189, v19
  v_mfma_f32_16x16x32_bf16 v[252:255], a[44:47], a[84:87], v[252:255]
  v_mfma_f32_16x16x32_bf16 v[252:255], a[48:51], a[92:95], v[252:255]
  ds_read_b128 a[36:39], v8 offset:9216
  v_mfma_f32_16x16x32_bf16 v[252:255], a[52:55], a[132:135], v[252:255]
  buffer_store_dwordx4 a[112:115], v9, s[4:7], s26 offen offset:0 sc1
  v_mfma_f32_16x16x32_bf16 v[252:255], a[56:59], a[140:143], v[252:255]
  ds_read_b128 a[40:43], v8 offset:10240
  v_mfma_f32_16x16x32_bf16 v[252:255], a[60:63], a[148:151], v[252:255]
  ds_read_b128 a[44:47], v8 offset:11264
  v_mfma_f32_16x16x32_bf16 v[64:67], a[0:3], a[96:99], v[32:35]
  s_waitcnt lgkmcnt(4)
  s_mov_b32 m0, s31
  ds_read_b128 a[48:51], v8 offset:12288
  v_mfma_f32_16x16x32_bf16 v[64:67], a[4:7], a[100:103], v[64:67]
  buffer_load_dwordx4 v4, s[68:71], s24 offen lds
  v_mfma_f32_16x16x32_bf16 v[64:67], a[8:11], a[104:107], v[64:67]
  s_add_u32 m0, m0, 4096
  ds_read_b128 a[52:55], v8 offset:13312
  v_cvt_pk_bf16_f32 v20, v248, v249
  v_cvt_pk_bf16_f32 v21, v250, v251
  v_mfma_f32_16x16x32_bf16 v[64:67], a[12:15], a[108:111], v[64:67]
  s_add_u32 s24, s24, s30
  v_accvgpr_write_b32 a126, v20
  v_accvgpr_write_b32 a127, v21
  v_mfma_f32_16x16x32_bf16 v[64:67], a[16:19], a[112:115], v[64:67]
  s_add_u32 s32, s32, 32768
  ds_read_b128 a[56:59], v8 offset:14336
  v_mfma_f32_16x16x32_bf16 v[64:67], a[20:23], a[116:119], v[64:67]
  buffer_load_dwordx4 v4, s[68:71], s24 offen lds
  v_mfma_f32_16x16x32_bf16 v[64:67], a[24:27], a[120:123], v[64:67]
  s_add_u32 m0, m0, 4096
  ds_read_b128 a[60:63], v8 offset:15360
  v_mfma_f32_16x16x32_bf16 v[64:67], a[28:31], a[124:127], v[64:67]
  s_add_u32 s24, s24, s30
  v_cvt_pk_bf16_f32 v22, v252, v253
  v_cvt_pk_bf16_f32 v23, v254, v255
  v_accvgpr_write_b32 a190, v22
  v_mfma_f32_16x16x32_bf16 v[68:71], a[0:3], a[160:163], 0
  s_and_b32 s32, s32, 0x1ffff
  ds_read_b128 a[0:3], v8 offset:16384
  v_accvgpr_write_b32 a191, v23
  v_mfma_f32_16x16x32_bf16 v[68:71], a[4:7], a[164:167], v[68:71]
  buffer_load_dwordx4 v4, s[68:71], s24 offen lds
  v_mfma_f32_16x16x32_bf16 v[68:71], a[8:11], a[168:171], v[68:71]
  s_add_u32 m0, m0, 4096
  ds_read_b128 a[4:7], v8 offset:17408
  v_mfma_f32_16x16x32_bf16 v[68:71], a[12:15], a[172:175], v[68:71]
  s_add_u32 s24, s24, s30
  v_mfma_f32_16x16x32_bf16 v[68:71], a[16:19], a[176:179], v[68:71]
  ds_read_b128 a[8:11], v8 offset:18432
  v_mfma_f32_16x16x32_bf16 v[68:71], a[20:23], a[180:183], v[68:71]
  buffer_load_dwordx4 v4, s[68:71], s24 offen lds
  v_mfma_f32_16x16x32_bf16 v[68:71], a[24:27], a[184:187], v[68:71]
  s_add_u32 m0, m0, 4096
  ds_read_b128 a[12:15], v8 offset:19456
  v_mfma_f32_16x16x32_bf16 v[68:71], a[28:31], a[188:191], v[68:71]
  s_waitcnt lgkmcnt(3)
  s_add_u32 s24, s24, s30
  v_max3_f32 v10, v64, v65, v66
  v_mfma_f32_16x16x32_bf16 v[72:75], a[32:35], a[96:99], v[36:39]
  ds_read_b128 a[16:19], v8 offset:20480
  v_max_f32 v10, v10, v67
  v_mfma_f32_16x16x32_bf16 v[72:75], a[36:39], a[100:103], v[72:75]
  buffer_load_dwordx4 v4, s[68:71], s24 offen lds
  v_mfma_f32_16x16x32_bf16 v[72:75], a[40:43], a[104:107], v[72:75]
  s_add_u32 m0, m0, 4096
  ds_read_b128 a[20:23], v8 offset:21504
  v_mfma_f32_16x16x32_bf16 v[72:75], a[44:47], a[108:111], v[72:75]
  s_add_u32 s24, s24, s30
  v_mfma_f32_16x16x32_bf16 v[72:75], a[48:51], a[112:115], v[72:75]
  ds_read_b128 a[24:27], v8 offset:22528
  v_mfma_f32_16x16x32_bf16 v[72:75], a[52:55], a[116:119], v[72:75]
  buffer_load_dwordx4 v4, s[68:71], s24 offen lds
  v_mfma_f32_16x16x32_bf16 v[72:75], a[56:59], a[120:123], v[72:75]
  s_add_u32 m0, m0, 4096
  ds_read_b128 a[28:31], v8 offset:23552
  v_mfma_f32_16x16x32_bf16 v[72:75], a[60:63], a[124:127], v[72:75]
  s_add_u32 s24, s24, s30
  v_max3_f32 v11, v68, v69, v70
  v_max_f32 v11, v11, v71
  v_mfma_f32_16x16x32_bf16 v[76:79], a[32:35], a[160:163], 0
  ds_read_b128 a[32:35], v8 offset:24576
  v_mov_b32 v2, v10
  v_mfma_f32_16x16x32_bf16 v[76:79], a[36:39], a[164:167], v[76:79]
  buffer_load_dwordx4 v4, s[68:71], s24 offen lds
  v_mfma_f32_16x16x32_bf16 v[76:79], a[40:43], a[168:171], v[76:79]
  s_add_u32 m0, m0, 4096
  ds_read_b128 a[36:39], v8 offset:25600
  v_mov_b32 v3, v11
  v_mfma_f32_16x16x32_bf16 v[76:79], a[44:47], a[172:175], v[76:79]
  s_add_u32 s24, s24, s30
  v_mfma_f32_16x16x32_bf16 v[76:79], a[48:51], a[176:179], v[76:79]
  ds_read_b128 a[40:43], v8 offset:26624
  v_permlane16_swap_b32 v10, v2
  v_mfma_f32_16x16x32_bf16 v[76:79], a[52:55], a[180:183], v[76:79]
  buffer_load_dwordx4 v4, s[68:71], s24 offen lds
  v_mfma_f32_16x16x32_bf16 v[76:79], a[56:59], a[184:187], v[76:79]
  s_add_u32 s31, s31, 32768
  ds_read_b128 a[44:47], v8 offset:27648
  v_permlane16_swap_b32 v11, v3
  v_mfma_f32_16x16x32_bf16 v[76:79], a[60:63], a[188:191], v[76:79]
  s_and_b32 s31, s31, 0x1ffff
  v_max_f32 v10, v10, v2
  v_max_f32 v11, v11, v3
  v_mfma_f32_16x16x32_bf16 v[80:83], a[0:3], a[96:99], v[40:43]
  s_waitcnt lgkmcnt(3)
  ds_read_b128 a[48:51], v8 offset:28672
  v_mov_b32 v2, v10
  v_mfma_f32_16x16x32_bf16 v[80:83], a[4:7], a[100:103], v[80:83]
  s_add_u32 s25, s25, 1
  v_readlane_b32 s24, v5, s25
  v_mov_b32 v3, v11
  v_mfma_f32_16x16x32_bf16 v[80:83], a[8:11], a[104:107], v[80:83]
  ds_read_b128 a[52:55], v8 offset:29696
  v_mfma_f32_16x16x32_bf16 v[80:83], a[12:15], a[108:111], v[80:83]
  v_permlane32_swap_b32 v10, v2
  v_permlane32_swap_b32 v11, v3
  v_mfma_f32_16x16x32_bf16 v[80:83], a[16:19], a[112:115], v[80:83]
  ds_read_b128 a[56:59], v8 offset:30720
  v_max_f32 v10, v10, v2
  v_mfma_f32_16x16x32_bf16 v[80:83], a[20:23], a[116:119], v[80:83]
  v_max_f32 v11, v11, v3
  v_sub_f32 v10, 0, v10
  v_mfma_f32_16x16x32_bf16 v[80:83], a[24:27], a[120:123], v[80:83]
  ds_read_b128 a[60:63], v8 offset:31744
  v_add_u32 v8, s32, v9
  v_mfma_f32_16x16x32_bf16 v[80:83], a[28:31], a[124:127], v[80:83]
  v_sub_f32 v11, 0, v11
  v_add_f32 v64, v64, v10
  v_mfma_f32_16x16x32_bf16 v[84:87], a[0:3], a[160:163], 0
  s_waitcnt vmcnt(13)
  v_mfma_f32_16x16x32_bf16 v[84:87], a[4:7], a[164:167], v[84:87]
  s_barrier
  v_mfma_f32_16x16x32_bf16 v[84:87], a[8:11], a[168:171], v[84:87]
  ds_read_b128 a[0:3], v8 offset:0
  v_add_f32 v65, v65, v10
  v_mfma_f32_16x16x32_bf16 v[84:87], a[12:15], a[172:175], v[84:87]
  buffer_store_dwordx4 a[176:179], v9, s[4:7], s26 offen offset:1024 sc1
  v_add_f32 v66, v66, v10
  v_add_f32 v67, v67, v10
  v_add_f32 v68, v68, v11
  v_mfma_f32_16x16x32_bf16 v[84:87], a[16:19], a[176:179], v[84:87]
  ds_read_b128 a[4:7], v8 offset:1024
  v_add_f32 v69, v69, v11
  v_mfma_f32_16x16x32_bf16 v[84:87], a[20:23], a[180:183], v[84:87]
  v_exp_f32 v16, v64
  v_mfma_f32_16x16x32_bf16 v[84:87], a[24:27], a[184:187], v[84:87]
  ds_read_b128 a[8:11], v8 offset:2048
  v_add_f32 v70, v70, v11
  v_mfma_f32_16x16x32_bf16 v[84:87], a[28:31], a[188:191], v[84:87]
  buffer_store_dwordx4 a[116:119], v9, s[4:7], s26 offen offset:2048 sc1
  v_add_f32 v71, v71, v11
  v_add_f32 v72, v72, v10
  v_add_f32 v73, v73, v10
  v_mfma_f32_16x16x32_bf16 v[88:91], a[32:35], a[96:99], v[44:47]
  s_waitcnt lgkmcnt(3)
  ds_read_b128 a[12:15], v8 offset:3072
  v_add_f32 v74, v74, v10
  v_mfma_f32_16x16x32_bf16 v[88:91], a[36:39], a[100:103], v[88:91]
  v_exp_f32 v17, v65
  v_mfma_f32_16x16x32_bf16 v[88:91], a[40:43], a[104:107], v[88:91]
  ds_read_b128 a[16:19], v8 offset:4096
  v_add_f32 v14, v16, v17
  v_mfma_f32_16x16x32_bf16 v[88:91], a[44:47], a[108:111], v[88:91]
  buffer_store_dwordx4 a[180:183], v9, s[4:7], s26 offen offset:3072 sc1
  s_add_u32 s26, s26, 4096
  v_add_f32 v75, v75, v10
  v_add_f32 v76, v76, v11
  v_mfma_f32_16x16x32_bf16 v[88:91], a[48:51], a[112:115], v[88:91]
  ds_read_b128 a[20:23], v8 offset:5120
  v_cvt_pk_bf16_f32 v32, v16, v17
  v_mfma_f32_16x16x32_bf16 v[88:91], a[52:55], a[116:119], v[88:91]
  v_exp_f32 v18, v66
  v_mfma_f32_16x16x32_bf16 v[88:91], a[56:59], a[120:123], v[88:91]
  ds_read_b128 a[24:27], v8 offset:6144
  v_add_f32 v14, v14, v18
  v_mfma_f32_16x16x32_bf16 v[88:91], a[60:63], a[124:127], v[88:91]
  buffer_store_dwordx4 v[48:51], v9, s[12:15], s54 offen offset:0 sc1
  v_add_f32 v77, v77, v11
  v_add_f32 v78, v78, v11
  v_add_f32 v79, v79, v11
  v_mfma_f32_16x16x32_bf16 v[92:95], a[32:35], a[160:163], 0
  ds_read_b128 a[28:31], v8 offset:7168
  v_add_f32 v80, v80, v10
  v_mfma_f32_16x16x32_bf16 v[92:95], a[36:39], a[164:167], v[92:95]
  v_exp_f32 v19, v67
  v_mfma_f32_16x16x32_bf16 v[92:95], a[40:43], a[168:171], v[92:95]
  ds_read_b128 a[32:35], v8 offset:8192
  v_add_f32 v14, v14, v19
  v_mfma_f32_16x16x32_bf16 v[92:95], a[44:47], a[172:175], v[92:95]
  buffer_store_dwordx4 v[52:55], v9, s[12:15], s54 offen offset:1024 sc1
  s_add_u32 s54, s54, s47
  v_cvt_pk_bf16_f32 v33, v18, v19
  v_add_f32 v81, v81, v10
  v_mfma_f32_16x16x32_bf16 v[92:95], a[48:51], a[176:179], v[92:95]
  ds_read_b128 a[36:39], v8 offset:9216
  v_add_f32 v82, v82, v10
  v_mfma_f32_16x16x32_bf16 v[92:95], a[52:55], a[180:183], v[92:95]
  v_exp_f32 v20, v68
  v_mfma_f32_16x16x32_bf16 v[92:95], a[56:59], a[184:187], v[92:95]
  ds_read_b128 a[40:43], v8 offset:10240
  v_add_f32 v83, v83, v10
  v_mfma_f32_16x16x32_bf16 v[92:95], a[60:63], a[188:191], v[92:95]
  ds_read_b128 a[44:47], v8 offset:11264
  v_add_f32 v84, v84, v11
  v_exp_f32 v21, v69
  v_exp_f32 v22, v70
  v_exp_f32 v23, v71
  v_exp_f32 v28, v72
  v_exp_f32 v29, v73
  v_exp_f32 v30, v74
  buffer_store_dwordx4 v[56:59], v9, s[12:15], s54 offen offset:0 sc1
  v_exp_f32 v31, v75
  v_exp_f32 v16, v76
  v_exp_f32 v17, v77
  v_exp_f32 v18, v78
  v_exp_f32 v19, v79
  v_add_f32 v15, v20, v21
  buffer_store_dwordx4 v[60:63], v9, s[12:15], s54 offen offset:1024 sc1
  s_add_u32 s54, s54, s47
  v_cvt_pk_bf16_f32 v40, v20, v21
  v_exp_f32 v20, v80
  v_exp_f32 v21, v81
  v_add_f32 v15, v15, v22
  v_add_f32 v15, v15, v23
  v_cvt_pk_bf16_f32 v41, v22, v23
  buffer_store_dwordx4 a[120:123], v9, s[4:7], s26 offen offset:0 sc1
  v_exp_f32 v22, v82
  v_exp_f32 v23, v83
  v_add_f32 v14, v14, v28
  v_add_f32 v14, v14, v29
  v_cvt_pk_bf16_f32 v34, v28, v29
  v_exp_f32 v28, v84
  buffer_store_dwordx4 a[184:187], v9, s[4:7], s26 offen offset:1024 sc1
  v_add_f32 v14, v14, v30
  v_add_f32 v14, v14, v31
  v_cvt_pk_bf16_f32 v35, v30, v31
  v_add_f32 v15, v15, v16
  v_add_f32 v15, v15, v17
  v_cvt_pk_bf16_f32 v42, v16, v17
  buffer_store_dwordx4 a[124:127], v9, s[4:7], s26 offen offset:2048 sc1
  v_add_f32 v15, v15, v18
  v_add_f32 v15, v15, v19
  v_cvt_pk_bf16_f32 v43, v18, v19
  v_add_f32 v14, v14, v20
  v_add_f32 v14, v14, v21
  v_cvt_pk_bf16_f32 v36, v20, v21
  buffer_store_dwordx4 a[188:191], v9, s[4:7], s26 offen offset:3072 sc1
  s_add_u32 s26, s26, 4096
  v_add_f32 v14, v14, v22
  v_add_f32 v14, v14, v23
  v_cvt_pk_bf16_f32 v37, v22, v23
  v_add_f32 v15, v15, v28
  v_add_f32 v85, v85, v11
  v_exp_f32 v29, v85
  buffer_store_dwordx4 v[10:13], v9, s[4:7], s26 offen sc1
  v_add_f32 v15, v15, v29
  v_cvt_pk_bf16_f32 v44, v28, v29
  v_add_f32 v86, v86, v11
  v_exp_f32 v30, v86
  v_add_f32 v87, v87, v11
  v_exp_f32 v31, v87
  s_mov_b32 m0, s31
  s_nop 0
  buffer_load_dwordx4 v4, s[68:71], s24 offen lds
  s_add_u32 m0, m0, 4096
  s_add_u32 s24, s24, s30
  v_add_f32 v15, v15, v30
  v_add_f32 v15, v15, v31
  v_cvt_pk_bf16_f32 v45, v30, v31
  v_add_f32 v88, v88, v10
  v_exp_f32 v16, v88
  v_add_f32 v89, v89, v10
  buffer_load_dwordx4 v4, s[68:71], s24 offen lds
  s_add_u32 m0, m0, 4096
  s_add_u32 s24, s24, s30
  v_exp_f32 v17, v89
  v_add_f32 v14, v14, v16
  v_add_f32 v14, v14, v17
  v_cvt_pk_bf16_f32 v38, v16, v17
  v_add_f32 v90, v90, v10
  v_exp_f32 v18, v90
  buffer_load_dwordx4 v4, s[68:71], s24 offen lds
  s_add_u32 m0, m0, 4096
  s_add_u32 s24, s24, s30
  v_add_f32 v14, v14, v18
  v_add_f32 v91, v91, v10
  v_exp_f32 v19, v91
  v_add_f32 v92, v92, v11
  v_exp_f32 v20, v92
  v_add_f32 v14, v14, v19
  buffer_load_dwordx4 v4, s[68:71], s24 offen lds
  s_add_u32 m0, m0, 4096
  s_add_u32 s24, s24, s30
  v_cvt_pk_bf16_f32 v39, v18, v19
  v_add_f32 v15, v15, v20
  v_add_f32 v93, v93, v11
  v_exp_f32 v21, v93
  v_add_f32 v94, v94, v11
  v_exp_f32 v22, v94
  buffer_load_dwordx4 v4, s[68:71], s24 offen lds
  s_add_u32 m0, m0, 4096
  s_add_u32 s24, s24, s30
  v_add_f32 v15, v15, v21
  v_cvt_pk_bf16_f32 v46, v20, v21
  v_add_f32 v15, v15, v22
  v_add_f32 v95, v95, v11
  v_exp_f32 v23, v95
  v_mov_b32 v96, v10
  buffer_load_dwordx4 v4, s[68:71], s24 offen lds
  s_add_u32 m0, m0, 4096
  s_add_u32 s24, s24, s30
  v_add_f32 v15, v15, v23
  v_cvt_pk_bf16_f32 v47, v22, v23
  v_max_f32 v26, v14, v15
  v_cmp_nge_f32 vcc, 0x53800000, v26
  v_mov_b32 v97, v10
  v_mov_b64 v[98:99], v[96:97]
  buffer_load_dwordx4 v4, s[68:71], s24 offen lds
  s_add_u32 m0, m0, 4096
  s_add_u32 s24, s24, s30
  v_mov_b64 v[104:105], v[96:97]
  v_mov_b64 v[106:107], v[96:97]
  v_mov_b64 v[112:113], v[96:97]
  v_mov_b64 v[114:115], v[96:97]
  v_mov_b64 v[120:121], v[96:97]
  v_mov_b64 v[122:123], v[96:97]
  buffer_load_dwordx4 v4, s[68:71], s24 offen lds
  s_add_u32 s31, s31, 32768
  s_and_b32 s31, s31, 0x1ffff
  s_add_u32 s25, s25, 1
  v_readlane_b32 s24, v5, s25
  s_nop 3
  v_mov_b32 v100, v11
  v_mov_b32 v101, v11
  v_mov_b64 v[102:103], v[100:101]
  v_mov_b64 v[108:109], v[100:101]
  v_mov_b64 v[110:111], v[100:101]
  v_mov_b64 v[116:117], v[100:101]
  buffer_load_dword v25, off, s[12:15], s51 sc1
  v_mov_b64 v[118:119], v[100:101]
  v_mov_b64 v[124:125], v[100:101]
  v_mov_b64 v[126:127], v[100:101]
  s_cbranch_vccnz AT_HZ
AT_FZ:
  s_cmp_le_u32 s43, s45
  s_cbranch_scc1 AT_Z0
AT_BODYZ:
  s_waitcnt lgkmcnt(4)
  v_mfma_f32_16x16x32_bf16 v[64:67], a[0:3], a[96:99], v[96:99]
  s_add_u32 s32, s32, 32768
  ds_read_b128 a[48:51], v8 offset:12288
  v_mfma_f32_16x16x32_bf16 v[64:67], a[4:7], a[100:103], v[64:67]
  s_and_b32 s32, s32, 0x1ffff
  v_mfma_f32_16x16x32_bf16 v[64:67], a[8:11], a[104:107], v[64:67]
  s_mov_b32 m0, s31
  ds_read_b128 a[52:55], v8 offset:13312
  v_add_f32 v12, v12, v14
  v_mfma_f32_16x16x32_bf16 v[64:67], a[12:15], a[108:111], v[64:67]
  buffer_load_dwordx4 v4, s[68:71], s24 offen lds
  v_mfma_f32_16x16x32_bf16 v[64:67], a[16:19], a[112:115], v[64:67]
  s_add_u32 m0, m0, 4096
  ds_read_b128 a[56:59], v8 offset:14336
  v_add_f32 v13, v13, v15
  v_mfma_f32_16x16x32_bf16 v[64:67], a[20:23], a[116:119], v[64:67]
  s_add_u32 s24, s24, s30
  v_mfma_f32_16x16x32_bf16 v[64:67], a[24:27], a[120:123], v[64:67]
  ds_read_b128 a[60:63], v8 offset:15360
  v_mfma_f32_16x16x32_bf16 v[64:67], a[28:31], a[124:127], v[64:67]
  buffer_load_dwordx4 v4, s[68:71], s24 offen lds
  v_mfma_f32_16x16x32_bf16 v[68:71], a[0:3], a[160:163], v[100:103]
  s_add_u32 m0, m0, 4096
  ds_read_b128 a[0:3], v8 offset:16384
  v_mfma_f32_16x16x32_bf16 v[68:71], a[4:7], a[164:167], v[68:71]
  s_add_u32 s24, s24, s30
  v_mfma_f32_16x16x32_bf16 v[68:71], a[8:11], a[168:171], v[68:71]
  ds_read_b128 a[4:7], v8 offset:17408
  v_mfma_f32_16x16x32_bf16 v[68:71], a[12:15], a[172:175], v[68:71]
  v_mfma_f32_16x16x32_bf16 v[68:71], a[16:19], a[176:179], v[68:71]
  ds_read_b128 a[8:11], v8 offset:18432
  v_mfma_f32_16x16x32_bf16 v[68:71], a[20:23], a[180:183], v[68:71]
  buffer_load_dwordx4 v4, s[68:71], s24 offen lds
  v_mfma_f32_16x16x32_bf16 v[68:71], a[24:27], a[184:187], v[68:71]
  s_add_u32 m0, m0, 4096
  ds_read_b128 a[12:15], v8 offset:19456
  v_mfma_f32_16x16x32_bf16 v[68:71], a[28:31], a[188:191], v[68:71]
  s_waitcnt lgkmcnt(3)
  s_add_u32 s24, s24, s30
  v_mfma_f32_16x16x32_bf16 v[72:75], a[32:35], a[96:99], v[104:107]
  ds_read_b128 a[16:19], v8 offset:20480
  v_mfma_f32_16x16x32_bf16 v[72:75], a[36:39], a[100:103], v[72:75]
  buffer_load_dwordx4 v4, s[68:71], s24 offen lds
  v_mfma_f32_16x16x32_bf16 v[72:75], a[40:43], a[104:107], v[72:75]
  s_add_u32 m0, m0, 4096
  ds_read_b128 a[20:23], v8 offset:21504
  v_mfma_f32_16x16x32_bf16 v[72:75], a[44:47], a[108:111], v[72:75]
  s_add_u32 s24, s24, s30
  v_exp_f32 v16, v64
  v_mfma_f32_16x16x32_bf16 v[72:75], a[48:51], a[112:115], v[72:75]
  ds_read_b128 a[24:27], v8 offset:22528
  v_mfma_f32_16x16x32_bf16 v[72:75], a[52:55], a[116:119], v[72:75]
  v_exp_f32 v17, v65
  v_mfma_f32_16x16x32_bf16 v[72:75], a[56:59], a[120:123], v[72:75]
  ds_read_b128 a[28:31], v8 offset:23552
  v_add_f32 v14, v16, v17
  v_mfma_f32_16x16x32_bf16 v[72:75], a[60:63], a[124:127], v[72:75]
  buffer_load_dwordx4 v4, s[68:71], s24 offen lds
  v_mfma_f32_16x16x32_bf16 v[76:79], a[32:35], a[160:163], v[108:111]
  s_add_u32 m0, m0, 4096
  ds_read_b128 a[32:35], v8 offset:24576
  v_cvt_pk_bf16_f32 v48, v16, v17
  v_mfma_f32_16x16x32_bf16 v[76:79], a[36:39], a[164:167], v[76:79]
  s_add_u32 s24, s24, s30
  v_exp_f32 v18, v66
  v_mfma_f32_16x16x32_bf16 v[76:79], a[40:43], a[168:171], v[76:79]
  ds_read_b128 a[36:39], v8 offset:25600
  v_add_f32 v14, v14, v18
  v_mfma_f32_16x16x32_bf16 v[76:79], a[44:47], a[172:175], v[76:79]
  buffer_load_dwordx4 v4, s[68:71], s24 offen lds
  v_mfma_f32_16x16x32_bf16 v[76:79], a[48:51], a[176:179], v[76:79]
  s_add_u32 m0, m0, 4096
  ds_read_b128 a[40:43], v8 offset:26624
  v_mfma_f32_16x16x32_bf16 v[76:79], a[52:55], a[180:183], v[76:79]
  s_add_u32 s24, s24, s30
  v_exp_f32 v19, v67
  v_mfma_f32_16x16x32_bf16 v[76:79], a[56:59], a[184:187], v[76:79]
  ds_read_b128 a[44:47], v8 offset:27648
  v_add_f32 v14, v14, v19
  v_mfma_f32_16x16x32_bf16 v[76:79], a[60:63], a[188:191], v[76:79]
  v_exp_f32 v20, v68
  v_mfma_f32_16x16x32_bf16 v[80:83], a[0:3], a[96:99], v[112:115]
  s_waitcnt lgkmcnt(3)
  ds_read_b128 a[48:51], v8 offset:28672
  v_cvt_pk_bf16_f32 v49, v18, v19
  v_mfma_f32_16x16x32_bf16 v[80:83], a[4:7], a[100:103], v[80:83]
  buffer_load_dwordx4 v4, s[68:71], s24 offen lds
  v_mfma_f32_16x16x32_bf16 v[80:83], a[8:11], a[104:107], v[80:83]
  s_add_u32 m0, m0, 4096
  ds_read_b128 a[52:55], v8 offset:29696
  v_mfma_f32_16x16x32_bf16 v[80:83], a[12:15], a[108:111], v[80:83]
  s_add_u32 s24, s24, s30
  v_exp_f32 v21, v69
  v_mfma_f32_16x16x32_bf16 v[80:83], a[16:19], a[112:115], v[80:83]
  ds_read_b128 a[56:59], v8 offset:30720
  v_add_f32 v15, v20, v21
  v_mfma_f32_16x16x32_bf16 v[80:83], a[20:23], a[116:119], v[80:83]
  buffer_load_dwordx4 v4, s[68:71], s24 offen lds
  v_mfma_f32_16x16x32_bf16 v[80:83], a[24:27], a[120:123], v[80:83]
  s_add_u32 s31, s31, 32768
  ds_read_b128 a[60:63], v8 offset:31744
  v_add_u32 v8, s32, v9
  v_mfma_f32_16x16x32_bf16 v[80:83], a[28:31], a[124:127], v[80:83]
  s_and_b32 s31, s31, 0x1ffff
  v_exp_f32 v22, v70
  v_mfma_f32_16x16x32_bf16 v[84:87], a[0:3], a[160:163], v[116:119]
  s_waitcnt vmcnt(17)
  v_mfma_f32_16x16x32_bf16 v[84:87], a[4:7], a[164:167], v[84:87]
  s_barrier
  v_mfma_f32_16x16x32_bf16 v[84:87], a[8:11], a[168:171], v[84:87]
  s_add_u32 s25, s25, 1
  ds_read_b128 a[0:3], v8 offset:0
  v_cvt_pk_bf16_f32 v56, v20, v21
  v_mfma_f32_16x16x32_bf16 v[84:87], a[12:15], a[172:175], v[84:87]
  s_cmp_eq_u32 s25, s28
  v_exp_f32 v23, v71
  v_mfma_f32_16x16x32_bf16 v[84:87], a[16:19], a[176:179], v[84:87]
  s_cbranch_scc1 AT_NS_6
AT_NB_7:
  ds_read_b128 a[4:7], v8 offset:1024
  v_add_f32 v15, v15, v22
  v_mfma_f32_16x16x32_bf16 v[84:87], a[20:23], a[180:183], v[84:87]
  v_readlane_b32 s24, v5, s25
  v_mfma_f32_16x16x32_bf16 v[84:87], a[24:27], a[184:187], v[84:87]
  s_cmp_eq_u32 s8, s9
  ds_read_b128 a[8:11], v8 offset:2048
  v_add_f32 v15, v15, v23
  v_mfma_f32_16x16x32_bf16 v[84:87], a[28:31], a[188:191], v[84:87]
  s_cselect_b32 s82, 8192, 0
  v_exp_f32 v28, v72
  v_mfma_f32_16x16x32_bf16 v[88:91], a[32:35], a[96:99], v[120:123]
  s_waitcnt lgkmcnt(3)
  ds_read_b128 a[12:15], v8 offset:3072
  v_cvt_pk_bf16_f32 v57, v22, v23
  v_mfma_f32_16x16x32_bf16 v[88:91], a[36:39], a[100:103], v[88:91]
  s_cmov_b32 s9, s10
  v_exp_f32 v29, v73
  v_mfma_f32_16x16x32_bf16 v[88:91], a[40:43], a[104:107], v[88:91]
  s_cmov_b32 s10, s11
  ds_read_b128 a[16:19], v8 offset:4096
  v_add_f32 v14, v14, v28
  v_mfma_f32_16x16x32_bf16 v[88:91], a[44:47], a[108:111], v[88:91]
  s_mov_b64 s[80:81], s[76:77]
  v_exp_f32 v30, v74
  v_mfma_f32_16x16x32_bf16 v[88:91], a[48:51], a[112:115], v[88:91]
  s_cmov_b64 s[76:77], s[84:85]
  ds_read_b128 a[20:23], v8 offset:5120
  v_add_f32 v14, v14, v29
  v_mfma_f32_16x16x32_bf16 v[88:91], a[52:55], a[116:119], v[88:91]
  s_cmov_b64 s[84:85], s[86:87]
  v_exp_f32 v31, v75
  v_mfma_f32_16x16x32_bf16 v[88:91], a[56:59], a[120:123], v[88:91]
  s_add_u32 s8, s8, 1
  ds_read_b128 a[24:27], v8 offset:6144
  v_cvt_pk_bf16_f32 v50, v28, v29
  v_mfma_f32_16x16x32_bf16 v[88:91], a[60:63], a[124:127], v[88:91]
  v_exp_f32 v16, v76
  v_mfma_f32_16x16x32_bf16 v[92:95], a[32:35], a[160:163], v[124:127]
  ds_read_b128 a[28:31], v8 offset:7168
  v_add_f32 v14, v14, v30
  v_mfma_f32_16x16x32_bf16 v[92:95], a[36:39], a[164:167], v[92:95]
  v_exp_f32 v17, v77
  v_mfma_f32_16x16x32_bf16 v[92:95], a[40:43], a[168:171], v[92:95]
  ds_read_b128 a[32:35], v8 offset:8192
  v_add_f32 v14, v14, v31
  v_mfma_f32_16x16x32_bf16 v[92:95], a[44:47], a[172:175], v[92:95]
  v_exp_f32 v18, v78
  v_mfma_f32_16x16x32_bf16 v[92:95], a[48:51], a[176:179], v[92:95]
  ds_read_b128 a[36:39], v8 offset:9216
  v_cvt_pk_bf16_f32 v51, v30, v31
  v_mfma_f32_16x16x32_bf16 v[92:95], a[52:55], a[180:183], v[92:95]
  v_exp_f32 v19, v79
  v_mfma_f32_16x16x32_bf16 v[92:95], a[56:59], a[184:187], v[92:95]
  ds_read_b128 a[40:43], v8 offset:10240
  v_add_f32 v15, v15, v16
  v_mfma_f32_16x16x32_bf16 v[92:95], a[60:63], a[188:191], v[92:95]
  s_waitcnt lgkmcnt(3)
  ds_read_b128 a[44:47], v8 offset:11264
  v_add_f32 v15, v15, v17
  v_mfma_f32_16x16x32_bf16 v[128:131], a[0:3], v[32:35], 0
  s_add_u32 s32, s32, 32768
  ds_read_b128 a[48:51], v8 offset:12288
  v_cvt_pk_bf16_f32 v58, v16, v17
  v_mfma_f32_16x16x32_bf16 v[128:131], a[4:7], v[36:39], v[128:131]
  s_and_b32 s32, s32, 0x1ffff
  v_exp_f32 v20, v80
  v_mfma_f32_16x16x32_bf16 v[132:135], a[4:7], v[44:47], 0
  s_mov_b32 m0, s31
  ds_read_b128 a[52:55], v8 offset:13312
  v_add_f32 v15, v15, v18
  v_mfma_f32_16x16x32_bf16 v[132:135], a[0:3], v[40:43], v[132:135]
  buffer_load_dwordx4 v4, s[68:71], s24 offen lds
  v_mfma_f32_16x16x32_bf16 v[136:139], a[8:11], v[32:35], 0
  s_add_u32 m0, m0, 4096
  ds_read_b128 a[56:59], v8 offset:14336
  v_add_f32 v15, v15, v19
  v_mfma_f32_16x16x32_bf16 v[136:139], a[12:15], v[36:39], v[136:139]
  s_add_u32 s24, s24, s30
  v_exp_f32 v21, v81
  v_mfma_f32_16x16x32_bf16 v[140:143], a[12:15], v[44:47], 0
  ds_read_b128 a[60:63], v8 offset:15360
  v_cvt_pk_bf16_f32 v59, v18, v19
  v_mfma_f32_16x16x32_bf16 v[140:143], a[8:11], v[40:43], v[140:143]
  buffer_load_dwordx4 v4, s[68:71], s24 offen lds
  v_mfma_f32_16x16x32_bf16 v[144:147], a[16:19], v[32:35], 0
  s_add_u32 m0, m0, 4096
  ds_read_b128 a[0:3], v8 offset:16384
  v_add_f32 v14, v14, v20
  v_mfma_f32_16x16x32_bf16 v[144:147], a[20:23], v[36:39], v[144:147]
  s_add_u32 s24, s24, s30
  v_exp_f32 v22, v82
  v_mfma_f32_16x16x32_bf16 v[148:151], a[20:23], v[44:47], 0
  ds_read_b128 a[4:7], v8 offset:17408
  v_add_f32 v14, v14, v21
  v_mfma_f32_16x16x32_bf16 v[148:151], a[16:19], v[40:43], v[148:151]
  v_exp_f32 v23, v83
  v_mfma_f32_16x16x32_bf16 v[152:155], a[24:27], v[32:35], 0
  ds_read_b128 a[8:11], v8 offset:18432
  v_cvt_pk_bf16_f32 v52, v20, v21
  v_mfma_f32_16x16x32_bf16 v[152:155], a[28:31], v[36:39], v[152:155]
  buffer_load_dwordx4 v4, s[68:71], s24 offen lds
  v_mfma_f32_16x16x32_bf16 v[156:159], a[28:31], v[44:47], 0
  s_add_u32 m0, m0, 4096
  ds_read_b128 a[12:15], v8 offset:19456
  v_add_f32 v14, v14, v22
  v_mfma_f32_16x16x32_bf16 v[156:159], a[24:27], v[40:43], v[156:159]
  s_waitcnt lgkmcnt(3)
  s_add_u32 s24, s24, s30
  v_add_f32 v14, v14, v23
  v_mfma_f32_16x16x32_bf16 v[160:163], a[32:35], v[32:35], 0
  ds_read_b128 a[16:19], v8 offset:20480
  v_cvt_pk_bf16_f32 v53, v22, v23
  v_mfma_f32_16x16x32_bf16 v[160:163], a[36:39], v[36:39], v[160:163]
  buffer_load_dwordx4 v4, s[68:71], s24 offen lds
  v_mfma_f32_16x16x32_bf16 v[164:167], a[36:39], v[44:47], 0
  s_add_u32 m0, m0, 4096
  ds_read_b128 a[20:23], v8 offset:21504
  v_mfma_f32_16x16x32_bf16 v[164:167], a[32:35], v[40:43], v[164:167]
  s_add_u32 s24, s24, s30
  v_exp_f32 v28, v84
  v_mfma_f32_16x16x32_bf16 v[168:171], a[40:43], v[32:35], 0
  ds_read_b128 a[24:27], v8 offset:22528
  v_add_f32 v15, v15, v28
  v_mfma_f32_16x16x32_bf16 v[168:171], a[44:47], v[36:39], v[168:171]
  v_exp_f32 v29, v85
  v_mfma_f32_16x16x32_bf16 v[172:175], a[44:47], v[44:47], 0
  ds_read_b128 a[28:31], v8 offset:23552
  v_add_f32 v15, v15, v29
  v_mfma_f32_16x16x32_bf16 v[172:175], a[40:43], v[40:43], v[172:175]
  buffer_load_dwordx4 v4, s[68:71], s24 offen lds
  v_mfma_f32_16x16x32_bf16 v[176:179], a[48:51], v[32:35], 0
  s_add_u32 m0, m0, 4096
  ds_read_b128 a[32:35], v8 offset:24576
  v_cvt_pk_bf16_f32 v60, v28, v29
  v_mfma_f32_16x16x32_bf16 v[176:179], a[52:55], v[36:39], v[176:179]
  s_add_u32 s24, s24, s30
  v_exp_f32 v30, v86
  v_mfma_f32_16x16x32_bf16 v[180:183], a[52:55], v[44:47], 0
  ds_read_b128 a[36:39], v8 offset:25600
  v_add_f32 v15, v15, v30
  v_mfma_f32_16x16x32_bf16 v[180:183], a[48:51], v[40:43], v[180:183]
  buffer_load_dwordx4 v4, s[68:71], s24 offen lds
  v_mfma_f32_16x16x32_bf16 v[184:187], a[56:59], v[32:35], 0
  s_add_u32 m0, m0, 4096
  ds_read_b128 a[40:43], v8 offset:26624
  v_mfma_f32_16x16x32_bf16 v[184:187], a[60:63], v[36:39], v[184:187]
  s_add_u32 s24, s24, s30
  v_exp_f32 v31, v87
  v_mfma_f32_16x16x32_bf16 v[188:191], a[60:63], v[44:47], 0
  ds_read_b128 a[44:47], v8 offset:27648
  v_add_f32 v15, v15, v31
  v_mfma_f32_16x16x32_bf16 v[188:191], a[56:59], v[40:43], v[188:191]
  v_exp_f32 v16, v88
  v_mfma_f32_16x16x32_bf16 v[192:195], a[0:3], v[32:35], 0
  s_waitcnt lgkmcnt(3)
  ds_read_b128 a[48:51], v8 offset:28672
  v_cvt_pk_bf16_f32 v61, v30, v31
  v_mfma_f32_16x16x32_bf16 v[192:195], a[4:7], v[36:39], v[192:195]
  buffer_load_dwordx4 v4, s[68:71], s24 offen lds
  v_mfma_f32_16x16x32_bf16 v[196:199], a[4:7], v[44:47], 0
  s_add_u32 m0, m0, 4096
  ds_read_b128 a[52:55], v8 offset:29696
  v_add_f32 v14, v14, v16
  v_mfma_f32_16x16x32_bf16 v[196:199], a[0:3], v[40:43], v[196:199]
  s_add_u32 s24, s24, s30
  v_exp_f32 v17, v89
  v_mfma_f32_16x16x32_bf16 v[200:203], a[8:11], v[32:35], 0
  ds_read_b128 a[56:59], v8 offset:30720
  v_add_f32 v14, v14, v17
  v_mfma_f32_16x16x32_bf16 v[200:203], a[12:15], v[36:39], v[200:203]
  buffer_load_dwordx4 v4, s[68:71], s24 offen lds
  v_mfma_f32_16x16x32_bf16 v[204:207], a[12:15], v[44:47], 0
  s_add_u32 s31, s31, 32768
  ds_read_b128 a[60:63], v8 offset:31744
  v_add_u32 v8, s32, v9
  v_mfma_f32_16x16x32_bf16 v[204:207], a[8:11], v[40:43], v[204:207]
  s_and_b32 s31, s31, 0x1ffff
  v_exp_f32 v18, v90
  v_mfma_f32_16x16x32_bf16 v[208:211], a[16:19], v[32:35], 0
  s_waitcnt vmcnt(17)
  v_mfma_f32_16x16x32_bf16 v[208:211], a[20:23], v[36:39], v[208:211]
  s_barrier
  v_mfma_f32_16x16x32_bf16 v[212:215], a[20:23], v[44:47], 0
  s_add_u32 s25, s25, 1
  ds_read_b128 a[0:3], v8 offset:0
  v_cvt_pk_bf16_f32 v54, v16, v17
  v_mfma_f32_16x16x32_bf16 v[212:215], a[16:19], v[40:43], v[212:215]
  s_cmp_eq_u32 s25, s28
  v_exp_f32 v19, v91
  v_mfma_f32_16x16x32_bf16 v[216:219], a[24:27], v[32:35], 0
  s_cbranch_scc1 AT_NS_8
AT_NB_9:
  ds_read_b128 a[4:7], v8 offset:1024
  v_add_f32 v14, v14, v18
  v_mfma_f32_16x16x32_bf16 v[216:219], a[28:31], v[36:39], v[216:219]
  v_readlane_b32 s24, v5, s25
  v_mfma_f32_16x16x32_bf16 v[220:223], a[28:31], v[44:47], 0
  s_sub_u32 s43, s43, 1
  ds_read_b128 a[8:11], v8 offset:2048
  v_add_f32 v14, v14, v19
  v_mfma_f32_16x16x32_bf16 v[220:223], a[24:27], v[40:43], v[220:223]
  s_cmp_le_u32 s43, s45
  v_exp_f32 v20, v92
  v_mfma_f32_16x16x32_bf16 v[224:227], a[32:35], v[32:35], 0
  s_waitcnt lgkmcnt(3)
  ds_read_b128 a[12:15], v8 offset:3072
  v_cvt_pk_bf16_f32 v55, v18, v19
  v_mfma_f32_16x16x32_bf16 v[224:227], a[36:39], v[36:39], v[224:227]
  v_exp_f32 v21, v93
  v_mfma_f32_16x16x32_bf16 v[228:231], a[36:39], v[44:47], 0
  ds_read_b128 a[16:19], v8 offset:4096
  v_add_f32 v15, v15, v20
  v_mfma_f32_16x16x32_bf16 v[228:231], a[32:35], v[40:43], v[228:231]
  v_exp_f32 v22, v94
  v_mfma_f32_16x16x32_bf16 v[232:235], a[40:43], v[32:35], 0
  ds_read_b128 a[20:23], v8 offset:5120
  v_add_f32 v15, v15, v21
  v_mfma_f32_16x16x32_bf16 v[232:235], a[44:47], v[36:39], v[232:235]
  v_exp_f32 v23, v95
  v_mfma_f32_16x16x32_bf16 v[236:239], a[44:47], v[44:47], 0
  ds_read_b128 a[24:27], v8 offset:6144
  v_cvt_pk_bf16_f32 v62, v20, v21
  v_mfma_f32_16x16x32_bf16 v[236:239], a[40:43], v[40:43], v[236:239]
  v_add_f32 v15, v15, v22
  v_add_f32 v15, v15, v23
  v_mfma_f32_16x16x32_bf16 v[240:243], a[48:51], v[32:35], 0
  ds_read_b128 a[28:31], v8 offset:7168
  v_cvt_pk_bf16_f32 v63, v22, v23
  v_mfma_f32_16x16x32_bf16 v[240:243], a[52:55], v[36:39], v[240:243]
  v_max_f32 v26, v14, v15
  v_cmp_nge_f32 vcc, 0x53800000, v26
  v_mfma_f32_16x16x32_bf16 v[244:247], a[52:55], v[44:47], 0
  ds_read_b128 a[32:35], v8 offset:8192
  v_mfma_f32_16x16x32_bf16 v[244:247], a[48:51], v[40:43], v[244:247]
  v_mfma_f32_16x16x32_bf16 v[248:251], a[56:59], v[32:35], 0
  ds_read_b128 a[36:39], v8 offset:9216
  v_mfma_f32_16x16x32_bf16 v[248:251], a[60:63], v[36:39], v[248:251]
  buffer_load_dword v27, v0, s[80:83], 0 offen
  v_mfma_f32_16x16x32_bf16 v[252:255], a[60:63], v[44:47], 0
  ds_read_b128 a[40:43], v8 offset:10240
  v_mfma_f32_16x16x32_bf16 v[252:255], a[56:59], v[40:43], v[252:255]
  ds_read_b128 a[44:47], v8 offset:11264
  s_cbranch_vccnz AT_H0
  s_cbranch_scc1 AT_H0B
  s_branch AT_BODY1
.p2align 6
AT_BODY0:
  s_waitcnt lgkmcnt(4)
  v_mfma_f32_16x16x32_bf16 v[64:67], a[0:3], a[96:99], v[96:99]
  s_add_u32 s32, s32, 32768
  ds_read_b128 a[48:51], v8 offset:12288
  v_mfma_f32_16x16x32_bf16 v[64:67], a[4:7], a[100:103], v[64:67]
  s_and_b32 s32, s32, 0x1ffff
  v_mfma_f32_16x16x32_bf16 v[64:67], a[8:11], a[104:107], v[64:67]
  s_mov_b32 m0, s31
  ds_read_b128 a[52:55], v8 offset:13312
  v_add_f32 v12, v12, v14
  v_mfma_f32_16x16x32_bf16 v[64:67], a[12:15], a[108:111], v[64:67]
  buffer_load_dwordx4 v4, s[68:71], s24 offen lds
  v_mfma_f32_16x16x32_bf16 v[64:67], a[16:19], a[112:115], v[64:67]
  s_add_u32 m0, m0, 4096
  ds_read_b128 a[56:59], v8 offset:14336
  v_add_f32 v13, v13, v15
  v_mfma_f32_16x16x32_bf16 v[64:67], a[20:23], a[116:119], v[64:67]
  s_add_u32 s24, s24, s30
  v_mfma_f32_16x16x32_bf16 v[64:67], a[24:27], a[120:123], v[64:67]
  ds_read_b128 a[60:63], v8 offset:15360
  v_mfma_f32_16x16x32_bf16 v[64:67], a[28:31], a[124:127], v[64:67]
  buffer_load_dwordx4 v4, s[68:71], s24 offen lds
  v_mfma_f32_16x16x32_bf16 v[68:71], a[0:3], a[160:163], v[100:103]
  s_add_u32 m0, m0, 4096
  ds_read_b128 a[0:3], v8 offset:16384
  v_mfma_f32_16x16x32_bf16 v[68:71], a[4:7], a[164:167], v[68:71]
  s_add_u32 s24, s24, s30
  v_mfma_f32_16x16x32_bf16 v[68:71], a[8:11], a[168:171], v[68:71]
  ds_read_b128 a[4:7], v8 offset:17408
  v_mfma_f32_16x16x32_bf16 v[68:71], a[12:15], a[172:175], v[68:71]
  v_mfma_f32_16x16x32_bf16 v[68:71], a[16:19], a[176:179], v[68:71]
  ds_read_b128 a[8:11], v8 offset:18432
  v_mfma_f32_16x16x32_bf16 v[68:71], a[20:23], a[180:183], v[68:71]
  buffer_load_dwordx4 v4, s[68:71], s24 offen lds
  v_mfma_f32_16x16x32_bf16 v[68:71], a[24:27], a[184:187], v[68:71]
  s_add_u32 m0, m0, 4096
  ds_read_b128 a[12:15], v8 offset:19456
  v_mfma_f32_16x16x32_bf16 v[68:71], a[28:31], a[188:191], v[68:71]
  s_waitcnt lgkmcnt(3)
  s_add_u32 s24, s24, s30
  v_mfma_f32_16x16x32_bf16 v[72:75], a[32:35], a[96:99], v[104:107]
  ds_read_b128 a[16:19], v8 offset:20480
  v_mfma_f32_16x16x32_bf16 v[72:75], a[36:39], a[100:103], v[72:75]
  buffer_load_dwordx4 v4, s[68:71], s24 offen lds
  v_mfma_f32_16x16x32_bf16 v[72:75], a[40:43], a[104:107], v[72:75]
  s_add_u32 m0, m0, 4096
  ds_read_b128 a[20:23], v8 offset:21504
  v_mfma_f32_16x16x32_bf16 v[72:75], a[44:47], a[108:111], v[72:75]
  s_add_u32 s24, s24, s30
  v_exp_f32 v16, v64
  v_mfma_f32_16x16x32_bf16 v[72:75], a[48:51], a[112:115], v[72:75]
  ds_read_b128 a[24:27], v8 offset:22528
  v_mfma_f32_16x16x32_bf16 v[72:75], a[52:55], a[116:119], v[72:75]
  v_exp_f32 v17, v65
  v_mfma_f32_16x16x32_bf16 v[72:75], a[56:59], a[120:123], v[72:75]
  ds_read_b128 a[28:31], v8 offset:23552
  v_add_f32 v14, v16, v17
  v_mfma_f32_16x16x32_bf16 v[72:75], a[60:63], a[124:127], v[72:75]
  buffer_load_dwordx4 v4, s[68:71], s24 offen lds
  v_mfma_f32_16x16x32_bf16 v[76:79], a[32:35], a[160:163], v[108:111]
  s_add_u32 m0, m0, 4096
  ds_read_b128 a[32:35], v8 offset:24576
  v_cvt_pk_bf16_f32 v48, v16, v17
  v_mfma_f32_16x16x32_bf16 v[76:79], a[36:39], a[164:167], v[76:79]
  s_add_u32 s24, s24, s30
  v_exp_f32 v18, v66
  v_mfma_f32_16x16x32_bf16 v[76:79], a[40:43], a[168:171], v[76:79]
  ds_read_b128 a[36:39], v8 offset:25600
  v_add_f32 v14, v14, v18
  v_mfma_f32_16x16x32_bf16 v[76:79], a[44:47], a[172:175], v[76:79]
  buffer_load_dwordx4 v4, s[68:71], s24 offen lds
  v_mfma_f32_16x16x32_bf16 v[76:79], a[48:51], a[176:179], v[76:79]
  s_add_u32 m0, m0, 4096
  ds_read_b128 a[40:43], v8 offset:26624
  v_mfma_f32_16x16x32_bf16 v[76:79], a[52:55], a[180:183], v[76:79]
  s_add_u32 s24, s24, s30
  v_exp_f32 v19, v67
  v_mfma_f32_16x16x32_bf16 v[76:79], a[56:59], a[184:187], v[76:79]
  ds_read_b128 a[44:47], v8 offset:27648
  v_add_f32 v14, v14, v19
  v_mfma_f32_16x16x32_bf16 v[76:79], a[60:63], a[188:191], v[76:79]
  v_exp_f32 v20, v68
  v_mfma_f32_16x16x32_bf16 v[80:83], a[0:3], a[96:99], v[112:115]
  s_waitcnt lgkmcnt(3)
  ds_read_b128 a[48:51], v8 offset:28672
  v_cvt_pk_bf16_f32 v49, v18, v19
  v_mfma_f32_16x16x32_bf16 v[80:83], a[4:7], a[100:103], v[80:83]
  buffer_load_dwordx4 v4, s[68:71], s24 offen lds
  v_mfma_f32_16x16x32_bf16 v[80:83], a[8:11], a[104:107], v[80:83]
  s_add_u32 m0, m0, 4096
  ds_read_b128 a[52:55], v8 offset:29696
  v_mfma_f32_16x16x32_bf16 v[80:83], a[12:15], a[108:111], v[80:83]
  s_add_u32 s24, s24, s30
  v_exp_f32 v21, v69
  v_mfma_f32_16x16x32_bf16 v[80:83], a[16:19], a[112:115], v[80:83]
  ds_read_b128 a[56:59], v8 offset:30720
  v_add_f32 v15, v20, v21
  v_mfma_f32_16x16x32_bf16 v[80:83], a[20:23], a[116:119], v[80:83]
  buffer_load_dwordx4 v4, s[68:71], s24 offen lds
  v_mfma_f32_16x16x32_bf16 v[80:83], a[24:27], a[120:123], v[80:83]
  s_add_u32 s31, s31, 32768
  ds_read_b128 a[60:63], v8 offset:31744
  v_add_u32 v8, s32, v9
  v_mfma_f32_16x16x32_bf16 v[80:83], a[28:31], a[124:127], v[80:83]
  s_and_b32 s31, s31, 0x1ffff
  v_exp_f32 v22, v70
  v_mfma_f32_16x16x32_bf16 v[84:87], a[0:3], a[160:163], v[116:119]
  s_waitcnt vmcnt(17)
  v_mfma_f32_16x16x32_bf16 v[84:87], a[4:7], a[164:167], v[84:87]
  s_barrier
  v_mfma_f32_16x16x32_bf16 v[84:87], a[8:11], a[168:171], v[84:87]
  s_add_u32 s25, s25, 1
  ds_read_b128 a[0:3], v8 offset:0
  v_cvt_pk_bf16_f32 v56, v20, v21
  v_mfma_f32_16x16x32_bf16 v[84:87], a[12:15], a[172:175], v[84:87]
  s_cmp_eq_u32 s25, s28
  v_exp_f32 v23, v71
  v_mfma_f32_16x16x32_bf16 v[84:87], a[16:19], a[176:179], v[84:87]
  s_cbranch_scc1 AT_NS_10
AT_NB_11:
  ds_read_b128 a[4:7], v8 offset:1024
  v_add_f32 v15, v15, v22
  v_mfma_f32_16x16x32_bf16 v[84:87], a[20:23], a[180:183], v[84:87]
  v_readlane_b32 s24, v5, s25
  v_mfma_f32_16x16x32_bf16 v[84:87], a[24:27], a[184:187], v[84:87]
  s_cmp_eq_u32 s8, s9
  ds_read_b128 a[8:11], v8 offset:2048
  v_add_f32 v15, v15, v23
  v_mfma_f32_16x16x32_bf16 v[84:87], a[28:31], a[188:191], v[84:87]
  s_cselect_b32 s82, 8192, 0
  v_exp_f32 v28, v72
  v_mfma_f32_16x16x32_bf16 v[88:91], a[32:35], a[96:99], v[120:123]
  s_waitcnt lgkmcnt(3)
  ds_read_b128 a[12:15], v8 offset:3072
  v_cvt_pk_bf16_f32 v57, v22, v23
  v_mfma_f32_16x16x32_bf16 v[88:91], a[36:39], a[100:103], v[88:91]
  s_cmov_b32 s9, s10
  v_exp_f32 v29, v73
  v_mfma_f32_16x16x32_bf16 v[88:91], a[40:43], a[104:107], v[88:91]
  s_cmov_b32 s10, s11
  ds_read_b128 a[16:19], v8 offset:4096
  v_add_f32 v14, v14, v28
  v_mfma_f32_16x16x32_bf16 v[88:91], a[44:47], a[108:111], v[88:91]
  s_mov_b64 s[80:81], s[76:77]
  v_exp_f32 v30, v74
  v_mfma_f32_16x16x32_bf16 v[88:91], a[48:51], a[112:115], v[88:91]
  s_cmov_b64 s[76:77], s[84:85]
  ds_read_b128 a[20:23], v8 offset:5120
  v_add_f32 v14, v14, v29
  v_mfma_f32_16x16x32_bf16 v[88:91], a[52:55], a[116:119], v[88:91]
  s_cmov_b64 s[84:85], s[86:87]
  v_exp_f32 v31, v75
  v_mfma_f32_16x16x32_bf16 v[88:91], a[56:59], a[120:123], v[88:91]
  s_add_u32 s8, s8, 1
  ds_read_b128 a[24:27], v8 offset:6144
  v_cvt_pk_bf16_f32 v50, v28, v29
  v_mfma_f32_16x16x32_bf16 v[88:91], a[60:63], a[124:127], v[88:91]
  v_exp_f32 v16, v76
  v_mfma_f32_16x16x32_bf16 v[92:95], a[32:35], a[160:163], v[124:127]
  ds_read_b128 a[28:31], v8 offset:7168
  v_add_f32 v14, v14, v30
  v_mfma_f32_16x16x32_bf16 v[92:95], a[36:39], a[164:167], v[92:95]
  v_exp_f32 v17, v77
  v_mfma_f32_16x16x32_bf16 v[92:95], a[40:43], a[168:171], v[92:95]
  ds_read_b128 a[32:35], v8 offset:8192
  v_add_f32 v14, v14, v31
  v_mfma_f32_16x16x32_bf16 v[92:95], a[44:47], a[172:175], v[92:95]
  v_exp_f32 v18, v78
  v_mfma_f32_16x16x32_bf16 v[92:95], a[48:51], a[176:179], v[92:95]
  ds_read_b128 a[36:39], v8 offset:9216
  v_cvt_pk_bf16_f32 v51, v30, v31
  v_mfma_f32_16x16x32_bf16 v[92:95], a[52:55], a[180:183], v[92:95]
  v_exp_f32 v19, v79
  v_mfma_f32_16x16x32_bf16 v[92:95], a[56:59], a[184:187], v[92:95]
  ds_read_b128 a[40:43], v8 offset:10240
  v_add_f32 v15, v15, v16
  v_mfma_f32_16x16x32_bf16 v[92:95], a[60:63], a[188:191], v[92:95]
  s_waitcnt lgkmcnt(3)
  ds_read_b128 a[44:47], v8 offset:11264
  v_add_f32 v15, v15, v17
  v_mfma_f32_16x16x32_bf16 v[128:131], a[0:3], v[32:35], v[128:131]
  s_add_u32 s32, s32, 32768
  ds_read_b128 a[48:51], v8 offset:12288
  v_cvt_pk_bf16_f32 v58, v16, v17
  v_mfma_f32_16x16x32_bf16 v[128:131], a[4:7], v[36:39], v[128:131]
  s_and_b32 s32, s32, 0x1ffff
  v_exp_f32 v20, v80
  v_mfma_f32_16x16x32_bf16 v[132:135], a[4:7], v[44:47], v[132:135]
  s_mov_b32 m0, s31
  ds_read_b128 a[52:55], v8 offset:13312
  v_add_f32 v15, v15, v18
  v_mfma_f32_16x16x32_bf16 v[132:135], a[0:3], v[40:43], v[132:135]
  buffer_load_dwordx4 v4, s[68:71], s24 offen lds
  v_mfma_f32_16x16x32_bf16 v[136:139], a[8:11], v[32:35], v[136:139]
  s_add_u32 m0, m0, 4096
  ds_read_b128 a[56:59], v8 offset:14336
  v_add_f32 v15, v15, v19
  v_mfma_f32_16x16x32_bf16 v[136:139], a[12:15], v[36:39], v[136:139]
  s_add_u32 s24, s24, s30
  v_exp_f32 v21, v81
  v_mfma_f32_16x16x32_bf16 v[140:143], a[12:15], v[44:47], v[140:143]
  ds_read_b128 a[60:63], v8 offset:15360
  v_cvt_pk_bf16_f32 v59, v18, v19
  v_mfma_f32_16x16x32_bf16 v[140:143], a[8:11], v[40:43], v[140:143]
  buffer_load_dwordx4 v4, s[68:71], s24 offen lds
  v_mfma_f32_16x16x32_bf16 v[144:147], a[16:19], v[32:35], v[144:147]
  s_add_u32 m0, m0, 4096
  ds_read_b128 a[0:3], v8 offset:16384
  v_add_f32 v14, v14, v20
  v_mfma_f32_16x16x32_bf16 v[144:147], a[20:23], v[36:39], v[144:147]
  s_add_u32 s24, s24, s30
  v_exp_f32 v22, v82
  v_mfma_f32_16x16x32_bf16 v[148:151], a[20:23], v[44:47], v[148:151]
  ds_read_b128 a[4:7], v8 offset:17408
  v_add_f32 v14, v14, v21
  v_mfma_f32_16x16x32_bf16 v[148:151], a[16:19], v[40:43], v[148:151]
  v_exp_f32 v23, v83
  v_mfma_f32_16x16x32_bf16 v[152:155], a[24:27], v[32:35], v[152:155]
  ds_read_b128 a[8:11], v8 offset:18432
  v_cvt_pk_bf16_f32 v52, v20, v21
  v_mfma_f32_16x16x32_bf16 v[152:155], a[28:31], v[36:39], v[152:155]
  buffer_load_dwordx4 v4, s[68:71], s24 offen lds
  v_mfma_f32_16x16x32_bf16 v[156:159], a[28:31], v[44:47], v[156:159]
  s_add_u32 m0, m0, 4096
  ds_read_b128 a[12:15], v8 offset:19456
  v_add_f32 v14, v14, v22
  v_mfma_f32_16x16x32_bf16 v[156:159], a[24:27], v[40:43], v[156:159]
  s_waitcnt lgkmcnt(3)
  s_add_u32 s24, s24, s30
  v_add_f32 v14, v14, v23
  v_mfma_f32_16x16x32_bf16 v[160:163], a[32:35], v[32:35], v[160:163]
  ds_read_b128 a[16:19], v8 offset:20480
  v_cvt_pk_bf16_f32 v53, v22, v23
  v_mfma_f32_16x16x32_bf16 v[160:163], a[36:39], v[36:39], v[160:163]
  buffer_load_dwordx4 v4, s[68:71], s24 offen lds
  v_mfma_f32_16x16x32_bf16 v[164:167], a[36:39], v[44:47], v[164:167]
  s_add_u32 m0, m0, 4096
  ds_read_b128 a[20:23], v8 offset:21504
  v_mfma_f32_16x16x32_bf16 v[164:167], a[32:35], v[40:43], v[164:167]
  s_add_u32 s24, s24, s30
  v_exp_f32 v28, v84
  v_mfma_f32_16x16x32_bf16 v[168:171], a[40:43], v[32:35], v[168:171]
  ds_read_b128 a[24:27], v8 offset:22528
  v_add_f32 v15, v15, v28
  v_mfma_f32_16x16x32_bf16 v[168:171], a[44:47], v[36:39], v[168:171]
  v_exp_f32 v29, v85
  v_mfma_f32_16x16x32_bf16 v[172:175], a[44:47], v[44:47], v[172:175]
  ds_read_b128 a[28:31], v8 offset:23552
  v_add_f32 v15, v15, v29
  v_mfma_f32_16x16x32_bf16 v[172:175], a[40:43], v[40:43], v[172:175]
  buffer_load_dwordx4 v4, s[68:71], s24 offen lds
  v_mfma_f32_16x16x32_bf16 v[176:179], a[48:51], v[32:35], v[176:179]
  s_add_u32 m0, m0, 4096
  ds_read_b128 a[32:35], v8 offset:24576
  v_cvt_pk_bf16_f32 v60, v28, v29
  v_mfma_f32_16x16x32_bf16 v[176:179], a[52:55], v[36:39], v[176:179]
  s_add_u32 s24, s24, s30
  v_exp_f32 v30, v86
  v_mfma_f32_16x16x32_bf16 v[180:183], a[52:55], v[44:47], v[180:183]
  ds_read_b128 a[36:39], v8 offset:25600
  v_add_f32 v15, v15, v30
  v_mfma_f32_16x16x32_bf16 v[180:183], a[48:51], v[40:43], v[180:183]
  buffer_load_dwordx4 v4, s[68:71], s24 offen lds
  v_mfma_f32_16x16x32_bf16 v[184:187], a[56:59], v[32:35], v[184:187]
  s_add_u32 m0, m0, 4096
  ds_read_b128 a[40:43], v8 offset:26624
  v_mfma_f32_16x16x32_bf16 v[184:187], a[60:63], v[36:39], v[184:187]
  s_add_u32 s24, s24, s30
  v_exp_f32 v31, v87
  v_mfma_f32_16x16x32_bf16 v[188:191], a[60:63], v[44:47], v[188:191]
  ds_read_b128 a[44:47], v8 offset:27648
  v_add_f32 v15, v15, v31
  v_mfma_f32_16x16x32_bf16 v[188:191], a[56:59], v[40:43], v[188:191]
  v_exp_f32 v16, v88
  v_mfma_f32_16x16x32_bf16 v[192:195], a[0:3], v[32:35], v[192:195]
  s_waitcnt lgkmcnt(3)
  ds_read_b128 a[48:51], v8 offset:28672
  v_cvt_pk_bf16_f32 v61, v30, v31
  v_mfma_f32_16x16x32_bf16 v[192:195], a[4:7], v[36:39], v[192:195]
  buffer_load_dwordx4 v4, s[68:71], s24 offen lds
  v_mfma_f32_16x16x32_bf16 v[196:199], a[4:7], v[44:47], v[196:199]
  s_add_u32 m0, m0, 4096
  ds_read_b128 a[52:55], v8 offset:29696
  v_add_f32 v14, v14, v16
  v_mfma_f32_16x16x32_bf16 v[196:199], a[0:3], v[40:43], v[196:199]
  s_add_u32 s24, s24, s30
  v_exp_f32 v17, v89
  v_mfma_f32_16x16x32_bf16 v[200:203], a[8:11], v[32:35], v[200:203]
  ds_read_b128 a[56:59], v8 offset:30720
  v_add_f32 v14, v14, v17
  v_mfma_f32_16x16x32_bf16 v[200:203], a[12:15], v[36:39], v[200:203]
  buffer_load_dwordx4 v4, s[68:71], s24 offen lds
  v_mfma_f32_16x16x32_bf16 v[204:207], a[12:15], v[44:47], v[204:207]
  s_add_u32 s31, s31, 32768
  ds_read_b128 a[60:63], v8 offset:31744
  v_add_u32 v8, s32, v9
  v_mfma_f32_16x16x32_bf16 v[204:207], a[8:11], v[40:43], v[204:207]
  s_and_b32 s31, s31, 0x1ffff
  v_exp_f32 v18, v90
  v_mfma_f32_16x16x32_bf16 v[208:211], a[16:19], v[32:35], v[208:211]
  s_waitcnt vmcnt(17)
  v_mfma_f32_16x16x32_bf16 v[208:211], a[20:23], v[36:39], v[208:211]
  s_barrier
  v_mfma_f32_16x16x32_bf16 v[212:215], a[20:23], v[44:47], v[212:215]
  s_add_u32 s25, s25, 1
  ds_read_b128 a[0:3], v8 offset:0
  v_cvt_pk_bf16_f32 v54, v16, v17
  v_mfma_f32_16x16x32_bf16 v[212:215], a[16:19], v[40:43], v[212:215]
  s_cmp_eq_u32 s25, s28
  v_exp_f32 v19, v91
  v_mfma_f32_16x16x32_bf16 v[216:219], a[24:27], v[32:35], v[216:219]
  s_cbranch_scc1 AT_NS_12
AT_NB_13:
  ds_read_b128 a[4:7], v8 offset:1024
  v_add_f32 v14, v14, v18
  v_mfma_f32_16x16x32_bf16 v[216:219], a[28:31], v[36:39], v[216:219]
  v_readlane_b32 s24, v5, s25
  v_mfma_f32_16x16x32_bf16 v[220:223], a[28:31], v[44:47], v[220:223]
  s_sub_u32 s43, s43, 1
  ds_read_b128 a[8:11], v8 offset:2048
  v_add_f32 v14, v14, v19
  v_mfma_f32_16x16x32_bf16 v[220:223], a[24:27], v[40:43], v[220:223]
  s_cmp_le_u32 s43, s45
  v_exp_f32 v20, v92
  v_mfma_f32_16x16x32_bf16 v[224:227], a[32:35], v[32:35], v[224:227]
  s_waitcnt lgkmcnt(3)
  ds_read_b128 a[12:15], v8 offset:3072
  v_cvt_pk_bf16_f32 v55, v18, v19
  v_mfma_f32_16x16x32_bf16 v[224:227], a[36:39], v[36:39], v[224:227]
  v_exp_f32 v21, v93
  v_mfma_f32_16x16x32_bf16 v[228:231], a[36:39], v[44:47], v[228:231]
  ds_read_b128 a[16:19], v8 offset:4096
  v_add_f32 v15, v15, v20
  v_mfma_f32_16x16x32_bf16 v[228:231], a[32:35], v[40:43], v[228:231]
  v_exp_f32 v22, v94
  v_mfma_f32_16x16x32_bf16 v[232:235], a[40:43], v[32:35], v[232:235]
  ds_read_b128 a[20:23], v8 offset:5120
  v_add_f32 v15, v15, v21
  v_mfma_f32_16x16x32_bf16 v[232:235], a[44:47], v[36:39], v[232:235]
  v_exp_f32 v23, v95
  v_mfma_f32_16x16x32_bf16 v[236:239], a[44:47], v[44:47], v[236:239]
  ds_read_b128 a[24:27], v8 offset:6144
  v_cvt_pk_bf16_f32 v62, v20, v21
  v_mfma_f32_16x16x32_bf16 v[236:239], a[40:43], v[40:43], v[236:239]
  v_add_f32 v15, v15, v22
  v_add_f32 v15, v15, v23
  v_mfma_f32_16x16x32_bf16 v[240:243], a[48:51], v[32:35], v[240:243]
  ds_read_b128 a[28:31], v8 offset:7168
  v_cvt_pk_bf16_f32 v63, v22, v23
  v_mfma_f32_16x16x32_bf16 v[240:243], a[52:55], v[36:39], v[240:243]
  v_max_f32 v26, v14, v15
  v_cmp_nge_f32 vcc, 0x53800000, v26
  v_mfma_f32_16x16x32_bf16 v[244:247], a[52:55], v[44:47], v[244:247]
  ds_read_b128 a[32:35], v8 offset:8192
  v_mfma_f32_16x16x32_bf16 v[244:247], a[48:51], v[40:43], v[244:247]
  v_mfma_f32_16x16x32_bf16 v[248:251], a[56:59], v[32:35], v[248:251]
  ds_read_b128 a[36:39], v8 offset:9216
  v_mfma_f32_16x16x32_bf16 v[248:251], a[60:63], v[36:39], v[248:251]
  buffer_load_dword v27, v0, s[80:83], 0 offen
  v_mfma_f32_16x16x32_bf16 v[252:255], a[60:63], v[44:47], v[252:255]
  ds_read_b128 a[40:43], v8 offset:10240
  v_mfma_f32_16x16x32_bf16 v[252:255], a[56:59], v[40:43], v[252:255]
  ds_read_b128 a[44:47], v8 offset:11264
  s_cbranch_vccnz AT_H0
  s_cbranch_scc1 AT_H0B
AT_BODY1:
  s_waitcnt lgkmcnt(4)
  v_mfma_f32_16x16x32_bf16 v[64:67], a[0:3], a[96:99], v[96:99]
  s_add_u32 s32, s32, 32768
  ds_read_b128 a[48:51], v8 offset:12288
  v_mfma_f32_16x16x32_bf16 v[64:67], a[4:7], a[100:103], v[64:67]
  s_and_b32 s32, s32, 0x1ffff
  v_mfma_f32_16x16x32_bf16 v[64:67], a[8:11], a[104:107], v[64:67]
  s_mov_b32 m0, s31
  ds_read_b128 a[52:55], v8 offset:13312
  v_add_f32 v12, v12, v14
  v_mfma_f32_16x16x32_bf16 v[64:67], a[12:15], a[108:111], v[64:67]
  buffer_load_dwordx4 v4, s[68:71], s24 offen lds
  v_mfma_f32_16x16x32_bf16 v[64:67], a[16:19], a[112:115], v[64:67]
  s_add_u32 m0, m0, 4096
  ds_read_b128 a[56:59], v8 offset:14336
  v_add_f32 v13, v13, v15
  v_mfma_f32_16x16x32_bf16 v[64:67], a[20:23], a[116:119], v[64:67]
  s_add_u32 s24, s24, s30
  v_mfma_f32_16x16x32_bf16 v[64:67], a[24:27], a[120:123], v[64:67]
  ds_read_b128 a[60:63], v8 offset:15360
  v_mfma_f32_16x16x32_bf16 v[64:67], a[28:31], a[124:127], v[64:67]
  buffer_load_dwordx4 v4, s[68:71], s24 offen lds
  v_mfma_f32_16x16x32_bf16 v[68:71], a[0:3], a[160:163], v[100:103]
  s_add_u32 m0, m0, 4096
  ds_read_b128 a[0:3], v8 offset:16384
  v_mfma_f32_16x16x32_bf16 v[68:71], a[4:7], a[164:167], v[68:71]
  s_add_u32 s24, s24, s30
  v_mfma_f32_16x16x32_bf16 v[68:71], a[8:11], a[168:171], v[68:71]
  ds_read_b128 a[4:7], v8 offset:17408
  v_mfma_f32_16x16x32_bf16 v[68:71], a[12:15], a[172:175], v[68:71]
  v_mfma_f32_16x16x32_bf16 v[68:71], a[16:19], a[176:179], v[68:71]
  ds_read_b128 a[8:11], v8 offset:18432
  v_mfma_f32_16x16x32_bf16 v[68:71], a[20:23], a[180:183], v[68:71]
  buffer_load_dwordx4 v4, s[68:71], s24 offen lds
  v_mfma_f32_16x16x32_bf16 v[68:71], a[24:27], a[184:187], v[68:71]
  s_add_u32 m0, m0, 4096
  ds_read_b128 a[12:15], v8 offset:19456
  v_mfma_f32_16x16x32_bf16 v[68:71], a[28:31], a[188:191], v[68:71]
  s_waitcnt lgkmcnt(3)
  s_add_u32 s24, s24, s30
  v_mfma_f32_16x16x32_bf16 v[72:75], a[32:35], a[96:99], v[104:107]
  ds_read_b128 a[16:19], v8 offset:20480
  v_mfma_f32_16x16x32_bf16 v[72:75], a[36:39], a[100:103], v[72:75]
  buffer_load_dwordx4 v4, s[68:71], s24 offen lds
  v_mfma_f32_16x16x32_bf16 v[72:75], a[40:43], a[104:107], v[72:75]
  s_add_u32 m0, m0, 4096
  ds_read_b128 a[20:23], v8 offset:21504
  v_mfma_f32_16x16x32_bf16 v[72:75], a[44:47], a[108:111], v[72:75]
  s_add_u32 s24, s24, s30
  v_exp_f32 v16, v64
  v_mfma_f32_16x16x32_bf16 v[72:75], a[48:51], a[112:115], v[72:75]
  ds_read_b128 a[24:27], v8 offset:22528
  v_mfma_f32_16x16x32_bf16 v[72:75], a[52:55], a[116:119], v[72:75]
  v_exp_f32 v17, v65
  v_mfma_f32_16x16x32_bf16 v[72:75], a[56:59], a[120:123], v[72:75]
  ds_read_b128 a[28:31], v8 offset:23552
  v_add_f32 v14, v16, v17
  v_mfma_f32_16x16x32_bf16 v[72:75], a[60:63], a[124:127], v[72:75]
  buffer_load_dwordx4 v4, s[68:71], s24 offen lds
  v_mfma_f32_16x16x32_bf16 v[76:79], a[32:35], a[160:163], v[108:111]
  s_add_u32 m0, m0, 4096
  ds_read_b128 a[32:35], v8 offset:24576
  v_cvt_pk_bf16_f32 v32, v16, v17
  v_mfma_f32_16x16x32_bf16 v[76:79], a[36:39], a[164:167], v[76:79]
  s_add_u32 s24, s24, s30
  v_exp_f32 v18, v66
  v_mfma_f32_16x16x32_bf16 v[76:79], a[40:43], a[168:171], v[76:79]
  ds_read_b128 a[36:39], v8 offset:25600
  v_add_f32 v14, v14, v18
  v_mfma_f32_16x16x32_bf16 v[76:79], a[44:47], a[172:175], v[76:79]
  buffer_load_dwordx4 v4, s[68:71], s24 offen lds
  v_mfma_f32_16x16x32_bf16 v[76:79], a[48:51], a[176:179], v[76:79]
  s_add_u32 m0, m0, 4096
  ds_read_b128 a[40:43], v8 offset:26624
  v_mfma_f32_16x16x32_bf16 v[76:79], a[52:55], a[180:183], v[76:79]
  s_add_u32 s24, s24, s30
  v_exp_f32 v19, v67
  v_mfma_f32_16x16x32_bf16 v[76:79], a[56:59], a[184:187], v[76:79]
  ds_read_b128 a[44:47], v8 offset:27648
  v_add_f32 v14, v14, v19
  v_mfma_f32_16x16x32_bf16 v[76:79], a[60:63], a[188:191], v[76:79]
  v_exp_f32 v20, v68
  v_mfma_f32_16x16x32_bf16 v[80:83], a[0:3], a[96:99], v[112:115]
  s_waitcnt lgkmcnt(3)
  ds_read_b128 a[48:51], v8 offset:28672
  v_cvt_pk_bf16_f32 v33, v18, v19
  v_mfma_f32_16x16x32_bf16 v[80:83], a[4:7], a[100:103], v[80:83]
  buffer_load_dwordx4 v4, s[68:71], s24 offen lds
  v_mfma_f32_16x16x32_bf16 v[80:83], a[8:11], a[104:107], v[80:83]
  s_add_u32 m0, m0, 4096
  ds_read_b128 a[52:55], v8 offset:29696
  v_mfma_f32_16x16x32_bf16 v[80:83], a[12:15], a[108:111], v[80:83]
  s_add_u32 s24, s24, s30
  v_exp_f32 v21, v69
  v_mfma_f32_16x16x32_bf16 v[80:83], a[16:19], a[112:115], v[80:83]
  ds_read_b128 a[56:59], v8 offset:30720
  v_add_f32 v15, v20, v21
  v_mfma_f32_16x16x32_bf16 v[80:83], a[20:23], a[116:119], v[80:83]
  buffer_load_dwordx4 v4, s[68:71], s24 offen lds
  v_mfma_f32_16x16x32_bf16 v[80:83], a[24:27], a[120:123], v[80:83]
  s_add_u32 s31, s31, 32768
  ds_read_b128 a[60:63], v8 offset:31744
  v_add_u32 v8, s32, v9
  v_mfma_f32_16x16x32_bf16 v[80:83], a[28:31], a[124:127], v[80:83]
  s_and_b32 s31, s31, 0x1ffff
  v_exp_f32 v22, v70
  v_mfma_f32_16x16x32_bf16 v[84:87], a[0:3], a[160:163], v[116:119]
  s_waitcnt vmcnt(17)
  v_mfma_f32_16x16x32_bf16 v[84:87], a[4:7], a[164:167], v[84:87]
  s_barrier
  v_mfma_f32_16x16x32_bf16 v[84:87], a[8:11], a[168:171], v[84:87]
  s_add_u32 s25, s25, 1
  ds_read_b128 a[0:3], v8 offset:0
  v_cvt_pk_bf16_f32 v40, v20, v21
  v_mfma_f32_16x16x32_bf16 v[84:87], a[12:15], a[172:175], v[84:87]
  s_cmp_eq_u32 s25, s28
  v_exp_f32 v23, v71
  v_mfma_f32_16x16x32_bf16 v[84:87], a[16:19], a[176:179], v[84:87]
  s_cbranch_scc1 AT_NS_14
AT_NB_15:
  ds_read_b128 a[4:7], v8 offset:1024
  v_add_f32 v15, v15, v22
  v_mfma_f32_16x16x32_bf16 v[84:87], a[20:23], a[180:183], v[84:87]
  v_readlane_b32 s24, v5, s25
  v_mfma_f32_16x16x32_bf16 v[84:87], a[24:27], a[184:187], v[84:87]
  s_cmp_eq_u32 s8, s9
  ds_read_b128 a[8:11], v8 offset:2048
  v_add_f32 v15, v15, v23
  v_mfma_f32_16x16x32_bf16 v[84:87], a[28:31], a[188:191], v[84:87]
  s_cselect_b32 s82, 8192, 0
  v_exp_f32 v28, v72
  v_mfma_f32_16x16x32_bf16 v[88:91], a[32:35], a[96:99], v[120:123]
  s_waitcnt lgkmcnt(3)
  ds_read_b128 a[12:15], v8 offset:3072
  v_cvt_pk_bf16_f32 v41, v22, v23
  v_mfma_f32_16x16x32_bf16 v[88:91], a[36:39], a[100:103], v[88:91]
  s_cmov_b32 s9, s10
  v_exp_f32 v29, v73
  v_mfma_f32_16x16x32_bf16 v[88:91], a[40:43], a[104:107], v[88:91]
  s_cmov_b32 s10, s11
  ds_read_b128 a[16:19], v8 offset:4096
  v_add_f32 v14, v14, v28
  v_mfma_f32_16x16x32_bf16 v[88:91], a[44:47], a[108:111], v[88:91]
  s_mov_b64 s[80:81], s[76:77]
  v_exp_f32 v30, v74
  v_mfma_f32_16x16x32_bf16 v[88:91], a[48:51], a[112:115], v[88:91]
  s_cmov_b64 s[76:77], s[84:85]
  ds_read_b128 a[20:23], v8 offset:5120
  v_add_f32 v14, v14, v29
  v_mfma_f32_16x16x32_bf16 v[88:91], a[52:55], a[116:119], v[88:91]
  s_cmov_b64 s[84:85], s[86:87]
  v_exp_f32 v31, v75
  v_mfma_f32_16x16x32_bf16 v[88:91], a[56:59], a[120:123], v[88:91]
  s_add_u32 s8, s8, 1
  ds_read_b128 a[24:27], v8 offset:6144
  v_cvt_pk_bf16_f32 v34, v28, v29
  v_mfma_f32_16x16x32_bf16 v[88:91], a[60:63], a[124:127], v[88:91]
  v_exp_f32 v16, v76
  v_mfma_f32_16x16x32_bf16 v[92:95], a[32:35], a[160:163], v[124:127]
  ds_read_b128 a[28:31], v8 offset:7168
  v_add_f32 v14, v14, v30
  v_mfma_f32_16x16x32_bf16 v[92:95], a[36:39], a[164:167], v[92:95]
  v_exp_f32 v17, v77
  v_mfma_f32_16x16x32_bf16 v[92:95], a[40:43], a[168:171], v[92:95]
  ds_read_b128 a[32:35], v8 offset:8192
  v_add_f32 v14, v14, v31
  v_mfma_f32_16x16x32_bf16 v[92:95], a[44:47], a[172:175], v[92:95]
  v_exp_f32 v18, v78
  v_mfma_f32_16x16x32_bf16 v[92:95], a[48:51], a[176:179], v[92:95]
  ds_read_b128 a[36:39], v8 offset:9216
  v_cvt_pk_bf16_f32 v35, v30, v31
  v_mfma_f32_16x16x32_bf16 v[92:95], a[52:55], a[180:183], v[92:95]
  v_exp_f32 v19, v79
  v_mfma_f32_16x16x32_bf16 v[92:95], a[56:59], a[184:187], v[92:95]
  ds_read_b128 a[40:43], v8 offset:10240
  v_add_f32 v15, v15, v16
  v_mfma_f32_16x16x32_bf16 v[92:95], a[60:63], a[188:191], v[92:95]
  s_waitcnt lgkmcnt(3)
  ds_read_b128 a[44:47], v8 offset:11264
  v_add_f32 v15, v15, v17
  v_mfma_f32_16x16x32_bf16 v[128:131], a[0:3], v[48:51], v[128:131]
  s_add_u32 s32, s32, 32768
  ds_read_b128 a[48:51], v8 offset:12288
  v_cvt_pk_bf16_f32 v42, v16, v17
  v_mfma_f32_16x16x32_bf16 v[128:131], a[4:7], v[52:55], v[128:131]
  s_and_b32 s32, s32, 0x1ffff
  v_exp_f32 v20, v80
  v_mfma_f32_16x16x32_bf16 v[132:135], a[4:7], v[60:63], v[132:135]
  s_mov_b32 m0, s31
  ds_read_b128 a[52:55], v8 offset:13312
  v_add_f32 v15, v15, v18
  v_mfma_f32_16x16x32_bf16 v[132:135], a[0:3], v[56:59], v[132:135]
  buffer_load_dwordx4 v4, s[68:71], s24 offen lds
  v_mfma_f32_16x16x32_bf16 v[136:139], a[8:11], v[48:51], v[136:139]
  s_add_u32 m0, m0, 4096
  ds_read_b128 a[56:59], v8 offset:14336
  v_add_f32 v15, v15, v19
  v_mfma_f32_16x16x32_bf16 v[136:139], a[12:15], v[52:55], v[136:139]
  s_add_u32 s24, s24, s30
  v_exp_f32 v21, v81
  v_mfma_f32_16x16x32_bf16 v[140:143], a[12:15], v[60:63], v[140:143]
  ds_read_b128 a[60:63], v8 offset:15360
  v_cvt_pk_bf16_f32 v43, v18, v19
  v_mfma_f32_16x16x32_bf16 v[140:143], a[8:11], v[56:59], v[140:143]
  buffer_load_dwordx4 v4, s[68:71], s24 offen lds
  v_mfma_f32_16x16x32_bf16 v[144:147], a[16:19], v[48:51], v[144:147]
  s_add_u32 m0, m0, 4096
  ds_read_b128 a[0:3], v8 offset:16384
  v_add_f32 v14, v14, v20
  v_mfma_f32_16x16x32_bf16 v[144:147], a[20:23], v[52:55], v[144:147]
  s_add_u32 s24, s24, s30
  v_exp_f32 v22, v82
  v_mfma_f32_16x16x32_bf16 v[148:151], a[20:23], v[60:63], v[148:151]
  ds_read_b128 a[4:7], v8 offset:17408
  v_add_f32 v14, v14, v21
  v_mfma_f32_16x16x32_bf16 v[148:151], a[16:19], v[56:59], v[148:151]
  v_exp_f32 v23, v83
  v_mfma_f32_16x16x32_bf16 v[152:155], a[24:27], v[48:51], v[152:155]
  ds_read_b128 a[8:11], v8 offset:18432
  v_cvt_pk_bf16_f32 v36, v20, v21
  v_mfma_f32_16x16x32_bf16 v[152:155], a[28:31], v[52:55], v[152:155]
  buffer_load_dwordx4 v4, s[68:71], s24 offen lds
  v_mfma_f32_16x16x32_bf16 v[156:159], a[28:31], v[60:63], v[156:159]
  s_add_u32 m0, m0, 4096
  ds_read_b128 a[12:15], v8 offset:19456
  v_add_f32 v14, v14, v22
  v_mfma_f32_16x16x32_bf16 v[156:159], a[24:27], v[56:59], v[156:159]
  s_waitcnt lgkmcnt(3)
  s_add_u32 s24, s24, s30
  v_add_f32 v14, v14, v23
  v_mfma_f32_16x16x32_bf16 v[160:163], a[32:35], v[48:51], v[160:163]
  ds_read_b128 a[16:19], v8 offset:20480
  v_cvt_pk_bf16_f32 v37, v22, v23
  v_mfma_f32_16x16x32_bf16 v[160:163], a[36:39], v[52:55], v[160:163]
  buffer_load_dwordx4 v4, s[68:71], s24 offen lds
  v_mfma_f32_16x16x32_bf16 v[164:167], a[36:39], v[60:63], v[164:167]
  s_add_u32 m0, m0, 4096
  ds_read_b128 a[20:23], v8 offset:21504
  v_mfma_f32_16x16x32_bf16 v[164:167], a[32:35], v[56:59], v[164:167]
  s_add_u32 s24, s24, s30
  v_exp_f32 v28, v84
  v_mfma_f32_16x16x32_bf16 v[168:171], a[40:43], v[48:51], v[168:171]
  ds_read_b128 a[24:27], v8 offset:22528
  v_add_f32 v15, v15, v28
  v_mfma_f32_16x16x32_bf16 v[168:171], a[44:47], v[52:55], v[168:171]
  v_exp_f32 v29, v85
  v_mfma_f32_16x16x32_bf16 v[172:175], a[44:47], v[60:63], v[172:175]
  ds_read_b128 a[28:31], v8 offset:23552
  v_add_f32 v15, v15, v29
  v_mfma_f32_16x16x32_bf16 v[172:175], a[40:43], v[56:59], v[172:175]
  buffer_load_dwordx4 v4, s[68:71], s24 offen lds
  v_mfma_f32_16x16x32_bf16 v[176:179], a[48:51], v[48:51], v[176:179]
  s_add_u32 m0, m0, 4096
  ds_read_b128 a[32:35], v8 offset:24576
  v_cvt_pk_bf16_f32 v44, v28, v29
  v_mfma_f32_16x16x32_bf16 v[176:179], a[52:55], v[52:55], v[176:179]
  s_add_u32 s24, s24, s30
  v_exp_f32 v30, v86
  v_mfma_f32_16x16x32_bf16 v[180:183], a[52:55], v[60:63], v[180:183]
  ds_read_b128 a[36:39], v8 offset:25600
  v_add_f32 v15, v15, v30
  v_mfma_f32_16x16x32_bf16 v[180:183], a[48:51], v[56:59], v[180:183]
  buffer_load_dwordx4 v4, s[68:71], s24 offen lds
  v_mfma_f32_16x16x32_bf16 v[184:187], a[56:59], v[48:51], v[184:187]
  s_add_u32 m0, m0, 4096
  ds_read_b128 a[40:43], v8 offset:26624
  v_mfma_f32_16x16x32_bf16 v[184:187], a[60:63], v[52:55], v[184:187]
  s_add_u32 s24, s24, s30
  v_exp_f32 v31, v87
  v_mfma_f32_16x16x32_bf16 v[188:191], a[60:63], v[60:63], v[188:191]
  ds_read_b128 a[44:47], v8 offset:27648
  v_add_f32 v15, v15, v31
  v_mfma_f32_16x16x32_bf16 v[188:191], a[56:59], v[56:59], v[188:191]
  v_exp_f32 v16, v88
  v_mfma_f32_16x16x32_bf16 v[192:195], a[0:3], v[48:51], v[192:195]
  s_waitcnt lgkmcnt(3)
  ds_read_b128 a[48:51], v8 offset:28672
  v_cvt_pk_bf16_f32 v45, v30, v31
  v_mfma_f32_16x16x32_bf16 v[192:195], a[4:7], v[52:55], v[192:195]
  buffer_load_dwordx4 v4, s[68:71], s24 offen lds
  v_mfma_f32_16x16x32_bf16 v[196:199], a[4:7], v[60:63], v[196:199]
  s_add_u32 m0, m0, 4096
  ds_read_b128 a[52:55], v8 offset:29696
  v_add_f32 v14, v14, v16
  v_mfma_f32_16x16x32_bf16 v[196:199], a[0:3], v[56:59], v[196:199]
  s_add_u32 s24, s24, s30
  v_exp_f32 v17, v89
  v_mfma_f32_16x16x32_bf16 v[200:203], a[8:11], v[48:51], v[200:203]
  ds_read_b128 a[56:59], v8 offset:30720
  v_add_f32 v14, v14, v17
  v_mfma_f32_16x16x32_bf16 v[200:203], a[12:15], v[52:55], v[200:203]
  buffer_load_dwordx4 v4, s[68:71], s24 offen lds
  v_mfma_f32_16x16x32_bf16 v[204:207], a[12:15], v[60:63], v[204:207]
  s_add_u32 s31, s31, 32768
  ds_read_b128 a[60:63], v8 offset:31744
  v_add_u32 v8, s32, v9
  v_mfma_f32_16x16x32_bf16 v[204:207], a[8:11], v[56:59], v[204:207]
  s_and_b32 s31, s31, 0x1ffff
  v_exp_f32 v18, v90
  v_mfma_f32_16x16x32_bf16 v[208:211], a[16:19], v[48:51], v[208:211]
  s_waitcnt vmcnt(17)
  v_mfma_f32_16x16x32_bf16 v[208:211], a[20:23], v[52:55], v[208:211]
  s_barrier
  v_mfma_f32_16x16x32_bf16 v[212:215], a[20:23], v[60:63], v[212:215]
  s_add_u32 s25, s25, 1
  ds_read_b128 a[0:3], v8 offset:0
  v_cvt_pk_bf16_f32 v38, v16, v17
  v_mfma_f32_16x16x32_bf16 v[212:215], a[16:19], v[56:59], v[212:215]
  s_cmp_eq_u32 s25, s28
  v_exp_f32 v19, v91
  v_mfma_f32_16x16x32_bf16 v[216:219], a[24:27], v[48:51], v[216:219]
  s_cbranch_scc1 AT_NS_16
AT_NB_17:
  ds_read_b128 a[4:7], v8 offset:1024
  v_add_f32 v14, v14, v18
  v_mfma_f32_16x16x32_bf16 v[216:219], a[28:31], v[52:55], v[216:219]
  v_readlane_b32 s24, v5, s25
  v_mfma_f32_16x16x32_bf16 v[220:223], a[28:31], v[60:63], v[220:223]
  s_sub_u32 s43, s43, 1
  ds_read_b128 a[8:11], v8 offset:2048
  v_add_f32 v14, v14, v19
  v_mfma_f32_16x16x32_bf16 v[220:223], a[24:27], v[56:59], v[220:223]
  s_cmp_le_u32 s43, s45
  v_exp_f32 v20, v92
  v_mfma_f32_16x16x32_bf16 v[224:227], a[32:35], v[48:51], v[224:227]
  s_waitcnt lgkmcnt(3)
  ds_read_b128 a[12:15], v8 offset:3072
  v_cvt_pk_bf16_f32 v39, v18, v19
  v_mfma_f32_16x16x32_bf16 v[224:227], a[36:39], v[52:55], v[224:227]
  v_exp_f32 v21, v93
  v_mfma_f32_16x16x32_bf16 v[228:231], a[36:39], v[60:63], v[228:231]
  ds_read_b128 a[16:19], v8 offset:4096
  v_add_f32 v15, v15, v20
  v_mfma_f32_16x16x32_bf16 v[228:231], a[32:35], v[56:59], v[228:231]
  v_exp_f32 v22, v94
  v_mfma_f32_16x16x32_bf16 v[232:235], a[40:43], v[48:51], v[232:235]
  ds_read_b128 a[20:23], v8 offset:5120
  v_add_f32 v15, v15, v21
  v_mfma_f32_16x16x32_bf16 v[232:235], a[44:47], v[52:55], v[232:235]
  v_exp_f32 v23, v95
  v_mfma_f32_16x16x32_bf16 v[236:239], a[44:47], v[60:63], v[236:239]
  ds_read_b128 a[24:27], v8 offset:6144
  v_cvt_pk_bf16_f32 v46, v20, v21
  v_mfma_f32_16x16x32_bf16 v[236:239], a[40:43], v[56:59], v[236:239]
  v_add_f32 v15, v15, v22
  v_add_f32 v15, v15, v23
  v_mfma_f32_16x16x32_bf16 v[240:243], a[48:51], v[48:51], v[240:243]
  ds_read_b128 a[28:31], v8 offset:7168
  v_cvt_pk_bf16_f32 v47, v22, v23
  v_mfma_f32_16x16x32_bf16 v[240:243], a[52:55], v[52:55], v[240:243]
  v_max_f32 v26, v14, v15
  v_cmp_nge_f32 vcc, 0x53800000, v26
  v_mfma_f32_16x16x32_bf16 v[244:247], a[52:55], v[60:63], v[244:247]
  ds_read_b128 a[32:35], v8 offset:8192
  v_mfma_f32_16x16x32_bf16 v[244:247], a[48:51], v[56:59], v[244:247]
  v_mfma_f32_16x16x32_bf16 v[248:251], a[56:59], v[48:51], v[248:251]
  ds_read_b128 a[36:39], v8 offset:9216
  v_mfma_f32_16x16x32_bf16 v[248:251], a[60:63], v[52:55], v[248:251]
  buffer_load_dword v27, v0, s[80:83], 0 offen
  v_mfma_f32_16x16x32_bf16 v[252:255], a[60:63], v[60:63], v[252:255]
  ds_read_b128 a[40:43], v8 offset:10240
  v_mfma_f32_16x16x32_bf16 v[252:255], a[56:59], v[56:59], v[252:255]
  ds_read_b128 a[44:47], v8 offset:11264
  s_cbranch_vccnz AT_H1
  s_cbranch_scc0 AT_BODY0
AT_H1B:
  s_cmp_eq_u32 s43, 0
  s_cbranch_scc1 AT_LAST0
  s_cmp_le_u32 s43, s45
  s_cbranch_scc0 AT_BODY0
  s_cmp_eq_u32 s43, 1
  s_cbranch_scc1 AT_BODYD0
  v_add_f32 v96, 0x0, v24
  v_min_f32 v96, v96, v10
  v_add_f32 v97, 0xf1800000, v24
  v_min_f32 v97, v97, v10
  v_add_f32 v98, 0xf2000000, v24
  v_min_f32 v98, v98, v10
  v_add_f32 v99, 0xf2400000, v24
  v_min_f32 v99, v99, v10
  v_add_f32 v104, 0xf3800000, v24
  v_min_f32 v104, v104, v10
  v_add_f32 v105, 0xf3880000, v24
  v_min_f32 v105, v105, v10
  v_add_f32 v106, 0xf3900000, v24
  v_min_f32 v106, v106, v10
  v_add_f32 v107, 0xf3980000, v24
  v_min_f32 v107, v107, v10
  v_add_f32 v112, 0xf4000000, v24
  v_min_f32 v112, v112, v10
  v_add_f32 v113, 0xf4040000, v24
  v_min_f32 v113, v113, v10
  v_add_f32 v114, 0xf4080000, v24
  v_min_f32 v114, v114, v10
  v_add_f32 v115, 0xf40c0000, v24
  v_min_f32 v115, v115, v10
  v_add_f32 v120, 0xf4400000, v24
  v_min_f32 v120, v120, v10
  v_add_f32 v121, 0xf4440000, v24
  v_min_f32 v121, v121, v10
  v_add_f32 v122, 0xf4480000, v24
  v_min_f32 v122, v122, v10
  v_add_f32 v123, 0xf44c0000, v24
  v_min_f32 v123, v123, v10
  s_branch AT_BODY0
AT_H0B:
  s_cmp_eq_u32 s43, 0
  s_cbranch_scc1 AT_LAST1
  s_cmp_le_u32 s43, s45
  s_cbranch_scc0 AT_BODY1
  s_cmp_eq_u32 s43, 1
  s_cbranch_scc1 AT_BODYD1
  v_add_f32 v96, 0x0, v24
  v_min_f32 v96, v96, v10
  v_add_f32 v97, 0xf1800000, v24
  v_min_f32 v97, v97, v10
  v_add_f32 v98, 0xf2000000, v24
  v_min_f32 v98, v98, v10
  v_add_f32 v99, 0xf2400000, v24
  v_min_f32 v99, v99, v10
  v_add_f32 v104, 0xf3800000, v24
  v_min_f32 v104, v104, v10
  v_add_f32 v105, 0xf3880000, v24
  v_min_f32 v105, v105, v10
  v_add_f32 v106, 0xf3900000, v24
  v_min_f32 v106, v106, v10
  v_add_f32 v107, 0xf3980000, v24
  v_min_f32 v107, v107, v10
  v_add_f32 v112, 0xf4000000, v24
  v_min_f32 v112, v112, v10
  v_add_f32 v113, 0xf4040000, v24
  v_min_f32 v113, v113, v10
  v_add_f32 v114, 0xf4080000, v24
  v_min_f32 v114, v114, v10
  v_add_f32 v115, 0xf40c0000, v24
  v_min_f32 v115, v115, v10
  v_add_f32 v120, 0xf4400000, v24
  v_min_f32 v120, v120, v10
  v_add_f32 v121, 0xf4440000, v24
  v_min_f32 v121, v121, v10
  v_add_f32 v122, 0xf4480000, v24
  v_min_f32 v122, v122, v10
  v_add_f32 v123, 0xf44c0000, v24
  v_min_f32 v123, v123, v10
  s_branch AT_BODY1
AT_NS_6:
  s_call_b64 s[34:35], AT_EV
  s_branch AT_NB_7
AT_NS_8:
  s_call_b64 s[34:35], AT_EV
  s_branch AT_NB_9
AT_NS_10:
  s_call_b64 s[34:35], AT_EV
  s_branch AT_NB_11
AT_NS_12:
  s_call_b64 s[34:35], AT_EV
  s_branch AT_NB_13
AT_NS_14:
  s_call_b64 s[34:35], AT_EV
  s_branch AT_NB_15
AT_NS_16:
  s_call_b64 s[34:35], AT_EV
  s_branch AT_NB_17
AT_EV:
  s_add_u32 s29, s29, 1
  s_cmp_le_u32 s29, 2
  s_cbranch_scc0 AT_EV3
  v_mov_b32 v2, s29
  s_cmp_eq_u32 s29, 2
  s_cbranch_scc1 AT_EV2
  s_mov_b32 s28, 11
  s_waitcnt vmcnt(17)
  s_mov_b64 exec, 1
  buffer_store_dword v2, off, s[12:15], s53 sc1
  s_mov_b64 exec, -1
  buffer_store_dwordx4 a[152:155], v9, s[12:15], s54 offen offset:0 sc1
  buffer_store_dwordx4 a[156:159], v9, s[12:15], s54 offen offset:1024 sc1
  s_add_u32 s54, s54, s47
  buffer_store_dwordx4 a[248:251], v9, s[12:15], s54 offen offset:0 sc1
  buffer_store_dwordx4 a[252:255], v9, s[12:15], s54 offen offset:1024 sc1
  s_add_u32 s54, s54, s47
  s_setpc_b64 s[34:35]
AT_EV2:
  s_lshl_b32 s63, s23, 1
  s_add_u32 s28, s63, 13
  s_mov_b64 exec, 1
  buffer_store_dword v2, off, s[12:15], s66 offset:2048 sc1
  s_mov_b64 exec, -1
  s_setpc_b64 s[34:35]
AT_EV3:
  s_cmp_eq_u32 s29, 4
  s_cbranch_scc1 AT_EV4
  s_cmp_eq_u32 s29, 5
  s_cbranch_scc1 AT_EV5
  v_and_b32 v6, 0x180, v0
  buffer_load_dword v6, v6, s[12:15], s56 offen offset:2048 sc1
  s_add_u32 s28, s28, 2
  s_setpc_b64 s[34:35]
AT_EV4:
  s_mov_b64 s[62:63], vcc
  s_waitcnt vmcnt(16)
  s_mov_b32 s59, 0x40000
AT_K2_P:
  v_cmp_le_u32 vcc, 2, v6
  s_nop 1
  s_cmp_eq_u64 vcc, -1
  s_cbranch_scc1 AT_K2OK
  s_sub_u32 s59, s59, 1
  s_cbranch_scc1 AT_K2OK
  s_sleep 1
  v_and_b32 v6, 0x180, v0
  buffer_load_dword v6, v6, s[12:15], s56 offen offset:2048 sc1
  s_waitcnt vmcnt(0)
  s_branch AT_K2_P
AT_K2OK:
  s_mov_b64 vcc, s[62:63]
  s_cmp_eq_u32 s28, s52
  s_mov_b32 s28, s52
  s_cbranch_scc1 AT_EV5
  s_setpc_b64 s[34:35]
AT_EV5:
  buffer_load_dword v27, v0, s[96:99], s16 offen
  s_mov_b64 s[68:69], s[100:101]
  s_mov_b32 s70, 3670016
  v_mov_b32 v4, v7
  s_mov_b32 s30, 28672
  s_setpc_b64 s[34:35]
AT_LAST1:
  s_cmp_eq_u32 s46, 1
  s_cbranch_scc0 AT_FIN
  v_mov_b64 v[32:33], v[48:49]
  v_mov_b64 v[34:35], v[50:51]
  v_mov_b64 v[36:37], v[52:53]
  v_mov_b64 v[38:39], v[54:55]
  v_mov_b64 v[40:41], v[56:57]
  v_mov_b64 v[42:43], v[58:59]
  v_mov_b64 v[44:45], v[60:61]
  v_mov_b64 v[46:47], v[62:63]
AT_LAST0:
  s_branch AT_LB
AT_Z0:
  v_mov_b64 v[128:129], 0
  v_mov_b64 v[130:131], 0
  v_mov_b64 v[132:133], 0
  v_mov_b64 v[134:135], 0
  v_mov_b64 v[136:137], 0
  v_mov_b64 v[138:139], 0
  v_mov_b64 v[140:141], 0
  v_mov_b64 v[142:143], 0
  v_mov_b64 v[144:145], 0
  v_mov_b64 v[146:147], 0
  v_mov_b64 v[148:149], 0
  v_mov_b64 v[150:151], 0
  v_mov_b64 v[152:153], 0
  v_mov_b64 v[154:155], 0
  v_mov_b64 v[156:157], 0
  v_mov_b64 v[158:159], 0
  v_mov_b64 v[160:161], 0
  v_mov_b64 v[162:163], 0
  v_mov_b64 v[164:165], 0
  v_mov_b64 v[166:167], 0
  v_mov_b64 v[168:169], 0
  v_mov_b64 v[170:171], 0
  v_mov_b64 v[172:173], 0
  v_mov_b64 v[174:175], 0
  v_mov_b64 v[176:177], 0
  v_mov_b64 v[178:179], 0
  v_mov_b64 v[180:181], 0
  v_mov_b64 v[182:183], 0
  v_mov_b64 v[184:185], 0
  v_mov_b64 v[186:187], 0
  v_mov_b64 v[188:189], 0
  v_mov_b64 v[190:191], 0
  v_mov_b64 v[192:193], 0
  v_mov_b64 v[194:195], 0
  v_mov_b64 v[196:197], 0
  v_mov_b64 v[198:199], 0
  v_mov_b64 v[200:201], 0
  v_mov_b64 v[202:203], 0
  v_mov_b64 v[204:205], 0
  v_mov_b64 v[206:207], 0
  v_mov_b64 v[208:209], 0
  v_mov_b64 v[210:211], 0
  v_mov_b64 v[212:213], 0
  v_mov_b64 v[214:215], 0
  v_mov_b64 v[216:217], 0
  v_mov_b64 v[218:219], 0
  v_mov_b64 v[220:221], 0
  v_mov_b64 v[222:223], 0
  v_mov_b64 v[224:225], 0
  v_mov_b64 v[226:227], 0
  v_mov_b64 v[228:229], 0
  v_mov_b64 v[230:231], 0
  v_mov_b64 v[232:233], 0
  v_mov_b64 v[234:235], 0
  v_mov_b64 v[236:237], 0
  v_mov_b64 v[238:239], 0
  v_mov_b64 v[240:241], 0
  v_mov_b64 v[242:243], 0
  v_mov_b64 v[244:245], 0
  v_mov_b64 v[246:247], 0
  v_mov_b64 v[248:249], 0
  v_mov_b64 v[250:251], 0
  v_mov_b64 v[252:253], 0
  v_mov_b64 v[254:255], 0
  s_branch AT_BODYD0
AT_BODYD1:
  v_mov_b64 v[32:33], v[48:49]
  v_mov_b64 v[34:35], v[50:51]
  v_mov_b64 v[36:37], v[52:53]
  v_mov_b64 v[38:39], v[54:55]
  v_mov_b64 v[40:41], v[56:57]
  v_mov_b64 v[42:43], v[58:59]
  v_mov_b64 v[44:45], v[60:61]
  v_mov_b64 v[46:47], v[62:63]
AT_BODYD0:
  s_waitcnt lgkmcnt(4)
  v_mfma_f32_16x16x32_bf16 v[68:71], a[0:3], a[160:163], v[100:103]
  s_add_u32 s32, s32, 32768
  ds_read_b128 a[48:51], v8 offset:12288
  v_add_f32 v96, 0x0, v24
  v_mfma_f32_16x16x32_bf16 v[68:71], a[4:7], a[164:167], v[68:71]
  s_and_b32 s32, s32, 0x1ffff
  ds_read_b128 a[52:55], v8 offset:13312
  v_add_f32 v97, 0xf1800000, v24
  v_mfma_f32_16x16x32_bf16 v[68:71], a[8:11], a[168:171], v[68:71]
  ds_read_b128 a[56:59], v8 offset:14336
  v_add_f32 v12, v12, v14
  v_mfma_f32_16x16x32_bf16 v[68:71], a[12:15], a[172:175], v[68:71]
  ds_read_b128 a[60:63], v8 offset:15360
  v_add_f32 v13, v13, v15
  v_mfma_f32_16x16x32_bf16 v[68:71], a[16:19], a[176:179], v[68:71]
  ds_read_b128 a[0:3], v8 offset:16384
  v_add_f32 v98, 0xf2000000, v24
  v_mfma_f32_16x16x32_bf16 v[68:71], a[20:23], a[180:183], v[68:71]
  ds_read_b128 a[4:7], v8 offset:17408
  v_add_f32 v99, 0xf2400000, v24
  v_mfma_f32_16x16x32_bf16 v[68:71], a[24:27], a[184:187], v[68:71]
  ds_read_b128 a[8:11], v8 offset:18432
  v_add_f32 v104, 0xf3800000, v24
  v_mfma_f32_16x16x32_bf16 v[68:71], a[28:31], a[188:191], v[68:71]
  s_waitcnt lgkmcnt(6)
  ds_read_b128 a[12:15], v8 offset:19456
  v_add_f32 v105, 0xf3880000, v24
  v_mfma_f32_16x16x32_bf16 v[76:79], a[32:35], a[160:163], v[108:111]
  ds_read_b128 a[16:19], v8 offset:20480
  v_add_f32 v106, 0xf3900000, v24
  v_mfma_f32_16x16x32_bf16 v[76:79], a[36:39], a[164:167], v[76:79]
  ds_read_b128 a[20:23], v8 offset:21504
  v_add_f32 v107, 0xf3980000, v24
  v_mfma_f32_16x16x32_bf16 v[76:79], a[40:43], a[168:171], v[76:79]
  ds_read_b128 a[24:27], v8 offset:22528
  v_add_f32 v112, 0xf4000000, v24
  v_mfma_f32_16x16x32_bf16 v[76:79], a[44:47], a[172:175], v[76:79]
  ds_read_b128 a[28:31], v8 offset:23552
  v_add_f32 v113, 0xf4040000, v24
  v_mfma_f32_16x16x32_bf16 v[76:79], a[48:51], a[176:179], v[76:79]
  s_waitcnt lgkmcnt(6)
  ds_read_b128 a[32:35], v8 offset:24576
  v_add_f32 v114, 0xf4080000, v24
  v_mfma_f32_16x16x32_bf16 v[76:79], a[52:55], a[180:183], v[76:79]
  ds_read_b128 a[36:39], v8 offset:25600
  v_add_f32 v115, 0xf40c0000, v24
  v_mfma_f32_16x16x32_bf16 v[76:79], a[56:59], a[184:187], v[76:79]
  ds_read_b128 a[40:43], v8 offset:26624
  v_add_f32 v120, 0xf4400000, v24
  v_mfma_f32_16x16x32_bf16 v[76:79], a[60:63], a[188:191], v[76:79]
  ds_read_b128 a[44:47], v8 offset:27648
  v_add_f32 v121, 0xf4440000, v24
  v_mfma_f32_16x16x32_bf16 v[84:87], a[0:3], a[160:163], v[116:119]
  ds_read_b128 a[48:51], v8 offset:28672
  v_add_f32 v122, 0xf4480000, v24
  v_mfma_f32_16x16x32_bf16 v[84:87], a[4:7], a[164:167], v[84:87]
  s_waitcnt lgkmcnt(6)
  ds_read_b128 a[52:55], v8 offset:29696
  v_add_f32 v123, 0xf44c0000, v24
  v_mfma_f32_16x16x32_bf16 v[84:87], a[8:11], a[168:171], v[84:87]
  ds_read_b128 a[56:59], v8 offset:30720
  v_min_f32 v68, v68, v96
  v_mfma_f32_16x16x32_bf16 v[84:87], a[12:15], a[172:175], v[84:87]
  ds_read_b128 a[60:63], v8 offset:31744
  v_add_u32 v8, s32, v9
  v_mfma_f32_16x16x32_bf16 v[84:87], a[16:19], a[176:179], v[84:87]
  s_waitcnt vmcnt(9)
  v_mfma_f32_16x16x32_bf16 v[84:87], a[20:23], a[180:183], v[84:87]
  s_waitcnt lgkmcnt(5)
  s_barrier
  v_mfma_f32_16x16x32_bf16 v[84:87], a[24:27], a[184:187], v[84:87]
  s_mov_b32 m0, s31
  ds_read_b128 a[0:3], v8 offset:0
  ds_read_b128 a[4:7], v8 offset:1024
  v_mfma_f32_16x16x32_bf16 v[84:87], a[28:31], a[188:191], v[84:87]
  buffer_load_dwordx4 v4, s[68:71], s24 offen lds
  v_mfma_f32_16x16x32_bf16 v[92:95], a[32:35], a[160:163], v[124:127]
  s_add_u32 m0, m0, 4096
  ds_read_b128 a[8:11], v8 offset:2048
  ds_read_b128 a[12:15], v8 offset:3072
  v_mfma_f32_16x16x32_bf16 v[92:95], a[36:39], a[164:167], v[92:95]
  s_add_u32 s24, s24, s30
  ds_read_b128 a[16:19], v8 offset:4096
  v_min_f32 v69, v69, v97
  v_mfma_f32_16x16x32_bf16 v[92:95], a[40:43], a[168:171], v[92:95]
  s_waitcnt lgkmcnt(5)
  ds_read_b128 a[20:23], v8 offset:5120
  ds_read_b128 a[24:27], v8 offset:6144
  v_mfma_f32_16x16x32_bf16 v[92:95], a[44:47], a[172:175], v[92:95]
  buffer_load_dwordx4 v4, s[68:71], s24 offen lds
  v_mfma_f32_16x16x32_bf16 v[92:95], a[48:51], a[176:179], v[92:95]
  s_add_u32 m0, m0, 4096
  ds_read_b128 a[28:31], v8 offset:7168
  ds_read_b128 a[32:35], v8 offset:8192
  v_mfma_f32_16x16x32_bf16 v[92:95], a[52:55], a[180:183], v[92:95]
  s_add_u32 s24, s24, s30
  ds_read_b128 a[36:39], v8 offset:9216
  v_min_f32 v70, v70, v98
  v_mfma_f32_16x16x32_bf16 v[92:95], a[56:59], a[184:187], v[92:95]
  s_waitcnt lgkmcnt(8)
  ds_read_b128 a[40:43], v8 offset:10240
  ds_read_b128 a[44:47], v8 offset:11264
  v_mfma_f32_16x16x32_bf16 v[92:95], a[60:63], a[188:191], v[92:95]
  buffer_load_dwordx4 v4, s[68:71], s24 offen lds
  v_mfma_f32_16x16x32_bf16 v[128:131], a[0:3], v[32:35], v[128:131]
  s_add_u32 m0, m0, 4096
  ds_read_b128 a[48:51], v8 offset:12288
  ds_read_b128 a[52:55], v8 offset:13312
  v_mfma_f32_16x16x32_bf16 v[128:131], a[4:7], v[36:39], v[128:131]
  s_add_u32 s24, s24, s30
  v_exp_f32 v16, v68
  v_mfma_f32_16x16x32_bf16 v[132:135], a[4:7], v[44:47], v[132:135]
  s_waitcnt lgkmcnt(7)
  v_exp_f32 v17, v69
  v_mfma_f32_16x16x32_bf16 v[132:135], a[0:3], v[40:43], v[132:135]
  buffer_load_dwordx4 v4, s[68:71], s24 offen lds
  v_mfma_f32_16x16x32_bf16 v[136:139], a[8:11], v[32:35], v[136:139]
  s_add_u32 m0, m0, 4096
  ds_read_b128 a[56:59], v8 offset:14336
  ds_read_b128 a[60:63], v8 offset:15360
  v_mfma_f32_16x16x32_bf16 v[136:139], a[12:15], v[36:39], v[136:139]
  s_add_u32 s24, s24, s30
  v_exp_f32 v18, v70
  v_mfma_f32_16x16x32_bf16 v[140:143], a[12:15], v[44:47], v[140:143]
  v_add_f32 v15, v16, v17
  v_cvt_pk_bf16_f32 v56, v16, v17
  v_mfma_f32_16x16x32_bf16 v[140:143], a[8:11], v[40:43], v[140:143]
  buffer_load_dwordx4 v4, s[68:71], s24 offen lds
  v_mfma_f32_16x16x32_bf16 v[144:147], a[16:19], v[32:35], v[144:147]
  s_add_u32 m0, m0, 4096
  ds_read_b128 a[0:3], v8 offset:16384
  ds_read_b128 a[4:7], v8 offset:17408
  v_mfma_f32_16x16x32_bf16 v[144:147], a[20:23], v[36:39], v[144:147]
  s_add_u32 s24, s24, s30
  v_add_f32 v15, v15, v18
  v_min_f32 v71, v71, v99
  v_mfma_f32_16x16x32_bf16 v[148:151], a[20:23], v[44:47], v[148:151]
  s_waitcnt lgkmcnt(4)
  v_exp_f32 v19, v71
  v_mfma_f32_16x16x32_bf16 v[148:151], a[16:19], v[40:43], v[148:151]
  buffer_load_dwordx4 v4, s[68:71], s24 offen lds
  v_mfma_f32_16x16x32_bf16 v[152:155], a[24:27], v[32:35], v[152:155]
  s_add_u32 m0, m0, 4096
  ds_read_b128 a[8:11], v8 offset:18432
  ds_read_b128 a[12:15], v8 offset:19456
  v_mfma_f32_16x16x32_bf16 v[152:155], a[28:31], v[36:39], v[152:155]
  s_add_u32 s24, s24, s30
  v_add_f32 v15, v15, v19
  v_cvt_pk_bf16_f32 v57, v18, v19
  v_mfma_f32_16x16x32_bf16 v[156:159], a[28:31], v[44:47], v[156:159]
  v_min_f32 v76, v76, v104
  v_min_f32 v77, v77, v105
  v_mfma_f32_16x16x32_bf16 v[156:159], a[24:27], v[40:43], v[156:159]
  buffer_load_dwordx4 v4, s[68:71], s24 offen lds
  v_mfma_f32_16x16x32_bf16 v[160:163], a[32:35], v[32:35], v[160:163]
  s_add_u32 m0, m0, 4096
  ds_read_b128 a[16:19], v8 offset:20480
  ds_read_b128 a[20:23], v8 offset:21504
  v_mfma_f32_16x16x32_bf16 v[160:163], a[36:39], v[36:39], v[160:163]
  s_add_u32 s24, s24, s30
  v_exp_f32 v20, v76
  v_mfma_f32_16x16x32_bf16 v[164:167], a[36:39], v[44:47], v[164:167]
  v_exp_f32 v21, v77
  v_mfma_f32_16x16x32_bf16 v[164:167], a[32:35], v[40:43], v[164:167]
  buffer_load_dwordx4 v4, s[68:71], s24 offen lds
  v_mfma_f32_16x16x32_bf16 v[168:171], a[40:43], v[32:35], v[168:171]
  s_add_u32 s31, s31, 32768
  ds_read_b128 a[24:27], v8 offset:22528
  ds_read_b128 a[28:31], v8 offset:23552
  v_mfma_f32_16x16x32_bf16 v[168:171], a[44:47], v[36:39], v[168:171]
  s_and_b32 s31, s31, 0x1ffff
  v_add_f32 v15, v15, v20
  v_add_f32 v15, v15, v21
  v_mfma_f32_16x16x32_bf16 v[172:175], a[44:47], v[44:47], v[172:175]
  s_add_u32 s25, s25, 1
  v_cvt_pk_bf16_f32 v58, v20, v21
  v_min_f32 v78, v78, v106
  v_mfma_f32_16x16x32_bf16 v[172:175], a[40:43], v[40:43], v[172:175]
  s_cmp_eq_u32 s25, s28
  v_exp_f32 v22, v78
  v_mfma_f32_16x16x32_bf16 v[176:179], a[48:51], v[32:35], v[176:179]
  s_cbranch_scc1 AT_NS_18
AT_NB_19:
  ds_read_b128 a[32:35], v8 offset:24576
  ds_read_b128 a[36:39], v8 offset:25600
  v_mfma_f32_16x16x32_bf16 v[176:179], a[52:55], v[36:39], v[176:179]
  v_readlane_b32 s24, v5, s25
  v_mfma_f32_16x16x32_bf16 v[180:183], a[52:55], v[44:47], v[180:183]
  s_waitcnt lgkmcnt(4)
  v_add_f32 v15, v15, v22
  v_min_f32 v79, v79, v107
  v_mfma_f32_16x16x32_bf16 v[180:183], a[48:51], v[40:43], v[180:183]
  buffer_load_dword v25, off, s[12:15], s51 sc1
  v_mfma_f32_16x16x32_bf16 v[184:187], a[56:59], v[32:35], v[184:187]
  s_mov_b32 m0, s31
  ds_read_b128 a[40:43], v8 offset:26624
  ds_read_b128 a[44:47], v8 offset:27648
  v_mfma_f32_16x16x32_bf16 v[184:187], a[60:63], v[36:39], v[184:187]
  buffer_load_dwordx4 v4, s[68:71], s24 offen lds
  v_mfma_f32_16x16x32_bf16 v[188:191], a[60:63], v[44:47], v[188:191]
  s_add_u32 m0, m0, 4096
  v_exp_f32 v23, v79
  v_mfma_f32_16x16x32_bf16 v[188:191], a[56:59], v[40:43], v[188:191]
  s_add_u32 s24, s24, s30
  v_add_f32 v15, v15, v23
  v_cvt_pk_bf16_f32 v59, v22, v23
  v_mfma_f32_16x16x32_bf16 v[192:195], a[0:3], v[32:35], v[192:195]
  s_add_u32 s32, s32, 32768
  ds_read_b128 a[48:51], v8 offset:28672
  ds_read_b128 a[52:55], v8 offset:29696
  v_mfma_f32_16x16x32_bf16 v[192:195], a[4:7], v[36:39], v[192:195]
  buffer_load_dwordx4 v4, s[68:71], s24 offen lds
  v_mfma_f32_16x16x32_bf16 v[196:199], a[4:7], v[44:47], v[196:199]
  s_add_u32 m0, m0, 4096
  v_min_f32 v84, v84, v112
  v_min_f32 v85, v85, v113
  v_mfma_f32_16x16x32_bf16 v[196:199], a[0:3], v[40:43], v[196:199]
  s_add_u32 s24, s24, s30
  v_exp_f32 v28, v84
  v_mfma_f32_16x16x32_bf16 v[200:203], a[8:11], v[32:35], v[200:203]
  s_and_b32 s32, s32, 0x1ffff
  v_exp_f32 v29, v85
  v_mfma_f32_16x16x32_bf16 v[200:203], a[12:15], v[36:39], v[200:203]
  buffer_load_dwordx4 v4, s[68:71], s24 offen lds
  v_mfma_f32_16x16x32_bf16 v[204:207], a[12:15], v[44:47], v[204:207]
  s_add_u32 m0, m0, 4096
  ds_read_b128 a[56:59], v8 offset:30720
  ds_read_b128 a[60:63], v8 offset:31744
  v_mfma_f32_16x16x32_bf16 v[204:207], a[8:11], v[40:43], v[204:207]
  s_add_u32 s24, s24, s30
  v_add_u32 v8, s32, v9
  v_add_f32 v15, v15, v28
  v_mfma_f32_16x16x32_bf16 v[208:211], a[16:19], v[32:35], v[208:211]
  s_waitcnt vmcnt(13)
  v_mfma_f32_16x16x32_bf16 v[208:211], a[20:23], v[36:39], v[208:211]
  s_barrier
  v_mfma_f32_16x16x32_bf16 v[212:215], a[20:23], v[44:47], v[212:215]
  s_waitcnt lgkmcnt(2)
  ds_read_b128 a[0:3], v8 offset:0
  v_add_f32 v15, v15, v29
  v_mfma_f32_16x16x32_bf16 v[212:215], a[16:19], v[40:43], v[212:215]
  buffer_load_dwordx4 v4, s[68:71], s24 offen lds
  v_mfma_f32_16x16x32_bf16 v[216:219], a[24:27], v[32:35], v[216:219]
  s_add_u32 m0, m0, 4096
  ds_read_b128 a[4:7], v8 offset:1024
  v_cvt_pk_bf16_f32 v60, v28, v29
  v_mfma_f32_16x16x32_bf16 v[216:219], a[28:31], v[36:39], v[216:219]
  s_add_u32 s24, s24, s30
  v_min_f32 v86, v86, v114
  v_min_f32 v87, v87, v115
  v_mfma_f32_16x16x32_bf16 v[220:223], a[28:31], v[44:47], v[220:223]
  ds_read_b128 a[8:11], v8 offset:2048
  v_min_f32 v92, v92, v120
  v_mfma_f32_16x16x32_bf16 v[220:223], a[24:27], v[40:43], v[220:223]
  buffer_load_dwordx4 v4, s[68:71], s24 offen lds
  v_mfma_f32_16x16x32_bf16 v[224:227], a[32:35], v[32:35], v[224:227]
  s_add_u32 m0, m0, 4096
  ds_read_b128 a[12:15], v8 offset:3072
  v_min_f32 v93, v93, v121
  v_mfma_f32_16x16x32_bf16 v[224:227], a[36:39], v[36:39], v[224:227]
  s_add_u32 s24, s24, s30
  v_exp_f32 v30, v86
  v_mfma_f32_16x16x32_bf16 v[228:231], a[36:39], v[44:47], v[228:231]
  ds_read_b128 a[16:19], v8 offset:4096
  v_add_f32 v15, v15, v30
  v_mfma_f32_16x16x32_bf16 v[228:231], a[32:35], v[40:43], v[228:231]
  buffer_load_dwordx4 v4, s[68:71], s24 offen lds
  v_mfma_f32_16x16x32_bf16 v[232:235], a[40:43], v[32:35], v[232:235]
  s_add_u32 m0, m0, 4096
  ds_read_b128 a[20:23], v8 offset:5120
  v_min_f32 v94, v94, v122
  v_mfma_f32_16x16x32_bf16 v[232:235], a[44:47], v[36:39], v[232:235]
  s_add_u32 s24, s24, s30
  v_exp_f32 v31, v87
  v_mfma_f32_16x16x32_bf16 v[236:239], a[44:47], v[44:47], v[236:239]
  ds_read_b128 a[24:27], v8 offset:6144
  v_add_f32 v15, v15, v31
  v_mfma_f32_16x16x32_bf16 v[236:239], a[40:43], v[40:43], v[236:239]
  buffer_load_dwordx4 v4, s[68:71], s24 offen lds
  v_mfma_f32_16x16x32_bf16 v[240:243], a[48:51], v[32:35], v[240:243]
  s_add_u32 m0, m0, 4096
  ds_read_b128 a[28:31], v8 offset:7168
  v_cvt_pk_bf16_f32 v61, v30, v31
  v_mfma_f32_16x16x32_bf16 v[240:243], a[52:55], v[36:39], v[240:243]
  s_add_u32 s24, s24, s30
  v_exp_f32 v16, v92
  v_mfma_f32_16x16x32_bf16 v[244:247], a[52:55], v[44:47], v[244:247]
  s_waitcnt lgkmcnt(3)
  ds_read_b128 a[32:35], v8 offset:8192
  v_add_f32 v15, v15, v16
  v_mfma_f32_16x16x32_bf16 v[244:247], a[48:51], v[40:43], v[244:247]
  buffer_load_dwordx4 v4, s[68:71], s24 offen lds
  v_mfma_f32_16x16x32_bf16 v[248:251], a[56:59], v[32:35], v[248:251]
  ds_read_b128 a[36:39], v8 offset:9216
  v_min_f32 v95, v95, v123
  v_mfma_f32_16x16x32_bf16 v[248:251], a[60:63], v[36:39], v[248:251]
  v_exp_f32 v17, v93
  v_mfma_f32_16x16x32_bf16 v[252:255], a[60:63], v[44:47], v[252:255]
  ds_read_b128 a[40:43], v8 offset:10240
  v_add_f32 v15, v15, v17
  v_mfma_f32_16x16x32_bf16 v[252:255], a[56:59], v[40:43], v[252:255]
  ds_read_b128 a[44:47], v8 offset:11264
  v_cvt_pk_bf16_f32 v62, v16, v17
  v_exp_f32 v18, v94
  v_exp_f32 v19, v95
  v_add_f32 v15, v15, v18
  v_add_f32 v15, v15, v19
  v_cvt_pk_bf16_f32 v63, v18, v19
  v_max_f32 v26, v14, v15
  v_cmp_nge_f32 vcc, 0x53800000, v26
  s_add_u32 s31, s31, 32768
  s_and_b32 s31, s31, 0x1ffff
  s_add_u32 s25, s25, 1
  s_cmp_eq_u32 s25, s28
  s_cbranch_scc1 AT_NS_20
AT_NB_21:
  v_readlane_b32 s24, v5, s25
  s_mov_b32 s43, 0
  s_waitcnt vmcnt(8)
  s_cbranch_vccnz AT_H0
AT_FIN:
  s_cmp_eq_u32 s46, 0
  s_cbranch_scc1 AT_LA
  s_mov_b32 s59, 0x40000
AT_PF_P:
  v_readfirstlane_b32 s60, v25
  s_cmp_ge_u32 s60, 1
  s_cbranch_scc1 AT_PFOK
  s_sub_u32 s59, s59, 1
  s_cbranch_scc1 AT_PFOK
  s_sleep 1
  buffer_load_dword v25, off, s[12:15], s51 sc1
  s_waitcnt vmcnt(0)
  s_branch AT_PF_P
AT_PFOK:
  s_cmp_eq_u32 s46, 3
  s_cbranch_scc1 AT_LQ
  s_lshr_b32 s60, s60, 1
  s_or_b32 s44, s44, s60
AT_LA:
  s_add_u32 s26, s55, 35651584
  buffer_load_dwordx4 a[192:195], v9, s[4:7], s26 offen offset:0 sc1
  s_waitcnt lgkmcnt(4)
  v_mfma_f32_16x16x32_bf16 v[132:135], a[0:3], v[56:59], v[132:135]
  s_add_u32 s32, s32, 32768
  ds_read_b128 a[48:51], v8 offset:12288
  ds_read_b128 a[52:55], v8 offset:13312
  v_mfma_f32_16x16x32_bf16 v[132:135], a[4:7], v[60:63], v[132:135]
  s_and_b32 s32, s32, 0x1ffff
  ds_read_b128 a[56:59], v8 offset:14336
  v_add_f32 v13, v13, v15
  v_mfma_f32_16x16x32_bf16 v[140:143], a[8:11], v[56:59], v[140:143]
  s_lshl_b32 s57, s40, 3
  ds_read_b128 a[60:63], v8 offset:15360
  v_mov_b32 v2, v12
  v_mfma_f32_16x16x32_bf16 v[140:143], a[12:15], v[60:63], v[140:143]
  buffer_load_dwordx4 a[196:199], v9, s[4:7], s26 offen offset:1024 sc1
  v_mfma_f32_16x16x32_bf16 v[148:151], a[16:19], v[56:59], v[148:151]
  s_add_u32 s57, s57, s20
  ds_read_b128 a[0:3], v8 offset:16384
  ds_read_b128 a[4:7], v8 offset:17408
  v_mfma_f32_16x16x32_bf16 v[148:151], a[20:23], v[60:63], v[148:151]
  s_lshl_b32 s57, s57, 4
  ds_read_b128 a[8:11], v8 offset:18432
  v_mov_b32 v3, v13
  v_mfma_f32_16x16x32_bf16 v[156:159], a[24:27], v[56:59], v[156:159]
  s_waitcnt lgkmcnt(7)
  ds_read_b128 a[12:15], v8 offset:19456
  v_mfma_f32_16x16x32_bf16 v[156:159], a[28:31], v[60:63], v[156:159]
  buffer_load_dwordx4 a[200:203], v9, s[4:7], s26 offen offset:2048 sc1
  v_mfma_f32_16x16x32_bf16 v[164:167], a[32:35], v[56:59], v[164:167]
  s_add_u32 s57, s57, s21
  ds_read_b128 a[16:19], v8 offset:20480
  ds_read_b128 a[20:23], v8 offset:21504
  v_mfma_f32_16x16x32_bf16 v[164:167], a[36:39], v[60:63], v[164:167]
  s_mul_i32 s57, s57, 14336
  ds_read_b128 a[24:27], v8 offset:22528
  v_permlane16_swap_b32 v12, v2
  v_mfma_f32_16x16x32_bf16 v[172:175], a[40:43], v[56:59], v[172:175]
  s_waitcnt lgkmcnt(7)
  ds_read_b128 a[28:31], v8 offset:23552
  v_permlane16_swap_b32 v13, v3
  v_mfma_f32_16x16x32_bf16 v[172:175], a[44:47], v[60:63], v[172:175]
  buffer_load_dwordx4 a[204:207], v9, s[4:7], s26 offen offset:3072 sc1
  s_add_u32 s26, s26, 4096
  v_mfma_f32_16x16x32_bf16 v[180:183], a[48:51], v[56:59], v[180:183]
  s_add_u32 s57, s57, 45088768
  ds_read_b128 a[32:35], v8 offset:24576
  ds_read_b128 a[36:39], v8 offset:25600
  v_mfma_f32_16x16x32_bf16 v[180:183], a[52:55], v[60:63], v[180:183]
  s_add_u32 s58, s57, 917504
  ds_read_b128 a[40:43], v8 offset:26624
  v_add_f32 v12, v12, v2
  v_mfma_f32_16x16x32_bf16 v[188:191], a[56:59], v[56:59], v[188:191]
  s_waitcnt lgkmcnt(7)
  ds_read_b128 a[44:47], v8 offset:27648
  v_add_f32 v13, v13, v3
  v_mfma_f32_16x16x32_bf16 v[188:191], a[60:63], v[60:63], v[188:191]
  buffer_load_dwordx4 a[208:211], v9, s[4:7], s26 offen offset:0 sc1
  v_mfma_f32_16x16x32_bf16 v[196:199], a[0:3], v[56:59], v[196:199]
  s_nop 0
  ds_read_b128 a[48:51], v8 offset:28672
  ds_read_b128 a[52:55], v8 offset:29696
  v_mfma_f32_16x16x32_bf16 v[196:199], a[4:7], v[60:63], v[196:199]
  ds_read_b128 a[56:59], v8 offset:30720
  v_mov_b32 v2, v12
  v_mfma_f32_16x16x32_bf16 v[204:207], a[8:11], v[56:59], v[204:207]
  s_waitcnt lgkmcnt(7)
  ds_read_b128 a[60:63], v8 offset:31744
  v_mov_b32 v3, v13
  v_mfma_f32_16x16x32_bf16 v[204:207], a[12:15], v[60:63], v[204:207]
  buffer_load_dwordx4 a[212:215], v9, s[4:7], s26 offen offset:1024 sc1
  v_mfma_f32_16x16x32_bf16 v[212:215], a[16:19], v[56:59], v[212:215]
  v_permlane32_swap_b32 v12, v2
  v_permlane32_swap_b32 v13, v3
  v_mfma_f32_16x16x32_bf16 v[212:215], a[20:23], v[60:63], v[212:215]
  v_add_f32 v12, v12, v2
  v_add_f32 v13, v13, v3
  v_mfma_f32_16x16x32_bf16 v[220:223], a[24:27], v[56:59], v[220:223]
  s_waitcnt lgkmcnt(4)
  v_bfe_u32 v2, v1, 2, 2
  v_lshrrev_b32 v3, 4, v1
  v_mfma_f32_16x16x32_bf16 v[220:223], a[28:31], v[60:63], v[220:223]
  buffer_load_dwordx4 a[216:219], v9, s[4:7], s26 offen offset:2048 sc1
  v_mfma_f32_16x16x32_bf16 v[228:231], a[32:35], v[56:59], v[228:231]
  v_cmp_eq_u32 vcc, v2, v3
  v_and_b32 v2, 1, v1
  v_mfma_f32_16x16x32_bf16 v[228:231], a[36:39], v[60:63], v[228:231]
  v_lshlrev_b32 v2, 4, v2
  v_mov_b32 v3, 0x3f80
  v_mfma_f32_16x16x32_bf16 v[236:239], a[40:43], v[56:59], v[236:239]
  s_waitcnt lgkmcnt(0)
  v_lshlrev_b32 v2, v2, v3
  v_cndmask_b32 v2, 0, v2, vcc
  v_mfma_f32_16x16x32_bf16 v[236:239], a[44:47], v[60:63], v[236:239]
  buffer_load_dwordx4 a[220:223], v9, s[4:7], s26 offen offset:3072 sc1
  s_add_u32 s26, s26, 4096
  v_mfma_f32_16x16x32_bf16 v[244:247], a[48:51], v[56:59], v[244:247]
  v_and_b32 v3, 2, v1
  v_cmp_eq_u32 vcc, 0, v3
  v_mfma_f32_16x16x32_bf16 v[244:247], a[52:55], v[60:63], v[244:247]
  v_mov_b64 v[32:33], 0
  v_mov_b64 v[36:37], 0
  v_mfma_f32_16x16x32_bf16 v[252:255], a[56:59], v[56:59], v[252:255]
  v_cndmask_b32 v34, 0, v2, vcc
  v_cndmask_b32 v35, v2, 0, vcc
  v_mfma_f32_16x16x32_bf16 v[252:255], a[60:63], v[60:63], v[252:255]
  buffer_load_dwordx4 a[224:227], v9, s[4:7], s26 offen offset:0 sc1
  v_lshrrev_b32 v2, 2, v1
  v_bfe_u32 v3, v2, 1, 2
  buffer_load_dwordx4 a[228:231], v9, s[4:7], s26 offen offset:1024 sc1
  v_lshlrev_b32 v2, 7, v2
  v_and_b32 v26, 3, v1
  buffer_load_dwordx4 a[232:235], v9, s[4:7], s26 offen offset:2048 sc1
  v_lshl_add_u32 v2, v26, 3, v2
  v_lshl_add_u32 v2, v3, 5, v2
  buffer_load_dwordx4 a[236:239], v9, s[4:7], s26 offen offset:3072 sc1
  s_add_u32 s26, s26, 4096
  v_add_u32 v16, s32, v2
  v_xor_b32 v17, 32, v16
  buffer_load_dwordx4 a[240:243], v9, s[4:7], s26 offen offset:0 sc1
  v_xor_b32 v18, 64, v16
  v_xor_b32 v19, 96, v16
  buffer_load_dwordx4 a[244:247], v9, s[4:7], s26 offen offset:1024 sc1
  buffer_load_dwordx4 a[64:67], v9, s[4:7], s26 offen offset:2048 sc1
  buffer_load_dwordx4 a[68:71], v9, s[4:7], s26 offen offset:3072 sc1
  s_add_u32 s26, s26, 4096
  buffer_load_dwordx4 v[28:31], v9, s[4:7], s26 offen offset:0 sc1
  s_cmp_lg_u32 s44, 0
  s_cbranch_scc1 AT_SLOW
AT_SLOW_B:
  s_waitcnt vmcnt(15)
  s_barrier
  v_mfma_f32_16x16x32_bf16 v[128:131], v[34:37], a[192:195], v[128:131]
  s_nop 0
  ds_read_b64_tr_b16 a[0:1], v16 offset:0
  ds_read_b64_tr_b16 a[2:3], v16 offset:2048
  v_mfma_f32_16x16x32_bf16 v[136:139], v[32:35], a[192:195], v[136:139]
  s_nop 0
  ds_read_b64_tr_b16 a[4:5], v16 offset:4096
  ds_read_b64_tr_b16 a[6:7], v16 offset:6144
  v_mfma_f32_16x16x32_bf16 v[132:135], v[34:37], a[196:199], v[132:135]
  s_nop 0
  ds_read_b64_tr_b16 a[8:9], v16 offset:8192
  ds_read_b64_tr_b16 a[10:11], v16 offset:10240
  v_mfma_f32_16x16x32_bf16 v[140:143], v[32:35], a[196:199], v[140:143]
  s_waitcnt vmcnt(13)
  ds_read_b64_tr_b16 a[12:13], v16 offset:12288
  ds_read_b64_tr_b16 a[14:15], v16 offset:14336
  v_mfma_f32_16x16x32_bf16 v[144:147], v[34:37], a[200:203], v[144:147]
  s_nop 0
  ds_read_b64_tr_b16 a[16:17], v16 offset:16384
  ds_read_b64_tr_b16 a[18:19], v16 offset:18432
  v_mfma_f32_16x16x32_bf16 v[152:155], v[32:35], a[200:203], v[152:155]
  s_nop 0
  ds_read_b64_tr_b16 a[20:21], v16 offset:20480
  ds_read_b64_tr_b16 a[22:23], v16 offset:22528
  v_mfma_f32_16x16x32_bf16 v[148:151], v[34:37], a[204:207], v[148:151]
  s_nop 0
  ds_read_b64_tr_b16 a[24:25], v16 offset:24576
  ds_read_b64_tr_b16 a[26:27], v16 offset:26624
  v_mfma_f32_16x16x32_bf16 v[156:159], v[32:35], a[204:207], v[156:159]
  s_waitcnt vmcnt(11)
  ds_read_b64_tr_b16 a[28:29], v16 offset:28672
  ds_read_b64_tr_b16 a[30:31], v16 offset:30720
  v_mfma_f32_16x16x32_bf16 v[160:163], v[34:37], a[208:211], v[160:163]
  ds_read_b64_tr_b16 a[32:33], v17 offset:0
  v_mfma_f32_16x16x32_bf16 v[168:171], v[32:35], a[208:211], v[168:171]
  ds_read_b64_tr_b16 a[34:35], v17 offset:2048
  v_cvt_pk_bf16_f32 v64, v128, v129
  v_mfma_f32_16x16x32_bf16 v[164:167], v[34:37], a[212:215], v[164:167]
  ds_read_b64_tr_b16 a[36:37], v17 offset:4096
  v_cvt_pk_bf16_f32 v65, v130, v131
  v_mfma_f32_16x16x32_bf16 v[172:175], v[32:35], a[212:215], v[172:175]
  s_waitcnt vmcnt(9)
  ds_read_b64_tr_b16 a[38:39], v17 offset:6144
  v_cvt_pk_bf16_f32 v66, v136, v137
  v_mfma_f32_16x16x32_bf16 v[176:179], v[34:37], a[216:219], v[176:179]
  ds_read_b64_tr_b16 a[40:41], v17 offset:8192
  v_cvt_pk_bf16_f32 v67, v138, v139
  v_mfma_f32_16x16x32_bf16 v[184:187], v[32:35], a[216:219], v[184:187]
  ds_read_b64_tr_b16 a[42:43], v17 offset:10240
  v_cvt_pk_bf16_f32 v96, v132, v133
  v_mfma_f32_16x16x32_bf16 v[180:183], v[34:37], a[220:223], v[180:183]
  ds_read_b64_tr_b16 a[44:45], v17 offset:12288
  v_cvt_pk_bf16_f32 v97, v134, v135
  v_mfma_f32_16x16x32_bf16 v[188:191], v[32:35], a[220:223], v[188:191]
  s_waitcnt vmcnt(7)
  ds_read_b64_tr_b16 a[46:47], v17 offset:14336
  v_cvt_pk_bf16_f32 v98, v140, v141
  v_mfma_f32_16x16x32_bf16 v[192:195], v[34:37], a[224:227], v[192:195]
  v_cvt_pk_bf16_f32 v99, v142, v143
  v_cvt_pk_bf16_f32 v68, v144, v145
  v_mfma_f32_16x16x32_bf16 v[200:203], v[32:35], a[224:227], v[200:203]
  v_cvt_pk_bf16_f32 v69, v146, v147
  v_cvt_pk_bf16_f32 v70, v152, v153
  v_mfma_f32_16x16x32_bf16 v[196:199], v[34:37], a[228:231], v[196:199]
  v_cvt_pk_bf16_f32 v71, v154, v155
  v_cvt_pk_bf16_f32 v100, v148, v149
  v_mfma_f32_16x16x32_bf16 v[204:207], v[32:35], a[228:231], v[204:207]
  s_waitcnt vmcnt(5)
  v_cvt_pk_bf16_f32 v101, v150, v151
  v_cvt_pk_bf16_f32 v102, v156, v157
  v_mfma_f32_16x16x32_bf16 v[208:211], v[34:37], a[232:235], v[208:211]
  v_cvt_pk_bf16_f32 v103, v158, v159
  v_cvt_pk_bf16_f32 v72, v160, v161
  v_mfma_f32_16x16x32_bf16 v[216:219], v[32:35], a[232:235], v[216:219]
  v_cvt_pk_bf16_f32 v73, v162, v163
  v_cvt_pk_bf16_f32 v74, v168, v169
  v_mfma_f32_16x16x32_bf16 v[212:215], v[34:37], a[236:239], v[212:215]
  v_cvt_pk_bf16_f32 v75, v170, v171
  v_cvt_pk_bf16_f32 v104, v164, v165
  v_mfma_f32_16x16x32_bf16 v[220:223], v[32:35], a[236:239], v[220:223]
  s_waitcnt vmcnt(3)
  v_cvt_pk_bf16_f32 v105, v166, v167
  v_cvt_pk_bf16_f32 v106, v172, v173
  v_mfma_f32_16x16x32_bf16 v[224:227], v[34:37], a[240:243], v[224:227]
  v_cvt_pk_bf16_f32 v107, v174, v175
  v_cvt_pk_bf16_f32 v76, v176, v177
  v_mfma_f32_16x16x32_bf16 v[232:235], v[32:35], a[240:243], v[232:235]
  v_cvt_pk_bf16_f32 v77, v178, v179
  v_cvt_pk_bf16_f32 v78, v184, v185
  v_mfma_f32_16x16x32_bf16 v[228:231], v[34:37], a[244:247], v[228:231]
  v_cvt_pk_bf16_f32 v79, v186, v187
  v_cvt_pk_bf16_f32 v108, v180, v181
  v_mfma_f32_16x16x32_bf16 v[236:239], v[32:35], a[244:247], v[236:239]
  s_waitcnt vmcnt(1)
  v_cvt_pk_bf16_f32 v109, v182, v183
  v_cvt_pk_bf16_f32 v110, v188, v189
  v_mfma_f32_16x16x32_bf16 v[240:243], v[34:37], a[64:67], v[240:243]
  v_cvt_pk_bf16_f32 v111, v190, v191
  v_cvt_pk_bf16_f32 v80, v192, v193
  v_mfma_f32_16x16x32_bf16 v[248:251], v[32:35], a[64:67], v[248:251]
  v_cvt_pk_bf16_f32 v81, v194, v195
  v_cvt_pk_bf16_f32 v82, v200, v201
  v_mfma_f32_16x16x32_bf16 v[244:247], v[34:37], a[68:71], v[244:247]
  v_cvt_pk_bf16_f32 v83, v202, v203
  v_cvt_pk_bf16_f32 v112, v196, v197
  v_mfma_f32_16x16x32_bf16 v[252:255], v[32:35], a[68:71], v[252:255]
  v_cvt_pk_bf16_f32 v113, v198, v199
  v_cvt_pk_bf16_f32 v114, v204, v205
  v_cvt_pk_bf16_f32 v115, v206, v207
  v_cvt_pk_bf16_f32 v84, v208, v209
  v_cvt_pk_bf16_f32 v85, v210, v211
  v_cvt_pk_bf16_f32 v86, v216, v217
  s_mov_b32 m0, s31
  s_nop 0
  buffer_load_dwordx4 v4, s[68:71], s24 offen lds
  s_add_u32 m0, m0, 4096
  s_add_u32 s24, s24, s30
  v_cvt_pk_bf16_f32 v87, v218, v219
  v_cvt_pk_bf16_f32 v116, v212, v213
  v_cvt_pk_bf16_f32 v117, v214, v215
  v_cvt_pk_bf16_f32 v118, v220, v221
  buffer_load_dwordx4 v4, s[68:71], s24 offen lds
  s_add_u32 m0, m0, 4096
  s_add_u32 s24, s24, s30
  v_cvt_pk_bf16_f32 v119, v222, v223
  v_cvt_pk_bf16_f32 v88, v224, v225
  v_cvt_pk_bf16_f32 v89, v226, v227
  v_cvt_pk_bf16_f32 v90, v232, v233
  buffer_load_dwordx4 v4, s[68:71], s24 offen lds
  s_add_u32 m0, m0, 4096
  s_add_u32 s24, s24, s30
  v_cvt_pk_bf16_f32 v91, v234, v235
  v_cvt_pk_bf16_f32 v120, v228, v229
  v_cvt_pk_bf16_f32 v121, v230, v231
  v_cvt_pk_bf16_f32 v122, v236, v237
  buffer_load_dwordx4 v4, s[68:71], s24 offen lds
  s_add_u32 m0, m0, 4096
  s_add_u32 s24, s24, s30
  v_cvt_pk_bf16_f32 v123, v238, v239
  v_cvt_pk_bf16_f32 v92, v240, v241
  v_cvt_pk_bf16_f32 v93, v242, v243
  v_cvt_pk_bf16_f32 v94, v248, v249
  buffer_load_dwordx4 v4, s[68:71], s24 offen lds
  s_add_u32 m0, m0, 4096
  s_add_u32 s24, s24, s30
  v_cvt_pk_bf16_f32 v95, v250, v251
  v_cvt_pk_bf16_f32 v124, v244, v245
  v_cvt_pk_bf16_f32 v125, v246, v247
  v_cvt_pk_bf16_f32 v126, v252, v253
  buffer_load_dwordx4 v4, s[68:71], s24 offen lds
  s_add_u32 m0, m0, 4096
  s_add_u32 s24, s24, s30
  v_cvt_pk_bf16_f32 v127, v254, v255
  buffer_load_dwordx4 v4, s[68:71], s24 offen lds
  s_add_u32 m0, m0, 4096
  s_add_u32 s24, s24, s30
  buffer_load_dwordx4 v4, s[68:71], s24 offen lds
  s_add_u32 s31, s31, 32768
  s_and_b32 s31, s31, 0x1ffff
  s_add_u32 s25, s25, 1
  s_cmp_eq_u32 s25, s28
  s_cbranch_scc1 AT_NS_22
AT_NB_23:
  v_readlane_b32 s24, v5, s25
  s_nop 3
  s_waitcnt vmcnt(8)
  v_add_f32 v12, v12, v30
  v_add_f32 v13, v13, v31
  v_rcp_f32 v20, v12
  v_rcp_f32 v21, v13
AT_OPROJ:
  s_waitcnt lgkmcnt(0)
  v_mfma_f32_16x16x32_bf16 v[128:131], a[0:3], v[64:67], 0
  ds_read_b64_tr_b16 a[48:49], v17 offset:16384
  v_mfma_f32_16x16x32_bf16 v[128:131], a[4:7], v[68:71], v[128:131]
  s_mov_b32 s24, 384
  ds_read_b64_tr_b16 a[50:51], v17 offset:18432
  v_mfma_f32_16x16x32_bf16 v[128:131], a[8:11], v[72:75], v[128:131]
  s_mov_b32 m0, s31
  ds_read_b64_tr_b16 a[52:53], v17 offset:20480
  v_mfma_f32_16x16x32_bf16 v[128:131], a[12:15], v[76:79], v[128:131]
  buffer_load_dwordx4 v4, s[68:71], s24 offen lds
  v_mfma_f32_16x16x32_bf16 v[128:131], a[16:19], v[80:83], v[128:131]
  s_add_u32 m0, m0, 4096
  ds_read_b64_tr_b16 a[54:55], v17 offset:22528
  ds_read_b64_tr_b16 a[56:57], v17 offset:24576
  v_mfma_f32_16x16x32_bf16 v[128:131], a[20:23], v[84:87], v[128:131]
  s_add_u32 s24, s24, s30
  ds_read_b64_tr_b16 a[58:59], v17 offset:26624
  v_mfma_f32_16x16x32_bf16 v[128:131], a[24:27], v[88:91], v[128:131]
  ds_read_b64_tr_b16 a[60:61], v17 offset:28672
  v_mfma_f32_16x16x32_bf16 v[128:131], a[28:31], v[92:95], v[128:131]
  buffer_load_dwordx4 v4, s[68:71], s24 offen lds
  v_mfma_f32_16x16x32_bf16 v[132:135], a[0:3], v[96:99], 0
  s_add_u32 m0, m0, 4096
  ds_read_b64_tr_b16 a[62:63], v17 offset:30720
  ds_read_b64_tr_b16 a[0:1], v18 offset:0
  v_mfma_f32_16x16x32_bf16 v[132:135], a[4:7], v[100:103], v[132:135]
  s_add_u32 s24, s24, s30
  ds_read_b64_tr_b16 a[2:3], v18 offset:2048
  v_mfma_f32_16x16x32_bf16 v[132:135], a[8:11], v[104:107], v[132:135]
  ds_read_b64_tr_b16 a[4:5], v18 offset:4096
  v_mfma_f32_16x16x32_bf16 v[132:135], a[12:15], v[108:111], v[132:135]
  ds_read_b64_tr_b16 a[6:7], v18 offset:6144
  v_mfma_f32_16x16x32_bf16 v[132:135], a[16:19], v[112:115], v[132:135]
  ds_read_b64_tr_b16 a[8:9], v18 offset:8192
  v_mfma_f32_16x16x32_bf16 v[132:135], a[20:23], v[116:119], v[132:135]
  buffer_load_dwordx4 v4, s[68:71], s24 offen lds
  v_mfma_f32_16x16x32_bf16 v[132:135], a[24:27], v[120:123], v[132:135]
  s_add_u32 m0, m0, 4096
  ds_read_b64_tr_b16 a[10:11], v18 offset:10240
  ds_read_b64_tr_b16 a[12:13], v18 offset:12288
  v_mfma_f32_16x16x32_bf16 v[132:135], a[28:31], v[124:127], v[132:135]
  s_add_u32 s24, s24, s30
  ds_read_b64_tr_b16 a[14:15], v18 offset:14336
  v_mul_f32 v128, v128, v20
  v_mfma_f32_16x16x32_bf16 v[136:139], a[32:35], v[64:67], 0
  ds_read_b64_tr_b16 a[16:17], v18 offset:16384
  v_mul_f32 v129, v129, v20
  v_mfma_f32_16x16x32_bf16 v[136:139], a[36:39], v[68:71], v[136:139]
  buffer_load_dwordx4 v4, s[68:71], s24 offen lds
  v_mfma_f32_16x16x32_bf16 v[136:139], a[40:43], v[72:75], v[136:139]
  s_add_u32 m0, m0, 4096
  ds_read_b64_tr_b16 a[18:19], v18 offset:18432
  ds_read_b64_tr_b16 a[20:21], v18 offset:20480
  v_mfma_f32_16x16x32_bf16 v[136:139], a[44:47], v[76:79], v[136:139]
  s_waitcnt lgkmcnt(6)
  s_add_u32 s24, s24, s30
  ds_read_b64_tr_b16 a[22:23], v18 offset:22528
  v_mfma_f32_16x16x32_bf16 v[136:139], a[48:51], v[80:83], v[136:139]
  ds_read_b64_tr_b16 a[24:25], v18 offset:24576
  v_mul_f32 v130, v130, v20
  v_mfma_f32_16x16x32_bf16 v[136:139], a[52:55], v[84:87], v[136:139]
  ds_read_b64_tr_b16 a[26:27], v18 offset:26624
  v_mul_f32 v131, v131, v20
  v_mfma_f32_16x16x32_bf16 v[136:139], a[56:59], v[88:91], v[136:139]
  ds_read_b64_tr_b16 a[28:29], v18 offset:28672
  v_cvt_pk_bf16_f32 v32, v128, v129
  v_mfma_f32_16x16x32_bf16 v[136:139], a[60:63], v[92:95], v[136:139]
  buffer_load_dwordx4 v4, s[68:71], s24 offen lds
  v_mfma_f32_16x16x32_bf16 v[140:143], a[32:35], v[96:99], 0
  s_add_u32 m0, m0, 4096
  ds_read_b64_tr_b16 a[30:31], v18 offset:30720
  ds_read_b64_tr_b16 a[32:33], v19 offset:0
  v_mfma_f32_16x16x32_bf16 v[140:143], a[36:39], v[100:103], v[140:143]
  s_add_u32 s24, s24, s30
  ds_read_b64_tr_b16 a[34:35], v19 offset:2048
  v_cvt_pk_bf16_f32 v33, v130, v131
  v_mfma_f32_16x16x32_bf16 v[140:143], a[40:43], v[104:107], v[140:143]
  ds_read_b64_tr_b16 a[36:37], v19 offset:4096
  v_mul_f32 v132, v132, v21
  v_mfma_f32_16x16x32_bf16 v[140:143], a[44:47], v[108:111], v[140:143]
  buffer_load_dwordx4 v4, s[68:71], s24 offen lds
  v_mfma_f32_16x16x32_bf16 v[140:143], a[48:51], v[112:115], v[140:143]
  s_add_u32 m0, m0, 4096
  ds_read_b64_tr_b16 a[38:39], v19 offset:6144
  ds_read_b64_tr_b16 a[40:41], v19 offset:8192
  v_mfma_f32_16x16x32_bf16 v[140:143], a[52:55], v[116:119], v[140:143]
  s_add_u32 s24, s24, s30
  ds_read_b64_tr_b16 a[42:43], v19 offset:10240
  v_mul_f32 v133, v133, v21
  v_mfma_f32_16x16x32_bf16 v[140:143], a[56:59], v[120:123], v[140:143]
  ds_read_b64_tr_b16 a[44:45], v19 offset:12288
  v_mul_f32 v134, v134, v21
  v_mfma_f32_16x16x32_bf16 v[140:143], a[60:63], v[124:127], v[140:143]
  ds_read_b64_tr_b16 a[46:47], v19 offset:14336
  v_mul_f32 v135, v135, v21
  v_mfma_f32_16x16x32_bf16 v[144:147], a[0:3], v[64:67], 0
  s_waitcnt lgkmcnt(6)
  ds_read_b64_tr_b16 a[48:49], v19 offset:16384
  v_cvt_pk_bf16_f32 v36, v132, v133
  v_mfma_f32_16x16x32_bf16 v[144:147], a[4:7], v[68:71], v[144:147]
  buffer_load_dwordx4 v4, s[68:71], s24 offen lds
  v_mfma_f32_16x16x32_bf16 v[144:147], a[8:11], v[72:75], v[144:147]
  s_add_u32 m0, m0, 4096
  ds_read_b64_tr_b16 a[50:51], v19 offset:18432
  ds_read_b64_tr_b16 a[52:53], v19 offset:20480
  v_mfma_f32_16x16x32_bf16 v[144:147], a[12:15], v[76:79], v[144:147]
  s_add_u32 s24, s24, s30
  ds_read_b64_tr_b16 a[54:55], v19 offset:22528
  v_cvt_pk_bf16_f32 v37, v134, v135
  v_mfma_f32_16x16x32_bf16 v[144:147], a[16:19], v[80:83], v[144:147]
  ds_read_b64_tr_b16 a[56:57], v19 offset:24576
  v_mul_f32 v136, v136, v20
  v_mfma_f32_16x16x32_bf16 v[144:147], a[20:23], v[84:87], v[144:147]
  buffer_load_dwordx4 v4, s[68:71], s24 offen lds
  v_mfma_f32_16x16x32_bf16 v[144:147], a[24:27], v[88:91], v[144:147]
  s_add_u32 s31, s31, 32768
  ds_read_b64_tr_b16 a[58:59], v19 offset:26624
  ds_read_b64_tr_b16 a[60:61], v19 offset:28672
  v_mfma_f32_16x16x32_bf16 v[144:147], a[28:31], v[92:95], v[144:147]
  s_and_b32 s31, s31, 0x1ffff
  ds_read_b64_tr_b16 a[62:63], v19 offset:30720
  v_mul_f32 v137, v137, v20
  v_mfma_f32_16x16x32_bf16 v[148:151], a[0:3], v[96:99], 0
  v_mfma_f32_16x16x32_bf16 v[148:151], a[4:7], v[100:103], v[148:151]
  s_barrier
  v_mfma_f32_16x16x32_bf16 v[148:151], a[8:11], v[104:107], v[148:151]
  s_nop 0
  ds_read_b64_tr_b16 a[0:1], v16 offset:32768
  ds_read_b64_tr_b16 a[2:3], v16 offset:34816
  v_mfma_f32_16x16x32_bf16 v[148:151], a[12:15], v[108:111], v[148:151]
  ds_read_b64_tr_b16 a[4:5], v16 offset:36864
  v_mul_f32 v138, v138, v20
  v_mul_f32 v139, v139, v20
  v_mfma_f32_16x16x32_bf16 v[148:151], a[16:19], v[112:115], v[148:151]
  ds_read_b64_tr_b16 a[6:7], v16 offset:38912
  v_cvt_pk_bf16_f32 v34, v136, v137
  v_cvt_pk_bf16_f32 v35, v138, v139
  v_mfma_f32_16x16x32_bf16 v[148:151], a[20:23], v[116:119], v[148:151]
  ds_read_b64_tr_b16 a[8:9], v16 offset:40960
  v_mul_f32 v140, v140, v21
  v_mfma_f32_16x16x32_bf16 v[148:151], a[24:27], v[120:123], v[148:151]
  ds_read_b64_tr_b16 a[10:11], v16 offset:43008
  v_mul_f32 v141, v141, v21
  v_mfma_f32_16x16x32_bf16 v[148:151], a[28:31], v[124:127], v[148:151]
  buffer_store_dwordx4 v[32:35], v9, s[12:15], s57 offen offset:0 sc1
  v_mul_f32 v142, v142, v21
  v_mul_f32 v143, v143, v21
  v_cvt_pk_bf16_f32 v38, v140, v141
  v_mfma_f32_16x16x32_bf16 v[152:155], a[32:35], v[64:67], 0
  s_waitcnt lgkmcnt(6)
  ds_read_b64_tr_b16 a[12:13], v16 offset:45056
  v_cvt_pk_bf16_f32 v39, v142, v143
  v_mfma_f32_16x16x32_bf16 v[152:155], a[36:39], v[68:71], v[152:155]
  s_nop 0
  ds_read_b64_tr_b16 a[14:15], v16 offset:47104
  ds_read_b64_tr_b16 a[16:17], v16 offset:49152
  v_mfma_f32_16x16x32_bf16 v[152:155], a[40:43], v[72:75], v[152:155]
  ds_read_b64_tr_b16 a[18:19], v16 offset:51200
  v_mul_f32 v144, v144, v20
  v_mfma_f32_16x16x32_bf16 v[152:155], a[44:47], v[76:79], v[152:155]
  ds_read_b64_tr_b16 a[20:21], v16 offset:53248
  v_mul_f32 v145, v145, v20
  v_mfma_f32_16x16x32_bf16 v[152:155], a[48:51], v[80:83], v[152:155]
  ds_read_b64_tr_b16 a[22:23], v16 offset:55296
  v_mul_f32 v146, v146, v20
  v_mfma_f32_16x16x32_bf16 v[152:155], a[52:55], v[84:87], v[152:155]
  ds_read_b64_tr_b16 a[24:25], v16 offset:57344
  v_mul_f32 v147, v147, v20
  v_mfma_f32_16x16x32_bf16 v[152:155], a[56:59], v[88:91], v[152:155]
  ds_read_b64_tr_b16 a[26:27], v16 offset:59392
  v_cvt_pk_bf16_f32 v40, v144, v145
  v_mfma_f32_16x16x32_bf16 v[152:155], a[60:63], v[92:95], v[152:155]
  ds_read_b64_tr_b16 a[28:29], v16 offset:61440
  v_cvt_pk_bf16_f32 v41, v146, v147
  v_mfma_f32_16x16x32_bf16 v[156:159], a[32:35], v[96:99], 0
  ds_read_b64_tr_b16 a[30:31], v16 offset:63488
  v_xor_b32 v16, 0x10000, v16
  v_mfma_f32_16x16x32_bf16 v[156:159], a[36:39], v[100:103], v[156:159]
  ds_read_b64_tr_b16 a[32:33], v17 offset:32768
  v_mul_f32 v148, v148, v21
  v_mfma_f32_16x16x32_bf16 v[156:159], a[40:43], v[104:107], v[156:159]
  ds_read_b64_tr_b16 a[34:35], v17 offset:34816
  v_mul_f32 v149, v149, v21
  v_mfma_f32_16x16x32_bf16 v[156:159], a[44:47], v[108:111], v[156:159]
  ds_read_b64_tr_b16 a[36:37], v17 offset:36864
  v_mul_f32 v150, v150, v21
  v_mfma_f32_16x16x32_bf16 v[156:159], a[48:51], v[112:115], v[156:159]
  ds_read_b64_tr_b16 a[38:39], v17 offset:38912
  v_mul_f32 v151, v151, v21
  v_mfma_f32_16x16x32_bf16 v[156:159], a[52:55], v[116:119], v[156:159]
  buffer_store_dwordx4 v[36:39], v9, s[12:15], s58 offen offset:0 sc1
  v_cvt_pk_bf16_f32 v44, v148, v149
  v_cvt_pk_bf16_f32 v45, v150, v151
  v_mfma_f32_16x16x32_bf16 v[156:159], a[56:59], v[120:123], v[156:159]
  ds_read_b64_tr_b16 a[40:41], v17 offset:40960
  v_mfma_f32_16x16x32_bf16 v[156:159], a[60:63], v[124:127], v[156:159]
  s_waitcnt lgkmcnt(5)
  ds_read_b64_tr_b16 a[42:43], v17 offset:43008
  ds_read_b64_tr_b16 a[44:45], v17 offset:45056
  v_mfma_f32_16x16x32_bf16 v[160:163], a[0:3], v[64:67], 0
  ds_read_b64_tr_b16 a[46:47], v17 offset:47104
  v_mul_f32 v152, v152, v20
  v_mfma_f32_16x16x32_bf16 v[160:163], a[4:7], v[68:71], v[160:163]
  s_mov_b32 s24, 512
  ds_read_b64_tr_b16 a[48:49], v17 offset:49152
  v_mul_f32 v153, v153, v20
  v_mfma_f32_16x16x32_bf16 v[160:163], a[8:11], v[72:75], v[160:163]
  s_mov_b32 m0, s31
  ds_read_b64_tr_b16 a[50:51], v17 offset:51200
  v_mul_f32 v154, v154, v20
  v_mfma_f32_16x16x32_bf16 v[160:163], a[12:15], v[76:79], v[160:163]
  buffer_load_dwordx4 v4, s[68:71], s24 offen lds
  v_mfma_f32_16x16x32_bf16 v[160:163], a[16:19], v[80:83], v[160:163]
  s_add_u32 m0, m0, 4096
  ds_read_b64_tr_b16 a[52:53], v17 offset:53248
  ds_read_b64_tr_b16 a[54:55], v17 offset:55296
  v_mfma_f32_16x16x32_bf16 v[160:163], a[20:23], v[84:87], v[160:163]
  s_add_u32 s24, s24, s30
  ds_read_b64_tr_b16 a[56:57], v17 offset:57344
  v_mul_f32 v155, v155, v20
  v_mfma_f32_16x16x32_bf16 v[160:163], a[24:27], v[88:91], v[160:163]
  ds_read_b64_tr_b16 a[58:59], v17 offset:59392
  v_cvt_pk_bf16_f32 v42, v152, v153
  v_mfma_f32_16x16x32_bf16 v[160:163], a[28:31], v[92:95], v[160:163]
  buffer_load_dwordx4 v4, s[68:71], s24 offen lds
  v_mfma_f32_16x16x32_bf16 v[164:167], a[0:3], v[96:99], 0
  s_add_u32 m0, m0, 4096
  ds_read_b64_tr_b16 a[60:61], v17 offset:61440
  ds_read_b64_tr_b16 a[62:63], v17 offset:63488
  v_mfma_f32_16x16x32_bf16 v[164:167], a[4:7], v[100:103], v[164:167]
  s_add_u32 s24, s24, s30
  ds_read_b64_tr_b16 a[0:1], v18 offset:32768
  v_xor_b32 v17, 0x10000, v17
  v_mfma_f32_16x16x32_bf16 v[164:167], a[8:11], v[104:107], v[164:167]
  ds_read_b64_tr_b16 a[2:3], v18 offset:34816
  v_cvt_pk_bf16_f32 v43, v154, v155
  v_mfma_f32_16x16x32_bf16 v[164:167], a[12:15], v[108:111], v[164:167]
  buffer_store_dwordx4 v[40:43], v9, s[12:15], s57 offen offset:1024 sc1
  v_mul_f32 v156, v156, v21
  v_mul_f32 v157, v157, v21
  v_mul_f32 v158, v158, v21
  v_mfma_f32_16x16x32_bf16 v[164:167], a[16:19], v[112:115], v[164:167]
  s_waitcnt lgkmcnt(5)
  ds_read_b64_tr_b16 a[4:5], v18 offset:36864
  v_mul_f32 v159, v159, v21
  v_mfma_f32_16x16x32_bf16 v[164:167], a[20:23], v[116:119], v[164:167]
  buffer_load_dwordx4 v4, s[68:71], s24 offen lds
  v_mfma_f32_16x16x32_bf16 v[164:167], a[24:27], v[120:123], v[164:167]
  s_add_u32 m0, m0, 4096
  ds_read_b64_tr_b16 a[6:7], v18 offset:38912
  ds_read_b64_tr_b16 a[8:9], v18 offset:40960
  v_mfma_f32_16x16x32_bf16 v[164:167], a[28:31], v[124:127], v[164:167]
  s_add_u32 s24, s24, s30
  ds_read_b64_tr_b16 a[10:11], v18 offset:43008
  ds_read_b64_tr_b16 a[12:13], v18 offset:45056
  v_mfma_f32_16x16x32_bf16 v[168:171], a[32:35], v[64:67], 0
  ds_read_b64_tr_b16 a[14:15], v18 offset:47104
  v_cvt_pk_bf16_f32 v46, v156, v157
  v_mfma_f32_16x16x32_bf16 v[168:171], a[36:39], v[68:71], v[168:171]
  buffer_load_dwordx4 v4, s[68:71], s24 offen lds
  v_mfma_f32_16x16x32_bf16 v[168:171], a[40:43], v[72:75], v[168:171]
  s_add_u32 m0, m0, 4096
  ds_read_b64_tr_b16 a[16:17], v18 offset:49152
  ds_read_b64_tr_b16 a[18:19], v18 offset:51200
  v_mfma_f32_16x16x32_bf16 v[168:171], a[44:47], v[76:79], v[168:171]
  s_add_u32 s24, s24, s30
  ds_read_b64_tr_b16 a[20:21], v18 offset:53248
  v_cvt_pk_bf16_f32 v47, v158, v159
  v_mfma_f32_16x16x32_bf16 v[168:171], a[48:51], v[80:83], v[168:171]
  ds_read_b64_tr_b16 a[22:23], v18 offset:55296
  v_mul_f32 v160, v160, v20
  v_mfma_f32_16x16x32_bf16 v[168:171], a[52:55], v[84:87], v[168:171]
  s_waitcnt lgkmcnt(7)
  ds_read_b64_tr_b16 a[24:25], v18 offset:57344
  v_mul_f32 v161, v161, v20
  v_mfma_f32_16x16x32_bf16 v[168:171], a[56:59], v[88:91], v[168:171]
  ds_read_b64_tr_b16 a[26:27], v18 offset:59392
  v_mul_f32 v162, v162, v20
  v_mfma_f32_16x16x32_bf16 v[168:171], a[60:63], v[92:95], v[168:171]
  buffer_load_dwordx4 v4, s[68:71], s24 offen lds
  v_mfma_f32_16x16x32_bf16 v[172:175], a[32:35], v[96:99], 0
  s_add_u32 m0, m0, 4096
  ds_read_b64_tr_b16 a[28:29], v18 offset:61440
  ds_read_b64_tr_b16 a[30:31], v18 offset:63488
  v_mfma_f32_16x16x32_bf16 v[172:175], a[36:39], v[100:103], v[172:175]
  s_add_u32 s24, s24, s30
  ds_read_b64_tr_b16 a[32:33], v19 offset:32768
  v_xor_b32 v18, 0x10000, v18
  v_mfma_f32_16x16x32_bf16 v[172:175], a[40:43], v[104:107], v[172:175]
  ds_read_b64_tr_b16 a[34:35], v19 offset:34816
  v_mul_f32 v163, v163, v20
  v_mfma_f32_16x16x32_bf16 v[172:175], a[44:47], v[108:111], v[172:175]
  buffer_load_dwordx4 v4, s[68:71], s24 offen lds
  v_mfma_f32_16x16x32_bf16 v[172:175], a[48:51], v[112:115], v[172:175]
  s_add_u32 m0, m0, 4096
  ds_read_b64_tr_b16 a[36:37], v19 offset:36864
  ds_read_b64_tr_b16 a[38:39], v19 offset:38912
  v_cvt_pk_bf16_f32 v48, v160, v161
  v_mfma_f32_16x16x32_bf16 v[172:175], a[52:55], v[116:119], v[172:175]
  s_add_u32 s24, s24, s30
  ds_read_b64_tr_b16 a[40:41], v19 offset:40960
  v_cvt_pk_bf16_f32 v49, v162, v163
  v_mfma_f32_16x16x32_bf16 v[172:175], a[56:59], v[120:123], v[172:175]
  ds_read_b64_tr_b16 a[42:43], v19 offset:43008
  v_mul_f32 v164, v164, v21
  v_mfma_f32_16x16x32_bf16 v[172:175], a[60:63], v[124:127], v[172:175]
  buffer_store_dwordx4 v[44:47], v9, s[12:15], s58 offen offset:1024 sc1
  v_mul_f32 v165, v165, v21
  v_mul_f32 v166, v166, v21
  v_mul_f32 v167, v167, v21
  v_mfma_f32_16x16x32_bf16 v[176:179], a[0:3], v[64:67], 0
  s_waitcnt lgkmcnt(5)
  ds_read_b64_tr_b16 a[44:45], v19 offset:45056
  v_cvt_pk_bf16_f32 v52, v164, v165
  v_mfma_f32_16x16x32_bf16 v[176:179], a[4:7], v[68:71], v[176:179]
  buffer_load_dwordx4 v4, s[68:71], s24 offen lds
  v_mfma_f32_16x16x32_bf16 v[176:179], a[8:11], v[72:75], v[176:179]
  s_add_u32 m0, m0, 4096
  ds_read_b64_tr_b16 a[46:47], v19 offset:47104
  ds_read_b64_tr_b16 a[48:49], v19 offset:49152
  v_mfma_f32_16x16x32_bf16 v[176:179], a[12:15], v[76:79], v[176:179]
  s_add_u32 s24, s24, s30
  ds_read_b64_tr_b16 a[50:51], v19 offset:51200
  ds_read_b64_tr_b16 a[52:53], v19 offset:53248
  v_cvt_pk_bf16_f32 v53, v166, v167
  v_mfma_f32_16x16x32_bf16 v[176:179], a[16:19], v[80:83], v[176:179]
  ds_read_b64_tr_b16 a[54:55], v19 offset:55296
  v_mul_f32 v168, v168, v20
  v_mfma_f32_16x16x32_bf16 v[176:179], a[20:23], v[84:87], v[176:179]
  buffer_load_dwordx4 v4, s[68:71], s24 offen lds
  v_mfma_f32_16x16x32_bf16 v[176:179], a[24:27], v[88:91], v[176:179]
  s_add_u32 s31, s31, 32768
  ds_read_b64_tr_b16 a[56:57], v19 offset:57344
  ds_read_b64_tr_b16 a[58:59], v19 offset:59392
  v_mfma_f32_16x16x32_bf16 v[176:179], a[28:31], v[92:95], v[176:179]
  s_and_b32 s31, s31, 0x1ffff
  ds_read_b64_tr_b16 a[60:61], v19 offset:61440
  v_mul_f32 v169, v169, v20
  v_mfma_f32_16x16x32_bf16 v[180:183], a[0:3], v[96:99], 0
  s_waitcnt vmcnt(20)
  ds_read_b64_tr_b16 a[62:63], v19 offset:63488
  v_mfma_f32_16x16x32_bf16 v[180:183], a[4:7], v[100:103], v[180:183]
  s_barrier
  v_mfma_f32_16x16x32_bf16 v[180:183], a[8:11], v[104:107], v[180:183]
  s_nop 0
  ds_read_b64_tr_b16 a[0:1], v16 offset:0
  ds_read_b64_tr_b16 a[2:3], v16 offset:2048
  v_mfma_f32_16x16x32_bf16 v[180:183], a[12:15], v[108:111], v[180:183]
  ds_read_b64_tr_b16 a[4:5], v16 offset:4096
  v_xor_b32 v19, 0x10000, v19
  v_mul_f32 v170, v170, v20
  v_mfma_f32_16x16x32_bf16 v[180:183], a[16:19], v[112:115], v[180:183]
  ds_read_b64_tr_b16 a[6:7], v16 offset:6144
  v_mul_f32 v171, v171, v20
  v_cvt_pk_bf16_f32 v50, v168, v169
  v_mfma_f32_16x16x32_bf16 v[180:183], a[20:23], v[116:119], v[180:183]
  ds_read_b64_tr_b16 a[8:9], v16 offset:8192
  v_cvt_pk_bf16_f32 v51, v170, v171
  v_mfma_f32_16x16x32_bf16 v[180:183], a[24:27], v[120:123], v[180:183]
  s_waitcnt lgkmcnt(6)
  ds_read_b64_tr_b16 a[10:11], v16 offset:10240
  v_mul_f32 v172, v172, v21
  v_mfma_f32_16x16x32_bf16 v[180:183], a[28:31], v[124:127], v[180:183]
  buffer_store_dwordx4 v[48:51], v9, s[12:15], s57 offen offset:2048 sc1
  v_mul_f32 v173, v173, v21
  v_mul_f32 v174, v174, v21
  v_mul_f32 v175, v175, v21
  v_mfma_f32_16x16x32_bf16 v[184:187], a[32:35], v[64:67], 0
  ds_read_b64_tr_b16 a[12:13], v16 offset:12288
  v_cvt_pk_bf16_f32 v54, v172, v173
  v_mfma_f32_16x16x32_bf16 v[184:187], a[36:39], v[68:71], v[184:187]
  s_nop 0
  ds_read_b64_tr_b16 a[14:15], v16 offset:14336
  ds_read_b64_tr_b16 a[16:17], v16 offset:16384
  v_mfma_f32_16x16x32_bf16 v[184:187], a[40:43], v[72:75], v[184:187]
  ds_read_b64_tr_b16 a[18:19], v16 offset:18432
  v_cvt_pk_bf16_f32 v55, v174, v175
  v_mfma_f32_16x16x32_bf16 v[184:187], a[44:47], v[76:79], v[184:187]
  ds_read_b64_tr_b16 a[20:21], v16 offset:20480
  v_mul_f32 v176, v176, v20
  v_mfma_f32_16x16x32_bf16 v[184:187], a[48:51], v[80:83], v[184:187]
  ds_read_b64_tr_b16 a[22:23], v16 offset:22528
  v_mul_f32 v177, v177, v20
  v_mfma_f32_16x16x32_bf16 v[184:187], a[52:55], v[84:87], v[184:187]
  ds_read_b64_tr_b16 a[24:25], v16 offset:24576
  v_mul_f32 v178, v178, v20
  v_mfma_f32_16x16x32_bf16 v[184:187], a[56:59], v[88:91], v[184:187]
  s_waitcnt lgkmcnt(7)
  ds_read_b64_tr_b16 a[26:27], v16 offset:26624
  v_mul_f32 v179, v179, v20
  v_mfma_f32_16x16x32_bf16 v[184:187], a[60:63], v[92:95], v[184:187]
  ds_read_b64_tr_b16 a[28:29], v16 offset:28672
  v_cvt_pk_bf16_f32 v56, v176, v177
  v_mfma_f32_16x16x32_bf16 v[188:191], a[32:35], v[96:99], 0
  ds_read_b64_tr_b16 a[30:31], v16 offset:30720
  v_cvt_pk_bf16_f32 v57, v178, v179
  v_mfma_f32_16x16x32_bf16 v[188:191], a[36:39], v[100:103], v[188:191]
  ds_read_b64_tr_b16 a[32:33], v17 offset:0
  v_mul_f32 v180, v180, v21
  v_mfma_f32_16x16x32_bf16 v[188:191], a[40:43], v[104:107], v[188:191]
  ds_read_b64_tr_b16 a[34:35], v17 offset:2048
  v_mul_f32 v181, v181, v21
  v_mfma_f32_16x16x32_bf16 v[188:191], a[44:47], v[108:111], v[188:191]
  ds_read_b64_tr_b16 a[36:37], v17 offset:4096
  v_mul_f32 v182, v182, v21
  v_mfma_f32_16x16x32_bf16 v[188:191], a[48:51], v[112:115], v[188:191]
  ds_read_b64_tr_b16 a[38:39], v17 offset:6144
  v_mul_f32 v183, v183, v21
  v_mfma_f32_16x16x32_bf16 v[188:191], a[52:55], v[116:119], v[188:191]
  buffer_store_dwordx4 v[52:55], v9, s[12:15], s58 offen offset:2048 sc1
  v_cvt_pk_bf16_f32 v60, v180, v181
  v_cvt_pk_bf16_f32 v61, v182, v183
  v_mfma_f32_16x16x32_bf16 v[188:191], a[56:59], v[120:123], v[188:191]
  ds_read_b64_tr_b16 a[40:41], v17 offset:8192
  v_mfma_f32_16x16x32_bf16 v[188:191], a[60:63], v[124:127], v[188:191]
  s_nop 0
  ds_read_b64_tr_b16 a[42:43], v17 offset:10240
  ds_read_b64_tr_b16 a[44:45], v17 offset:12288
  v_mfma_f32_16x16x32_bf16 v[192:195], a[0:3], v[64:67], 0
  ds_read_b64_tr_b16 a[46:47], v17 offset:14336
  v_mul_f32 v184, v184, v20
  v_mfma_f32_16x16x32_bf16 v[192:195], a[4:7], v[68:71], v[192:195]
  s_mov_b32 s24, 640
  ds_read_b64_tr_b16 a[48:49], v17 offset:16384
  v_mul_f32 v185, v185, v20
  v_mfma_f32_16x16x32_bf16 v[192:195], a[8:11], v[72:75], v[192:195]
  s_waitcnt lgkmcnt(6)
  s_mov_b32 m0, s31
  ds_read_b64_tr_b16 a[50:51], v17 offset:18432
  v_mfma_f32_16x16x32_bf16 v[192:195], a[12:15], v[76:79], v[192:195]
  buffer_load_dwordx4 v4, s[68:71], s24 offen lds
  v_mfma_f32_16x16x32_bf16 v[192:195], a[16:19], v[80:83], v[192:195]
  s_add_u32 m0, m0, 4096
  ds_read_b64_tr_b16 a[52:53], v17 offset:20480
  ds_read_b64_tr_b16 a[54:55], v17 offset:22528
  v_mfma_f32_16x16x32_bf16 v[192:195], a[20:23], v[84:87], v[192:195]
  s_add_u32 s24, s24, s30
  ds_read_b64_tr_b16 a[56:57], v17 offset:24576
  v_mul_f32 v186, v186, v20
  v_mfma_f32_16x16x32_bf16 v[192:195], a[24:27], v[88:91], v[192:195]
  ds_read_b64_tr_b16 a[58:59], v17 offset:26624
  v_mul_f32 v187, v187, v20
  v_mfma_f32_16x16x32_bf16 v[192:195], a[28:31], v[92:95], v[192:195]
  buffer_load_dwordx4 v4, s[68:71], s24 offen lds
  v_mfma_f32_16x16x32_bf16 v[196:199], a[0:3], v[96:99], 0
  s_add_u32 m0, m0, 4096
  ds_read_b64_tr_b16 a[60:61], v17 offset:28672
  ds_read_b64_tr_b16 a[62:63], v17 offset:30720
  v_mfma_f32_16x16x32_bf16 v[196:199], a[4:7], v[100:103], v[196:199]
  s_add_u32 s24, s24, s30
  ds_read_b64_tr_b16 a[0:1], v18 offset:0
  v_cvt_pk_bf16_f32 v58, v184, v185
  v_mfma_f32_16x16x32_bf16 v[196:199], a[8:11], v[104:107], v[196:199]
  ds_read_b64_tr_b16 a[2:3], v18 offset:2048
  v_cvt_pk_bf16_f32 v59, v186, v187
  v_mfma_f32_16x16x32_bf16 v[196:199], a[12:15], v[108:111], v[196:199]
  buffer_store_dwordx4 v[56:59], v9, s[12:15], s57 offen offset:3072 sc1
  s_add_u32 s57, s57, 4096
  v_mul_f32 v188, v188, v21
  v_mul_f32 v189, v189, v21
  v_mfma_f32_16x16x32_bf16 v[196:199], a[16:19], v[112:115], v[196:199]
  ds_read_b64_tr_b16 a[4:5], v18 offset:4096
  v_mul_f32 v190, v190, v21
  v_mfma_f32_16x16x32_bf16 v[196:199], a[20:23], v[116:119], v[196:199]
  buffer_load_dwordx4 v4, s[68:71], s24 offen lds
  v_mfma_f32_16x16x32_bf16 v[196:199], a[24:27], v[120:123], v[196:199]
  s_add_u32 m0, m0, 4096
  ds_read_b64_tr_b16 a[6:7], v18 offset:6144
  ds_read_b64_tr_b16 a[8:9], v18 offset:8192
  v_mfma_f32_16x16x32_bf16 v[196:199], a[28:31], v[124:127], v[196:199]
  s_add_u32 s24, s24, s30
  ds_read_b64_tr_b16 a[10:11], v18 offset:10240
  ds_read_b64_tr_b16 a[12:13], v18 offset:12288
  v_mfma_f32_16x16x32_bf16 v[200:203], a[32:35], v[64:67], 0
  s_waitcnt lgkmcnt(6)
  ds_read_b64_tr_b16 a[14:15], v18 offset:14336
  v_mul_f32 v191, v191, v21
  v_mfma_f32_16x16x32_bf16 v[200:203], a[36:39], v[68:71], v[200:203]
  buffer_load_dwordx4 v4, s[68:71], s24 offen lds
  v_mfma_f32_16x16x32_bf16 v[200:203], a[40:43], v[72:75], v[200:203]
  s_add_u32 m0, m0, 4096
  ds_read_b64_tr_b16 a[16:17], v18 offset:16384
  ds_read_b64_tr_b16 a[18:19], v18 offset:18432
  v_mfma_f32_16x16x32_bf16 v[200:203], a[44:47], v[76:79], v[200:203]
  s_add_u32 s24, s24, s30
  ds_read_b64_tr_b16 a[20:21], v18 offset:20480
  v_cvt_pk_bf16_f32 v62, v188, v189
  v_cvt_pk_bf16_f32 v63, v190, v191
  v_mfma_f32_16x16x32_bf16 v[200:203], a[48:51], v[80:83], v[200:203]
  ds_read_b64_tr_b16 a[22:23], v18 offset:22528
  v_mul_f32 v192, v192, v20
  v_mfma_f32_16x16x32_bf16 v[200:203], a[52:55], v[84:87], v[200:203]
  ds_read_b64_tr_b16 a[24:25], v18 offset:24576
  v_mul_f32 v193, v193, v20
  v_mfma_f32_16x16x32_bf16 v[200:203], a[56:59], v[88:91], v[200:203]
  ds_read_b64_tr_b16 a[26:27], v18 offset:26624
  v_mul_f32 v194, v194, v20
  v_mfma_f32_16x16x32_bf16 v[200:203], a[60:63], v[92:95], v[200:203]
  buffer_load_dwordx4 v4, s[68:71], s24 offen lds
  v_mfma_f32_16x16x32_bf16 v[204:207], a[32:35], v[96:99], 0
  s_add_u32 m0, m0, 4096
  ds_read_b64_tr_b16 a[28:29], v18 offset:28672
  ds_read_b64_tr_b16 a[30:31], v18 offset:30720
  v_mfma_f32_16x16x32_bf16 v[204:207], a[36:39], v[100:103], v[204:207]
  s_add_u32 s24, s24, s30
  ds_read_b64_tr_b16 a[32:33], v19 offset:0
  v_mul_f32 v195, v195, v20
  v_mfma_f32_16x16x32_bf16 v[204:207], a[40:43], v[104:107], v[204:207]
  ds_read_b64_tr_b16 a[34:35], v19 offset:2048
  v_cvt_pk_bf16_f32 v32, v192, v193
  v_mfma_f32_16x16x32_bf16 v[204:207], a[44:47], v[108:111], v[204:207]
  buffer_load_dwordx4 v4, s[68:71], s24 offen lds
  v_mfma_f32_16x16x32_bf16 v[204:207], a[48:51], v[112:115], v[204:207]
  s_add_u32 m0, m0, 4096
  ds_read_b64_tr_b16 a[36:37], v19 offset:4096
  ds_read_b64_tr_b16 a[38:39], v19 offset:6144
  v_cvt_pk_bf16_f32 v33, v194, v195
  v_mfma_f32_16x16x32_bf16 v[204:207], a[52:55], v[116:119], v[204:207]
  s_add_u32 s24, s24, s30
  ds_read_b64_tr_b16 a[40:41], v19 offset:8192
  v_mul_f32 v196, v196, v21
  v_mfma_f32_16x16x32_bf16 v[204:207], a[56:59], v[120:123], v[204:207]
  s_waitcnt lgkmcnt(7)
  ds_read_b64_tr_b16 a[42:43], v19 offset:10240
  v_mul_f32 v197, v197, v21
  v_mfma_f32_16x16x32_bf16 v[204:207], a[60:63], v[124:127], v[204:207]
  buffer_store_dwordx4 v[60:63], v9, s[12:15], s58 offen offset:3072 sc1
  s_add_u32 s58, s58, 4096
  v_mul_f32 v198, v198, v21
  v_mul_f32 v199, v199, v21
  v_mfma_f32_16x16x32_bf16 v[208:211], a[0:3], v[64:67], 0
  ds_read_b64_tr_b16 a[44:45], v19 offset:12288
  v_cvt_pk_bf16_f32 v36, v196, v197
  v_mfma_f32_16x16x32_bf16 v[208:211], a[4:7], v[68:71], v[208:211]
  buffer_load_dwordx4 v4, s[68:71], s24 offen lds
  v_mfma_f32_16x16x32_bf16 v[208:211], a[8:11], v[72:75], v[208:211]
  s_add_u32 m0, m0, 4096
  ds_read_b64_tr_b16 a[46:47], v19 offset:14336
  ds_read_b64_tr_b16 a[48:49], v19 offset:16384
  v_mfma_f32_16x16x32_bf16 v[208:211], a[12:15], v[76:79], v[208:211]
  s_add_u32 s24, s24, s30
  ds_read_b64_tr_b16 a[50:51], v19 offset:18432
  ds_read_b64_tr_b16 a[52:53], v19 offset:20480
  v_cvt_pk_bf16_f32 v37, v198, v199
  v_mfma_f32_16x16x32_bf16 v[208:211], a[16:19], v[80:83], v[208:211]
  ds_read_b64_tr_b16 a[54:55], v19 offset:22528
  v_mul_f32 v200, v200, v20
  v_mfma_f32_16x16x32_bf16 v[208:211], a[20:23], v[84:87], v[208:211]
  buffer_load_dwordx4 v4, s[68:71], s24 offen lds
  v_mfma_f32_16x16x32_bf16 v[208:211], a[24:27], v[88:91], v[208:211]
  s_waitcnt lgkmcnt(6)
  ds_read_b64_tr_b16 a[56:57], v19 offset:24576
  ds_read_b64_tr_b16 a[58:59], v19 offset:26624
  v_mfma_f32_16x16x32_bf16 v[208:211], a[28:31], v[92:95], v[208:211]
  s_add_u32 s31, s31, 32768
  ds_read_b64_tr_b16 a[60:61], v19 offset:28672
  v_mul_f32 v201, v201, v20
  v_mfma_f32_16x16x32_bf16 v[212:215], a[0:3], v[96:99], 0
  s_waitcnt vmcnt(24)
  ds_read_b64_tr_b16 a[62:63], v19 offset:30720
  v_mfma_f32_16x16x32_bf16 v[212:215], a[4:7], v[100:103], v[212:215]
  s_barrier
  v_mfma_f32_16x16x32_bf16 v[212:215], a[8:11], v[104:107], v[212:215]
  s_and_b32 s31, s31, 0x1ffff
  ds_read_b64_tr_b16 a[0:1], v16 offset:32768
  ds_read_b64_tr_b16 a[2:3], v16 offset:34816
  v_mfma_f32_16x16x32_bf16 v[212:215], a[12:15], v[108:111], v[212:215]
  ds_read_b64_tr_b16 a[4:5], v16 offset:36864
  v_mul_f32 v202, v202, v20
  v_mul_f32 v203, v203, v20
  v_mfma_f32_16x16x32_bf16 v[212:215], a[16:19], v[112:115], v[212:215]
  ds_read_b64_tr_b16 a[6:7], v16 offset:38912
  v_cvt_pk_bf16_f32 v34, v200, v201
  v_cvt_pk_bf16_f32 v35, v202, v203
  v_mfma_f32_16x16x32_bf16 v[212:215], a[20:23], v[116:119], v[212:215]
  ds_read_b64_tr_b16 a[8:9], v16 offset:40960
  v_mul_f32 v204, v204, v21
  v_mfma_f32_16x16x32_bf16 v[212:215], a[24:27], v[120:123], v[212:215]
  ds_read_b64_tr_b16 a[10:11], v16 offset:43008
  v_mul_f32 v205, v205, v21
  v_mfma_f32_16x16x32_bf16 v[212:215], a[28:31], v[124:127], v[212:215]
  buffer_store_dwordx4 v[32:35], v9, s[12:15], s57 offen offset:0 sc1
  v_mul_f32 v206, v206, v21
  v_mul_f32 v207, v207, v21
  v_cvt_pk_bf16_f32 v38, v204, v205
  v_mfma_f32_16x16x32_bf16 v[216:219], a[32:35], v[64:67], 0
  ds_read_b64_tr_b16 a[12:13], v16 offset:45056
  v_cvt_pk_bf16_f32 v39, v206, v207
  v_mfma_f32_16x16x32_bf16 v[216:219], a[36:39], v[68:71], v[216:219]
  s_nop 0
  ds_read_b64_tr_b16 a[14:15], v16 offset:47104
  ds_read_b64_tr_b16 a[16:17], v16 offset:49152
  v_mfma_f32_16x16x32_bf16 v[216:219], a[40:43], v[72:75], v[216:219]
  s_waitcnt lgkmcnt(6)
  ds_read_b64_tr_b16 a[18:19], v16 offset:51200
  v_mul_f32 v208, v208, v20
  v_mfma_f32_16x16x32_bf16 v[216:219], a[44:47], v[76:79], v[216:219]
  ds_read_b64_tr_b16 a[20:21], v16 offset:53248
  v_mul_f32 v209, v209, v20
  v_mfma_f32_16x16x32_bf16 v[216:219], a[48:51], v[80:83], v[216:219]
  ds_read_b64_tr_b16 a[22:23], v16 offset:55296
  v_mul_f32 v210, v210, v20
  v_mfma_f32_16x16x32_bf16 v[216:219], a[52:55], v[84:87], v[216:219]
  ds_read_b64_tr_b16 a[24:25], v16 offset:57344
  v_mul_f32 v211, v211, v20
  v_mfma_f32_16x16x32_bf16 v[216:219], a[56:59], v[88:91], v[216:219]
  ds_read_b64_tr_b16 a[26:27], v16 offset:59392
  v_cvt_pk_bf16_f32 v40, v208, v209
  v_mfma_f32_16x16x32_bf16 v[216:219], a[60:63], v[92:95], v[216:219]
  ds_read_b64_tr_b16 a[28:29], v16 offset:61440
  v_cvt_pk_bf16_f32 v41, v210, v211
  v_mfma_f32_16x16x32_bf16 v[220:223], a[32:35], v[96:99], 0
  ds_read_b64_tr_b16 a[30:31], v16 offset:63488
  v_xor_b32 v16, 0x10000, v16
  v_mfma_f32_16x16x32_bf16 v[220:223], a[36:39], v[100:103], v[220:223]
  ds_read_b64_tr_b16 a[32:33], v17 offset:32768
  v_mul_f32 v212, v212, v21
  v_mfma_f32_16x16x32_bf16 v[220:223], a[40:43], v[104:107], v[220:223]
  ds_read_b64_tr_b16 a[34:35], v17 offset:34816
  v_mul_f32 v213, v213, v21
  v_mfma_f32_16x16x32_bf16 v[220:223], a[44:47], v[108:111], v[220:223]
  ds_read_b64_tr_b16 a[36:37], v17 offset:36864
  v_mul_f32 v214, v214, v21
  v_mfma_f32_16x16x32_bf16 v[220:223], a[48:51], v[112:115], v[220:223]
  ds_read_b64_tr_b16 a[38:39], v17 offset:38912
  v_mul_f32 v215, v215, v21
  v_mfma_f32_16x16x32_bf16 v[220:223], a[52:55], v[116:119], v[220:223]
  buffer_store_dwordx4 v[36:39], v9, s[12:15], s58 offen offset:0 sc1
  v_cvt_pk_bf16_f32 v44, v212, v213
  v_cvt_pk_bf16_f32 v45, v214, v215
  v_mfma_f32_16x16x32_bf16 v[220:223], a[56:59], v[120:123], v[220:223]
  ds_read_b64_tr_b16 a[40:41], v17 offset:40960
  v_mfma_f32_16x16x32_bf16 v[220:223], a[60:63], v[124:127], v[220:223]
  s_nop 0
  ds_read_b64_tr_b16 a[42:43], v17 offset:43008
  ds_read_b64_tr_b16 a[44:45], v17 offset:45056
  v_mfma_f32_16x16x32_bf16 v[224:227], a[0:3], v[64:67], 0
  s_waitcnt lgkmcnt(6)
  ds_read_b64_tr_b16 a[46:47], v17 offset:47104
  v_mul_f32 v216, v216, v20
  v_mfma_f32_16x16x32_bf16 v[224:227], a[4:7], v[68:71], v[224:227]
  s_mov_b32 s24, 768
  ds_read_b64_tr_b16 a[48:49], v17 offset:49152
  v_mul_f32 v217, v217, v20
  v_mfma_f32_16x16x32_bf16 v[224:227], a[8:11], v[72:75], v[224:227]
  s_mov_b32 m0, s31
  ds_read_b64_tr_b16 a[50:51], v17 offset:51200
  v_mul_f32 v218, v218, v20
  v_mfma_f32_16x16x32_bf16 v[224:227], a[12:15], v[76:79], v[224:227]
  buffer_load_dwordx4 v4, s[68:71], s24 offen lds
  v_mfma_f32_16x16x32_bf16 v[224:227], a[16:19], v[80:83], v[224:227]
  s_add_u32 m0, m0, 4096
  ds_read_b64_tr_b16 a[52:53], v17 offset:53248
  ds_read_b64_tr_b16 a[54:55], v17 offset:55296
  v_mfma_f32_16x16x32_bf16 v[224:227], a[20:23], v[84:87], v[224:227]
  s_add_u32 s24, s24, s30
  ds_read_b64_tr_b16 a[56:57], v17 offset:57344
  v_mul_f32 v219, v219, v20
  v_mfma_f32_16x16x32_bf16 v[224:227], a[24:27], v[88:91], v[224:227]
  ds_read_b64_tr_b16 a[58:59], v17 offset:59392
  v_cvt_pk_bf16_f32 v42, v216, v217
  v_mfma_f32_16x16x32_bf16 v[224:227], a[28:31], v[92:95], v[224:227]
  buffer_load_dwordx4 v4, s[68:71], s24 offen lds
  v_mfma_f32_16x16x32_bf16 v[228:231], a[0:3], v[96:99], 0
  s_add_u32 m0, m0, 4096
  ds_read_b64_tr_b16 a[60:61], v17 offset:61440
  ds_read_b64_tr_b16 a[62:63], v17 offset:63488
  v_mfma_f32_16x16x32_bf16 v[228:231], a[4:7], v[100:103], v[228:231]
  s_add_u32 s24, s24, s30
  ds_read_b64_tr_b16 a[0:1], v18 offset:32768
  v_xor_b32 v17, 0x10000, v17
  v_mfma_f32_16x16x32_bf16 v[228:231], a[8:11], v[104:107], v[228:231]
  s_load_dwordx2 s[76:77], s[0:1], 0
  ds_read_b64_tr_b16 a[2:3], v18 offset:34816
  v_cvt_pk_bf16_f32 v43, v218, v219
  v_mfma_f32_16x16x32_bf16 v[228:231], a[12:15], v[108:111], v[228:231]
  buffer_store_dwordx4 v[40:43], v9, s[12:15], s57 offen offset:1024 sc1
  v_mul_f32 v220, v220, v21
  v_mul_f32 v221, v221, v21
  v_mul_f32 v222, v222, v21
  v_mfma_f32_16x16x32_bf16 v[228:231], a[16:19], v[112:115], v[228:231]
  s_waitcnt lgkmcnt(5)
  ds_read_b64_tr_b16 a[4:5], v18 offset:36864
  v_mul_f32 v223, v223, v21
  v_mfma_f32_16x16x32_bf16 v[228:231], a[20:23], v[116:119], v[228:231]
  buffer_load_dwordx4 v4, s[68:71], s24 offen lds
  v_mfma_f32_16x16x32_bf16 v[228:231], a[24:27], v[120:123], v[228:231]
  s_add_u32 m0, m0, 4096
  ds_read_b64_tr_b16 a[6:7], v18 offset:38912
  ds_read_b64_tr_b16 a[8:9], v18 offset:40960
  v_mfma_f32_16x16x32_bf16 v[228:231], a[28:31], v[124:127], v[228:231]
  s_add_u32 s24, s24, s30
  ds_read_b64_tr_b16 a[10:11], v18 offset:43008
  ds_read_b64_tr_b16 a[12:13], v18 offset:45056
  v_mfma_f32_16x16x32_bf16 v[232:235], a[32:35], v[64:67], 0
  s_load_dwordx4 s[4:7], s[0:1], 56
  ds_read_b64_tr_b16 a[14:15], v18 offset:47104
  v_cvt_pk_bf16_f32 v46, v220, v221
  v_mfma_f32_16x16x32_bf16 v[232:235], a[36:39], v[68:71], v[232:235]
  buffer_load_dwordx4 v4, s[68:71], s24 offen lds
  v_mfma_f32_16x16x32_bf16 v[232:235], a[40:43], v[72:75], v[232:235]
  s_add_u32 m0, m0, 4096
  ds_read_b64_tr_b16 a[16:17], v18 offset:49152
  ds_read_b64_tr_b16 a[18:19], v18 offset:51200
  v_mfma_f32_16x16x32_bf16 v[232:235], a[44:47], v[76:79], v[232:235]
  s_add_u32 s24, s24, s30
  ds_read_b64_tr_b16 a[20:21], v18 offset:53248
  v_cvt_pk_bf16_f32 v47, v222, v223
  v_mfma_f32_16x16x32_bf16 v[232:235], a[48:51], v[80:83], v[232:235]
  s_load_dwordx4 s[8:11], s[0:1], 72
  ds_read_b64_tr_b16 a[22:23], v18 offset:55296
  v_mul_f32 v224, v224, v20
  v_mfma_f32_16x16x32_bf16 v[232:235], a[52:55], v[84:87], v[232:235]
  s_waitcnt lgkmcnt(7)
  ds_read_b64_tr_b16 a[24:25], v18 offset:57344
  v_mul_f32 v225, v225, v20
  v_mfma_f32_16x16x32_bf16 v[232:235], a[56:59], v[88:91], v[232:235]
  s_load_dwordx2 s[84:85], s[0:1], 88
  ds_read_b64_tr_b16 a[26:27], v18 offset:59392
  v_mul_f32 v226, v226, v20
  v_mfma_f32_16x16x32_bf16 v[232:235], a[60:63], v[92:95], v[232:235]
  buffer_load_dwordx4 v4, s[68:71], s24 offen lds
  v_mfma_f32_16x16x32_bf16 v[236:239], a[32:35], v[96:99], 0
  s_add_u32 m0, m0, 4096
  ds_read_b64_tr_b16 a[28:29], v18 offset:61440
  ds_read_b64_tr_b16 a[30:31], v18 offset:63488
  v_mfma_f32_16x16x32_bf16 v[236:239], a[36:39], v[100:103], v[236:239]
  s_add_u32 s24, s24, s30
  ds_read_b64_tr_b16 a[32:33], v19 offset:32768
  v_xor_b32 v18, 0x10000, v18
  v_mfma_f32_16x16x32_bf16 v[236:239], a[40:43], v[104:107], v[236:239]
  s_lshl_b32 s61, s40, 1
  ds_read_b64_tr_b16 a[34:35], v19 offset:34816
  v_mul_f32 v227, v227, v20
  v_mfma_f32_16x16x32_bf16 v[236:239], a[44:47], v[108:111], v[236:239]
  buffer_load_dwordx4 v4, s[68:71], s24 offen lds
  v_mfma_f32_16x16x32_bf16 v[236:239], a[48:51], v[112:115], v[236:239]
  s_add_u32 m0, m0, 4096
  ds_read_b64_tr_b16 a[36:37], v19 offset:36864
  ds_read_b64_tr_b16 a[38:39], v19 offset:38912
  v_cvt_pk_bf16_f32 v48, v224, v225
  v_mfma_f32_16x16x32_bf16 v[236:239], a[52:55], v[116:119], v[236:239]
  s_add_u32 s24, s24, s30
  ds_read_b64_tr_b16 a[40:41], v19 offset:40960
  v_cvt_pk_bf16_f32 v49, v226, v227
  v_mfma_f32_16x16x32_bf16 v[236:239], a[56:59], v[120:123], v[236:239]
  s_bfe_u32 s62, s2, 0x10003
  ds_read_b64_tr_b16 a[42:43], v19 offset:43008
  v_mul_f32 v228, v228, v21
  v_mfma_f32_16x16x32_bf16 v[236:239], a[60:63], v[124:127], v[236:239]
  buffer_store_dwordx4 v[44:47], v9, s[12:15], s58 offen offset:1024 sc1
  v_mul_f32 v229, v229, v21
  v_mul_f32 v230, v230, v21
  v_mul_f32 v231, v231, v21
  v_mfma_f32_16x16x32_bf16 v[240:243], a[0:3], v[64:67], 0
  s_waitcnt lgkmcnt(5)
  ds_read_b64_tr_b16 a[44:45], v19 offset:45056
  v_cvt_pk_bf16_f32 v52, v228, v229
  v_mfma_f32_16x16x32_bf16 v[240:243], a[4:7], v[68:71], v[240:243]
  buffer_load_dwordx4 v4, s[68:71], s24 offen lds
  v_mfma_f32_16x16x32_bf16 v[240:243], a[8:11], v[72:75], v[240:243]
  s_add_u32 m0, m0, 4096
  ds_read_b64_tr_b16 a[46:47], v19 offset:47104
  ds_read_b64_tr_b16 a[48:49], v19 offset:49152
  v_mfma_f32_16x16x32_bf16 v[240:243], a[12:15], v[76:79], v[240:243]
  s_add_u32 s24, s24, s30
  ds_read_b64_tr_b16 a[50:51], v19 offset:51200
  ds_read_b64_tr_b16 a[52:53], v19 offset:53248
  v_cvt_pk_bf16_f32 v53, v230, v231
  v_mfma_f32_16x16x32_bf16 v[240:243], a[16:19], v[80:83], v[240:243]
  s_add_u32 s61, s61, s62
  ds_read_b64_tr_b16 a[54:55], v19 offset:55296
  v_mul_f32 v232, v232, v20
  v_mfma_f32_16x16x32_bf16 v[240:243], a[20:23], v[84:87], v[240:243]
  buffer_load_dwordx4 v4, s[68:71], s24 offen lds
  v_mfma_f32_16x16x32_bf16 v[240:243], a[24:27], v[88:91], v[240:243]
  s_add_u32 s31, s31, 32768
  ds_read_b64_tr_b16 a[56:57], v19 offset:57344
  ds_read_b64_tr_b16 a[58:59], v19 offset:59392
  v_mfma_f32_16x16x32_bf16 v[240:243], a[28:31], v[92:95], v[240:243]
  s_and_b32 s31, s31, 0x1ffff
  ds_read_b64_tr_b16 a[60:61], v19 offset:61440
  v_mul_f32 v233, v233, v20
  v_mfma_f32_16x16x32_bf16 v[244:247], a[0:3], v[96:99], 0
  s_waitcnt vmcnt(24)
  ds_read_b64_tr_b16 a[62:63], v19 offset:63488
  v_mfma_f32_16x16x32_bf16 v[244:247], a[4:7], v[100:103], v[244:247]
  s_barrier
  v_mfma_f32_16x16x32_bf16 v[244:247], a[8:11], v[104:107], v[244:247]
  s_mul_i32 s62, s61, 43
  ds_read_b64_tr_b16 a[0:1], v16 offset:0
  ds_read_b64_tr_b16 a[2:3], v16 offset:2048
  v_mfma_f32_16x16x32_bf16 v[244:247], a[12:15], v[108:111], v[244:247]
  ds_read_b64_tr_b16 a[4:5], v16 offset:4096
  v_xor_b32 v19, 0x10000, v19
  v_mul_f32 v234, v234, v20
  v_mfma_f32_16x16x32_bf16 v[244:247], a[16:19], v[112:115], v[244:247]
  ds_read_b64_tr_b16 a[6:7], v16 offset:6144
  v_mul_f32 v235, v235, v20
  v_cvt_pk_bf16_f32 v50, v232, v233
  v_mfma_f32_16x16x32_bf16 v[244:247], a[20:23], v[116:119], v[244:247]
  s_lshr_b32 s62, s62, 7
  ds_read_b64_tr_b16 a[8:9], v16 offset:8192
  v_cvt_pk_bf16_f32 v51, v234, v235
  v_mfma_f32_16x16x32_bf16 v[244:247], a[24:27], v[120:123], v[244:247]
  s_waitcnt lgkmcnt(6)
  ds_read_b64_tr_b16 a[10:11], v16 offset:10240
  v_mul_f32 v236, v236, v21
  v_mfma_f32_16x16x32_bf16 v[244:247], a[28:31], v[124:127], v[244:247]
  buffer_store_dwordx4 v[48:51], v9, s[12:15], s57 offen offset:2048 sc1
  v_mul_f32 v237, v237, v21
  v_mul_f32 v238, v238, v21
  v_mul_f32 v239, v239, v21
  v_mfma_f32_16x16x32_bf16 v[248:251], a[32:35], v[64:67], 0
  s_mul_i32 s63, s62, 3
  ds_read_b64_tr_b16 a[12:13], v16 offset:12288
  v_cvt_pk_bf16_f32 v54, v236, v237
  v_mfma_f32_16x16x32_bf16 v[248:251], a[36:39], v[68:71], v[248:251]
  s_sub_u32 s63, s61, s63
  ds_read_b64_tr_b16 a[14:15], v16 offset:14336
  ds_read_b64_tr_b16 a[16:17], v16 offset:16384
  v_mfma_f32_16x16x32_bf16 v[248:251], a[40:43], v[72:75], v[248:251]
  s_and_b32 s3, s61, 3
  ds_read_b64_tr_b16 a[18:19], v16 offset:18432
  v_cvt_pk_bf16_f32 v55, v238, v239
  v_mfma_f32_16x16x32_bf16 v[248:251], a[44:47], v[76:79], v[248:251]
  s_lshr_b32 s61, s61, 2
  ds_read_b64_tr_b16 a[20:21], v16 offset:20480
  v_mul_f32 v240, v240, v20
  v_mfma_f32_16x16x32_bf16 v[248:251], a[48:51], v[80:83], v[248:251]
  s_bitcmp1_b32 s2, 2
  s_cmov_b32 s3, s63
  s_cmov_b32 s61, s62
  ds_read_b64_tr_b16 a[22:23], v16 offset:22528
  v_mul_f32 v241, v241, v20
  v_mfma_f32_16x16x32_bf16 v[248:251], a[52:55], v[84:87], v[248:251]
  s_and_b32 s63, s2, 7
  ds_read_b64_tr_b16 a[24:25], v16 offset:24576
  v_mul_f32 v242, v242, v20
  v_mfma_f32_16x16x32_bf16 v[248:251], a[56:59], v[88:91], v[248:251]
  s_waitcnt lgkmcnt(7)
  ds_read_b64_tr_b16 a[26:27], v16 offset:26624
  v_mul_f32 v243, v243, v20
  v_mfma_f32_16x16x32_bf16 v[248:251], a[60:63], v[92:95], v[248:251]
  s_mul_i32 s26, s63, 3
  ds_read_b64_tr_b16 a[28:29], v16 offset:28672
  v_cvt_pk_bf16_f32 v56, v240, v241
  v_mfma_f32_16x16x32_bf16 v[252:255], a[32:35], v[96:99], 0
  s_min_u32 s63, s63, 4
  ds_read_b64_tr_b16 a[30:31], v16 offset:30720
  v_cvt_pk_bf16_f32 v57, v242, v243
  v_mfma_f32_16x16x32_bf16 v[252:255], a[36:39], v[100:103], v[252:255]
  s_add_u32 s26, s26, s63
  ds_read_b64_tr_b16 a[32:33], v17 offset:0
  v_mul_f32 v244, v244, v21
  v_mfma_f32_16x16x32_bf16 v[252:255], a[40:43], v[104:107], v[252:255]
  s_add_u32 s26, s26, s3
  ds_read_b64_tr_b16 a[34:35], v17 offset:2048
  v_mul_f32 v245, v245, v21
  v_mfma_f32_16x16x32_bf16 v[252:255], a[44:47], v[108:111], v[252:255]
  s_lshl_b32 s64, s3, 1
  ds_read_b64_tr_b16 a[36:37], v17 offset:4096
  v_mul_f32 v246, v246, v21
  v_mfma_f32_16x16x32_bf16 v[252:255], a[48:51], v[112:115], v[252:255]
  s_add_u32 s64, s64, s61
  ds_read_b64_tr_b16 a[38:39], v17 offset:6144
  v_mul_f32 v247, v247, v21
  v_mfma_f32_16x16x32_bf16 v[252:255], a[52:55], v[116:119], v[252:255]
  buffer_store_dwordx4 v[52:55], v9, s[12:15], s58 offen offset:2048 sc1
  v_cvt_pk_bf16_f32 v60, v244, v245
  v_cvt_pk_bf16_f32 v61, v246, v247
  v_mfma_f32_16x16x32_bf16 v[252:255], a[56:59], v[120:123], v[252:255]
  s_sub_u32 s62, s64, 7
  s_cmp_ge_u32 s64, 7
  s_cmov_b32 s64, s62
  ds_read_b64_tr_b16 a[40:41], v17 offset:8192
  v_mfma_f32_16x16x32_bf16 v[252:255], a[60:63], v[124:127], v[252:255]
  s_cmp_ge_u32 s61, 7
  s_cmov_b32 s26, 99
  ds_read_b64_tr_b16 a[42:43], v17 offset:10240
  ds_read_b64_tr_b16 a[44:45], v17 offset:12288
  v_mfma_f32_16x16x32_bf16 v[128:131], a[0:3], v[64:67], 0
  s_and_b32 s63, s2, 4
  ds_read_b64_tr_b16 a[46:47], v17 offset:14336
  v_mul_f32 v248, v248, v20
  v_mfma_f32_16x16x32_bf16 v[128:131], a[4:7], v[68:71], v[128:131]
  s_add_u32 s3, s3, s63
  ds_read_b64_tr_b16 a[48:49], v17 offset:16384
  v_mul_f32 v249, v249, v20
  v_mfma_f32_16x16x32_bf16 v[128:131], a[8:11], v[72:75], v[128:131]
  s_waitcnt lgkmcnt(6)
  ds_read_b64_tr_b16 a[50:51], v17 offset:18432
  v_mul_f32 v250, v250, v20
  v_mfma_f32_16x16x32_bf16 v[128:131], a[12:15], v[76:79], v[128:131]
  s_and_b32 s62, s2, 3
  ds_read_b64_tr_b16 a[52:53], v17 offset:20480
  v_mul_f32 v251, v251, v20
  v_mfma_f32_16x16x32_bf16 v[128:131], a[16:19], v[80:83], v[128:131]
  s_lshl_b32 s62, s62, 3
  ds_read_b64_tr_b16 a[54:55], v17 offset:22528
  v_cvt_pk_bf16_f32 v58, v248, v249
  v_mfma_f32_16x16x32_bf16 v[128:131], a[20:23], v[84:87], v[128:131]
  s_add_u32 s27, s62, s61
  ds_read_b64_tr_b16 a[56:57], v17 offset:24576
  v_cvt_pk_bf16_f32 v59, v250, v251
  v_mfma_f32_16x16x32_bf16 v[128:131], a[24:27], v[88:91], v[128:131]
  s_cmp_ge_u32 s61, 8
  s_cmov_b32 s27, 99
  ds_read_b64_tr_b16 a[58:59], v17 offset:26624
  v_lshrrev_b32 v22, 3, v1
  v_mfma_f32_16x16x32_bf16 v[128:131], a[28:31], v[92:95], v[128:131]
  s_lshl_b32 s66, s20, 13
  ds_read_b64_tr_b16 a[60:61], v17 offset:28672
  v_mul_f32 v252, v252, v21
  v_mfma_f32_16x16x32_bf16 v[132:135], a[0:3], v[96:99], 0
  s_mov_b32 s41, s66
  ds_read_b64_tr_b16 a[62:63], v17 offset:30720
  v_mul_f32 v253, v253, v21
  v_mfma_f32_16x16x32_bf16 v[132:135], a[4:7], v[100:103], v[132:135]
  s_add_u32 s65, s41, 0x10000
  ds_read_b64_tr_b16 a[0:1], v18 offset:0
  v_mul_f32 v254, v254, v21
  v_mfma_f32_16x16x32_bf16 v[132:135], a[8:11], v[104:107], v[132:135]
  s_add_u32 s66, s66, 131072
  ds_read_b64_tr_b16 a[2:3], v18 offset:2048
  v_mul_f32 v255, v255, v21
  v_mfma_f32_16x16x32_bf16 v[132:135], a[12:15], v[108:111], v[132:135]
  buffer_store_dwordx4 v[56:59], v9, s[12:15], s57 offen offset:3072 sc1
  s_add_u32 s57, s57, 4096
  v_cvt_pk_bf16_f32 v62, v252, v253
  v_cvt_pk_bf16_f32 v63, v254, v255
  v_mfma_f32_16x16x32_bf16 v[132:135], a[16:19], v[112:115], v[132:135]
  s_lshl_b32 s42, s40, 4
  ds_read_b64_tr_b16 a[4:5], v18 offset:4096
  v_and_b32 v23, 1, v1
  v_mfma_f32_16x16x32_bf16 v[132:135], a[20:23], v[116:119], v[132:135]
  s_add_u32 s42, s42, s21
  ds_read_b64_tr_b16 a[6:7], v18 offset:6144
  ds_read_b64_tr_b16 a[8:9], v18 offset:8192
  v_mfma_f32_16x16x32_bf16 v[132:135], a[24:27], v[120:123], v[132:135]
  s_mul_i32 s38, s20, 114688
  ds_read_b64_tr_b16 a[10:11], v18 offset:10240
  v_bfe_u32 v24, v1, 1, 2
  v_mfma_f32_16x16x32_bf16 v[132:135], a[28:31], v[124:127], v[132:135]
  s_add_u32 s38, s38, 458752
  ds_read_b64_tr_b16 a[12:13], v18 offset:12288
  v_mul_f32 v128, v128, v20
  v_mfma_f32_16x16x32_bf16 v[136:139], a[32:35], v[64:67], 0
  s_waitcnt lgkmcnt(6)
  ds_read_b64_tr_b16 a[14:15], v18 offset:14336
  v_mul_f32 v129, v129, v20
  v_mfma_f32_16x16x32_bf16 v[136:139], a[36:39], v[68:71], v[136:139]
  s_lshl_b32 s61, s26, 7
  ds_read_b64_tr_b16 a[16:17], v18 offset:16384
  v_mul_f32 v130, v130, v20
  v_mfma_f32_16x16x32_bf16 v[136:139], a[40:43], v[72:75], v[136:139]
  s_add_u32 s38, s38, s61
  ds_read_b64_tr_b16 a[18:19], v18 offset:18432
  v_mul_f32 v131, v131, v20
  v_mfma_f32_16x16x32_bf16 v[136:139], a[44:47], v[76:79], v[136:139]
  s_waitcnt lgkmcnt(0)
  ds_read_b64_tr_b16 a[20:21], v18 offset:20480
  v_cvt_pk_bf16_f32 v32, v128, v129
  v_mfma_f32_16x16x32_bf16 v[136:139], a[48:51], v[80:83], v[136:139]
  s_mov_b64 s[72:73], s[6:7]
  ds_read_b64_tr_b16 a[22:23], v18 offset:22528
  v_cvt_pk_bf16_f32 v33, v130, v131
  v_mfma_f32_16x16x32_bf16 v[136:139], a[52:55], v[84:87], v[136:139]
  s_cmp_lt_u32 s26, 28
  s_cselect_b32 s6, 7340032, 0
  ds_read_b64_tr_b16 a[24:25], v18 offset:24576
  v_mul_u32_u24 v10, 3584, v22
  v_mfma_f32_16x16x32_bf16 v[136:139], a[56:59], v[88:91], v[136:139]
  s_mov_b32 s7, 0x20000
  ds_read_b64_tr_b16 a[26:27], v18 offset:26624
  v_lshl_add_u32 v10, v23, 4, v10
  v_mfma_f32_16x16x32_bf16 v[136:139], a[60:63], v[92:95], v[136:139]
  s_cmp_eq_u32 s20, 3
  s_cselect_b32 s46, 0x7fff0000, 0
  ds_read_b64_tr_b16 a[28:29], v18 offset:28672
  v_mul_f32 v132, v132, v21
  v_mfma_f32_16x16x32_bf16 v[140:143], a[32:35], v[96:99], 0
  s_lshl_b32 s61, s40, 2
  ds_read_b64_tr_b16 a[30:31], v18 offset:30720
  v_mul_f32 v133, v133, v21
  v_mfma_f32_16x16x32_bf16 v[140:143], a[36:39], v[100:103], v[140:143]
  s_add_u32 s45, s61, s20
  ds_read_b64_tr_b16 a[32:33], v19 offset:0
  v_mul_f32 v134, v134, v21
  v_mfma_f32_16x16x32_bf16 v[140:143], a[40:43], v[104:107], v[140:143]
  s_lshl_b32 s45, s45, 4
  ds_read_b64_tr_b16 a[34:35], v19 offset:2048
  v_mul_f32 v135, v135, v21
  v_mfma_f32_16x16x32_bf16 v[140:143], a[44:47], v[108:111], v[140:143]
  s_add_u32 s45, s45, s21
  ds_read_b64_tr_b16 a[36:37], v19 offset:4096
  v_cvt_pk_bf16_f32 v36, v132, v133
  v_mfma_f32_16x16x32_bf16 v[140:143], a[48:51], v[112:115], v[140:143]
  s_lshl_b32 s45, s45, 7
  ds_read_b64_tr_b16 a[38:39], v19 offset:6144
  v_cvt_pk_bf16_f32 v37, v134, v135
  v_mfma_f32_16x16x32_bf16 v[140:143], a[52:55], v[116:119], v[140:143]
  s_add_u32 s45, s45, 94371840
  ds_read_b64_tr_b16 a[40:41], v19 offset:8192
  v_bfe_u32 v25, v1, 4, 1
  v_mfma_f32_16x16x32_bf16 v[140:143], a[56:59], v[120:123], v[140:143]
  s_waitcnt lgkmcnt(6)
  ds_read_b64_tr_b16 a[42:43], v19 offset:10240
  v_xor_b32 v25, v25, v24
  v_mfma_f32_16x16x32_bf16 v[140:143], a[60:63], v[124:127], v[140:143]
  buffer_store_dwordx4 v[60:63], v9, s[12:15], s58 offen offset:3072 sc1
  s_add_u32 s58, s58, 4096
  v_mul_f32 v136, v136, v20
  v_mul_f32 v137, v137, v20
  v_mfma_f32_16x16x32_bf16 v[144:147], a[0:3], v[64:67], 0
  s_bfe_u32 s62, s21, 0x20001
  ds_read_b64_tr_b16 a[44:45], v19 offset:12288
  v_mul_f32 v138, v138, v20
  v_mfma_f32_16x16x32_bf16 v[144:147], a[4:7], v[68:71], v[144:147]
  s_add_u32 s43, s61, s62
  ds_read_b64_tr_b16 a[46:47], v19 offset:14336
  ds_read_b64_tr_b16 a[48:49], v19 offset:16384
  v_mfma_f32_16x16x32_bf16 v[144:147], a[8:11], v[72:75], v[144:147]
  s_lshl_b32 s43, s43, 11
  ds_read_b64_tr_b16 a[50:51], v19 offset:18432
  v_mul_f32 v139, v139, v20
  v_mfma_f32_16x16x32_bf16 v[144:147], a[12:15], v[76:79], v[144:147]
  s_add_u32 s43, s43, 94371840
  ds_read_b64_tr_b16 a[52:53], v19 offset:20480
  v_cvt_pk_bf16_f32 v34, v136, v137
  v_mfma_f32_16x16x32_bf16 v[144:147], a[16:19], v[80:83], v[144:147]
  s_lshr_b32 s39, s42, 1
  ds_read_b64_tr_b16 a[54:55], v19 offset:22528
  v_cvt_pk_bf16_f32 v35, v138, v139
  v_mfma_f32_16x16x32_bf16 v[144:147], a[20:23], v[84:87], v[144:147]
  s_mul_i32 s39, s39, 229376
  ds_read_b64_tr_b16 a[56:57], v19 offset:24576
  v_lshl_add_u32 v10, v25, 5, v10
  v_mfma_f32_16x16x32_bf16 v[144:147], a[24:27], v[88:91], v[144:147]
  s_waitcnt lgkmcnt(7)
  ds_read_b64_tr_b16 a[58:59], v19 offset:26624
  v_xor_b32 v11, 64, v10
  v_mfma_f32_16x16x32_bf16 v[144:147], a[28:31], v[92:95], v[144:147]
  s_and_b32 s61, s42, 1
  ds_read_b64_tr_b16 a[60:61], v19 offset:28672
  v_mul_f32 v140, v140, v21
  v_mfma_f32_16x16x32_bf16 v[148:151], a[0:3], v[96:99], 0
  s_waitcnt vmcnt(16)
  ds_read_b64_tr_b16 a[62:63], v19 offset:30720
  v_mfma_f32_16x16x32_bf16 v[148:151], a[4:7], v[100:103], v[148:151]
  s_barrier
  v_mfma_f32_16x16x32_bf16 v[148:151], a[8:11], v[104:107], v[148:151]
  s_lshl_b32 s61, s61, 7
  ds_read_b64_tr_b16 a[0:1], v16 offset:32768
  ds_read_b64_tr_b16 a[2:3], v16 offset:34816
  v_mfma_f32_16x16x32_bf16 v[148:151], a[12:15], v[108:111], v[148:151]
  s_add_u32 s39, s39, s61
  ds_read_b64_tr_b16 a[4:5], v16 offset:36864
  v_mul_f32 v141, v141, v21
  v_mfma_f32_16x16x32_bf16 v[148:151], a[16:19], v[112:115], v[148:151]
  s_add_u32 s39, s39, 45088768
  ds_read_b64_tr_b16 a[6:7], v16 offset:38912
  v_mul_f32 v142, v142, v21
  v_mfma_f32_16x16x32_bf16 v[148:151], a[20:23], v[116:119], v[148:151]
  s_mul_i32 s44, s42, 7168
  ds_read_b64_tr_b16 a[8:9], v16 offset:40960
  v_mul_f32 v143, v143, v21
  v_mfma_f32_16x16x32_bf16 v[148:151], a[24:27], v[120:123], v[148:151]
  s_mov_b32 s74, 3584
  ds_read_b64_tr_b16 a[10:11], v16 offset:43008
  v_cvt_pk_bf16_f32 v38, v140, v141
  v_mfma_f32_16x16x32_bf16 v[148:151], a[28:31], v[124:127], v[148:151]
  buffer_store_dwordx4 v[32:35], v9, s[12:15], s57 offen offset:0 sc1
  v_cvt_pk_bf16_f32 v39, v142, v143
  v_mul_f32 v144, v144, v20
  v_mul_f32 v145, v145, v20
  v_mfma_f32_16x16x32_bf16 v[152:155], a[32:35], v[64:67], 0
  s_mov_b32 s75, 0x20000
  ds_read_b64_tr_b16 a[12:13], v16 offset:45056
  v_mul_f32 v146, v146, v20
  v_mfma_f32_16x16x32_bf16 v[152:155], a[36:39], v[68:71], v[152:155]
  s_mov_b64 s[80:81], s[10:11]
  ds_read_b64_tr_b16 a[14:15], v16 offset:47104
  ds_read_b64_tr_b16 a[16:17], v16 offset:49152
  v_mfma_f32_16x16x32_bf16 v[152:155], a[40:43], v[72:75], v[152:155]
  s_waitcnt lgkmcnt(6)
  ds_read_b64_tr_b16 a[18:19], v16 offset:51200
  v_mul_f32 v147, v147, v20
  v_mfma_f32_16x16x32_bf16 v[152:155], a[44:47], v[76:79], v[152:155]
  s_mov_b32 s82, 4096
  ds_read_b64_tr_b16 a[20:21], v16 offset:53248
  v_cvt_pk_bf16_f32 v40, v144, v145
  v_mfma_f32_16x16x32_bf16 v[152:155], a[48:51], v[80:83], v[152:155]
  s_mov_b32 s83, 0x20000
  ds_read_b64_tr_b16 a[22:23], v16 offset:55296
  v_cvt_pk_bf16_f32 v41, v146, v147
  v_mfma_f32_16x16x32_bf16 v[152:155], a[52:55], v[84:87], v[152:155]
  s_mov_b32 s10, 7340032
  ds_read_b64_tr_b16 a[24:25], v16 offset:57344
  v_add_u32 v11, 27648, v11
  v_mfma_f32_16x16x32_bf16 v[152:155], a[56:59], v[88:91], v[152:155]
  s_mov_b32 s11, 0x20000
  ds_read_b64_tr_b16 a[26:27], v16 offset:59392
  v_add_u32 v12, 55296, v10
  v_mfma_f32_16x16x32_bf16 v[152:155], a[60:63], v[92:95], v[152:155]
  s_mov_b32 s78, 1835008
  ds_read_b64_tr_b16 a[28:29], v16 offset:61440
  v_mul_f32 v148, v148, v21
  v_mfma_f32_16x16x32_bf16 v[156:159], a[32:35], v[96:99], 0
  s_mov_b32 s79, 0x20000
  ds_read_b64_tr_b16 a[30:31], v16 offset:63488
  v_xor_b32 v16, 0x10000, v16
  v_mfma_f32_16x16x32_bf16 v[156:159], a[36:39], v[100:103], v[156:159]
  s_mov_b32 s86, 1835008
  ds_read_b64_tr_b16 a[32:33], v17 offset:32768
  v_mul_f32 v149, v149, v21
  v_mfma_f32_16x16x32_bf16 v[156:159], a[40:43], v[104:107], v[156:159]
  s_mov_b32 s87, 0x20000
  ds_read_b64_tr_b16 a[34:35], v17 offset:34816
  v_mul_f32 v150, v150, v21
  v_mfma_f32_16x16x32_bf16 v[156:159], a[44:47], v[108:111], v[156:159]
  ds_read_b64_tr_b16 a[36:37], v17 offset:36864
  v_mul_f32 v151, v151, v21
  v_mfma_f32_16x16x32_bf16 v[156:159], a[48:51], v[112:115], v[156:159]
  ds_read_b64_tr_b16 a[38:39], v17 offset:38912
  v_cvt_pk_bf16_f32 v44, v148, v149
  v_mfma_f32_16x16x32_bf16 v[156:159], a[52:55], v[116:119], v[156:159]
  buffer_store_dwordx4 v[36:39], v9, s[12:15], s58 offen offset:0 sc1
  v_cvt_pk_bf16_f32 v45, v150, v151
  v_add_u32 v13, 55296, v11
  v_mov_b32 v2, 1
  v_mfma_f32_16x16x32_bf16 v[156:159], a[56:59], v[120:123], v[156:159]
  ds_read_b64_tr_b16 a[40:41], v17 offset:40960
  v_mfma_f32_16x16x32_bf16 v[156:159], a[60:63], v[124:127], v[156:159]
  s_nop 0
  ds_read_b64_tr_b16 a[42:43], v17 offset:43008
  ds_read_b64_tr_b16 a[44:45], v17 offset:45056
  v_mfma_f32_16x16x32_bf16 v[160:163], a[0:3], v[64:67], 0
  s_waitcnt lgkmcnt(6)
  ds_read_b64_tr_b16 a[46:47], v17 offset:47104
  v_mul_f32 v152, v152, v20
  v_mfma_f32_16x16x32_bf16 v[160:163], a[4:7], v[68:71], v[160:163]
  ds_read_b64_tr_b16 a[48:49], v17 offset:49152
  v_mul_f32 v153, v153, v20
  v_mfma_f32_16x16x32_bf16 v[160:163], a[8:11], v[72:75], v[160:163]
  ds_read_b64_tr_b16 a[50:51], v17 offset:51200
  v_mul_f32 v154, v154, v20
  v_mfma_f32_16x16x32_bf16 v[160:163], a[12:15], v[76:79], v[160:163]
  ds_read_b64_tr_b16 a[52:53], v17 offset:53248
  v_mul_f32 v155, v155, v20
  v_mfma_f32_16x16x32_bf16 v[160:163], a[16:19], v[80:83], v[160:163]
  ds_read_b64_tr_b16 a[54:55], v17 offset:55296
  v_cvt_pk_bf16_f32 v42, v152, v153
  v_mfma_f32_16x16x32_bf16 v[160:163], a[20:23], v[84:87], v[160:163]
  ds_read_b64_tr_b16 a[56:57], v17 offset:57344
  v_cvt_pk_bf16_f32 v43, v154, v155
  v_mfma_f32_16x16x32_bf16 v[160:163], a[24:27], v[88:91], v[160:163]
  ds_read_b64_tr_b16 a[58:59], v17 offset:59392
  v_mfma_f32_16x16x32_bf16 v[160:163], a[28:31], v[92:95], v[160:163]
  ds_read_b64_tr_b16 a[60:61], v17 offset:61440
  v_mul_f32 v156, v156, v21
  v_mfma_f32_16x16x32_bf16 v[164:167], a[0:3], v[96:99], 0
  ds_read_b64_tr_b16 a[62:63], v17 offset:63488
  v_xor_b32 v17, 0x10000, v17
  v_mfma_f32_16x16x32_bf16 v[164:167], a[4:7], v[100:103], v[164:167]
  ds_read_b64_tr_b16 a[0:1], v18 offset:32768
  v_mul_f32 v157, v157, v21
  v_mfma_f32_16x16x32_bf16 v[164:167], a[8:11], v[104:107], v[164:167]
  ds_read_b64_tr_b16 a[2:3], v18 offset:34816
  v_mul_f32 v158, v158, v21
  v_mfma_f32_16x16x32_bf16 v[164:167], a[12:15], v[108:111], v[164:167]
  buffer_store_dwordx4 v[40:43], v9, s[12:15], s57 offen offset:1024 sc1
  v_mul_f32 v159, v159, v21
  v_cvt_pk_bf16_f32 v46, v156, v157
  v_cvt_pk_bf16_f32 v47, v158, v159
  v_mfma_f32_16x16x32_bf16 v[164:167], a[16:19], v[112:115], v[164:167]
  ds_read_b64_tr_b16 a[4:5], v18 offset:36864
  v_and_b32 v4, 7, v1
  v_mfma_f32_16x16x32_bf16 v[164:167], a[20:23], v[116:119], v[164:167]
  s_nop 0
  ds_read_b64_tr_b16 a[6:7], v18 offset:38912
  ds_read_b64_tr_b16 a[8:9], v18 offset:40960
  v_mfma_f32_16x16x32_bf16 v[164:167], a[24:27], v[120:123], v[164:167]
  ds_read_b64_tr_b16 a[10:11], v18 offset:43008
  v_bfe_u32 v5, v1, 3, 2
  v_mfma_f32_16x16x32_bf16 v[164:167], a[28:31], v[124:127], v[164:167]
  s_waitcnt lgkmcnt(6)
  ds_read_b64_tr_b16 a[12:13], v18 offset:45056
  v_mul_f32 v160, v160, v20
  v_mfma_f32_16x16x32_bf16 v[168:171], a[32:35], v[64:67], 0
  ds_read_b64_tr_b16 a[14:15], v18 offset:47104
  v_mul_f32 v161, v161, v20
  v_mfma_f32_16x16x32_bf16 v[168:171], a[36:39], v[68:71], v[168:171]
  ds_read_b64_tr_b16 a[16:17], v18 offset:49152
  v_mul_f32 v162, v162, v20
  v_mfma_f32_16x16x32_bf16 v[168:171], a[40:43], v[72:75], v[168:171]
  ds_read_b64_tr_b16 a[18:19], v18 offset:51200
  v_mul_f32 v163, v163, v20
  v_mfma_f32_16x16x32_bf16 v[168:171], a[44:47], v[76:79], v[168:171]
  ds_read_b64_tr_b16 a[20:21], v18 offset:53248
  v_cvt_pk_bf16_f32 v48, v160, v161
  v_mfma_f32_16x16x32_bf16 v[168:171], a[48:51], v[80:83], v[168:171]
  ds_read_b64_tr_b16 a[22:23], v18 offset:55296
  v_cvt_pk_bf16_f32 v49, v162, v163
  v_mfma_f32_16x16x32_bf16 v[168:171], a[52:55], v[84:87], v[168:171]
  ds_read_b64_tr_b16 a[24:25], v18 offset:57344
  v_lshrrev_b32 v6, 5, v1
  v_mfma_f32_16x16x32_bf16 v[168:171], a[56:59], v[88:91], v[168:171]
  ds_read_b64_tr_b16 a[26:27], v18 offset:59392
  v_lshl_add_u32 v6, s20, 1, v6
  v_mfma_f32_16x16x32_bf16 v[168:171], a[60:63], v[92:95], v[168:171]
  ds_read_b64_tr_b16 a[28:29], v18 offset:61440
  v_mul_f32 v164, v164, v21
  v_mfma_f32_16x16x32_bf16 v[172:175], a[32:35], v[96:99], 0
  ds_read_b64_tr_b16 a[30:31], v18 offset:63488
  v_xor_b32 v18, 0x10000, v18
  v_mfma_f32_16x16x32_bf16 v[172:175], a[36:39], v[100:103], v[172:175]
  ds_read_b64_tr_b16 a[32:33], v19 offset:32768
  v_mul_f32 v165, v165, v21
  v_mfma_f32_16x16x32_bf16 v[172:175], a[40:43], v[104:107], v[172:175]
  ds_read_b64_tr_b16 a[34:35], v19 offset:34816
  v_mul_f32 v166, v166, v21
  v_mfma_f32_16x16x32_bf16 v[172:175], a[44:47], v[108:111], v[172:175]
  ds_read_b64_tr_b16 a[36:37], v19 offset:36864
  v_mul_f32 v167, v167, v21
  v_mfma_f32_16x16x32_bf16 v[172:175], a[48:51], v[112:115], v[172:175]
  ds_read_b64_tr_b16 a[38:39], v19 offset:38912
  v_cvt_pk_bf16_f32 v52, v164, v165
  v_mfma_f32_16x16x32_bf16 v[172:175], a[52:55], v[116:119], v[172:175]
  ds_read_b64_tr_b16 a[40:41], v19 offset:40960
  v_cvt_pk_bf16_f32 v53, v166, v167
  v_mfma_f32_16x16x32_bf16 v[172:175], a[56:59], v[120:123], v[172:175]
  s_waitcnt lgkmcnt(6)
  ds_read_b64_tr_b16 a[42:43], v19 offset:43008
  v_lshlrev_b32 v7, 10, v6
  v_mfma_f32_16x16x32_bf16 v[172:175], a[60:63], v[124:127], v[172:175]
  buffer_store_dwordx4 v[44:47], v9, s[12:15], s58 offen offset:1024 sc1
  v_mul_f32 v168, v168, v20
  v_mul_f32 v169, v169, v20
  v_mul_f32 v170, v170, v20
  v_mfma_f32_16x16x32_bf16 v[176:179], a[0:3], v[64:67], 0
  ds_read_b64_tr_b16 a[44:45], v19 offset:45056
  v_mul_f32 v171, v171, v20
  v_mfma_f32_16x16x32_bf16 v[176:179], a[4:7], v[68:71], v[176:179]
  s_nop 0
  ds_read_b64_tr_b16 a[46:47], v19 offset:47104
  ds_read_b64_tr_b16 a[48:49], v19 offset:49152
  v_mfma_f32_16x16x32_bf16 v[176:179], a[8:11], v[72:75], v[176:179]
  ds_read_b64_tr_b16 a[50:51], v19 offset:51200
  v_cvt_pk_bf16_f32 v50, v168, v169
  v_mfma_f32_16x16x32_bf16 v[176:179], a[12:15], v[76:79], v[176:179]
  ds_read_b64_tr_b16 a[52:53], v19 offset:53248
  v_cvt_pk_bf16_f32 v51, v170, v171
  v_mfma_f32_16x16x32_bf16 v[176:179], a[16:19], v[80:83], v[176:179]
  ds_read_b64_tr_b16 a[54:55], v19 offset:55296
  v_lshl_add_u32 v7, v5, 8, v7
  v_mfma_f32_16x16x32_bf16 v[176:179], a[20:23], v[84:87], v[176:179]
  ds_read_b64_tr_b16 a[56:57], v19 offset:57344
  v_lshl_add_u32 v7, v4, 4, v7
  v_mfma_f32_16x16x32_bf16 v[176:179], a[24:27], v[88:91], v[176:179]
  s_waitcnt lgkmcnt(7)
  ds_read_b64_tr_b16 a[58:59], v19 offset:59392
  v_add_u32 v8, s46, v7
  v_mfma_f32_16x16x32_bf16 v[176:179], a[28:31], v[92:95], v[176:179]
  ds_read_b64_tr_b16 a[60:61], v19 offset:61440
  v_mul_f32 v172, v172, v21
  v_mfma_f32_16x16x32_bf16 v[180:183], a[0:3], v[96:99], 0
  s_waitcnt vmcnt(8)
  ds_read_b64_tr_b16 a[62:63], v19 offset:63488
  v_mfma_f32_16x16x32_bf16 v[180:183], a[4:7], v[100:103], v[180:183]
  s_barrier
  v_mfma_f32_16x16x32_bf16 v[180:183], a[8:11], v[104:107], v[180:183]
  s_nop 0
  ds_read_b64_tr_b16 a[0:1], v16 offset:0
  ds_read_b64_tr_b16 a[2:3], v16 offset:2048
  v_mfma_f32_16x16x32_bf16 v[180:183], a[12:15], v[108:111], v[180:183]
  ds_read_b64_tr_b16 a[4:5], v16 offset:4096
  v_xor_b32 v19, 0x10000, v19
  v_mfma_f32_16x16x32_bf16 v[180:183], a[16:19], v[112:115], v[180:183]
  ds_read_b64_tr_b16 a[6:7], v16 offset:6144
  v_mul_f32 v173, v173, v21
  v_mfma_f32_16x16x32_bf16 v[180:183], a[20:23], v[116:119], v[180:183]
  ds_read_b64_tr_b16 a[8:9], v16 offset:8192
  v_mul_f32 v174, v174, v21
  v_mfma_f32_16x16x32_bf16 v[180:183], a[24:27], v[120:123], v[180:183]
  ds_read_b64_tr_b16 a[10:11], v16 offset:10240
  v_mul_f32 v175, v175, v21
  v_mfma_f32_16x16x32_bf16 v[180:183], a[28:31], v[124:127], v[180:183]
  buffer_store_dwordx4 v[48:51], v9, s[12:15], s57 offen offset:2048 sc1
  v_cvt_pk_bf16_f32 v54, v172, v173
  v_cvt_pk_bf16_f32 v55, v174, v175
  v_mul_f32 v176, v176, v20
  v_mfma_f32_16x16x32_bf16 v[184:187], a[32:35], v[64:67], 0
  ds_read_b64_tr_b16 a[12:13], v16 offset:12288
  v_mul_f32 v177, v177, v20
  v_mfma_f32_16x16x32_bf16 v[184:187], a[36:39], v[68:71], v[184:187]
  s_nop 0
  ds_read_b64_tr_b16 a[14:15], v16 offset:14336
  ds_read_b64_tr_b16 a[16:17], v16 offset:16384
  v_mfma_f32_16x16x32_bf16 v[184:187], a[40:43], v[72:75], v[184:187]
  s_waitcnt lgkmcnt(6)
  ds_read_b64_tr_b16 a[18:19], v16 offset:18432
  v_mul_f32 v178, v178, v20
  v_mfma_f32_16x16x32_bf16 v[184:187], a[44:47], v[76:79], v[184:187]
  ds_read_b64_tr_b16 a[20:21], v16 offset:20480
  v_mul_f32 v179, v179, v20
  v_mfma_f32_16x16x32_bf16 v[184:187], a[48:51], v[80:83], v[184:187]
  ds_read_b64_tr_b16 a[22:23], v16 offset:22528
  v_cvt_pk_bf16_f32 v56, v176, v177
  v_mfma_f32_16x16x32_bf16 v[184:187], a[52:55], v[84:87], v[184:187]
  ds_read_b64_tr_b16 a[24:25], v16 offset:24576
  v_cvt_pk_bf16_f32 v57, v178, v179
  v_mfma_f32_16x16x32_bf16 v[184:187], a[56:59], v[88:91], v[184:187]
  ds_read_b64_tr_b16 a[26:27], v16 offset:26624
  v_add_u32 v8, 8192, v8
  v_mfma_f32_16x16x32_bf16 v[184:187], a[60:63], v[92:95], v[184:187]
  ds_read_b64_tr_b16 a[28:29], v16 offset:28672
  v_mul_f32 v180, v180, v21
  v_mfma_f32_16x16x32_bf16 v[188:191], a[32:35], v[96:99], 0
  ds_read_b64_tr_b16 a[30:31], v16 offset:30720
  v_mul_f32 v181, v181, v21
  v_mfma_f32_16x16x32_bf16 v[188:191], a[36:39], v[100:103], v[188:191]
  ds_read_b64_tr_b16 a[32:33], v17 offset:0
  v_mul_f32 v182, v182, v21
  v_mfma_f32_16x16x32_bf16 v[188:191], a[40:43], v[104:107], v[188:191]
  ds_read_b64_tr_b16 a[34:35], v17 offset:2048
  v_mul_f32 v183, v183, v21
  v_mfma_f32_16x16x32_bf16 v[188:191], a[44:47], v[108:111], v[188:191]
  ds_read_b64_tr_b16 a[36:37], v17 offset:4096
  v_cvt_pk_bf16_f32 v60, v180, v181
  v_mfma_f32_16x16x32_bf16 v[188:191], a[48:51], v[112:115], v[188:191]
  ds_read_b64_tr_b16 a[38:39], v17 offset:6144
  v_cvt_pk_bf16_f32 v61, v182, v183
  v_mfma_f32_16x16x32_bf16 v[188:191], a[52:55], v[116:119], v[188:191]
  buffer_store_dwordx4 v[52:55], v9, s[12:15], s58 offen offset:2048 sc1
  v_min_u32 v25, 1920, v0
  v_mfma_f32_16x16x32_bf16 v[188:191], a[56:59], v[120:123], v[188:191]
  ds_read_b64_tr_b16 a[40:41], v17 offset:8192
  v_mfma_f32_16x16x32_bf16 v[188:191], a[60:63], v[124:127], v[188:191]
  s_nop 0
  ds_read_b64_tr_b16 a[42:43], v17 offset:10240
  ds_read_b64_tr_b16 a[44:45], v17 offset:12288
  v_mfma_f32_16x16x32_bf16 v[192:195], a[0:3], v[64:67], 0
  s_waitcnt lgkmcnt(6)
  ds_read_b64_tr_b16 a[46:47], v17 offset:14336
  v_mul_f32 v184, v184, v20
  v_mfma_f32_16x16x32_bf16 v[192:195], a[4:7], v[68:71], v[192:195]
  ds_read_b64_tr_b16 a[48:49], v17 offset:16384
  v_mul_f32 v185, v185, v20
  v_mfma_f32_16x16x32_bf16 v[192:195], a[8:11], v[72:75], v[192:195]
  ds_read_b64_tr_b16 a[50:51], v17 offset:18432
  v_mul_f32 v186, v186, v20
  v_mfma_f32_16x16x32_bf16 v[192:195], a[12:15], v[76:79], v[192:195]
  ds_read_b64_tr_b16 a[52:53], v17 offset:20480
  v_mul_f32 v187, v187, v20
  v_mfma_f32_16x16x32_bf16 v[192:195], a[16:19], v[80:83], v[192:195]
  ds_read_b64_tr_b16 a[54:55], v17 offset:22528
  v_cvt_pk_bf16_f32 v58, v184, v185
  v_mfma_f32_16x16x32_bf16 v[192:195], a[20:23], v[84:87], v[192:195]
  ds_read_b64_tr_b16 a[56:57], v17 offset:24576
  v_cvt_pk_bf16_f32 v59, v186, v187
  v_mfma_f32_16x16x32_bf16 v[192:195], a[24:27], v[88:91], v[192:195]
  ds_read_b64_tr_b16 a[58:59], v17 offset:26624
  v_mfma_f32_16x16x32_bf16 v[192:195], a[28:31], v[92:95], v[192:195]
  ds_read_b64_tr_b16 a[60:61], v17 offset:28672
  v_mul_f32 v188, v188, v21
  v_mfma_f32_16x16x32_bf16 v[196:199], a[0:3], v[96:99], 0
  ds_read_b64_tr_b16 a[62:63], v17 offset:30720
  v_mul_f32 v189, v189, v21
  v_mfma_f32_16x16x32_bf16 v[196:199], a[4:7], v[100:103], v[196:199]
  ds_read_b64_tr_b16 a[0:1], v18 offset:0
  v_mul_f32 v190, v190, v21
  v_mfma_f32_16x16x32_bf16 v[196:199], a[8:11], v[104:107], v[196:199]
  ds_read_b64_tr_b16 a[2:3], v18 offset:2048
  v_mul_f32 v191, v191, v21
  v_mfma_f32_16x16x32_bf16 v[196:199], a[12:15], v[108:111], v[196:199]
  buffer_store_dwordx4 v[56:59], v9, s[12:15], s57 offen offset:3072 sc1
  s_add_u32 s57, s57, 4096
  v_cvt_pk_bf16_f32 v62, v188, v189
  v_cvt_pk_bf16_f32 v63, v190, v191
  v_mfma_f32_16x16x32_bf16 v[196:199], a[16:19], v[112:115], v[196:199]
  ds_read_b64_tr_b16 a[4:5], v18 offset:4096
  v_mfma_f32_16x16x32_bf16 v[196:199], a[20:23], v[116:119], v[196:199]
  s_nop 0
  ds_read_b64_tr_b16 a[6:7], v18 offset:6144
  ds_read_b64_tr_b16 a[8:9], v18 offset:8192
  v_mfma_f32_16x16x32_bf16 v[196:199], a[24:27], v[120:123], v[196:199]
  ds_read_b64_tr_b16 a[10:11], v18 offset:10240
  v_mfma_f32_16x16x32_bf16 v[196:199], a[28:31], v[124:127], v[196:199]
  s_waitcnt lgkmcnt(6)
  ds_read_b64_tr_b16 a[12:13], v18 offset:12288
  v_mul_f32 v192, v192, v20
  v_mfma_f32_16x16x32_bf16 v[200:203], a[32:35], v[64:67], 0
  ds_read_b64_tr_b16 a[14:15], v18 offset:14336
  v_mul_f32 v193, v193, v20
  v_mfma_f32_16x16x32_bf16 v[200:203], a[36:39], v[68:71], v[200:203]
  ds_read_b64_tr_b16 a[16:17], v18 offset:16384
  v_mul_f32 v194, v194, v20
  v_mfma_f32_16x16x32_bf16 v[200:203], a[40:43], v[72:75], v[200:203]
  ds_read_b64_tr_b16 a[18:19], v18 offset:18432
  v_mul_f32 v195, v195, v20
  v_mfma_f32_16x16x32_bf16 v[200:203], a[44:47], v[76:79], v[200:203]
  ds_read_b64_tr_b16 a[20:21], v18 offset:20480
  v_cvt_pk_bf16_f32 v32, v192, v193
  v_mfma_f32_16x16x32_bf16 v[200:203], a[48:51], v[80:83], v[200:203]
  ds_read_b64_tr_b16 a[22:23], v18 offset:22528
  v_cvt_pk_bf16_f32 v33, v194, v195
  v_mfma_f32_16x16x32_bf16 v[200:203], a[52:55], v[84:87], v[200:203]
  ds_read_b64_tr_b16 a[24:25], v18 offset:24576
  v_mfma_f32_16x16x32_bf16 v[200:203], a[56:59], v[88:91], v[200:203]
  ds_read_b64_tr_b16 a[26:27], v18 offset:26624
  v_mfma_f32_16x16x32_bf16 v[200:203], a[60:63], v[92:95], v[200:203]
  ds_read_b64_tr_b16 a[28:29], v18 offset:28672
  v_mul_f32 v196, v196, v21
  v_mfma_f32_16x16x32_bf16 v[204:207], a[32:35], v[96:99], 0
  ds_read_b64_tr_b16 a[30:31], v18 offset:30720
  v_mul_f32 v197, v197, v21
  v_mfma_f32_16x16x32_bf16 v[204:207], a[36:39], v[100:103], v[204:207]
  ds_read_b64_tr_b16 a[32:33], v19 offset:0
  v_mul_f32 v198, v198, v21
  v_mfma_f32_16x16x32_bf16 v[204:207], a[40:43], v[104:107], v[204:207]
  ds_read_b64_tr_b16 a[34:35], v19 offset:2048
  v_mul_f32 v199, v199, v21
  v_mfma_f32_16x16x32_bf16 v[204:207], a[44:47], v[108:111], v[204:207]
  ds_read_b64_tr_b16 a[36:37], v19 offset:4096
  v_cvt_pk_bf16_f32 v36, v196, v197
  v_mfma_f32_16x16x32_bf16 v[204:207], a[48:51], v[112:115], v[204:207]
  ds_read_b64_tr_b16 a[38:39], v19 offset:6144
  v_cvt_pk_bf16_f32 v37, v198, v199
  v_mfma_f32_16x16x32_bf16 v[204:207], a[52:55], v[116:119], v[204:207]
  ds_read_b64_tr_b16 a[40:41], v19 offset:8192
  v_mfma_f32_16x16x32_bf16 v[204:207], a[56:59], v[120:123], v[204:207]
  s_waitcnt lgkmcnt(6)
  ds_read_b64_tr_b16 a[42:43], v19 offset:10240
  v_mfma_f32_16x16x32_bf16 v[204:207], a[60:63], v[124:127], v[204:207]
  buffer_store_dwordx4 v[60:63], v9, s[12:15], s58 offen offset:3072 sc1
  s_add_u32 s58, s58, 4096
  v_mul_f32 v200, v200, v20
  v_mul_f32 v201, v201, v20
  v_mfma_f32_16x16x32_bf16 v[208:211], a[0:3], v[64:67], 0
  ds_read_b64_tr_b16 a[44:45], v19 offset:12288
  v_mul_f32 v202, v202, v20
  v_mfma_f32_16x16x32_bf16 v[208:211], a[4:7], v[68:71], v[208:211]
  s_nop 0
  ds_read_b64_tr_b16 a[46:47], v19 offset:14336
  ds_read_b64_tr_b16 a[48:49], v19 offset:16384
  v_mfma_f32_16x16x32_bf16 v[208:211], a[8:11], v[72:75], v[208:211]
  ds_read_b64_tr_b16 a[50:51], v19 offset:18432
  v_mul_f32 v203, v203, v20
  v_mfma_f32_16x16x32_bf16 v[208:211], a[12:15], v[76:79], v[208:211]
  ds_read_b64_tr_b16 a[52:53], v19 offset:20480
  v_cvt_pk_bf16_f32 v34, v200, v201
  v_mfma_f32_16x16x32_bf16 v[208:211], a[16:19], v[80:83], v[208:211]
  ds_read_b64_tr_b16 a[54:55], v19 offset:22528
  v_cvt_pk_bf16_f32 v35, v202, v203
  v_mfma_f32_16x16x32_bf16 v[208:211], a[20:23], v[84:87], v[208:211]
  ds_read_b64_tr_b16 a[56:57], v19 offset:24576
  v_mfma_f32_16x16x32_bf16 v[208:211], a[24:27], v[88:91], v[208:211]
  s_waitcnt lgkmcnt(7)
  ds_read_b64_tr_b16 a[58:59], v19 offset:26624
  v_mfma_f32_16x16x32_bf16 v[208:211], a[28:31], v[92:95], v[208:211]
  ds_read_b64_tr_b16 a[60:61], v19 offset:28672
  v_mul_f32 v204, v204, v21
  v_mfma_f32_16x16x32_bf16 v[212:215], a[0:3], v[96:99], 0
  buffer_load_dword v25, v25, s[12:15], s43 offen sc1
  v_mfma_f32_16x16x32_bf16 v[212:215], a[4:7], v[100:103], v[212:215]
  buffer_store_dwordx4 v[32:35], v9, s[12:15], s57 offen offset:0 sc1
  v_mul_f32 v205, v205, v21
  v_mul_f32 v206, v206, v21
  v_mul_f32 v207, v207, v21
  v_mfma_f32_16x16x32_bf16 v[212:215], a[8:11], v[104:107], v[212:215]
  ds_read_b64_tr_b16 a[62:63], v19 offset:30720
  v_cvt_pk_bf16_f32 v38, v204, v205
  v_mfma_f32_16x16x32_bf16 v[212:215], a[12:15], v[108:111], v[212:215]
  v_cvt_pk_bf16_f32 v39, v206, v207
  v_mfma_f32_16x16x32_bf16 v[212:215], a[16:19], v[112:115], v[212:215]
  buffer_store_dwordx4 v[36:39], v9, s[12:15], s58 offen offset:0 sc1
  v_mfma_f32_16x16x32_bf16 v[212:215], a[20:23], v[116:119], v[212:215]
  v_mfma_f32_16x16x32_bf16 v[212:215], a[24:27], v[120:123], v[212:215]
  v_mfma_f32_16x16x32_bf16 v[212:215], a[28:31], v[124:127], v[212:215]
  v_mul_f32 v208, v208, v20
  v_mul_f32 v209, v209, v20
  v_mfma_f32_16x16x32_bf16 v[216:219], a[32:35], v[64:67], 0
  v_mul_f32 v210, v210, v20
  v_mul_f32 v211, v211, v20
  v_mfma_f32_16x16x32_bf16 v[216:219], a[36:39], v[68:71], v[216:219]
  v_cvt_pk_bf16_f32 v40, v208, v209
  v_cvt_pk_bf16_f32 v41, v210, v211
  v_mfma_f32_16x16x32_bf16 v[216:219], a[40:43], v[72:75], v[216:219]
  s_waitcnt lgkmcnt(0)
  v_mfma_f32_16x16x32_bf16 v[216:219], a[44:47], v[76:79], v[216:219]
  v_mfma_f32_16x16x32_bf16 v[216:219], a[48:51], v[80:83], v[216:219]
  v_mfma_f32_16x16x32_bf16 v[216:219], a[52:55], v[84:87], v[216:219]
  v_mfma_f32_16x16x32_bf16 v[216:219], a[56:59], v[88:91], v[216:219]
  v_mfma_f32_16x16x32_bf16 v[216:219], a[60:63], v[92:95], v[216:219]
  v_mul_f32 v212, v212, v21
  v_mul_f32 v213, v213, v21
  v_mfma_f32_16x16x32_bf16 v[220:223], a[32:35], v[96:99], 0
  v_mul_f32 v214, v214, v21
  v_mul_f32 v215, v215, v21
  v_mfma_f32_16x16x32_bf16 v[220:223], a[36:39], v[100:103], v[220:223]
  v_cvt_pk_bf16_f32 v44, v212, v213
  v_cvt_pk_bf16_f32 v45, v214, v215
  v_mfma_f32_16x16x32_bf16 v[220:223], a[40:43], v[104:107], v[220:223]
  v_mfma_f32_16x16x32_bf16 v[220:223], a[44:47], v[108:111], v[220:223]
  v_mfma_f32_16x16x32_bf16 v[220:223], a[48:51], v[112:115], v[220:223]
  v_mfma_f32_16x16x32_bf16 v[220:223], a[52:55], v[116:119], v[220:223]
  v_mfma_f32_16x16x32_bf16 v[220:223], a[56:59], v[120:123], v[220:223]
  v_mfma_f32_16x16x32_bf16 v[220:223], a[60:63], v[124:127], v[220:223]
  v_mul_f32 v216, v216, v20
  v_mul_f32 v217, v217, v20
  v_mul_f32 v218, v218, v20
  v_mul_f32 v219, v219, v20
  v_cvt_pk_bf16_f32 v42, v216, v217
  v_cvt_pk_bf16_f32 v43, v218, v219
  s_nop 0
  buffer_store_dwordx4 v[40:43], v9, s[12:15], s57 offen offset:1024 sc1
  s_nop 0
  s_nop 0
  v_mul_f32 v220, v220, v21
  v_mul_f32 v221, v221, v21
  v_mul_f32 v222, v222, v21
  v_mul_f32 v223, v223, v21
  v_cvt_pk_bf16_f32 v46, v220, v221
  v_cvt_pk_bf16_f32 v47, v222, v223
  s_nop 0
  buffer_store_dwordx4 v[44:47], v9, s[12:15], s58 offen offset:1024 sc1
TL_BEGIN:
  s_cmp_lt_u32 s26, 28
  s_cselect_b32 s51, 0, 4
  s_lshl_b32 s60, s20, 6
  v_add_u32 v24, s60, v1
  v_mul_u32_u24 v22, 896, v4
  v_lshl_add_u32 v22, v6, 6, v22
  v_lshl_add_u32 v22, v5, 3, v22
  v_add_u32 v23, s46, v22
  buffer_load_dwordx2 v[28:29], v22, s[76:79], s44 offen offset:0
  buffer_load_dwordx2 v[30:31], v22, s[76:79], s44 offen offset:32
  buffer_load_dwordx2 v[32:33], v23, s[76:79], s44 offen offset:512
  buffer_load_dwordx2 v[34:35], v23, s[76:79], s44 offen offset:544
  v_lshrrev_b32 v3, 4, v1
  v_bfe_u32 v26, v1, 2, 2
  v_lshl_add_u32 v27, v3, 3, v26
  v_and_b32 v3, 1, v3
  v_lshlrev_b32 v3, 1, v3
  v_lshrrev_b32 v26, 1, v26
  v_or_b32 v3, v3, v26
  v_lshlrev_b32 v27, 7, v27
  v_and_b32 v26, 3, v1
  v_lshl_add_u32 v27, v26, 3, v27
  v_lshl_add_u32 v27, v3, 5, v27
  v_add_u32 v18, s41, v27
  v_xor_b32 v19, 32, v18
  v_xor_b32 v20, 64, v18
  v_xor_b32 v21, 96, v18
  v_add_u32 v241, s65, v27
  v_xor_b32 v242, 32, v241
  v_xor_b32 v243, 64, v241
  v_xor_b32 v244, 96, v241
  v_lshrrev_b32 v26, 3, v1
  v_lshlrev_b32 v14, 12, v26
  v_and_b32 v26, 1, v1
  v_lshl_add_u32 v14, v26, 4, v14
  v_bfe_u32 v26, v1, 1, 2
  v_lshrrev_b32 v27, 4, v1
  v_xor_b32 v26, v26, v27
  v_lshl_add_u32 v14, v26, 5, v14
  v_add_u32 v15, 31744, v14
  v_add_u32 v16, 63488, v14
  v_add_u32 v17, 95232, v14
  s_add_u32 s60, s20, 0
  s_and_b32 s60, s60, 3
  s_lshl_b32 s60, s60, 10
  v_add_u32 v60, s60, v9
  s_add_u32 s60, s20, 1
  s_and_b32 s60, s60, 3
  s_lshl_b32 s60, s60, 10
  v_add_u32 v61, s60, v9
  s_add_u32 s60, s20, 2
  s_and_b32 s60, s60, 3
  s_lshl_b32 s60, s60, 10
  v_add_u32 v62, s60, v9
  s_add_u32 s60, s20, 3
  s_and_b32 s60, s60, 3
  s_lshl_b32 s60, s60, 10
  v_add_u32 v63, s60, v9
  v_lshrrev_b32 v3, 2, v1
  v_add_u32 v26, 1, v3
  v_and_b32 v26, 7, v26
  v_cmp_gt_u32 vcc, 8, v3
  s_nop 1
  v_cndmask_b32 v3, v3, v26, vcc
  v_lshlrev_b32 v3, 11, v3
  v_and_b32 v26, 0x180, v0
  v_add_u32 v3, v3, v26
  v_mov_b32 v26, 0x00003f80
  v_mov_b32 v27, 0x3f800000
  v_mov_b64 v[64:65], 0
  v_mov_b64 v[66:67], 0
  v_mov_b64 v[68:69], 0
  v_mov_b64 v[70:71], 0
  v_mov_b64 v[72:73], 0
  v_mov_b64 v[74:75], 0
  v_mov_b64 v[76:77], 0
  v_mov_b64 v[78:79], 0
  v_mov_b64 v[80:81], 0
  v_mov_b64 v[82:83], 0
  v_mov_b64 v[84:85], 0
  v_mov_b64 v[86:87], 0
  v_mov_b64 v[88:89], 0
  v_mov_b64 v[90:91], 0
  v_mov_b64 v[92:93], 0
  v_mov_b64 v[94:95], 0
  v_mov_b64 v[224:225], 0
  v_mov_b64 v[226:227], 0
  v_mov_b64 v[228:229], 0
  v_mov_b64 v[230:231], 0
  v_mov_b64 v[232:233], 0
  v_mov_b64 v[234:235], 0
  v_mov_b64 v[236:237], 0
  v_mov_b64 v[238:239], 0
  s_mov_b32 s59, 0x40000
  v_lshl_add_u32 v249, v4, 4, v22
  v_add_u32 v249, 131072, v249
  v_lshlrev_b32 v250, 3, v4
  v_add_u32 v250, 139264, v250
  s_lshl_b32 s60, s20, 6
  v_add_u32 v251, s60, v250
  v_lshlrev_b32 v252, 4, v24
  v_add_u32 v56, 131072, v252
  v_bfe_u32 v57, v1, 2, 2
  v_mul_u32_u24 v57, 912, v57
  v_lshrrev_b32 v58, 4, v24
  v_lshl_add_u32 v57, v58, 5, v57
  v_and_b32 v59, 3, v1
  v_lshl_add_u32 v57, v59, 3, v57
  v_add_u32 v57, 131072, v57
  v_lshlrev_b32 v58, 10, v58
  v_and_b32 v59, 15, v1
  v_lshl_add_u32 v58, v59, 4, v58
  v_add_u32 v59, s46, v58
  v_add_u32 v59, 16384, v59
  v_cmp_gt_u32 vcc, 200, v24
  v_add_u32 v253, 4096, v252
  v_mov_b32 v254, 0x7fff0000
  v_cndmask_b32 v253, v254, v253, vcc
  s_mul_i32 s44, s42, 7296
  s_add_u32 s44, s44, 74448896
  s_lshr_b32 s67, s42, 2
  s_mul_i32 s67, s67, 28672
  s_and_b32 s61, s42, 3
  s_lshl_b32 s61, s61, 8
  s_add_u32 s67, s67, s61
  s_add_u32 s67, s67, 76546048
  s_mov_b32 s48, 0
  s_mov_b32 s53, 0
  s_lshl_b32 s58, s42, 7
  s_add_u32 s58, s58, 94502912
  s_cmp_eq_u32 s20, 0
  s_cselect_b32 s58, s58, 268435456
  s_barrier
  s_waitcnt vmcnt(4)
  s_mov_b64 exec, 1
  buffer_store_dword v2, off, s[12:15], s45 sc1
  s_mov_b64 exec, -1
  v_cmp_eq_u32 vcc, 1, v25
  s_nop 1
  s_lshr_b32 s60, vcc_lo, 1
  s_and_b32 s60, s60, vcc_lo
  s_lshr_b32 s61, s60, 2
  s_and_b32 s60, s60, s61
  s_and_b32 s60, s60, 0x1111
  s_andn2_b32 s50, s60, s48
  s_or_b32 s48, s48, s60
  s_bitcmp1_b32 s50, 0
  s_cbranch_scc0 TL_A0
  s_add_u32 s60, s39, 0
  buffer_load_dwordx4 v[96:99], v7, s[12:15], s60 offen sc1
  buffer_load_dwordx4 v[100:103], v8, s[12:15], s60 offen sc1
  s_add_u32 s60, s39, 14336
  buffer_load_dwordx4 v[104:107], v7, s[12:15], s60 offen sc1
  buffer_load_dwordx4 v[108:111], v8, s[12:15], s60 offen sc1
  s_add_u32 s60, s39, 28672
  buffer_load_dwordx4 v[112:115], v7, s[12:15], s60 offen sc1
  buffer_load_dwordx4 v[116:119], v8, s[12:15], s60 offen sc1
  s_add_u32 s60, s39, 43008
  buffer_load_dwordx4 v[120:123], v7, s[12:15], s60 offen sc1
  buffer_load_dwordx4 v[124:127], v8, s[12:15], s60 offen sc1
TL_A0:
  s_bitcmp1_b32 s50, 4
  s_cbranch_scc0 TL_A1
  s_add_u32 s60, s39, 57344
  buffer_load_dwordx4 v[128:131], v7, s[12:15], s60 offen sc1
  buffer_load_dwordx4 v[132:135], v8, s[12:15], s60 offen sc1
  s_add_u32 s60, s39, 71680
  buffer_load_dwordx4 v[136:139], v7, s[12:15], s60 offen sc1
  buffer_load_dwordx4 v[140:143], v8, s[12:15], s60 offen sc1
  s_add_u32 s60, s39, 86016
  buffer_load_dwordx4 v[144:147], v7, s[12:15], s60 offen sc1
  buffer_load_dwordx4 v[148:151], v8, s[12:15], s60 offen sc1
  s_add_u32 s60, s39, 100352
  buffer_load_dwordx4 v[152:155], v7, s[12:15], s60 offen sc1
  buffer_load_dwordx4 v[156:159], v8, s[12:15], s60 offen sc1
TL_A1:
  s_bitcmp1_b32 s50, 8
  s_cbranch_scc0 TL_A2
  s_add_u32 s60, s39, 114688
  buffer_load_dwordx4 v[160:163], v7, s[12:15], s60 offen sc1
  buffer_load_dwordx4 v[164:167], v8, s[12:15], s60 offen sc1
  s_add_u32 s60, s39, 129024
  buffer_load_dwordx4 v[168:171], v7, s[12:15], s60 offen sc1
  buffer_load_dwordx4 v[172:175], v8, s[12:15], s60 offen sc1
  s_add_u32 s60, s39, 143360
  buffer_load_dwordx4 v[176:179], v7, s[12:15], s60 offen sc1
  buffer_load_dwordx4 v[180:183], v8, s[12:15], s60 offen sc1
  s_add_u32 s60, s39, 157696
  buffer_load_dwordx4 v[184:187], v7, s[12:15], s60 offen sc1
  buffer_load_dwordx4 v[188:191], v8, s[12:15], s60 offen sc1
TL_A2:
  s_bitcmp1_b32 s50, 12
  s_cbranch_scc0 TL_A3
  s_add_u32 s60, s39, 172032
  buffer_load_dwordx4 v[192:195], v7, s[12:15], s60 offen sc1
  buffer_load_dwordx4 v[196:199], v8, s[12:15], s60 offen sc1
  s_add_u32 s60, s39, 186368
  buffer_load_dwordx4 v[200:203], v7, s[12:15], s60 offen sc1
  buffer_load_dwordx4 v[204:207], v8, s[12:15], s60 offen sc1
  s_add_u32 s60, s39, 200704
  buffer_load_dwordx4 v[208:211], v7, s[12:15], s60 offen sc1
  buffer_load_dwordx4 v[212:215], v8, s[12:15], s60 offen sc1
  s_add_u32 s60, s39, 215040
  buffer_load_dwordx4 v[216:219], v7, s[12:15], s60 offen sc1
  buffer_load_dwordx4 v[220:223], v8, s[12:15], s60 offen sc1
TL_A3:
TL_RL:
  s_mov_b32 s49, s50
  s_mov_b32 s50, 0
  s_cmp_eq_u32 s48, 0x1111
  s_cbranch_scc1 TL_R1
  v_min_u32 v25, 1920, v0
  buffer_load_dword v25, v25, s[12:15], s43 offen sc1
  s_waitcnt vmcnt(0)
  v_cmp_eq_u32 vcc, 1, v25
  s_nop 1
  s_lshr_b32 s60, vcc_lo, 1
  s_and_b32 s60, s60, vcc_lo
  s_lshr_b32 s61, s60, 2
  s_and_b32 s60, s60, s61
  s_and_b32 s60, s60, 0x1111
  s_andn2_b32 s50, s60, s48
  s_or_b32 s48, s48, s60
  s_bitcmp1_b32 s50, 0
  s_cbranch_scc0 TL_B0
  s_add_u32 s60, s39, 0
  buffer_load_dwordx4 v[96:99], v7, s[12:15], s60 offen sc1
  buffer_load_dwordx4 v[100:103], v8, s[12:15], s60 offen sc1
  s_add_u32 s60, s39, 14336
  buffer_load_dwordx4 v[104:107], v7, s[12:15], s60 offen sc1
  buffer_load_dwordx4 v[108:111], v8, s[12:15], s60 offen sc1
  s_add_u32 s60, s39, 28672
  buffer_load_dwordx4 v[112:115], v7, s[12:15], s60 offen sc1
  buffer_load_dwordx4 v[116:119], v8, s[12:15], s60 offen sc1
  s_add_u32 s60, s39, 43008
  buffer_load_dwordx4 v[120:123], v7, s[12:15], s60 offen sc1
  buffer_load_dwordx4 v[124:127], v8, s[12:15], s60 offen sc1
TL_B0:
  s_bitcmp1_b32 s50, 4
  s_cbranch_scc0 TL_B1
  s_add_u32 s60, s39, 57344
  buffer_load_dwordx4 v[128:131], v7, s[12:15], s60 offen sc1
  buffer_load_dwordx4 v[132:135], v8, s[12:15], s60 offen sc1
  s_add_u32 s60, s39, 71680
  buffer_load_dwordx4 v[136:139], v7, s[12:15], s60 offen sc1
  buffer_load_dwordx4 v[140:143], v8, s[12:15], s60 offen sc1
  s_add_u32 s60, s39, 86016
  buffer_load_dwordx4 v[144:147], v7, s[12:15], s60 offen sc1
  buffer_load_dwordx4 v[148:151], v8, s[12:15], s60 offen sc1
  s_add_u32 s60, s39, 100352
  buffer_load_dwordx4 v[152:155], v7, s[12:15], s60 offen sc1
  buffer_load_dwordx4 v[156:159], v8, s[12:15], s60 offen sc1
TL_B1:
  s_bitcmp1_b32 s50, 8
  s_cbranch_scc0 TL_B2
  s_add_u32 s60, s39, 114688
  buffer_load_dwordx4 v[160:163], v7, s[12:15], s60 offen sc1
  buffer_load_dwordx4 v[164:167], v8, s[12:15], s60 offen sc1
  s_add_u32 s60, s39, 129024
  buffer_load_dwordx4 v[168:171], v7, s[12:15], s60 offen sc1
  buffer_load_dwordx4 v[172:175], v8, s[12:15], s60 offen sc1
  s_add_u32 s60, s39, 143360
  buffer_load_dwordx4 v[176:179], v7, s[12:15], s60 offen sc1
  buffer_load_dwordx4 v[180:183], v8, s[12:15], s60 offen sc1
  s_add_u32 s60, s39, 157696
  buffer_load_dwordx4 v[184:187], v7, s[12:15], s60 offen sc1
  buffer_load_dwordx4 v[188:191], v8, s[12:15], s60 offen sc1
TL_B2:
  s_bitcmp1_b32 s50, 12
  s_cbranch_scc0 TL_B3
  s_add_u32 s60, s39, 172032
  buffer_load_dwordx4 v[192:195], v7, s[12:15], s60 offen sc1
  buffer_load_dwordx4 v[196:199], v8, s[12:15], s60 offen sc1
  s_add_u32 s60, s39, 186368
  buffer_load_dwordx4 v[200:203], v7, s[12:15], s60 offen sc1
  buffer_load_dwordx4 v[204:207], v8, s[12:15], s60 offen sc1
  s_add_u32 s60, s39, 200704
  buffer_load_dwordx4 v[208:211], v7, s[12:15], s60 offen sc1
  buffer_load_dwordx4 v[212:215], v8, s[12:15], s60 offen sc1
  s_add_u32 s60, s39, 215040
  buffer_load_dwordx4 v[216:219], v7, s[12:15], s60 offen sc1
  buffer_load_dwordx4 v[220:223], v8, s[12:15], s60 offen sc1
TL_B3:
  s_branch TL_R2
TL_R1:
  s_waitcnt vmcnt(0)
TL_R2:
  s_bitcmp1_b32 s49, 0
  s_cbranch_scc0 TL_C0
  v_lshlrev_b32 v36, 16, v28
  v_and_b32 v37, 0xffff0000, v28
  v_lshlrev_b32 v38, 16, v29
  v_and_b32 v39, 0xffff0000, v29
  v_lshlrev_b32 v40, 16, v30
  v_and_b32 v41, 0xffff0000, v30
  v_lshlrev_b32 v42, 16, v31
  v_and_b32 v43, 0xffff0000, v31
  v_lshlrev_b32 v44, 16, v32
  v_and_b32 v45, 0xffff0000, v32
  v_lshlrev_b32 v46, 16, v33
  v_and_b32 v47, 0xffff0000, v33
  v_lshlrev_b32 v48, 16, v34
  v_and_b32 v49, 0xffff0000, v34
  v_lshlrev_b32 v50, 16, v35
  v_and_b32 v51, 0xffff0000, v35
  v_dot2c_f32_bf16 v36, v96, v26
  v_dot2c_f32_bf16 v37, v96, v27
  v_dot2c_f32_bf16 v38, v97, v26
  v_dot2c_f32_bf16 v39, v97, v27
  v_dot2c_f32_bf16 v40, v98, v26
  v_dot2c_f32_bf16 v41, v98, v27
  v_dot2c_f32_bf16 v42, v99, v26
  v_dot2c_f32_bf16 v43, v99, v27
  v_dot2c_f32_bf16 v44, v100, v26
  v_dot2c_f32_bf16 v45, v100, v27
  v_dot2c_f32_bf16 v46, v101, v26
  v_dot2c_f32_bf16 v47, v101, v27
  v_dot2c_f32_bf16 v48, v102, v26
  v_dot2c_f32_bf16 v49, v102, v27
  v_dot2c_f32_bf16 v50, v103, v26
  v_dot2c_f32_bf16 v51, v103, v27
  v_dot2c_f32_bf16 v36, v104, v26
  v_dot2c_f32_bf16 v37, v104, v27
  v_dot2c_f32_bf16 v38, v105, v26
  v_dot2c_f32_bf16 v39, v105, v27
  v_dot2c_f32_bf16 v40, v106, v26
  v_dot2c_f32_bf16 v41, v106, v27
  v_dot2c_f32_bf16 v42, v107, v26
  v_dot2c_f32_bf16 v43, v107, v27
  v_dot2c_f32_bf16 v44, v108, v26
  v_dot2c_f32_bf16 v45, v108, v27
  v_dot2c_f32_bf16 v46, v109, v26
  v_dot2c_f32_bf16 v47, v109, v27
  v_dot2c_f32_bf16 v48, v110, v26
  v_dot2c_f32_bf16 v49, v110, v27
  v_dot2c_f32_bf16 v50, v111, v26
  v_dot2c_f32_bf16 v51, v111, v27
  v_dot2c_f32_bf16 v36, v112, v26
  v_dot2c_f32_bf16 v37, v112, v27
  v_dot2c_f32_bf16 v38, v113, v26
  v_dot2c_f32_bf16 v39, v113, v27
  v_dot2c_f32_bf16 v40, v114, v26
  v_dot2c_f32_bf16 v41, v114, v27
  v_dot2c_f32_bf16 v42, v115, v26
  v_dot2c_f32_bf16 v43, v115, v27
  v_dot2c_f32_bf16 v44, v116, v26
  v_dot2c_f32_bf16 v45, v116, v27
  v_dot2c_f32_bf16 v46, v117, v26
  v_dot2c_f32_bf16 v47, v117, v27
  v_dot2c_f32_bf16 v48, v118, v26
  v_dot2c_f32_bf16 v49, v118, v27
  v_dot2c_f32_bf16 v50, v119, v26
  v_dot2c_f32_bf16 v51, v119, v27
  v_dot2c_f32_bf16 v36, v120, v26
  v_dot2c_f32_bf16 v37, v120, v27
  v_dot2c_f32_bf16 v38, v121, v26
  v_dot2c_f32_bf16 v39, v121, v27
  v_dot2c_f32_bf16 v40, v122, v26
  v_dot2c_f32_bf16 v41, v122, v27
  v_dot2c_f32_bf16 v42, v123, v26
  v_dot2c_f32_bf16 v43, v123, v27
  v_dot2c_f32_bf16 v44, v124, v26
  v_dot2c_f32_bf16 v45, v124, v27
  v_dot2c_f32_bf16 v46, v125, v26
  v_dot2c_f32_bf16 v47, v125, v27
  v_dot2c_f32_bf16 v48, v126, v26
  v_dot2c_f32_bf16 v49, v126, v27
  v_dot2c_f32_bf16 v50, v127, v26
  v_dot2c_f32_bf16 v51, v127, v27
TL_C0:
  s_bitcmp1_b32 s49, 4
  s_cbranch_scc0 TL_C1
  v_dot2c_f32_bf16 v64, v128, v26
  v_dot2c_f32_bf16 v65, v128, v27
  v_dot2c_f32_bf16 v66, v129, v26
  v_dot2c_f32_bf16 v67, v129, v27
  v_dot2c_f32_bf16 v68, v130, v26
  v_dot2c_f32_bf16 v69, v130, v27
  v_dot2c_f32_bf16 v70, v131, v26
  v_dot2c_f32_bf16 v71, v131, v27
  v_dot2c_f32_bf16 v72, v132, v26
  v_dot2c_f32_bf16 v73, v132, v27
  v_dot2c_f32_bf16 v74, v133, v26
  v_dot2c_f32_bf16 v75, v133, v27
  v_dot2c_f32_bf16 v76, v134, v26
  v_dot2c_f32_bf16 v77, v134, v27
  v_dot2c_f32_bf16 v78, v135, v26
  v_dot2c_f32_bf16 v79, v135, v27
  v_dot2c_f32_bf16 v64, v136, v26
  v_dot2c_f32_bf16 v65, v136, v27
  v_dot2c_f32_bf16 v66, v137, v26
  v_dot2c_f32_bf16 v67, v137, v27
  v_dot2c_f32_bf16 v68, v138, v26
  v_dot2c_f32_bf16 v69, v138, v27
  v_dot2c_f32_bf16 v70, v139, v26
  v_dot2c_f32_bf16 v71, v139, v27
  v_dot2c_f32_bf16 v72, v140, v26
  v_dot2c_f32_bf16 v73, v140, v27
  v_dot2c_f32_bf16 v74, v141, v26
  v_dot2c_f32_bf16 v75, v141, v27
  v_dot2c_f32_bf16 v76, v142, v26
  v_dot2c_f32_bf16 v77, v142, v27
  v_dot2c_f32_bf16 v78, v143, v26
  v_dot2c_f32_bf16 v79, v143, v27
  v_dot2c_f32_bf16 v64, v144, v26
  v_dot2c_f32_bf16 v65, v144, v27
  v_dot2c_f32_bf16 v66, v145, v26
  v_dot2c_f32_bf16 v67, v145, v27
  v_dot2c_f32_bf16 v68, v146, v26
  v_dot2c_f32_bf16 v69, v146, v27
  v_dot2c_f32_bf16 v70, v147, v26
  v_dot2c_f32_bf16 v71, v147, v27
  v_dot2c_f32_bf16 v72, v148, v26
  v_dot2c_f32_bf16 v73, v148, v27
  v_dot2c_f32_bf16 v74, v149, v26
  v_dot2c_f32_bf16 v75, v149, v27
  v_dot2c_f32_bf16 v76, v150, v26
  v_dot2c_f32_bf16 v77, v150, v27
  v_dot2c_f32_bf16 v78, v151, v26
  v_dot2c_f32_bf16 v79, v151, v27
  v_dot2c_f32_bf16 v64, v152, v26
  v_dot2c_f32_bf16 v65, v152, v27
  v_dot2c_f32_bf16 v66, v153, v26
  v_dot2c_f32_bf16 v67, v153, v27
  v_dot2c_f32_bf16 v68, v154, v26
  v_dot2c_f32_bf16 v69, v154, v27
  v_dot2c_f32_bf16 v70, v155, v26
  v_dot2c_f32_bf16 v71, v155, v27
  v_dot2c_f32_bf16 v72, v156, v26
  v_dot2c_f32_bf16 v73, v156, v27
  v_dot2c_f32_bf16 v74, v157, v26
  v_dot2c_f32_bf16 v75, v157, v27
  v_dot2c_f32_bf16 v76, v158, v26
  v_dot2c_f32_bf16 v77, v158, v27
  v_dot2c_f32_bf16 v78, v159, v26
  v_dot2c_f32_bf16 v79, v159, v27
TL_C1:
  s_bitcmp1_b32 s49, 8
  s_cbranch_scc0 TL_C2
  v_dot2c_f32_bf16 v80, v160, v26
  v_dot2c_f32_bf16 v81, v160, v27
  v_dot2c_f32_bf16 v82, v161, v26
  v_dot2c_f32_bf16 v83, v161, v27
  v_dot2c_f32_bf16 v84, v162, v26
  v_dot2c_f32_bf16 v85, v162, v27
  v_dot2c_f32_bf16 v86, v163, v26
  v_dot2c_f32_bf16 v87, v163, v27
  v_dot2c_f32_bf16 v88, v164, v26
  v_dot2c_f32_bf16 v89, v164, v27
  v_dot2c_f32_bf16 v90, v165, v26
  v_dot2c_f32_bf16 v91, v165, v27
  v_dot2c_f32_bf16 v92, v166, v26
  v_dot2c_f32_bf16 v93, v166, v27
  v_dot2c_f32_bf16 v94, v167, v26
  v_dot2c_f32_bf16 v95, v167, v27
  v_dot2c_f32_bf16 v80, v168, v26
  v_dot2c_f32_bf16 v81, v168, v27
  v_dot2c_f32_bf16 v82, v169, v26
  v_dot2c_f32_bf16 v83, v169, v27
  v_dot2c_f32_bf16 v84, v170, v26
  v_dot2c_f32_bf16 v85, v170, v27
  v_dot2c_f32_bf16 v86, v171, v26
  v_dot2c_f32_bf16 v87, v171, v27
  v_dot2c_f32_bf16 v88, v172, v26
  v_dot2c_f32_bf16 v89, v172, v27
  v_dot2c_f32_bf16 v90, v173, v26
  v_dot2c_f32_bf16 v91, v173, v27
  v_dot2c_f32_bf16 v92, v174, v26
  v_dot2c_f32_bf16 v93, v174, v27
  v_dot2c_f32_bf16 v94, v175, v26
  v_dot2c_f32_bf16 v95, v175, v27
  v_dot2c_f32_bf16 v80, v176, v26
  v_dot2c_f32_bf16 v81, v176, v27
  v_dot2c_f32_bf16 v82, v177, v26
  v_dot2c_f32_bf16 v83, v177, v27
  v_dot2c_f32_bf16 v84, v178, v26
  v_dot2c_f32_bf16 v85, v178, v27
  v_dot2c_f32_bf16 v86, v179, v26
  v_dot2c_f32_bf16 v87, v179, v27
  v_dot2c_f32_bf16 v88, v180, v26
  v_dot2c_f32_bf16 v89, v180, v27
  v_dot2c_f32_bf16 v90, v181, v26
  v_dot2c_f32_bf16 v91, v181, v27
  v_dot2c_f32_bf16 v92, v182, v26
  v_dot2c_f32_bf16 v93, v182, v27
  v_dot2c_f32_bf16 v94, v183, v26
  v_dot2c_f32_bf16 v95, v183, v27
  v_dot2c_f32_bf16 v80, v184, v26
  v_dot2c_f32_bf16 v81, v184, v27
  v_dot2c_f32_bf16 v82, v185, v26
  v_dot2c_f32_bf16 v83, v185, v27
  v_dot2c_f32_bf16 v84, v186, v26
  v_dot2c_f32_bf16 v85, v186, v27
  v_dot2c_f32_bf16 v86, v187, v26
  v_dot2c_f32_bf16 v87, v187, v27
  v_dot2c_f32_bf16 v88, v188, v26
  v_dot2c_f32_bf16 v89, v188, v27
  v_dot2c_f32_bf16 v90, v189, v26
  v_dot2c_f32_bf16 v91, v189, v27
  v_dot2c_f32_bf16 v92, v190, v26
  v_dot2c_f32_bf16 v93, v190, v27
  v_dot2c_f32_bf16 v94, v191, v26
  v_dot2c_f32_bf16 v95, v191, v27
TL_C2:
  s_bitcmp1_b32 s49, 12
  s_cbranch_scc0 TL_C3
  v_dot2c_f32_bf16 v224, v192, v26
  v_dot2c_f32_bf16 v225, v192, v27
  v_dot2c_f32_bf16 v226, v193, v26
  v_dot2c_f32_bf16 v227, v193, v27
  v_dot2c_f32_bf16 v228, v194, v26
  v_dot2c_f32_bf16 v229, v194, v27
  v_dot2c_f32_bf16 v230, v195, v26
  v_dot2c_f32_bf16 v231, v195, v27
  v_dot2c_f32_bf16 v232, v196, v26
  v_dot2c_f32_bf16 v233, v196, v27
  v_dot2c_f32_bf16 v234, v197, v26
  v_dot2c_f32_bf16 v235, v197, v27
  v_dot2c_f32_bf16 v236, v198, v26
  v_dot2c_f32_bf16 v237, v198, v27
  v_dot2c_f32_bf16 v238, v199, v26
  v_dot2c_f32_bf16 v239, v199, v27
  v_dot2c_f32_bf16 v224, v200, v26
  v_dot2c_f32_bf16 v225, v200, v27
  v_dot2c_f32_bf16 v226, v201, v26
  v_dot2c_f32_bf16 v227, v201, v27
  v_dot2c_f32_bf16 v228, v202, v26
  v_dot2c_f32_bf16 v229, v202, v27
  v_dot2c_f32_bf16 v230, v203, v26
  v_dot2c_f32_bf16 v231, v203, v27
  v_dot2c_f32_bf16 v232, v204, v26
  v_dot2c_f32_bf16 v233, v204, v27
  v_dot2c_f32_bf16 v234, v205, v26
  v_dot2c_f32_bf16 v235, v205, v27
  v_dot2c_f32_bf16 v236, v206, v26
  v_dot2c_f32_bf16 v237, v206, v27
  v_dot2c_f32_bf16 v238, v207, v26
  v_dot2c_f32_bf16 v239, v207, v27
  v_dot2c_f32_bf16 v224, v208, v26
  v_dot2c_f32_bf16 v225, v208, v27
  v_dot2c_f32_bf16 v226, v209, v26
  v_dot2c_f32_bf16 v227, v209, v27
  v_dot2c_f32_bf16 v228, v210, v26
  v_dot2c_f32_bf16 v229, v210, v27
  v_dot2c_f32_bf16 v230, v211, v26
  v_dot2c_f32_bf16 v231, v211, v27
  v_dot2c_f32_bf16 v232, v212, v26
  v_dot2c_f32_bf16 v233, v212, v27
  v_dot2c_f32_bf16 v234, v213, v26
  v_dot2c_f32_bf16 v235, v213, v27
  v_dot2c_f32_bf16 v236, v214, v26
  v_dot2c_f32_bf16 v237, v214, v27
  v_dot2c_f32_bf16 v238, v215, v26
  v_dot2c_f32_bf16 v239, v215, v27
  v_dot2c_f32_bf16 v224, v216, v26
  v_dot2c_f32_bf16 v225, v216, v27
  v_dot2c_f32_bf16 v226, v217, v26
  v_dot2c_f32_bf16 v227, v217, v27
  v_dot2c_f32_bf16 v228, v218, v26
  v_dot2c_f32_bf16 v229, v218, v27
  v_dot2c_f32_bf16 v230, v219, v26
  v_dot2c_f32_bf16 v231, v219, v27
  v_dot2c_f32_bf16 v232, v220, v26
  v_dot2c_f32_bf16 v233, v220, v27
  v_dot2c_f32_bf16 v234, v221, v26
  v_dot2c_f32_bf16 v235, v221, v27
  v_dot2c_f32_bf16 v236, v222, v26
  v_dot2c_f32_bf16 v237, v222, v27
  v_dot2c_f32_bf16 v238, v223, v26
  v_dot2c_f32_bf16 v239, v223, v27
TL_C3:
  s_cmp_lg_u32 s50, 0
  s_cbranch_scc1 TL_RL
  s_cmp_eq_u32 s48, 0x1111
  s_cbranch_scc1 TL_RD
  s_cmp_lg_u32 s51, 0
  s_cbranch_scc1 TL_R30
  s_add_u32 m0, s41, 0
  s_nop 0
  buffer_load_dwordx4 v10, s[4:7], s38 offen offset:0 lds
  buffer_load_dwordx4 v11, s[4:7], s38 offen offset:1024 lds
  buffer_load_dwordx4 v12, s[4:7], s38 offen offset:2048 lds
  buffer_load_dwordx4 v13, s[4:7], s38 offen offset:3072 lds
  s_add_u32 s38, s38, 458752
  s_add_u32 m0, s41, 4096
  s_nop 0
  buffer_load_dwordx4 v10, s[4:7], s38 offen offset:0 lds
  buffer_load_dwordx4 v11, s[4:7], s38 offen offset:1024 lds
  buffer_load_dwordx4 v12, s[4:7], s38 offen offset:2048 lds
  buffer_load_dwordx4 v13, s[4:7], s38 offen offset:3072 lds
  s_add_u32 s38, s38, 458752
  s_add_u32 m0, s41, 32768
  s_nop 0
  buffer_load_dwordx4 v10, s[4:7], s38 offen offset:0 lds
  buffer_load_dwordx4 v11, s[4:7], s38 offen offset:1024 lds
  buffer_load_dwordx4 v12, s[4:7], s38 offen offset:2048 lds
  buffer_load_dwordx4 v13, s[4:7], s38 offen offset:3072 lds
  s_add_u32 s38, s38, 458752
  s_add_u32 m0, s41, 36864
  s_nop 0
  buffer_load_dwordx4 v10, s[4:7], s38 offen offset:0 lds
  buffer_load_dwordx4 v11, s[4:7], s38 offen offset:1024 lds
  buffer_load_dwordx4 v12, s[4:7], s38 offen offset:2048 lds
  buffer_load_dwordx4 v13, s[4:7], s38 offen offset:3072 lds
  s_add_u32 s38, s38, 458752
  s_mov_b32 s51, 1
  s_branch TL_RL
TL_R30:
  s_cmp_lg_u32 s51, 1
  s_cbranch_scc1 TL_R31
  s_add_u32 m0, s65, 0
  s_nop 0
  buffer_load_dwordx4 v10, s[4:7], s38 offen offset:0 lds
  buffer_load_dwordx4 v11, s[4:7], s38 offen offset:1024 lds
  buffer_load_dwordx4 v12, s[4:7], s38 offen offset:2048 lds
  buffer_load_dwordx4 v13, s[4:7], s38 offen offset:3072 lds
  s_add_u32 s38, s38, 458752
  s_add_u32 m0, s65, 4096
  s_nop 0
  buffer_load_dwordx4 v10, s[4:7], s38 offen offset:0 lds
  buffer_load_dwordx4 v11, s[4:7], s38 offen offset:1024 lds
  buffer_load_dwordx4 v12, s[4:7], s38 offen offset:2048 lds
  buffer_load_dwordx4 v13, s[4:7], s38 offen offset:3072 lds
  s_add_u32 s38, s38, 458752
  s_add_u32 m0, s65, 32768
  s_nop 0
  buffer_load_dwordx4 v10, s[4:7], s38 offen offset:0 lds
  buffer_load_dwordx4 v11, s[4:7], s38 offen offset:1024 lds
  buffer_load_dwordx4 v12, s[4:7], s38 offen offset:2048 lds
  buffer_load_dwordx4 v13, s[4:7], s38 offen offset:3072 lds
  s_add_u32 s38, s38, 4291756032
  s_add_u32 m0, s65, 36864
  s_nop 0
  buffer_load_dwordx4 v10, s[4:7], s38 offen offset:0 lds
  buffer_load_dwordx4 v11, s[4:7], s38 offen offset:1024 lds
  buffer_load_dwordx4 v12, s[4:7], s38 offen offset:2048 lds
  buffer_load_dwordx4 v13, s[4:7], s38 offen offset:3072 lds
  s_add_u32 s38, s38, 3670016
  s_mov_b32 s51, 2
  s_branch TL_RL
TL_R31:
  s_cmp_lg_u32 s51, 2
  s_cbranch_scc1 TL_R32
  ds_read_b64_tr_b16 a[0:1], v18 offset:0
  ds_read_b64_tr_b16 a[2:3], v18 offset:512
  ds_read_b64_tr_b16 a[4:5], v19 offset:0
  ds_read_b64_tr_b16 a[6:7], v19 offset:512
  ds_read_b64_tr_b16 a[8:9], v20 offset:0
  ds_read_b64_tr_b16 a[10:11], v20 offset:512
  ds_read_b64_tr_b16 a[12:13], v21 offset:0
  ds_read_b64_tr_b16 a[14:15], v21 offset:512
  ds_read_b64_tr_b16 a[16:17], v18 offset:4096
  ds_read_b64_tr_b16 a[18:19], v18 offset:4608
  ds_read_b64_tr_b16 a[20:21], v19 offset:4096
  ds_read_b64_tr_b16 a[22:23], v19 offset:4608
  ds_read_b64_tr_b16 a[24:25], v20 offset:4096
  ds_read_b64_tr_b16 a[26:27], v20 offset:4608
  ds_read_b64_tr_b16 a[28:29], v21 offset:4096
  ds_read_b64_tr_b16 a[30:31], v21 offset:4608
  ds_read_b64_tr_b16 a[32:33], v18 offset:32768
  ds_read_b64_tr_b16 a[34:35], v18 offset:33280
  ds_read_b64_tr_b16 a[36:37], v19 offset:32768
  ds_read_b64_tr_b16 a[38:39], v19 offset:33280
  ds_read_b64_tr_b16 a[40:41], v20 offset:32768
  ds_read_b64_tr_b16 a[42:43], v20 offset:33280
  ds_read_b64_tr_b16 a[44:45], v21 offset:32768
  ds_read_b64_tr_b16 a[46:47], v21 offset:33280
  ds_read_b64_tr_b16 a[48:49], v18 offset:36864
  ds_read_b64_tr_b16 a[50:51], v18 offset:37376
  ds_read_b64_tr_b16 a[52:53], v19 offset:36864
  ds_read_b64_tr_b16 a[54:55], v19 offset:37376
  ds_read_b64_tr_b16 a[56:57], v20 offset:36864
  ds_read_b64_tr_b16 a[58:59], v20 offset:37376
  ds_read_b64_tr_b16 a[60:61], v21 offset:36864
  ds_read_b64_tr_b16 a[62:63], v21 offset:37376
  ds_read_b64_tr_b16 a[64:65], v241 offset:0
  ds_read_b64_tr_b16 a[66:67], v241 offset:512
  ds_read_b64_tr_b16 a[68:69], v242 offset:0
  ds_read_b64_tr_b16 a[70:71], v242 offset:512
  ds_read_b64_tr_b16 a[72:73], v243 offset:0
  ds_read_b64_tr_b16 a[74:75], v243 offset:512
  ds_read_b64_tr_b16 a[76:77], v244 offset:0
  ds_read_b64_tr_b16 a[78:79], v244 offset:512
  ds_read_b64_tr_b16 a[80:81], v241 offset:4096
  ds_read_b64_tr_b16 a[82:83], v241 offset:4608
  ds_read_b64_tr_b16 a[84:85], v242 offset:4096
  ds_read_b64_tr_b16 a[86:87], v242 offset:4608
  ds_read_b64_tr_b16 a[88:89], v243 offset:4096
  ds_read_b64_tr_b16 a[90:91], v243 offset:4608
  ds_read_b64_tr_b16 a[92:93], v244 offset:4096
  ds_read_b64_tr_b16 a[94:95], v244 offset:4608
  ds_read_b64_tr_b16 a[96:97], v241 offset:32768
  ds_read_b64_tr_b16 a[98:99], v241 offset:33280
  ds_read_b64_tr_b16 a[100:101], v242 offset:32768
  ds_read_b64_tr_b16 a[102:103], v242 offset:33280
  ds_read_b64_tr_b16 a[104:105], v243 offset:32768
  ds_read_b64_tr_b16 a[106:107], v243 offset:33280
  ds_read_b64_tr_b16 a[108:109], v244 offset:32768
  ds_read_b64_tr_b16 a[110:111], v244 offset:33280
  ds_read_b64_tr_b16 a[112:113], v241 offset:36864
  ds_read_b64_tr_b16 a[114:115], v241 offset:37376
  ds_read_b64_tr_b16 a[116:117], v242 offset:36864
  ds_read_b64_tr_b16 a[118:119], v242 offset:37376
  ds_read_b64_tr_b16 a[120:121], v243 offset:36864
  ds_read_b64_tr_b16 a[122:123], v243 offset:37376
  ds_read_b64_tr_b16 a[124:125], v244 offset:36864
  ds_read_b64_tr_b16 a[126:127], v244 offset:37376
  s_waitcnt lgkmcnt(0)
  s_add_u32 m0, s41, 0
  s_nop 0
  buffer_load_dwordx4 v10, s[4:7], s38 offen offset:0 lds
  buffer_load_dwordx4 v11, s[4:7], s38 offen offset:1024 lds
  buffer_load_dwordx4 v12, s[4:7], s38 offen offset:2048 lds
  buffer_load_dwordx4 v13, s[4:7], s38 offen offset:3072 lds
  s_add_u32 s38, s38, 458752
  s_add_u32 m0, s41, 4096
  s_nop 0
  buffer_load_dwordx4 v10, s[4:7], s38 offen offset:0 lds
  buffer_load_dwordx4 v11, s[4:7], s38 offen offset:1024 lds
  buffer_load_dwordx4 v12, s[4:7], s38 offen offset:2048 lds
  buffer_load_dwordx4 v13, s[4:7], s38 offen offset:3072 lds
  s_add_u32 s38, s38, 458752
  s_add_u32 m0, s41, 32768
  s_nop 0
  buffer_load_dwordx4 v10, s[4:7], s38 offen offset:0 lds
  buffer_load_dwordx4 v11, s[4:7], s38 offen offset:1024 lds
  buffer_load_dwordx4 v12, s[4:7], s38 offen offset:2048 lds
  buffer_load_dwordx4 v13, s[4:7], s38 offen offset:3072 lds
  s_add_u32 s38, s38, 458752
  s_add_u32 m0, s41, 36864
  s_nop 0
  buffer_load_dwordx4 v10, s[4:7], s38 offen offset:0 lds
  buffer_load_dwordx4 v11, s[4:7], s38 offen offset:1024 lds
  buffer_load_dwordx4 v12, s[4:7], s38 offen offset:2048 lds
  buffer_load_dwordx4 v13, s[4:7], s38 offen offset:3072 lds
  s_add_u32 s38, s38, 458752
  s_mov_b32 s51, 3
  s_branch TL_RL
TL_R32:
  s_cmp_lg_u32 s51, 3
  s_cbranch_scc1 TL_R33
  s_add_u32 m0, s65, 0
  s_nop 0
  buffer_load_dwordx4 v10, s[4:7], s38 offen offset:0 lds
  buffer_load_dwordx4 v11, s[4:7], s38 offen offset:1024 lds
  buffer_load_dwordx4 v12, s[4:7], s38 offen offset:2048 lds
  buffer_load_dwordx4 v13, s[4:7], s38 offen offset:3072 lds
  s_add_u32 s38, s38, 458752
  s_add_u32 m0, s65, 4096
  s_nop 0
  buffer_load_dwordx4 v10, s[4:7], s38 offen offset:0 lds
  buffer_load_dwordx4 v11, s[4:7], s38 offen offset:1024 lds
  buffer_load_dwordx4 v12, s[4:7], s38 offen offset:2048 lds
  buffer_load_dwordx4 v13, s[4:7], s38 offen offset:3072 lds
  s_add_u32 s38, s38, 458752
  s_add_u32 m0, s65, 32768
  s_nop 0
  buffer_load_dwordx4 v10, s[4:7], s38 offen offset:0 lds
  buffer_load_dwordx4 v11, s[4:7], s38 offen offset:1024 lds
  buffer_load_dwordx4 v12, s[4:7], s38 offen offset:2048 lds
  buffer_load_dwordx4 v13, s[4:7], s38 offen offset:3072 lds
  s_add_u32 s38, s38, 458752
  s_add_u32 m0, s65, 36864
  s_nop 0
  buffer_load_dwordx4 v10, s[4:7], s38 offen offset:0 lds
  buffer_load_dwordx4 v11, s[4:7], s38 offen offset:1024 lds
  buffer_load_dwordx4 v12, s[4:7], s38 offen offset:2048 lds
  buffer_load_dwordx4 v13, s[4:7], s38 offen offset:3072 lds
  s_add_u32 s38, s38, 458752
  s_mov_b32 s51, 4
  s_branch TL_RL
TL_R33:
  s_sleep 1
  s_sub_u32 s59, s59, 1
  s_cbranch_scc0 TL_RL
TL_RD:
  v_pk_add_f32 v[36:37], v[36:37], v[64:65]
  v_pk_add_f32 v[38:39], v[38:39], v[66:67]
  v_pk_add_f32 v[40:41], v[40:41], v[68:69]
  v_pk_add_f32 v[42:43], v[42:43], v[70:71]
  v_pk_add_f32 v[44:45], v[44:45], v[72:73]
  v_pk_add_f32 v[46:47], v[46:47], v[74:75]
  v_pk_add_f32 v[48:49], v[48:49], v[76:77]
  v_pk_add_f32 v[50:51], v[50:51], v[78:79]
  v_pk_add_f32 v[80:81], v[80:81], v[224:225]
  v_pk_add_f32 v[82:83], v[82:83], v[226:227]
  v_pk_add_f32 v[84:85], v[84:85], v[228:229]
  v_pk_add_f32 v[86:87], v[86:87], v[230:231]
  v_pk_add_f32 v[88:89], v[88:89], v[232:233]
  v_pk_add_f32 v[90:91], v[90:91], v[234:235]
  v_pk_add_f32 v[92:93], v[92:93], v[236:237]
  v_pk_add_f32 v[94:95], v[94:95], v[238:239]
  v_pk_add_f32 v[36:37], v[36:37], v[80:81]
  v_pk_add_f32 v[38:39], v[38:39], v[82:83]
  v_pk_add_f32 v[40:41], v[40:41], v[84:85]
  v_pk_add_f32 v[42:43], v[42:43], v[86:87]
  s_cmp_ge_u32 s51, 1
  s_cbranch_scc1 TL_S0
  s_add_u32 m0, s41, 0
  s_nop 0
  buffer_load_dwordx4 v10, s[4:7], s38 offen offset:0 lds
  buffer_load_dwordx4 v11, s[4:7], s38 offen offset:1024 lds
  buffer_load_dwordx4 v12, s[4:7], s38 offen offset:2048 lds
  buffer_load_dwordx4 v13, s[4:7], s38 offen offset:3072 lds
  s_add_u32 s38, s38, 458752
TL_S0:
  v_pk_add_f32 v[44:45], v[44:45], v[88:89]
  v_pk_add_f32 v[46:47], v[46:47], v[90:91]
  v_pk_add_f32 v[48:49], v[48:49], v[92:93]
  v_pk_add_f32 v[50:51], v[50:51], v[94:95]
  v_pk_mul_f32 v[54:55], v[36:37], v[36:37]
  v_pk_add_f32 v[52:53], v[36:37], v[38:39]
  v_pk_fma_f32 v[54:55], v[38:39], v[38:39], v[54:55]
  v_pk_fma_f32 v[54:55], v[40:41], v[40:41], v[54:55]
  v_pk_add_f32 v[52:53], v[52:53], v[40:41]
  v_pk_fma_f32 v[54:55], v[42:43], v[42:43], v[54:55]
  v_pk_add_f32 v[52:53], v[52:53], v[42:43]
  v_pk_fma_f32 v[54:55], v[44:45], v[44:45], v[54:55]
  v_pk_add_f32 v[52:53], v[52:53], v[44:45]
  v_pk_fma_f32 v[54:55], v[46:47], v[46:47], v[54:55]
  v_pk_add_f32 v[52:53], v[52:53], v[46:47]
  v_pk_fma_f32 v[54:55], v[48:49], v[48:49], v[54:55]
  v_pk_add_f32 v[52:53], v[52:53], v[48:49]
  v_pk_fma_f32 v[54:55], v[50:51], v[50:51], v[54:55]
  v_pk_add_f32 v[52:53], v[52:53], v[50:51]
  v_add_f32 v52, v52, v53
  s_cmp_ge_u32 s51, 1
  s_cbranch_scc1 TL_S1
  s_add_u32 m0, s41, 4096
  s_nop 0
  buffer_load_dwordx4 v10, s[4:7], s38 offen offset:0 lds
  buffer_load_dwordx4 v11, s[4:7], s38 offen offset:1024 lds
  buffer_load_dwordx4 v12, s[4:7], s38 offen offset:2048 lds
  buffer_load_dwordx4 v13, s[4:7], s38 offen offset:3072 lds
  s_add_u32 s38, s38, 458752
TL_S1:
  v_add_f32 v53, v54, v55
  v_cvt_pk_bf16_f32 v28, v36, v37
  v_cvt_pk_bf16_f32 v29, v38, v39
  v_add_f32_dpp v52, v52, v52 row_ror:8 row_mask:0xf bank_mask:0xf
  v_add_f32_dpp v53, v53, v53 row_ror:8 row_mask:0xf bank_mask:0xf
  v_mov_b64 v[54:55], v[52:53]
  v_cvt_pk_bf16_f32 v30, v40, v41
  v_cvt_pk_bf16_f32 v31, v42, v43
  v_permlane16_swap_b32 v52, v54
  v_permlane16_swap_b32 v53, v55
  v_cvt_pk_bf16_f32 v32, v44, v45
  v_pk_add_f32 v[52:53], v[52:53], v[54:55]
  v_mov_b64 v[54:55], v[52:53]
  v_cvt_pk_bf16_f32 v33, v46, v47
  v_cvt_pk_bf16_f32 v34, v48, v49
  v_permlane32_swap_b32 v52, v54
  v_permlane32_swap_b32 v53, v55
  v_cvt_pk_bf16_f32 v35, v50, v51
  v_pk_add_f32 v[52:53], v[52:53], v[54:55]
  ds_write_b64 v249, v[28:29]
  ds_write_b64 v249, v[30:31] offset:32
  ds_write_b64 v251, v[52:53]
  s_cmp_eq_u32 s20, 3
  s_cbranch_scc1 TL_H1
  ds_write_b64 v249, v[32:33] offset:512
  ds_write_b64 v249, v[34:35] offset:544
TL_H1:
  s_waitcnt lgkmcnt(0)
  s_barrier
  ds_read_b64 v[64:65], v250 offset:0
  ds_read_b64 v[66:67], v250 offset:64
  ds_read_b64 v[68:69], v250 offset:128
  ds_read_b64 v[70:71], v250 offset:192
  ds_read_b64_tr_b16 v[28:29], v57 offset:0
  ds_read_b64_tr_b16 v[30:31], v57 offset:3648
  ds_read_b64_tr_b16 v[32:33], v57 offset:512
  ds_read_b64_tr_b16 v[34:35], v57 offset:4160
  ds_read_b128 v[72:75], v56
  ds_read_b128 v[76:79], v56 offset:4096
  s_waitcnt lgkmcnt(6)
  v_pk_add_f32 v[64:65], v[64:65], v[66:67]
  s_cmp_ge_u32 s51, 1
  s_cbranch_scc1 TL_S2
  s_add_u32 m0, s41, 32768
  s_nop 0
  buffer_load_dwordx4 v10, s[4:7], s38 offen offset:0 lds
  buffer_load_dwordx4 v11, s[4:7], s38 offen offset:1024 lds
  buffer_load_dwordx4 v12, s[4:7], s38 offen offset:2048 lds
  buffer_load_dwordx4 v13, s[4:7], s38 offen offset:3072 lds
  s_add_u32 s38, s38, 458752
TL_S2:
  v_pk_add_f32 v[68:69], v[68:69], v[70:71]
  v_pk_add_f32 v[64:65], v[64:65], v[68:69]
  v_mul_f32 v64, 0x3b124925, v64
  v_mul_f32 v65, 0x3b124925, v65
  v_fma_f32 v65, -v64, v64, v65
  v_max_f32 v65, 0, v65
  v_add_f32 v66, 0x3727c5ac, v65
  v_rsq_f32 v66, v66
  s_nop 0
  v_mul_f32 v67, v66, v66
  v_fmaak_f32 v67, v67, v65, 0x3727c5ac
  v_rsq_f32 v67, v67
  s_nop 0
  v_mul_f32 v66, v66, v67
  v_readlane_b32 s48, v64, 0
  v_readlane_b32 s56, v66, 0
  v_readlane_b32 s49, v64, 1
  v_readlane_b32 s57, v66, 1
  v_readlane_b32 s50, v64, 2
  v_readlane_b32 s24, v66, 2
  s_cmp_ge_u32 s51, 1
  s_cbranch_scc1 TL_S3
  s_add_u32 m0, s41, 36864
  s_nop 0
  buffer_load_dwordx4 v10, s[4:7], s38 offen offset:0 lds
  buffer_load_dwordx4 v11, s[4:7], s38 offen offset:1024 lds
  buffer_load_dwordx4 v12, s[4:7], s38 offen offset:2048 lds
  buffer_load_dwordx4 v13, s[4:7], s38 offen offset:3072 lds
  s_add_u32 s38, s38, 458752
TL_S3:
  v_readlane_b32 s47, v64, 3
  v_readlane_b32 s25, v66, 3
  v_readlane_b32 s32, v64, 4
  v_readlane_b32 s28, v66, 4
  v_readlane_b32 s33, v64, 5
  v_readlane_b32 s29, v66, 5
  v_readlane_b32 s54, v64, 6
  v_readlane_b32 s30, v66, 6
  v_readlane_b32 s55, v64, 7
  v_readlane_b32 s31, v66, 7
  s_waitcnt lgkmcnt(2)
  v_lshlrev_b32 v36, 16, v28
  v_and_b32 v37, 0xffff0000, v28
  v_lshlrev_b32 v38, 16, v29
  v_and_b32 v39, 0xffff0000, v29
  v_lshlrev_b32 v40, 16, v30
  v_and_b32 v41, 0xffff0000, v30
  v_lshlrev_b32 v42, 16, v31
  v_and_b32 v43, 0xffff0000, v31
  v_subrev_f32 v36, s48, v36
  v_subrev_f32 v37, s49, v37
  v_subrev_f32 v38, s50, v38
  v_subrev_f32 v39, s47, v39
  v_subrev_f32 v40, s32, v40
  v_subrev_f32 v41, s33, v41
  v_subrev_f32 v42, s54, v42
  v_subrev_f32 v43, s55, v43
  v_mul_f32 v36, s56, v36
  v_mul_f32 v37, s57, v37
  v_mul_f32 v38, s24, v38
  v_mul_f32 v39, s25, v39
  v_mul_f32 v40, s28, v40
  v_mul_f32 v41, s29, v41
  v_mul_f32 v42, s30, v42
  v_mul_f32 v43, s31, v43
  v_cvt_pk_bf16_f32 v44, v36, v37
  v_cvt_pk_bf16_f32 v45, v38, v39
  v_cvt_pk_bf16_f32 v46, v40, v41
  v_cvt_pk_bf16_f32 v47, v42, v43
  buffer_store_dwordx4 v[44:47], v58, s[12:15], s67 offen sc1
  v_lshlrev_b32 v36, 16, v32
  v_and_b32 v37, 0xffff0000, v32
  v_lshlrev_b32 v38, 16, v33
  v_and_b32 v39, 0xffff0000, v33
  v_lshlrev_b32 v40, 16, v34
  v_and_b32 v41, 0xffff0000, v34
  v_lshlrev_b32 v42, 16, v35
  v_and_b32 v43, 0xffff0000, v35
  v_subrev_f32 v36, s48, v36
  v_subrev_f32 v37, s49, v37
  v_subrev_f32 v38, s50, v38
  v_subrev_f32 v39, s47, v39
  v_subrev_f32 v40, s32, v40
  v_subrev_f32 v41, s33, v41
  v_subrev_f32 v42, s54, v42
  v_subrev_f32 v43, s55, v43
  v_mul_f32 v36, s56, v36
  v_mul_f32 v37, s57, v37
  v_mul_f32 v38, s24, v38
  v_mul_f32 v39, s25, v39
  v_mul_f32 v40, s28, v40
  v_mul_f32 v41, s29, v41
  v_mul_f32 v42, s30, v42
  v_mul_f32 v43, s31, v43
  v_cvt_pk_bf16_f32 v48, v36, v37
  v_cvt_pk_bf16_f32 v49, v38, v39
  v_cvt_pk_bf16_f32 v50, v40, v41
  v_cvt_pk_bf16_f32 v51, v42, v43
  buffer_store_dwordx4 v[48:51], v59, s[12:15], s67 offen sc1
  s_waitcnt lgkmcnt(0)
  buffer_store_dwordx4 v[72:75], v252, s[12:15], s44 offen sc1
  buffer_store_dwordx4 v[76:79], v253, s[12:15], s44 offen sc1
  s_lshl_b32 s43, s20, 9
  s_add_u32 s43, s43, 94502912
  s_mov_b32 s52, 0
  v_mov_b32 v25, 0
  v_mov_b32 v4, v60
  v_mov_b32 v5, v61
  v_mov_b32 v6, v62
  v_mov_b32 v7, v63
  s_mul_i32 s39, s20, 28672
  s_lshl_b32 s60, s64, 12
  s_add_u32 s39, s39, s60
  s_add_u32 s39, s39, 76660736
  s_cmp_ge_u32 s51, 2
  s_cbranch_scc1 TL_E0
  s_add_u32 m0, s65, 0
  s_nop 0
  buffer_load_dwordx4 v10, s[4:7], s38 offen offset:0 lds
  buffer_load_dwordx4 v11, s[4:7], s38 offen offset:1024 lds
  buffer_load_dwordx4 v12, s[4:7], s38 offen offset:2048 lds
  buffer_load_dwordx4 v13, s[4:7], s38 offen offset:3072 lds
  s_add_u32 s38, s38, 458752
  s_add_u32 m0, s65, 4096
  s_nop 0
  buffer_load_dwordx4 v10, s[4:7], s38 offen offset:0 lds
  buffer_load_dwordx4 v11, s[4:7], s38 offen offset:1024 lds
  buffer_load_dwordx4 v12, s[4:7], s38 offen offset:2048 lds
  buffer_load_dwordx4 v13, s[4:7], s38 offen offset:3072 lds
  s_add_u32 s38, s38, 458752
  s_add_u32 m0, s65, 32768
  s_nop 0
  buffer_load_dwordx4 v10, s[4:7], s38 offen offset:0 lds
  buffer_load_dwordx4 v11, s[4:7], s38 offen offset:1024 lds
  buffer_load_dwordx4 v12, s[4:7], s38 offen offset:2048 lds
  buffer_load_dwordx4 v13, s[4:7], s38 offen offset:3072 lds
  s_add_u32 s38, s38, 4291756032
  s_add_u32 m0, s65, 36864
  s_nop 0
  buffer_load_dwordx4 v10, s[4:7], s38 offen offset:0 lds
  buffer_load_dwordx4 v11, s[4:7], s38 offen offset:1024 lds
  buffer_load_dwordx4 v12, s[4:7], s38 offen offset:2048 lds
  buffer_load_dwordx4 v13, s[4:7], s38 offen offset:3072 lds
  s_add_u32 s38, s38, 3670016
  s_waitcnt vmcnt(16)
  s_branch TL_E1
TL_E0:
  s_waitcnt vmcnt(0)
TL_E1:
  s_barrier
  s_mov_b64 exec, 1
  buffer_store_dword v2, off, s[12:15], s58 sc1
  s_mov_b64 exec, -1
  s_cmp_ge_u32 s27, 32
  s_cbranch_scc1 MN_END
  s_cmp_ge_u32 s26, 28
  s_cbranch_scc1 TL_NOM1
  s_cmp_ge_u32 s51, 3
  s_cbranch_scc1 TL_E2
  s_waitcnt vmcnt(1)
  ds_read_b64_tr_b16 a[0:1], v18 offset:0
  ds_read_b64_tr_b16 a[2:3], v18 offset:512
  ds_read_b64_tr_b16 a[4:5], v19 offset:0
  ds_read_b64_tr_b16 a[6:7], v19 offset:512
  ds_read_b64_tr_b16 a[8:9], v20 offset:0
  ds_read_b64_tr_b16 a[10:11], v20 offset:512
  ds_read_b64_tr_b16 a[12:13], v21 offset:0
  ds_read_b64_tr_b16 a[14:15], v21 offset:512
  ds_read_b64_tr_b16 a[16:17], v18 offset:4096
  ds_read_b64_tr_b16 a[18:19], v18 offset:4608
  ds_read_b64_tr_b16 a[20:21], v19 offset:4096
  ds_read_b64_tr_b16 a[22:23], v19 offset:4608
  ds_read_b64_tr_b16 a[24:25], v20 offset:4096
  ds_read_b64_tr_b16 a[26:27], v20 offset:4608
  ds_read_b64_tr_b16 a[28:29], v21 offset:4096
  ds_read_b64_tr_b16 a[30:31], v21 offset:4608
  ds_read_b64_tr_b16 a[32:33], v18 offset:32768
  ds_read_b64_tr_b16 a[34:35], v18 offset:33280
  ds_read_b64_tr_b16 a[36:37], v19 offset:32768
  ds_read_b64_tr_b16 a[38:39], v19 offset:33280
  ds_read_b64_tr_b16 a[40:41], v20 offset:32768
  ds_read_b64_tr_b16 a[42:43], v20 offset:33280
  ds_read_b64_tr_b16 a[44:45], v21 offset:32768
  ds_read_b64_tr_b16 a[46:47], v21 offset:33280
  ds_read_b64_tr_b16 a[48:49], v18 offset:36864
  ds_read_b64_tr_b16 a[50:51], v18 offset:37376
  ds_read_b64_tr_b16 a[52:53], v19 offset:36864
  ds_read_b64_tr_b16 a[54:55], v19 offset:37376
  ds_read_b64_tr_b16 a[56:57], v20 offset:36864
  ds_read_b64_tr_b16 a[58:59], v20 offset:37376
  ds_read_b64_tr_b16 a[60:61], v21 offset:36864
  ds_read_b64_tr_b16 a[62:63], v21 offset:37376
  ds_read_b64_tr_b16 a[64:65], v241 offset:0
  ds_read_b64_tr_b16 a[66:67], v241 offset:512
  ds_read_b64_tr_b16 a[68:69], v242 offset:0
  ds_read_b64_tr_b16 a[70:71], v242 offset:512
  ds_read_b64_tr_b16 a[72:73], v243 offset:0
  ds_read_b64_tr_b16 a[74:75], v243 offset:512
  ds_read_b64_tr_b16 a[76:77], v244 offset:0
  ds_read_b64_tr_b16 a[78:79], v244 offset:512
  ds_read_b64_tr_b16 a[80:81], v241 offset:4096
  ds_read_b64_tr_b16 a[82:83], v241 offset:4608
  ds_read_b64_tr_b16 a[84:85], v242 offset:4096
  ds_read_b64_tr_b16 a[86:87], v242 offset:4608
  ds_read_b64_tr_b16 a[88:89], v243 offset:4096
  ds_read_b64_tr_b16 a[90:91], v243 offset:4608
  ds_read_b64_tr_b16 a[92:93], v244 offset:4096
  ds_read_b64_tr_b16 a[94:95], v244 offset:4608
  ds_read_b64_tr_b16 a[96:97], v241 offset:32768
  ds_read_b64_tr_b16 a[98:99], v241 offset:33280
  ds_read_b64_tr_b16 a[100:101], v242 offset:32768
  ds_read_b64_tr_b16 a[102:103], v242 offset:33280
  ds_read_b64_tr_b16 a[104:105], v243 offset:32768
  ds_read_b64_tr_b16 a[106:107], v243 offset:33280
  ds_read_b64_tr_b16 a[108:109], v244 offset:32768
  ds_read_b64_tr_b16 a[110:111], v244 offset:33280
  ds_read_b64_tr_b16 a[112:113], v241 offset:36864
  ds_read_b64_tr_b16 a[114:115], v241 offset:37376
  ds_read_b64_tr_b16 a[116:117], v242 offset:36864
  ds_read_b64_tr_b16 a[118:119], v242 offset:37376
  ds_read_b64_tr_b16 a[120:121], v243 offset:36864
  ds_read_b64_tr_b16 a[122:123], v243 offset:37376
  ds_read_b64_tr_b16 a[124:125], v244 offset:36864
  ds_read_b64_tr_b16 a[126:127], v244 offset:37376
  s_waitcnt lgkmcnt(0)
  s_add_u32 m0, s41, 0
  s_nop 0
  buffer_load_dwordx4 v10, s[4:7], s38 offen offset:0 lds
  buffer_load_dwordx4 v11, s[4:7], s38 offen offset:1024 lds
  buffer_load_dwordx4 v12, s[4:7], s38 offen offset:2048 lds
  buffer_load_dwordx4 v13, s[4:7], s38 offen offset:3072 lds
  s_add_u32 s38, s38, 458752
  s_add_u32 m0, s41, 4096
  s_nop 0
  buffer_load_dwordx4 v10, s[4:7], s38 offen offset:0 lds
  buffer_load_dwordx4 v11, s[4:7], s38 offen offset:1024 lds
  buffer_load_dwordx4 v12, s[4:7], s38 offen offset:2048 lds
  buffer_load_dwordx4 v13, s[4:7], s38 offen offset:3072 lds
  s_add_u32 s38, s38, 458752
  s_add_u32 m0, s41, 32768
  s_nop 0
  buffer_load_dwordx4 v10, s[4:7], s38 offen offset:0 lds
  buffer_load_dwordx4 v11, s[4:7], s38 offen offset:1024 lds
  buffer_load_dwordx4 v12, s[4:7], s38 offen offset:2048 lds
  buffer_load_dwordx4 v13, s[4:7], s38 offen offset:3072 lds
  s_add_u32 s38, s38, 458752
  s_add_u32 m0, s41, 36864
  s_nop 0
  buffer_load_dwordx4 v10, s[4:7], s38 offen offset:0 lds
  buffer_load_dwordx4 v11, s[4:7], s38 offen offset:1024 lds
  buffer_load_dwordx4 v12, s[4:7], s38 offen offset:2048 lds
  buffer_load_dwordx4 v13, s[4:7], s38 offen offset:3072 lds
  s_add_u32 s38, s38, 458752
TL_E2:
  s_cmp_ge_u32 s51, 4
  s_cbranch_scc1 TL_E3
  s_add_u32 m0, s65, 0
  s_nop 0
  buffer_load_dwordx4 v10, s[4:7], s38 offen offset:0 lds
  buffer_load_dwordx4 v11, s[4:7], s38 offen offset:1024 lds
  buffer_load_dwordx4 v12, s[4:7], s38 offen offset:2048 lds
  buffer_load_dwordx4 v13, s[4:7], s38 offen offset:3072 lds
  s_add_u32 s38, s38, 458752
  s_add_u32 m0, s65, 4096
  s_nop 0
  buffer_load_dwordx4 v10, s[4:7], s38 offen offset:0 lds
  buffer_load_dwordx4 v11, s[4:7], s38 offen offset:1024 lds
  buffer_load_dwordx4 v12, s[4:7], s38 offen offset:2048 lds
  buffer_load_dwordx4 v13, s[4:7], s38 offen offset:3072 lds
  s_add_u32 s38, s38, 458752
  s_add_u32 m0, s65, 32768
  s_nop 0
  buffer_load_dwordx4 v10, s[4:7], s38 offen offset:0 lds
  buffer_load_dwordx4 v11, s[4:7], s38 offen offset:1024 lds
  buffer_load_dwordx4 v12, s[4:7], s38 offen offset:2048 lds
  buffer_load_dwordx4 v13, s[4:7], s38 offen offset:3072 lds
  s_add_u32 s38, s38, 458752
  s_add_u32 m0, s65, 36864
  s_nop 0
  buffer_load_dwordx4 v10, s[4:7], s38 offen offset:0 lds
  buffer_load_dwordx4 v11, s[4:7], s38 offen offset:1024 lds
  buffer_load_dwordx4 v12, s[4:7], s38 offen offset:2048 lds
  buffer_load_dwordx4 v13, s[4:7], s38 offen offset:3072 lds
  s_add_u32 s38, s38, 458752
TL_E3:
  s_mul_i32 s38, s20, 1835008
  s_lshl_b32 s60, s27, 7
  s_add_u32 s38, s38, s60
  s_mov_b32 s51, 0
  v_lshrrev_b32 v26, 4, v1
  v_lshlrev_b32 v26, 3, v26
  s_lshl_b32 s60, s26, 7
  buffer_load_dwordx2 v[224:225], v26, s[72:75], s60 offen offset:0
  buffer_load_dwordx2 v[226:227], v26, s[72:75], s60 offen offset:32
  buffer_load_dwordx2 v[228:229], v26, s[72:75], s60 offen offset:64
  buffer_load_dwordx2 v[230:231], v26, s[72:75], s60 offen offset:96
  s_cmp_ge_u32 s52, 4
  s_cbranch_scc0 TL_G_24
TL_GB_25:
  buffer_load_dwordx4 v[96:99], v4, s[12:15], s39 offen sc1
  buffer_load_dwordx4 v[100:103], v5, s[12:15], s39 offen sc1
  buffer_load_dwordx4 v[104:107], v6, s[12:15], s39 offen sc1
  buffer_load_dwordx4 v[108:111], v7, s[12:15], s39 offen sc1
  s_add_u32 s39, s39, 114688
  s_cmp_ge_u32 s52, 8
  s_cbranch_scc0 TL_G_26
TL_GB_27:
  buffer_load_dwordx4 v[112:115], v4, s[12:15], s39 offen sc1
  buffer_load_dwordx4 v[116:119], v5, s[12:15], s39 offen sc1
  buffer_load_dwordx4 v[120:123], v6, s[12:15], s39 offen sc1
  buffer_load_dwordx4 v[124:127], v7, s[12:15], s39 offen sc1
  s_add_u32 s39, s39, 114688
  s_cmp_ge_u32 s52, 12
  s_cbranch_scc0 TL_G_28
TL_GB_29:
  buffer_load_dwordx4 v[128:131], v4, s[12:15], s39 offen sc1
  buffer_load_dwordx4 v[132:135], v5, s[12:15], s39 offen sc1
  buffer_load_dwordx4 v[136:139], v6, s[12:15], s39 offen sc1
  buffer_load_dwordx4 v[140:143], v7, s[12:15], s39 offen sc1
  s_add_u32 s39, s39, 114688
  s_cmp_ge_u32 s52, 16
  s_cbranch_scc0 TL_G_30
TL_GB_31:
  buffer_load_dwordx4 v[144:147], v4, s[12:15], s39 offen sc1
  buffer_load_dwordx4 v[148:151], v5, s[12:15], s39 offen sc1
  buffer_load_dwordx4 v[152:155], v6, s[12:15], s39 offen sc1
  buffer_load_dwordx4 v[156:159], v7, s[12:15], s39 offen sc1
  s_add_u32 s39, s39, 114688
  s_cmp_ge_u32 s52, 20
  s_cbranch_scc0 TL_G_32
TL_GB_33:
  buffer_load_dwordx4 v[160:163], v4, s[12:15], s39 offen sc1
  buffer_load_dwordx4 v[164:167], v5, s[12:15], s39 offen sc1
  buffer_load_dwordx4 v[168:171], v6, s[12:15], s39 offen sc1
  buffer_load_dwordx4 v[172:175], v7, s[12:15], s39 offen sc1
  s_add_u32 s39, s39, 114688
  s_cmp_ge_u32 s52, 24
  s_cbranch_scc0 TL_G_34
TL_GB_35:
  buffer_load_dwordx4 v[176:179], v4, s[12:15], s39 offen sc1
  buffer_load_dwordx4 v[180:183], v5, s[12:15], s39 offen sc1
  buffer_load_dwordx4 v[184:187], v6, s[12:15], s39 offen sc1
  buffer_load_dwordx4 v[188:191], v7, s[12:15], s39 offen sc1
  s_add_u32 s39, s39, 114688
  s_waitcnt vmcnt(20)
  v_mfma_f32_16x16x32_bf16 v[32:35], a[0:3], v[96:99], 0
  v_mfma_f32_16x16x32_bf16 v[48:51], a[0:3], v[100:103], 0
  v_mfma_f32_16x16x32_bf16 v[64:67], a[0:3], v[104:107], 0
  v_mfma_f32_16x16x32_bf16 v[80:83], a[0:3], v[108:111], 0
  s_cmp_ge_u32 s52, 28
  s_cbranch_scc0 TL_G_36
TL_GB_37:
  buffer_load_dwordx4 v[192:195], v4, s[12:15], s39 offen sc1
  v_mfma_f32_16x16x32_bf16 v[84:87], a[4:7], v[108:111], 0
  v_mfma_f32_16x16x32_bf16 v[68:71], a[4:7], v[104:107], 0
  v_mfma_f32_16x16x32_bf16 v[52:55], a[4:7], v[100:103], 0
  v_mfma_f32_16x16x32_bf16 v[36:39], a[4:7], v[96:99], 0
  buffer_load_dwordx4 v[196:199], v5, s[12:15], s39 offen sc1
  v_mfma_f32_16x16x32_bf16 v[40:43], a[8:11], v[96:99], 0
  v_mfma_f32_16x16x32_bf16 v[56:59], a[8:11], v[100:103], 0
  v_mfma_f32_16x16x32_bf16 v[72:75], a[8:11], v[104:107], 0
  v_mfma_f32_16x16x32_bf16 v[88:91], a[8:11], v[108:111], 0
  buffer_load_dwordx4 v[200:203], v6, s[12:15], s39 offen sc1
  v_mfma_f32_16x16x32_bf16 v[92:95], a[12:15], v[108:111], 0
  v_mfma_f32_16x16x32_bf16 v[76:79], a[12:15], v[104:107], 0
  v_mfma_f32_16x16x32_bf16 v[60:63], a[12:15], v[100:103], 0
  v_mfma_f32_16x16x32_bf16 v[44:47], a[12:15], v[96:99], 0
  buffer_load_dwordx4 v[204:207], v7, s[12:15], s39 offen sc1
  s_add_u32 s39, s39, 4294164480
  s_waitcnt vmcnt(20)
  s_cmp_eq_u32 s51, 0
  s_cbranch_scc0 TL_X3
  ds_read_b64_tr_b16 a[128:129], v18 offset:0
  ds_read_b64_tr_b16 a[130:131], v18 offset:512
  ds_read_b64_tr_b16 a[132:133], v19 offset:0
  ds_read_b64_tr_b16 a[134:135], v19 offset:512
  ds_read_b64_tr_b16 a[136:137], v20 offset:0
  ds_read_b64_tr_b16 a[138:139], v20 offset:512
  ds_read_b64_tr_b16 a[140:141], v21 offset:0
  ds_read_b64_tr_b16 a[142:143], v21 offset:512
  ds_read_b64_tr_b16 a[144:145], v18 offset:4096
  ds_read_b64_tr_b16 a[146:147], v18 offset:4608
  ds_read_b64_tr_b16 a[148:149], v19 offset:4096
  ds_read_b64_tr_b16 a[150:151], v19 offset:4608
  ds_read_b64_tr_b16 a[152:153], v20 offset:4096
  ds_read_b64_tr_b16 a[154:155], v20 offset:4608
  ds_read_b64_tr_b16 a[156:157], v21 offset:4096
  ds_read_b64_tr_b16 a[158:159], v21 offset:4608
  ds_read_b64_tr_b16 a[160:161], v18 offset:32768
  ds_read_b64_tr_b16 a[162:163], v18 offset:33280
  ds_read_b64_tr_b16 a[164:165], v19 offset:32768
  ds_read_b64_tr_b16 a[166:167], v19 offset:33280
  ds_read_b64_tr_b16 a[168:169], v20 offset:32768
  ds_read_b64_tr_b16 a[170:171], v20 offset:33280
  ds_read_b64_tr_b16 a[172:173], v21 offset:32768
  ds_read_b64_tr_b16 a[174:175], v21 offset:33280
  ds_read_b64_tr_b16 a[176:177], v18 offset:36864
  ds_read_b64_tr_b16 a[178:179], v18 offset:37376
  ds_read_b64_tr_b16 a[180:181], v19 offset:36864
  ds_read_b64_tr_b16 a[182:183], v19 offset:37376
  ds_read_b64_tr_b16 a[184:185], v20 offset:36864
  ds_read_b64_tr_b16 a[186:187], v20 offset:37376
  ds_read_b64_tr_b16 a[188:189], v21 offset:36864
  ds_read_b64_tr_b16 a[190:191], v21 offset:37376
  ds_read_b64_tr_b16 a[192:193], v241 offset:0
  ds_read_b64_tr_b16 a[194:195], v241 offset:512
  ds_read_b64_tr_b16 a[196:197], v242 offset:0
  ds_read_b64_tr_b16 a[198:199], v242 offset:512
  ds_read_b64_tr_b16 a[200:201], v243 offset:0
  ds_read_b64_tr_b16 a[202:203], v243 offset:512
  ds_read_b64_tr_b16 a[204:205], v244 offset:0
  ds_read_b64_tr_b16 a[206:207], v244 offset:512
  ds_read_b64_tr_b16 a[208:209], v241 offset:4096
  ds_read_b64_tr_b16 a[210:211], v241 offset:4608
  ds_read_b64_tr_b16 a[212:213], v242 offset:4096
  ds_read_b64_tr_b16 a[214:215], v242 offset:4608
  ds_read_b64_tr_b16 a[216:217], v243 offset:4096
  ds_read_b64_tr_b16 a[218:219], v243 offset:4608
  ds_read_b64_tr_b16 a[220:221], v244 offset:4096
  ds_read_b64_tr_b16 a[222:223], v244 offset:4608
  ds_read_b64_tr_b16 a[224:225], v241 offset:32768
  ds_read_b64_tr_b16 a[226:227], v241 offset:33280
  ds_read_b64_tr_b16 a[228:229], v242 offset:32768
  ds_read_b64_tr_b16 a[230:231], v242 offset:33280
  ds_read_b64_tr_b16 a[232:233], v243 offset:32768
  ds_read_b64_tr_b16 a[234:235], v243 offset:33280
  ds_read_b64_tr_b16 a[236:237], v244 offset:32768
  ds_read_b64_tr_b16 a[238:239], v244 offset:33280
  ds_read_b64_tr_b16 a[240:241], v241 offset:36864
  ds_read_b64_tr_b16 a[242:243], v241 offset:37376
  ds_read_b64_tr_b16 a[244:245], v242 offset:36864
  ds_read_b64_tr_b16 a[246:247], v242 offset:37376
  ds_read_b64_tr_b16 a[248:249], v243 offset:36864
  ds_read_b64_tr_b16 a[250:251], v243 offset:37376
  ds_read_b64_tr_b16 a[252:253], v244 offset:36864
  ds_read_b64_tr_b16 a[254:255], v244 offset:37376
  v_lshrrev_b32 v27, 2, v1
  v_bfe_u32 v26, v27, 1, 2
  v_lshlrev_b32 v27, 7, v27
  v_and_b32 v28, 3, v1
  v_lshl_add_u32 v27, v28, 3, v27
  v_lshl_add_u32 v27, v26, 5, v27
  v_add_u32 v18, s41, v27
  v_xor_b32 v19, 32, v18
  v_xor_b32 v20, 64, v18
  v_xor_b32 v21, 96, v18
  v_add_u32 v241, s65, v27
  v_xor_b32 v242, 32, v241
  v_xor_b32 v243, 64, v241
  v_xor_b32 v244, 96, v241
  s_mov_b32 s51, 4
TL_X3:
  v_mfma_f32_16x16x32_bf16 v[32:35], a[16:19], v[112:115], v[32:35]
  v_mfma_f32_16x16x32_bf16 v[48:51], a[16:19], v[116:119], v[48:51]
  v_mfma_f32_16x16x32_bf16 v[64:67], a[16:19], v[120:123], v[64:67]
  v_mfma_f32_16x16x32_bf16 v[80:83], a[16:19], v[124:127], v[80:83]
  s_cmp_ge_u32 s52, 32
  s_cbranch_scc0 TL_G_38
TL_GB_39:
  buffer_load_dwordx4 v[208:211], v4, s[12:15], s39 offen sc1
  v_mfma_f32_16x16x32_bf16 v[84:87], a[20:23], v[124:127], v[84:87]
  v_mfma_f32_16x16x32_bf16 v[68:71], a[20:23], v[120:123], v[68:71]
  v_mfma_f32_16x16x32_bf16 v[52:55], a[20:23], v[116:119], v[52:55]
  v_mfma_f32_16x16x32_bf16 v[36:39], a[20:23], v[112:115], v[36:39]
  buffer_load_dwordx4 v[212:215], v5, s[12:15], s39 offen sc1
  v_mfma_f32_16x16x32_bf16 v[40:43], a[24:27], v[112:115], v[40:43]
  v_mfma_f32_16x16x32_bf16 v[56:59], a[24:27], v[116:119], v[56:59]
  v_mfma_f32_16x16x32_bf16 v[72:75], a[24:27], v[120:123], v[72:75]
  v_mfma_f32_16x16x32_bf16 v[88:91], a[24:27], v[124:127], v[88:91]
  buffer_load_dwordx4 v[216:219], v6, s[12:15], s39 offen sc1
  v_mfma_f32_16x16x32_bf16 v[92:95], a[28:31], v[124:127], v[92:95]
  v_mfma_f32_16x16x32_bf16 v[76:79], a[28:31], v[120:123], v[76:79]
  v_mfma_f32_16x16x32_bf16 v[60:63], a[28:31], v[116:119], v[60:63]
  v_mfma_f32_16x16x32_bf16 v[44:47], a[28:31], v[112:115], v[44:47]
  buffer_load_dwordx4 v[220:223], v7, s[12:15], s39 offen sc1
  s_add_u32 s39, s39, 917504
  s_waitcnt vmcnt(20)
  v_mfma_f32_16x16x32_bf16 v[32:35], a[32:35], v[128:131], v[32:35]
  v_mfma_f32_16x16x32_bf16 v[48:51], a[32:35], v[132:135], v[48:51]
  v_mfma_f32_16x16x32_bf16 v[64:67], a[32:35], v[136:139], v[64:67]
  v_mfma_f32_16x16x32_bf16 v[80:83], a[32:35], v[140:143], v[80:83]
  s_cmp_ge_u32 s52, 36
  s_cbranch_scc0 TL_G_40
TL_GB_41:
  buffer_load_dwordx4 v[96:99], v4, s[12:15], s39 offen sc1
  v_mfma_f32_16x16x32_bf16 v[84:87], a[36:39], v[140:143], v[84:87]
  v_mfma_f32_16x16x32_bf16 v[68:71], a[36:39], v[136:139], v[68:71]
  v_mfma_f32_16x16x32_bf16 v[52:55], a[36:39], v[132:135], v[52:55]
  v_mfma_f32_16x16x32_bf16 v[36:39], a[36:39], v[128:131], v[36:39]
  buffer_load_dwordx4 v[100:103], v5, s[12:15], s39 offen sc1
  v_mfma_f32_16x16x32_bf16 v[40:43], a[40:43], v[128:131], v[40:43]
  v_mfma_f32_16x16x32_bf16 v[56:59], a[40:43], v[132:135], v[56:59]
  v_mfma_f32_16x16x32_bf16 v[72:75], a[40:43], v[136:139], v[72:75]
  v_mfma_f32_16x16x32_bf16 v[88:91], a[40:43], v[140:143], v[88:91]
  buffer_load_dwordx4 v[104:107], v6, s[12:15], s39 offen sc1
  v_mfma_f32_16x16x32_bf16 v[92:95], a[44:47], v[140:143], v[92:95]
  v_mfma_f32_16x16x32_bf16 v[76:79], a[44:47], v[136:139], v[76:79]
  v_mfma_f32_16x16x32_bf16 v[60:63], a[44:47], v[132:135], v[60:63]
  v_mfma_f32_16x16x32_bf16 v[44:47], a[44:47], v[128:131], v[44:47]
  buffer_load_dwordx4 v[108:111], v7, s[12:15], s39 offen sc1
  s_add_u32 s39, s39, 114688
  s_waitcnt vmcnt(20)
  v_mfma_f32_16x16x32_bf16 v[32:35], a[48:51], v[144:147], v[32:35]
  v_mfma_f32_16x16x32_bf16 v[48:51], a[48:51], v[148:151], v[48:51]
  v_mfma_f32_16x16x32_bf16 v[64:67], a[48:51], v[152:155], v[64:67]
  v_mfma_f32_16x16x32_bf16 v[80:83], a[48:51], v[156:159], v[80:83]
  s_cmp_ge_u32 s52, 40
  s_cbranch_scc0 TL_G_42
TL_GB_43:
  buffer_load_dwordx4 v[112:115], v4, s[12:15], s39 offen sc1
  v_mfma_f32_16x16x32_bf16 v[84:87], a[52:55], v[156:159], v[84:87]
  v_mfma_f32_16x16x32_bf16 v[68:71], a[52:55], v[152:155], v[68:71]
  v_mfma_f32_16x16x32_bf16 v[52:55], a[52:55], v[148:151], v[52:55]
  v_mfma_f32_16x16x32_bf16 v[36:39], a[52:55], v[144:147], v[36:39]
  buffer_load_dwordx4 v[116:119], v5, s[12:15], s39 offen sc1
  v_mfma_f32_16x16x32_bf16 v[40:43], a[56:59], v[144:147], v[40:43]
  v_mfma_f32_16x16x32_bf16 v[56:59], a[56:59], v[148:151], v[56:59]
  v_mfma_f32_16x16x32_bf16 v[72:75], a[56:59], v[152:155], v[72:75]
  v_mfma_f32_16x16x32_bf16 v[88:91], a[56:59], v[156:159], v[88:91]
  buffer_load_dwordx4 v[120:123], v6, s[12:15], s39 offen sc1
  v_mfma_f32_16x16x32_bf16 v[92:95], a[60:63], v[156:159], v[92:95]
  v_mfma_f32_16x16x32_bf16 v[76:79], a[60:63], v[152:155], v[76:79]
  v_mfma_f32_16x16x32_bf16 v[60:63], a[60:63], v[148:151], v[60:63]
  v_mfma_f32_16x16x32_bf16 v[44:47], a[60:63], v[144:147], v[44:47]
  buffer_load_dwordx4 v[124:127], v7, s[12:15], s39 offen sc1
  s_add_u32 s39, s39, 114688
  s_waitcnt vmcnt(20)
  v_mfma_f32_16x16x32_bf16 v[32:35], a[64:67], v[160:163], v[32:35]
  v_mfma_f32_16x16x32_bf16 v[48:51], a[64:67], v[164:167], v[48:51]
  v_mfma_f32_16x16x32_bf16 v[64:67], a[64:67], v[168:171], v[64:67]
  v_mfma_f32_16x16x32_bf16 v[80:83], a[64:67], v[172:175], v[80:83]
  s_cmp_ge_u32 s52, 44
  s_cbranch_scc0 TL_G_44
TL_GB_45:
  buffer_load_dwordx4 v[128:131], v4, s[12:15], s39 offen sc1
  v_mfma_f32_16x16x32_bf16 v[84:87], a[68:71], v[172:175], v[84:87]
  v_mfma_f32_16x16x32_bf16 v[68:71], a[68:71], v[168:171], v[68:71]
  v_mfma_f32_16x16x32_bf16 v[52:55], a[68:71], v[164:167], v[52:55]
  v_mfma_f32_16x16x32_bf16 v[36:39], a[68:71], v[160:163], v[36:39]
  buffer_load_dwordx4 v[132:135], v5, s[12:15], s39 offen sc1
  v_mfma_f32_16x16x32_bf16 v[40:43], a[72:75], v[160:163], v[40:43]
  v_mfma_f32_16x16x32_bf16 v[56:59], a[72:75], v[164:167], v[56:59]
  v_mfma_f32_16x16x32_bf16 v[72:75], a[72:75], v[168:171], v[72:75]
  v_mfma_f32_16x16x32_bf16 v[88:91], a[72:75], v[172:175], v[88:91]
  buffer_load_dwordx4 v[136:139], v6, s[12:15], s39 offen sc1
  v_mfma_f32_16x16x32_bf16 v[92:95], a[76:79], v[172:175], v[92:95]
  v_mfma_f32_16x16x32_bf16 v[76:79], a[76:79], v[168:171], v[76:79]
  v_mfma_f32_16x16x32_bf16 v[60:63], a[76:79], v[164:167], v[60:63]
  v_mfma_f32_16x16x32_bf16 v[44:47], a[76:79], v[160:163], v[44:47]
  buffer_load_dwordx4 v[140:143], v7, s[12:15], s39 offen sc1
  s_add_u32 s39, s39, 114688
  s_waitcnt vmcnt(20)
  v_mfma_f32_16x16x32_bf16 v[32:35], a[80:83], v[176:179], v[32:35]
  v_mfma_f32_16x16x32_bf16 v[48:51], a[80:83], v[180:183], v[48:51]
  v_mfma_f32_16x16x32_bf16 v[64:67], a[80:83], v[184:187], v[64:67]
  v_mfma_f32_16x16x32_bf16 v[80:83], a[80:83], v[188:191], v[80:83]
  s_cmp_ge_u32 s52, 48
  s_cbranch_scc0 TL_G_46
TL_GB_47:
  buffer_load_dwordx4 v[144:147], v4, s[12:15], s39 offen sc1
  v_mfma_f32_16x16x32_bf16 v[84:87], a[84:87], v[188:191], v[84:87]
  v_mfma_f32_16x16x32_bf16 v[68:71], a[84:87], v[184:187], v[68:71]
  v_mfma_f32_16x16x32_bf16 v[52:55], a[84:87], v[180:183], v[52:55]
  v_mfma_f32_16x16x32_bf16 v[36:39], a[84:87], v[176:179], v[36:39]
  buffer_load_dwordx4 v[148:151], v5, s[12:15], s39 offen sc1
  v_mfma_f32_16x16x32_bf16 v[40:43], a[88:91], v[176:179], v[40:43]
  v_mfma_f32_16x16x32_bf16 v[56:59], a[88:91], v[180:183], v[56:59]
  v_mfma_f32_16x16x32_bf16 v[72:75], a[88:91], v[184:187], v[72:75]
  v_mfma_f32_16x16x32_bf16 v[88:91], a[88:91], v[188:191], v[88:91]
  buffer_load_dwordx4 v[152:155], v6, s[12:15], s39 offen sc1
  v_mfma_f32_16x16x32_bf16 v[92:95], a[92:95], v[188:191], v[92:95]
  v_mfma_f32_16x16x32_bf16 v[76:79], a[92:95], v[184:187], v[76:79]
  v_mfma_f32_16x16x32_bf16 v[60:63], a[92:95], v[180:183], v[60:63]
  v_mfma_f32_16x16x32_bf16 v[44:47], a[92:95], v[176:179], v[44:47]
  buffer_load_dwordx4 v[156:159], v7, s[12:15], s39 offen sc1
  s_add_u32 s39, s39, 114688
  s_waitcnt vmcnt(20)
  v_mfma_f32_16x16x32_bf16 v[32:35], a[96:99], v[192:195], v[32:35]
  v_mfma_f32_16x16x32_bf16 v[48:51], a[96:99], v[196:199], v[48:51]
  v_mfma_f32_16x16x32_bf16 v[64:67], a[96:99], v[200:203], v[64:67]
  v_mfma_f32_16x16x32_bf16 v[80:83], a[96:99], v[204:207], v[80:83]
  s_cmp_ge_u32 s52, 52
  s_cbranch_scc0 TL_G_48
TL_GB_49:
  buffer_load_dwordx4 v[160:163], v4, s[12:15], s39 offen sc1
  v_mfma_f32_16x16x32_bf16 v[84:87], a[100:103], v[204:207], v[84:87]
  v_mfma_f32_16x16x32_bf16 v[68:71], a[100:103], v[200:203], v[68:71]
  v_mfma_f32_16x16x32_bf16 v[52:55], a[100:103], v[196:199], v[52:55]
  v_mfma_f32_16x16x32_bf16 v[36:39], a[100:103], v[192:195], v[36:39]
  buffer_load_dwordx4 v[164:167], v5, s[12:15], s39 offen sc1
  v_mfma_f32_16x16x32_bf16 v[40:43], a[104:107], v[192:195], v[40:43]
  v_mfma_f32_16x16x32_bf16 v[56:59], a[104:107], v[196:199], v[56:59]
  v_mfma_f32_16x16x32_bf16 v[72:75], a[104:107], v[200:203], v[72:75]
  v_mfma_f32_16x16x32_bf16 v[88:91], a[104:107], v[204:207], v[88:91]
  buffer_load_dwordx4 v[168:171], v6, s[12:15], s39 offen sc1
  v_mfma_f32_16x16x32_bf16 v[92:95], a[108:111], v[204:207], v[92:95]
  v_mfma_f32_16x16x32_bf16 v[76:79], a[108:111], v[200:203], v[76:79]
  v_mfma_f32_16x16x32_bf16 v[60:63], a[108:111], v[196:199], v[60:63]
  v_mfma_f32_16x16x32_bf16 v[44:47], a[108:111], v[192:195], v[44:47]
  buffer_load_dwordx4 v[172:175], v7, s[12:15], s39 offen sc1
  s_add_u32 s39, s39, 114688
  s_waitcnt vmcnt(20)
  v_mfma_f32_16x16x32_bf16 v[32:35], a[112:115], v[208:211], v[32:35]
  v_mfma_f32_16x16x32_bf16 v[48:51], a[112:115], v[212:215], v[48:51]
  v_mfma_f32_16x16x32_bf16 v[64:67], a[112:115], v[216:219], v[64:67]
  v_mfma_f32_16x16x32_bf16 v[80:83], a[112:115], v[220:223], v[80:83]
  s_cmp_ge_u32 s52, 56
  s_cbranch_scc0 TL_G_50
TL_GB_51:
  buffer_load_dwordx4 v[176:179], v4, s[12:15], s39 offen sc1
  v_mfma_f32_16x16x32_bf16 v[84:87], a[116:119], v[220:223], v[84:87]
  v_mfma_f32_16x16x32_bf16 v[68:71], a[116:119], v[216:219], v[68:71]
  v_mfma_f32_16x16x32_bf16 v[52:55], a[116:119], v[212:215], v[52:55]
  v_mfma_f32_16x16x32_bf16 v[36:39], a[116:119], v[208:211], v[36:39]
  buffer_load_dwordx4 v[180:183], v5, s[12:15], s39 offen sc1
  v_mfma_f32_16x16x32_bf16 v[40:43], a[120:123], v[208:211], v[40:43]
  v_mfma_f32_16x16x32_bf16 v[56:59], a[120:123], v[212:215], v[56:59]
  v_mfma_f32_16x16x32_bf16 v[72:75], a[120:123], v[216:219], v[72:75]
  v_mfma_f32_16x16x32_bf16 v[88:91], a[120:123], v[220:223], v[88:91]
  buffer_load_dwordx4 v[184:187], v6, s[12:15], s39 offen sc1
  v_mfma_f32_16x16x32_bf16 v[92:95], a[124:127], v[220:223], v[92:95]
  v_mfma_f32_16x16x32_bf16 v[76:79], a[124:127], v[216:219], v[76:79]
  v_mfma_f32_16x16x32_bf16 v[60:63], a[124:127], v[212:215], v[60:63]
  v_mfma_f32_16x16x32_bf16 v[44:47], a[124:127], v[208:211], v[44:47]
  buffer_load_dwordx4 v[188:191], v7, s[12:15], s39 offen sc1
  s_add_u32 s39, s39, 114688
  s_waitcnt vmcnt(20)
  s_waitcnt lgkmcnt(0)
  s_barrier
  s_cmp_eq_u32 s51, 1
  s_cbranch_scc0 TL_X0
  ds_read_b64_tr_b16 a[0:1], v18 offset:0
  ds_read_b64_tr_b16 a[2:3], v18 offset:2048
  ds_read_b64_tr_b16 a[4:5], v19 offset:0
  ds_read_b64_tr_b16 a[6:7], v19 offset:2048
  ds_read_b64_tr_b16 a[8:9], v20 offset:0
  ds_read_b64_tr_b16 a[10:11], v20 offset:2048
  ds_read_b64_tr_b16 a[12:13], v21 offset:0
  ds_read_b64_tr_b16 a[14:15], v21 offset:2048
  ds_read_b64_tr_b16 a[16:17], v18 offset:4096
  ds_read_b64_tr_b16 a[18:19], v18 offset:6144
  ds_read_b64_tr_b16 a[20:21], v19 offset:4096
  ds_read_b64_tr_b16 a[22:23], v19 offset:6144
  ds_read_b64_tr_b16 a[24:25], v20 offset:4096
  ds_read_b64_tr_b16 a[26:27], v20 offset:6144
  ds_read_b64_tr_b16 a[28:29], v21 offset:4096
  ds_read_b64_tr_b16 a[30:31], v21 offset:6144
  ds_read_b64_tr_b16 a[32:33], v18 offset:32768
  ds_read_b64_tr_b16 a[34:35], v18 offset:34816
  ds_read_b64_tr_b16 a[36:37], v19 offset:32768
  ds_read_b64_tr_b16 a[38:39], v19 offset:34816
  ds_read_b64_tr_b16 a[40:41], v20 offset:32768
  ds_read_b64_tr_b16 a[42:43], v20 offset:34816
  ds_read_b64_tr_b16 a[44:45], v21 offset:32768
  ds_read_b64_tr_b16 a[46:47], v21 offset:34816
  ds_read_b64_tr_b16 a[48:49], v18 offset:36864
  ds_read_b64_tr_b16 a[50:51], v18 offset:38912
  ds_read_b64_tr_b16 a[52:53], v19 offset:36864
  ds_read_b64_tr_b16 a[54:55], v19 offset:38912
  ds_read_b64_tr_b16 a[56:57], v20 offset:36864
  ds_read_b64_tr_b16 a[58:59], v20 offset:38912
  ds_read_b64_tr_b16 a[60:61], v21 offset:36864
  ds_read_b64_tr_b16 a[62:63], v21 offset:38912
  ds_read_b64_tr_b16 a[64:65], v241 offset:0
  ds_read_b64_tr_b16 a[66:67], v241 offset:2048
  ds_read_b64_tr_b16 a[68:69], v242 offset:0
  ds_read_b64_tr_b16 a[70:71], v242 offset:2048
  ds_read_b64_tr_b16 a[72:73], v243 offset:0
  ds_read_b64_tr_b16 a[74:75], v243 offset:2048
  ds_read_b64_tr_b16 a[76:77], v244 offset:0
  ds_read_b64_tr_b16 a[78:79], v244 offset:2048
  ds_read_b64_tr_b16 a[80:81], v241 offset:4096
  ds_read_b64_tr_b16 a[82:83], v241 offset:6144
  ds_read_b64_tr_b16 a[84:85], v242 offset:4096
  ds_read_b64_tr_b16 a[86:87], v242 offset:6144
  ds_read_b64_tr_b16 a[88:89], v243 offset:4096
  ds_read_b64_tr_b16 a[90:91], v243 offset:6144
  ds_read_b64_tr_b16 a[92:93], v244 offset:4096
  ds_read_b64_tr_b16 a[94:95], v244 offset:6144
  ds_read_b64_tr_b16 a[96:97], v241 offset:32768
  ds_read_b64_tr_b16 a[98:99], v241 offset:34816
  ds_read_b64_tr_b16 a[100:101], v242 offset:32768
  ds_read_b64_tr_b16 a[102:103], v242 offset:34816
  ds_read_b64_tr_b16 a[104:105], v243 offset:32768
  ds_read_b64_tr_b16 a[106:107], v243 offset:34816
  ds_read_b64_tr_b16 a[108:109], v244 offset:32768
  ds_read_b64_tr_b16 a[110:111], v244 offset:34816
TL_X0:
  s_or_b32 s51, s51, 2
  v_mfma_f32_16x16x32_bf16 v[32:35], a[128:131], v[96:99], v[32:35]
  v_mfma_f32_16x16x32_bf16 v[48:51], a[128:131], v[100:103], v[48:51]
  v_mfma_f32_16x16x32_bf16 v[64:67], a[128:131], v[104:107], v[64:67]
  v_mfma_f32_16x16x32_bf16 v[80:83], a[128:131], v[108:111], v[80:83]
  s_cmp_ge_u32 s52, 60
  s_cbranch_scc0 TL_G_52
TL_GB_53:
  buffer_load_dwordx4 v[192:195], v4, s[12:15], s39 offen sc1
  v_mfma_f32_16x16x32_bf16 v[84:87], a[132:135], v[108:111], v[84:87]
  v_mfma_f32_16x16x32_bf16 v[68:71], a[132:135], v[104:107], v[68:71]
  v_mfma_f32_16x16x32_bf16 v[52:55], a[132:135], v[100:103], v[52:55]
  v_mfma_f32_16x16x32_bf16 v[36:39], a[132:135], v[96:99], v[36:39]
  buffer_load_dwordx4 v[196:199], v5, s[12:15], s39 offen sc1
  v_mfma_f32_16x16x32_bf16 v[40:43], a[136:139], v[96:99], v[40:43]
  v_mfma_f32_16x16x32_bf16 v[56:59], a[136:139], v[100:103], v[56:59]
  v_mfma_f32_16x16x32_bf16 v[72:75], a[136:139], v[104:107], v[72:75]
  v_mfma_f32_16x16x32_bf16 v[88:91], a[136:139], v[108:111], v[88:91]
  buffer_load_dwordx4 v[200:203], v6, s[12:15], s39 offen sc1
  v_mfma_f32_16x16x32_bf16 v[92:95], a[140:143], v[108:111], v[92:95]
  v_mfma_f32_16x16x32_bf16 v[76:79], a[140:143], v[104:107], v[76:79]
  v_mfma_f32_16x16x32_bf16 v[60:63], a[140:143], v[100:103], v[60:63]
  v_mfma_f32_16x16x32_bf16 v[44:47], a[140:143], v[96:99], v[44:47]
  buffer_load_dwordx4 v[204:207], v7, s[12:15], s39 offen sc1
  s_add_u32 s39, s39, 114688
  s_waitcnt vmcnt(20)
  v_mfma_f32_16x16x32_bf16 v[32:35], a[144:147], v[112:115], v[32:35]
  v_mfma_f32_16x16x32_bf16 v[48:51], a[144:147], v[116:119], v[48:51]
  v_mfma_f32_16x16x32_bf16 v[64:67], a[144:147], v[120:123], v[64:67]
  v_mfma_f32_16x16x32_bf16 v[80:83], a[144:147], v[124:127], v[80:83]
  s_cmp_ge_u32 s52, 64
  s_cbranch_scc0 TL_G_54
TL_GB_55:
  buffer_load_dwordx4 v[208:211], v4, s[12:15], s39 offen sc1
  v_mfma_f32_16x16x32_bf16 v[84:87], a[148:151], v[124:127], v[84:87]
  v_mfma_f32_16x16x32_bf16 v[68:71], a[148:151], v[120:123], v[68:71]
  v_mfma_f32_16x16x32_bf16 v[52:55], a[148:151], v[116:119], v[52:55]
  v_mfma_f32_16x16x32_bf16 v[36:39], a[148:151], v[112:115], v[36:39]
  buffer_load_dwordx4 v[212:215], v5, s[12:15], s39 offen sc1
  v_mfma_f32_16x16x32_bf16 v[40:43], a[152:155], v[112:115], v[40:43]
  v_mfma_f32_16x16x32_bf16 v[56:59], a[152:155], v[116:119], v[56:59]
  v_mfma_f32_16x16x32_bf16 v[72:75], a[152:155], v[120:123], v[72:75]
  v_mfma_f32_16x16x32_bf16 v[88:91], a[152:155], v[124:127], v[88:91]
  buffer_load_dwordx4 v[216:219], v6, s[12:15], s39 offen sc1
  v_mfma_f32_16x16x32_bf16 v[92:95], a[156:159], v[124:127], v[92:95]
  v_mfma_f32_16x16x32_bf16 v[76:79], a[156:159], v[120:123], v[76:79]
  v_mfma_f32_16x16x32_bf16 v[60:63], a[156:159], v[116:119], v[60:63]
  v_mfma_f32_16x16x32_bf16 v[44:47], a[156:159], v[112:115], v[44:47]
  buffer_load_dwordx4 v[220:223], v7, s[12:15], s39 offen sc1
  s_add_u32 s39, s39, 114688
  s_waitcnt vmcnt(20)
  s_waitcnt lgkmcnt(0)
  v_mfma_f32_16x16x32_bf16 v[32:35], a[160:163], v[128:131], v[32:35]
  v_mfma_f32_16x16x32_bf16 v[48:51], a[160:163], v[132:135], v[48:51]
  v_mfma_f32_16x16x32_bf16 v[64:67], a[160:163], v[136:139], v[64:67]
  v_mfma_f32_16x16x32_bf16 v[80:83], a[160:163], v[140:143], v[80:83]
  s_add_u32 m0, s41, 0
  s_nop 0
  buffer_load_dwordx4 v14, s[8:11], s38 offen offset:0 lds
  v_mfma_f32_16x16x32_bf16 v[84:87], a[164:167], v[140:143], v[84:87]
  v_mfma_f32_16x16x32_bf16 v[68:71], a[164:167], v[136:139], v[68:71]
  v_mfma_f32_16x16x32_bf16 v[52:55], a[164:167], v[132:135], v[52:55]
  v_mfma_f32_16x16x32_bf16 v[36:39], a[164:167], v[128:131], v[36:39]
  buffer_load_dwordx4 v15, s[8:11], s38 offen offset:1024 lds
  v_mfma_f32_16x16x32_bf16 v[40:43], a[168:171], v[128:131], v[40:43]
  v_mfma_f32_16x16x32_bf16 v[56:59], a[168:171], v[132:135], v[56:59]
  v_mfma_f32_16x16x32_bf16 v[72:75], a[168:171], v[136:139], v[72:75]
  v_mfma_f32_16x16x32_bf16 v[88:91], a[168:171], v[140:143], v[88:91]
  buffer_load_dwordx4 v16, s[8:11], s38 offen offset:2048 lds
  v_mfma_f32_16x16x32_bf16 v[92:95], a[172:175], v[140:143], v[92:95]
  v_mfma_f32_16x16x32_bf16 v[76:79], a[172:175], v[136:139], v[76:79]
  v_mfma_f32_16x16x32_bf16 v[60:63], a[172:175], v[132:135], v[60:63]
  v_mfma_f32_16x16x32_bf16 v[44:47], a[172:175], v[128:131], v[44:47]
  buffer_load_dwordx4 v17, s[8:11], s38 offen offset:3072 lds
  s_add_u32 s38, s38, 131072
  s_waitcnt vmcnt(20)
  v_mfma_f32_16x16x32_bf16 v[32:35], a[176:179], v[144:147], v[32:35]
  v_mfma_f32_16x16x32_bf16 v[48:51], a[176:179], v[148:151], v[48:51]
  v_mfma_f32_16x16x32_bf16 v[64:67], a[176:179], v[152:155], v[64:67]
  v_mfma_f32_16x16x32_bf16 v[80:83], a[176:179], v[156:159], v[80:83]
  s_add_u32 m0, s41, 4096
  s_nop 0
  buffer_load_dwordx4 v14, s[8:11], s38 offen offset:0 lds
  v_mfma_f32_16x16x32_bf16 v[84:87], a[180:183], v[156:159], v[84:87]
  v_mfma_f32_16x16x32_bf16 v[68:71], a[180:183], v[152:155], v[68:71]
  v_mfma_f32_16x16x32_bf16 v[52:55], a[180:183], v[148:151], v[52:55]
  v_mfma_f32_16x16x32_bf16 v[36:39], a[180:183], v[144:147], v[36:39]
  buffer_load_dwordx4 v15, s[8:11], s38 offen offset:1024 lds
  v_mfma_f32_16x16x32_bf16 v[40:43], a[184:187], v[144:147], v[40:43]
  v_mfma_f32_16x16x32_bf16 v[56:59], a[184:187], v[148:151], v[56:59]
  v_mfma_f32_16x16x32_bf16 v[72:75], a[184:187], v[152:155], v[72:75]
  v_mfma_f32_16x16x32_bf16 v[88:91], a[184:187], v[156:159], v[88:91]
  buffer_load_dwordx4 v16, s[8:11], s38 offen offset:2048 lds
  v_mfma_f32_16x16x32_bf16 v[92:95], a[188:191], v[156:159], v[92:95]
  v_mfma_f32_16x16x32_bf16 v[76:79], a[188:191], v[152:155], v[76:79]
  v_mfma_f32_16x16x32_bf16 v[60:63], a[188:191], v[148:151], v[60:63]
  v_mfma_f32_16x16x32_bf16 v[44:47], a[188:191], v[144:147], v[44:47]
  buffer_load_dwordx4 v17, s[8:11], s38 offen offset:3072 lds
  s_add_u32 s38, s38, 131072
  s_waitcnt vmcnt(20)
  v_mfma_f32_16x16x32_bf16 v[32:35], a[192:195], v[160:163], v[32:35]
  v_mfma_f32_16x16x32_bf16 v[48:51], a[192:195], v[164:167], v[48:51]
  v_mfma_f32_16x16x32_bf16 v[64:67], a[192:195], v[168:171], v[64:67]
  v_mfma_f32_16x16x32_bf16 v[80:83], a[192:195], v[172:175], v[80:83]
  s_add_u32 m0, s41, 32768
  s_nop 0
  buffer_load_dwordx4 v14, s[8:11], s38 offen offset:0 lds
  v_mfma_f32_16x16x32_bf16 v[84:87], a[196:199], v[172:175], v[84:87]
  v_mfma_f32_16x16x32_bf16 v[68:71], a[196:199], v[168:171], v[68:71]
  v_mfma_f32_16x16x32_bf16 v[52:55], a[196:199], v[164:167], v[52:55]
  v_mfma_f32_16x16x32_bf16 v[36:39], a[196:199], v[160:163], v[36:39]
  buffer_load_dwordx4 v15, s[8:11], s38 offen offset:1024 lds
  v_mfma_f32_16x16x32_bf16 v[40:43], a[200:203], v[160:163], v[40:43]
  v_mfma_f32_16x16x32_bf16 v[56:59], a[200:203], v[164:167], v[56:59]
  v_mfma_f32_16x16x32_bf16 v[72:75], a[200:203], v[168:171], v[72:75]
  v_mfma_f32_16x16x32_bf16 v[88:91], a[200:203], v[172:175], v[88:91]
  buffer_load_dwordx4 v16, s[8:11], s38 offen offset:2048 lds
  v_mfma_f32_16x16x32_bf16 v[92:95], a[204:207], v[172:175], v[92:95]
  v_mfma_f32_16x16x32_bf16 v[76:79], a[204:207], v[168:171], v[76:79]
  v_mfma_f32_16x16x32_bf16 v[60:63], a[204:207], v[164:167], v[60:63]
  v_mfma_f32_16x16x32_bf16 v[44:47], a[204:207], v[160:163], v[44:47]
  buffer_load_dwordx4 v17, s[8:11], s38 offen offset:3072 lds
  s_add_u32 s38, s38, 131072
  s_waitcnt vmcnt(20)
  v_mfma_f32_16x16x32_bf16 v[32:35], a[208:211], v[176:179], v[32:35]
  v_mfma_f32_16x16x32_bf16 v[48:51], a[208:211], v[180:183], v[48:51]
  v_mfma_f32_16x16x32_bf16 v[64:67], a[208:211], v[184:187], v[64:67]
  v_mfma_f32_16x16x32_bf16 v[80:83], a[208:211], v[188:191], v[80:83]
  s_add_u32 m0, s41, 36864
  s_nop 0
  buffer_load_dwordx4 v14, s[8:11], s38 offen offset:0 lds
  v_mfma_f32_16x16x32_bf16 v[84:87], a[212:215], v[188:191], v[84:87]
  v_mfma_f32_16x16x32_bf16 v[68:71], a[212:215], v[184:187], v[68:71]
  v_mfma_f32_16x16x32_bf16 v[52:55], a[212:215], v[180:183], v[52:55]
  v_mfma_f32_16x16x32_bf16 v[36:39], a[212:215], v[176:179], v[36:39]
  buffer_load_dwordx4 v15, s[8:11], s38 offen offset:1024 lds
  v_mfma_f32_16x16x32_bf16 v[40:43], a[216:219], v[176:179], v[40:43]
  v_mfma_f32_16x16x32_bf16 v[56:59], a[216:219], v[180:183], v[56:59]
  v_mfma_f32_16x16x32_bf16 v[72:75], a[216:219], v[184:187], v[72:75]
  v_mfma_f32_16x16x32_bf16 v[88:91], a[216:219], v[188:191], v[88:91]
  buffer_load_dwordx4 v16, s[8:11], s38 offen offset:2048 lds
  v_mfma_f32_16x16x32_bf16 v[92:95], a[220:223], v[188:191], v[92:95]
  v_mfma_f32_16x16x32_bf16 v[76:79], a[220:223], v[184:187], v[76:79]
  v_mfma_f32_16x16x32_bf16 v[60:63], a[220:223], v[180:183], v[60:63]
  v_mfma_f32_16x16x32_bf16 v[44:47], a[220:223], v[176:179], v[44:47]
  buffer_load_dwordx4 v17, s[8:11], s38 offen offset:3072 lds
  s_add_u32 s38, s38, 131072
  s_waitcnt vmcnt(20)
  v_mfma_f32_16x16x32_bf16 v[32:35], a[224:227], v[192:195], v[32:35]
  v_mfma_f32_16x16x32_bf16 v[48:51], a[224:227], v[196:199], v[48:51]
  v_mfma_f32_16x16x32_bf16 v[64:67], a[224:227], v[200:203], v[64:67]
  v_mfma_f32_16x16x32_bf16 v[80:83], a[224:227], v[204:207], v[80:83]
  s_add_u32 m0, s65, 0
  s_nop 0
  buffer_load_dwordx4 v14, s[8:11], s38 offen offset:0 lds
  v_mfma_f32_16x16x32_bf16 v[84:87], a[228:231], v[204:207], v[84:87]
  v_mfma_f32_16x16x32_bf16 v[68:71], a[228:231], v[200:203], v[68:71]
  v_mfma_f32_16x16x32_bf16 v[52:55], a[228:231], v[196:199], v[52:55]
  v_mfma_f32_16x16x32_bf16 v[36:39], a[228:231], v[192:195], v[36:39]
  buffer_load_dwordx4 v15, s[8:11], s38 offen offset:1024 lds
  v_mfma_f32_16x16x32_bf16 v[40:43], a[232:235], v[192:195], v[40:43]
  v_mfma_f32_16x16x32_bf16 v[56:59], a[232:235], v[196:199], v[56:59]
  v_mfma_f32_16x16x32_bf16 v[72:75], a[232:235], v[200:203], v[72:75]
  v_mfma_f32_16x16x32_bf16 v[88:91], a[232:235], v[204:207], v[88:91]
  buffer_load_dwordx4 v16, s[8:11], s38 offen offset:2048 lds
  v_mfma_f32_16x16x32_bf16 v[92:95], a[236:239], v[204:207], v[92:95]
  v_mfma_f32_16x16x32_bf16 v[76:79], a[236:239], v[200:203], v[76:79]
  v_mfma_f32_16x16x32_bf16 v[60:63], a[236:239], v[196:199], v[60:63]
  v_mfma_f32_16x16x32_bf16 v[44:47], a[236:239], v[192:195], v[44:47]
  buffer_load_dwordx4 v17, s[8:11], s38 offen offset:3072 lds
  s_add_u32 s38, s38, 131072
  s_waitcnt vmcnt(20)
  v_mfma_f32_16x16x32_bf16 v[32:35], a[240:243], v[208:211], v[32:35]
  v_mfma_f32_16x16x32_bf16 v[48:51], a[240:243], v[212:215], v[48:51]
  v_mfma_f32_16x16x32_bf16 v[64:67], a[240:243], v[216:219], v[64:67]
  v_mfma_f32_16x16x32_bf16 v[80:83], a[240:243], v[220:223], v[80:83]
  s_add_u32 m0, s65, 4096
  s_nop 0
  buffer_load_dwordx4 v14, s[8:11], s38 offen offset:0 lds
  v_mfma_f32_16x16x32_bf16 v[84:87], a[244:247], v[220:223], v[84:87]
  v_mfma_f32_16x16x32_bf16 v[68:71], a[244:247], v[216:219], v[68:71]
  v_mfma_f32_16x16x32_bf16 v[52:55], a[244:247], v[212:215], v[52:55]
  v_mfma_f32_16x16x32_bf16 v[36:39], a[244:247], v[208:211], v[36:39]
  buffer_load_dwordx4 v15, s[8:11], s38 offen offset:1024 lds
  v_mfma_f32_16x16x32_bf16 v[40:43], a[248:251], v[208:211], v[40:43]
  v_mfma_f32_16x16x32_bf16 v[56:59], a[248:251], v[212:215], v[56:59]
  v_mfma_f32_16x16x32_bf16 v[72:75], a[248:251], v[216:219], v[72:75]
  v_mfma_f32_16x16x32_bf16 v[88:91], a[248:251], v[220:223], v[88:91]
  buffer_load_dwordx4 v16, s[8:11], s38 offen offset:2048 lds
  v_mfma_f32_16x16x32_bf16 v[92:95], a[252:255], v[220:223], v[92:95]
  v_mfma_f32_16x16x32_bf16 v[76:79], a[252:255], v[216:219], v[76:79]
  v_mfma_f32_16x16x32_bf16 v[60:63], a[252:255], v[212:215], v[60:63]
  v_mfma_f32_16x16x32_bf16 v[44:47], a[252:255], v[208:211], v[44:47]
  buffer_load_dwordx4 v17, s[8:11], s38 offen offset:3072 lds
  s_add_u32 s38, s38, 131072
  s_add_u32 m0, s65, 32768
  s_nop 0
  buffer_load_dwordx4 v14, s[8:11], s38 offen offset:0 lds
  buffer_load_dwordx4 v15, s[8:11], s38 offen offset:1024 lds
  buffer_load_dwordx4 v16, s[8:11], s38 offen offset:2048 lds
  buffer_load_dwordx4 v17, s[8:11], s38 offen offset:3072 lds
  s_add_u32 s38, s38, 131072
  s_and_b32 s60, s65, 0x10000
  s_add_u32 s60, s60, 36864
  v_lshrrev_b32 v26, 10, v5
  v_lshl_add_u32 v26, v26, 13, v9
  v_add_u32 v5, 131072, v26
  v_lshrrev_b32 v26, 10, v6
  v_lshl_add_u32 v26, v26, 13, v9
  v_add_u32 v6, 135168, v26
  v_lshrrev_b32 v26, 10, v7
  v_lshl_add_u32 v26, v26, 13, v9
  v_add_u32 v7, s60, v26
  v_add_u32 v4, s66, v9
  v_add_u32 v8, s65, v9
  ds_write_b128 v5, v[48:51] offset:0
  v_lshlrev_b32 v96, 16, v224
  v_and_b32 v97, 0xffff0000, v224
  v_lshlrev_b32 v98, 16, v225
  v_and_b32 v99, 0xffff0000, v225
  ds_write_b128 v5, v[52:55] offset:1024
  v_lshlrev_b32 v100, 16, v226
  v_and_b32 v101, 0xffff0000, v226
  v_lshlrev_b32 v102, 16, v227
  v_and_b32 v103, 0xffff0000, v227
  ds_write_b128 v5, v[56:59] offset:2048
  v_lshlrev_b32 v104, 16, v228
  v_and_b32 v105, 0xffff0000, v228
  v_lshlrev_b32 v106, 16, v229
  v_and_b32 v107, 0xffff0000, v229
  ds_write_b128 v5, v[60:63] offset:3072
  v_lshlrev_b32 v108, 16, v230
  v_and_b32 v109, 0xffff0000, v230
  v_lshlrev_b32 v110, 16, v231
  v_and_b32 v111, 0xffff0000, v231
  ds_write_b128 v6, v[64:67] offset:0
  v_pk_add_f32 v[32:33], v[32:33], v[96:97]
  v_pk_add_f32 v[34:35], v[34:35], v[98:99]
  v_pk_add_f32 v[36:37], v[36:37], v[100:101]
  v_pk_add_f32 v[38:39], v[38:39], v[102:103]
  ds_write_b128 v6, v[68:71] offset:1024
  v_pk_add_f32 v[40:41], v[40:41], v[104:105]
  v_pk_add_f32 v[42:43], v[42:43], v[106:107]
  v_pk_add_f32 v[44:45], v[44:45], v[108:109]
  v_pk_add_f32 v[46:47], v[46:47], v[110:111]
  ds_write_b128 v6, v[72:75] offset:2048
  v_mov_b32 v26, 0xbdd2d3e8
  v_mov_b32 v27, 0xc0135761
  s_mul_i32 s60, s26, 57344
  s_lshl_b32 s62, s64, 2
  ds_write_b128 v6, v[76:79] offset:3072
  s_add_u32 s62, s62, s20
  s_lshl_b32 s62, s62, 10
  s_add_u32 s60, s60, s62
  s_add_u32 s60, s60, 78643200
  ds_write_b128 v7, v[80:83] offset:0
  s_add_u32 s62, s60, 28672
  s_mul_i32 s61, s64, 28
  s_add_u32 s61, s61, s26
  s_nop 0
  ds_write_b128 v7, v[84:87] offset:1024
  s_lshl_b32 s61, s61, 7
  s_add_u32 s61, s61, 94535680
  s_nop 0
  s_nop 0
  ds_write_b128 v7, v[88:91] offset:2048
  s_cmp_eq_u32 s20, 0
  s_cselect_b32 s61, s61, 268435456
  ds_write_b128 v7, v[92:95] offset:3072
  s_waitcnt lgkmcnt(0)
  s_barrier
  ds_read_b128 v[48:51], v4 offset:0
  ds_read_b128 v[52:55], v4 offset:1024
  ds_read_b128 v[56:59], v4 offset:2048
  ds_read_b128 v[60:63], v4 offset:3072
  ds_read_b128 v[64:67], v4 offset:4096
  ds_read_b128 v[68:71], v4 offset:5120
  ds_read_b128 v[72:75], v4 offset:6144
  ds_read_b128 v[76:79], v4 offset:7168
  ds_read_b128 v[80:83], v8 offset:36864
  ds_read_b128 v[84:87], v8 offset:37888
  ds_read_b128 v[88:91], v8 offset:38912
  ds_read_b128 v[92:95], v8 offset:39936
  s_waitcnt lgkmcnt(8)
  v_pk_add_f32 v[32:33], v[32:33], v[48:49]
  v_pk_add_f32 v[34:35], v[34:35], v[50:51]
  v_pk_add_f32 v[36:37], v[36:37], v[52:53]
  v_pk_add_f32 v[38:39], v[38:39], v[54:55]
  v_pk_add_f32 v[40:41], v[40:41], v[56:57]
  v_pk_add_f32 v[42:43], v[42:43], v[58:59]
  v_pk_add_f32 v[44:45], v[44:45], v[60:61]
  v_pk_add_f32 v[46:47], v[46:47], v[62:63]
  s_waitcnt lgkmcnt(4)
  v_pk_add_f32 v[32:33], v[32:33], v[64:65]
  v_pk_add_f32 v[34:35], v[34:35], v[66:67]
  v_pk_add_f32 v[36:37], v[36:37], v[68:69]
  v_pk_add_f32 v[38:39], v[38:39], v[70:71]
  v_pk_add_f32 v[40:41], v[40:41], v[72:73]
  v_pk_add_f32 v[42:43], v[42:43], v[74:75]
  v_pk_add_f32 v[44:45], v[44:45], v[76:77]
  v_pk_add_f32 v[46:47], v[46:47], v[78:79]
  s_waitcnt lgkmcnt(0)
  v_pk_add_f32 v[32:33], v[32:33], v[80:81]
  v_pk_add_f32 v[34:35], v[34:35], v[82:83]
  v_pk_add_f32 v[36:37], v[36:37], v[84:85]
  v_pk_add_f32 v[38:39], v[38:39], v[86:87]
  v_pk_add_f32 v[40:41], v[40:41], v[88:89]
  v_pk_add_f32 v[42:43], v[42:43], v[90:91]
  v_pk_add_f32 v[44:45], v[44:45], v[92:93]
  v_pk_add_f32 v[46:47], v[46:47], v[94:95]
  v_pk_mul_f32 v[48:49], v[32:33], v[32:33]
  v_pk_mul_f32 v[50:51], v[34:35], v[34:35]
  v_pk_mul_f32 v[52:53], v[36:37], v[36:37]
  v_pk_mul_f32 v[54:55], v[38:39], v[38:39]
  v_pk_mul_f32 v[56:57], v[40:41], v[40:41]
  v_pk_mul_f32 v[58:59], v[42:43], v[42:43]
  v_pk_mul_f32 v[60:61], v[44:45], v[44:45]
  v_pk_mul_f32 v[62:63], v[46:47], v[46:47]
  v_pk_fma_f32 v[48:49], v[48:49], v[26:27], v[26:27] op_sel:[0,0,1] op_sel_hi:[1,0,1]
  v_pk_fma_f32 v[50:51], v[50:51], v[26:27], v[26:27] op_sel:[0,0,1] op_sel_hi:[1,0,1]
  v_pk_fma_f32 v[52:53], v[52:53], v[26:27], v[26:27] op_sel:[0,0,1] op_sel_hi:[1,0,1]
  v_pk_fma_f32 v[54:55], v[54:55], v[26:27], v[26:27] op_sel:[0,0,1] op_sel_hi:[1,0,1]
  v_pk_fma_f32 v[56:57], v[56:57], v[26:27], v[26:27] op_sel:[0,0,1] op_sel_hi:[1,0,1]
  v_pk_fma_f32 v[58:59], v[58:59], v[26:27], v[26:27] op_sel:[0,0,1] op_sel_hi:[1,0,1]
  v_pk_fma_f32 v[60:61], v[60:61], v[26:27], v[26:27] op_sel:[0,0,1] op_sel_hi:[1,0,1]
  v_pk_fma_f32 v[62:63], v[62:63], v[26:27], v[26:27] op_sel:[0,0,1] op_sel_hi:[1,0,1]
  v_pk_mul_f32 v[48:49], v[48:49], v[32:33]
  v_pk_mul_f32 v[50:51], v[50:51], v[34:35]
  v_pk_mul_f32 v[52:53], v[52:53], v[36:37]
  v_pk_mul_f32 v[54:55], v[54:55], v[38:39]
  v_pk_mul_f32 v[56:57], v[56:57], v[40:41]
  v_pk_mul_f32 v[58:59], v[58:59], v[42:43]
  v_pk_mul_f32 v[60:61], v[60:61], v[44:45]
  v_pk_mul_f32 v[62:63], v[62:63], v[46:47]
  v_exp_f32 v48, v48
  v_exp_f32 v49, v49
  v_exp_f32 v50, v50
  v_exp_f32 v51, v51
  v_exp_f32 v52, v52
  v_exp_f32 v53, v53
  v_exp_f32 v54, v54
  v_exp_f32 v55, v55
  v_exp_f32 v56, v56
  v_exp_f32 v57, v57
  v_exp_f32 v58, v58
  v_exp_f32 v59, v59
  v_exp_f32 v60, v60
  v_exp_f32 v61, v61
  v_exp_f32 v62, v62
  v_exp_f32 v63, v63
  v_pk_add_f32 v[48:49], v[48:49], 1.0 op_sel_hi:[1,0]
  v_pk_add_f32 v[50:51], v[50:51], 1.0 op_sel_hi:[1,0]
  v_pk_add_f32 v[52:53], v[52:53], 1.0 op_sel_hi:[1,0]
  v_pk_add_f32 v[54:55], v[54:55], 1.0 op_sel_hi:[1,0]
  v_pk_add_f32 v[56:57], v[56:57], 1.0 op_sel_hi:[1,0]
  v_pk_add_f32 v[58:59], v[58:59], 1.0 op_sel_hi:[1,0]
  v_pk_add_f32 v[60:61], v[60:61], 1.0 op_sel_hi:[1,0]
  v_pk_add_f32 v[62:63], v[62:63], 1.0 op_sel_hi:[1,0]
  v_rcp_f32 v48, v48
  v_rcp_f32 v49, v49
  v_rcp_f32 v50, v50
  v_rcp_f32 v51, v51
  v_rcp_f32 v52, v52
  v_rcp_f32 v53, v53
  v_rcp_f32 v54, v54
  v_rcp_f32 v55, v55
  v_rcp_f32 v56, v56
  v_rcp_f32 v57, v57
  v_rcp_f32 v58, v58
  v_rcp_f32 v59, v59
  v_rcp_f32 v60, v60
  v_rcp_f32 v61, v61
  v_rcp_f32 v62, v62
  v_rcp_f32 v63, v63
  v_pk_mul_f32 v[32:33], v[32:33], v[48:49]
  v_pk_mul_f32 v[34:35], v[34:35], v[50:51]
  v_pk_mul_f32 v[36:37], v[36:37], v[52:53]
  v_pk_mul_f32 v[38:39], v[38:39], v[54:55]
  v_pk_mul_f32 v[40:41], v[40:41], v[56:57]
  v_pk_mul_f32 v[42:43], v[42:43], v[58:59]
  v_pk_mul_f32 v[44:45], v[44:45], v[60:61]
  v_pk_mul_f32 v[46:47], v[46:47], v[62:63]
  v_cvt_pk_bf16_f32 v48, v32, v33
  v_cvt_pk_bf16_f32 v49, v34, v35
  v_cvt_pk_bf16_f32 v50, v36, v37
  v_cvt_pk_bf16_f32 v51, v38, v39
  v_cvt_pk_bf16_f32 v52, v40, v41
  v_cvt_pk_bf16_f32 v53, v42, v43
  v_cvt_pk_bf16_f32 v54, v44, v45
  v_cvt_pk_bf16_f32 v55, v46, v47
  buffer_store_dwordx4 v[48:51], v9, s[12:15], s60 offen sc1
  buffer_store_dwordx4 v[52:55], v9, s[12:15], s62 offen sc1
  s_waitcnt vmcnt(2)
  s_cmp_eq_u32 s51, 3
  s_cbranch_scc0 TL_X1
  s_waitcnt vmcnt(0)
  s_barrier
  s_mov_b64 exec, 1
  buffer_store_dword v2, off, s[12:15], s61 sc1
  s_mov_b64 exec, -1
  s_branch TL_M2
TL_X1:
  ds_read_b64_tr_b16 a[0:1], v18 offset:0
  ds_read_b64_tr_b16 a[2:3], v18 offset:2048
  ds_read_b64_tr_b16 a[4:5], v19 offset:0
  ds_read_b64_tr_b16 a[6:7], v19 offset:2048
  ds_read_b64_tr_b16 a[8:9], v20 offset:0
  ds_read_b64_tr_b16 a[10:11], v20 offset:2048
  ds_read_b64_tr_b16 a[12:13], v21 offset:0
  ds_read_b64_tr_b16 a[14:15], v21 offset:2048
  ds_read_b64_tr_b16 a[16:17], v18 offset:4096
  ds_read_b64_tr_b16 a[18:19], v18 offset:6144
  ds_read_b64_tr_b16 a[20:21], v19 offset:4096
  ds_read_b64_tr_b16 a[22:23], v19 offset:6144
  ds_read_b64_tr_b16 a[24:25], v20 offset:4096
  ds_read_b64_tr_b16 a[26:27], v20 offset:6144
  ds_read_b64_tr_b16 a[28:29], v21 offset:4096
  ds_read_b64_tr_b16 a[30:31], v21 offset:6144
  ds_read_b64_tr_b16 a[32:33], v18 offset:32768
  ds_read_b64_tr_b16 a[34:35], v18 offset:34816
  ds_read_b64_tr_b16 a[36:37], v19 offset:32768
  ds_read_b64_tr_b16 a[38:39], v19 offset:34816
  ds_read_b64_tr_b16 a[40:41], v20 offset:32768
  ds_read_b64_tr_b16 a[42:43], v20 offset:34816
  ds_read_b64_tr_b16 a[44:45], v21 offset:32768
  ds_read_b64_tr_b16 a[46:47], v21 offset:34816
  ds_read_b64_tr_b16 a[48:49], v18 offset:36864
  ds_read_b64_tr_b16 a[50:51], v18 offset:38912
  ds_read_b64_tr_b16 a[52:53], v19 offset:36864
  ds_read_b64_tr_b16 a[54:55], v19 offset:38912
  ds_read_b64_tr_b16 a[56:57], v20 offset:36864
  ds_read_b64_tr_b16 a[58:59], v20 offset:38912
  ds_read_b64_tr_b16 a[60:61], v21 offset:36864
  ds_read_b64_tr_b16 a[62:63], v21 offset:38912
  ds_read_b64_tr_b16 a[64:65], v241 offset:0
  ds_read_b64_tr_b16 a[66:67], v241 offset:2048
  ds_read_b64_tr_b16 a[68:69], v242 offset:0
  ds_read_b64_tr_b16 a[70:71], v242 offset:2048
  ds_read_b64_tr_b16 a[72:73], v243 offset:0
  ds_read_b64_tr_b16 a[74:75], v243 offset:2048
  ds_read_b64_tr_b16 a[76:77], v244 offset:0
  ds_read_b64_tr_b16 a[78:79], v244 offset:2048
  ds_read_b64_tr_b16 a[80:81], v241 offset:4096
  ds_read_b64_tr_b16 a[82:83], v241 offset:6144
  ds_read_b64_tr_b16 a[84:85], v242 offset:4096
  ds_read_b64_tr_b16 a[86:87], v242 offset:6144
  ds_read_b64_tr_b16 a[88:89], v243 offset:4096
  ds_read_b64_tr_b16 a[90:91], v243 offset:6144
  ds_read_b64_tr_b16 a[92:93], v244 offset:4096
  ds_read_b64_tr_b16 a[94:95], v244 offset:6144
  ds_read_b64_tr_b16 a[96:97], v241 offset:32768
  ds_read_b64_tr_b16 a[98:99], v241 offset:34816
  ds_read_b64_tr_b16 a[100:101], v242 offset:32768
  ds_read_b64_tr_b16 a[102:103], v242 offset:34816
  ds_read_b64_tr_b16 a[104:105], v243 offset:32768
  ds_read_b64_tr_b16 a[106:107], v243 offset:34816
  ds_read_b64_tr_b16 a[108:109], v244 offset:32768
  ds_read_b64_tr_b16 a[110:111], v244 offset:34816
  s_waitcnt lgkmcnt(0)
  s_add_u32 m0, s41, 0
  s_nop 0
  buffer_load_dwordx4 v14, s[8:11], s38 offen offset:0 lds
  buffer_load_dwordx4 v15, s[8:11], s38 offen offset:1024 lds
  buffer_load_dwordx4 v16, s[8:11], s38 offen offset:2048 lds
  buffer_load_dwordx4 v17, s[8:11], s38 offen offset:3072 lds
  s_add_u32 s38, s38, 131072
  s_add_u32 m0, s41, 4096
  s_nop 0
  buffer_load_dwordx4 v14, s[8:11], s38 offen offset:0 lds
  buffer_load_dwordx4 v15, s[8:11], s38 offen offset:1024 lds
  buffer_load_dwordx4 v16, s[8:11], s38 offen offset:2048 lds
  buffer_load_dwordx4 v17, s[8:11], s38 offen offset:3072 lds
  s_add_u32 s38, s38, 131072
  s_waitcnt vmcnt(8)
  s_barrier
  s_mov_b64 exec, 1
  buffer_store_dword v2, off, s[12:15], s61 sc1
  s_mov_b64 exec, -1
  s_branch TL_X2
TL_NOM1:
  s_mul_i32 s38, s20, 1835008
  s_lshl_b32 s60, s27, 7
  s_add_u32 s38, s38, s60
  v_lshrrev_b32 v27, 2, v1
  v_bfe_u32 v26, v27, 1, 2
  v_lshlrev_b32 v27, 7, v27
  v_and_b32 v28, 3, v1
  v_lshl_add_u32 v27, v28, 3, v27
  v_lshl_add_u32 v27, v26, 5, v27
  v_add_u32 v18, s41, v27
  v_xor_b32 v19, 32, v18
  v_xor_b32 v20, 64, v18
  v_xor_b32 v21, 96, v18
  v_add_u32 v241, s65, v27
  v_xor_b32 v242, 32, v241
  v_xor_b32 v243, 64, v241
  v_xor_b32 v244, 96, v241
  s_add_u32 m0, s41, 0
  s_nop 0
  buffer_load_dwordx4 v14, s[8:11], s38 offen offset:0 lds
  buffer_load_dwordx4 v15, s[8:11], s38 offen offset:1024 lds
  buffer_load_dwordx4 v16, s[8:11], s38 offen offset:2048 lds
  buffer_load_dwordx4 v17, s[8:11], s38 offen offset:3072 lds
  s_add_u32 s38, s38, 131072
  s_add_u32 m0, s41, 4096
  s_nop 0
  buffer_load_dwordx4 v14, s[8:11], s38 offen offset:0 lds
  buffer_load_dwordx4 v15, s[8:11], s38 offen offset:1024 lds
  buffer_load_dwordx4 v16, s[8:11], s38 offen offset:2048 lds
  buffer_load_dwordx4 v17, s[8:11], s38 offen offset:3072 lds
  s_add_u32 s38, s38, 131072
  s_add_u32 m0, s41, 32768
  s_nop 0
  buffer_load_dwordx4 v14, s[8:11], s38 offen offset:0 lds
  buffer_load_dwordx4 v15, s[8:11], s38 offen offset:1024 lds
  buffer_load_dwordx4 v16, s[8:11], s38 offen offset:2048 lds
  buffer_load_dwordx4 v17, s[8:11], s38 offen offset:3072 lds
  s_add_u32 s38, s38, 131072
  s_add_u32 m0, s41, 36864
  s_nop 0
  buffer_load_dwordx4 v14, s[8:11], s38 offen offset:0 lds
  buffer_load_dwordx4 v15, s[8:11], s38 offen offset:1024 lds
  buffer_load_dwordx4 v16, s[8:11], s38 offen offset:2048 lds
  buffer_load_dwordx4 v17, s[8:11], s38 offen offset:3072 lds
  s_add_u32 s38, s38, 131072
  s_add_u32 m0, s65, 0
  s_nop 0
  buffer_load_dwordx4 v14, s[8:11], s38 offen offset:0 lds
  buffer_load_dwordx4 v15, s[8:11], s38 offen offset:1024 lds
  buffer_load_dwordx4 v16, s[8:11], s38 offen offset:2048 lds
  buffer_load_dwordx4 v17, s[8:11], s38 offen offset:3072 lds
  s_add_u32 s38, s38, 131072
  s_add_u32 m0, s65, 4096
  s_nop 0
  buffer_load_dwordx4 v14, s[8:11], s38 offen offset:0 lds
  buffer_load_dwordx4 v15, s[8:11], s38 offen offset:1024 lds
  buffer_load_dwordx4 v16, s[8:11], s38 offen offset:2048 lds
  buffer_load_dwordx4 v17, s[8:11], s38 offen offset:3072 lds
  s_add_u32 s38, s38, 131072
  s_add_u32 m0, s65, 32768
  s_nop 0
  buffer_load_dwordx4 v14, s[8:11], s38 offen offset:0 lds
  buffer_load_dwordx4 v15, s[8:11], s38 offen offset:1024 lds
  buffer_load_dwordx4 v16, s[8:11], s38 offen offset:2048 lds
  buffer_load_dwordx4 v17, s[8:11], s38 offen offset:3072 lds
  s_add_u32 s38, s38, 131072
  s_waitcnt vmcnt(0)
  ds_read_b64_tr_b16 a[0:1], v18 offset:0
  ds_read_b64_tr_b16 a[2:3], v18 offset:2048
  ds_read_b64_tr_b16 a[4:5], v19 offset:0
  ds_read_b64_tr_b16 a[6:7], v19 offset:2048
  ds_read_b64_tr_b16 a[8:9], v20 offset:0
  ds_read_b64_tr_b16 a[10:11], v20 offset:2048
  ds_read_b64_tr_b16 a[12:13], v21 offset:0
  ds_read_b64_tr_b16 a[14:15], v21 offset:2048
  ds_read_b64_tr_b16 a[16:17], v18 offset:4096
  ds_read_b64_tr_b16 a[18:19], v18 offset:6144
  ds_read_b64_tr_b16 a[20:21], v19 offset:4096
  ds_read_b64_tr_b16 a[22:23], v19 offset:6144
  ds_read_b64_tr_b16 a[24:25], v20 offset:4096
  ds_read_b64_tr_b16 a[26:27], v20 offset:6144
  ds_read_b64_tr_b16 a[28:29], v21 offset:4096
  ds_read_b64_tr_b16 a[30:31], v21 offset:6144
  ds_read_b64_tr_b16 a[32:33], v18 offset:32768
  ds_read_b64_tr_b16 a[34:35], v18 offset:34816
  ds_read_b64_tr_b16 a[36:37], v19 offset:32768
  ds_read_b64_tr_b16 a[38:39], v19 offset:34816
  ds_read_b64_tr_b16 a[40:41], v20 offset:32768
  ds_read_b64_tr_b16 a[42:43], v20 offset:34816
  ds_read_b64_tr_b16 a[44:45], v21 offset:32768
  ds_read_b64_tr_b16 a[46:47], v21 offset:34816
  ds_read_b64_tr_b16 a[48:49], v18 offset:36864
  ds_read_b64_tr_b16 a[50:51], v18 offset:38912
  ds_read_b64_tr_b16 a[52:53], v19 offset:36864
  ds_read_b64_tr_b16 a[54:55], v19 offset:38912
  ds_read_b64_tr_b16 a[56:57], v20 offset:36864
  ds_read_b64_tr_b16 a[58:59], v20 offset:38912
  ds_read_b64_tr_b16 a[60:61], v21 offset:36864
  ds_read_b64_tr_b16 a[62:63], v21 offset:38912
  ds_read_b64_tr_b16 a[64:65], v241 offset:0
  ds_read_b64_tr_b16 a[66:67], v241 offset:2048
  ds_read_b64_tr_b16 a[68:69], v242 offset:0
  ds_read_b64_tr_b16 a[70:71], v242 offset:2048
  ds_read_b64_tr_b16 a[72:73], v243 offset:0
  ds_read_b64_tr_b16 a[74:75], v243 offset:2048
  ds_read_b64_tr_b16 a[76:77], v244 offset:0
  ds_read_b64_tr_b16 a[78:79], v244 offset:2048
  ds_read_b64_tr_b16 a[80:81], v241 offset:4096
  ds_read_b64_tr_b16 a[82:83], v241 offset:6144
  ds_read_b64_tr_b16 a[84:85], v242 offset:4096
  ds_read_b64_tr_b16 a[86:87], v242 offset:6144
  ds_read_b64_tr_b16 a[88:89], v243 offset:4096
  ds_read_b64_tr_b16 a[90:91], v243 offset:6144
  ds_read_b64_tr_b16 a[92:93], v244 offset:4096
  ds_read_b64_tr_b16 a[94:95], v244 offset:6144
  ds_read_b64_tr_b16 a[96:97], v241 offset:32768
  ds_read_b64_tr_b16 a[98:99], v241 offset:34816
  ds_read_b64_tr_b16 a[100:101], v242 offset:32768
  ds_read_b64_tr_b16 a[102:103], v242 offset:34816
  ds_read_b64_tr_b16 a[104:105], v243 offset:32768
  ds_read_b64_tr_b16 a[106:107], v243 offset:34816
  ds_read_b64_tr_b16 a[108:109], v244 offset:32768
  ds_read_b64_tr_b16 a[110:111], v244 offset:34816
  s_waitcnt lgkmcnt(0)
  s_add_u32 m0, s41, 0
  s_nop 0
  buffer_load_dwordx4 v14, s[8:11], s38 offen offset:0 lds
  buffer_load_dwordx4 v15, s[8:11], s38 offen offset:1024 lds
  buffer_load_dwordx4 v16, s[8:11], s38 offen offset:2048 lds
  buffer_load_dwordx4 v17, s[8:11], s38 offen offset:3072 lds
  s_add_u32 s38, s38, 131072
  s_add_u32 m0, s41, 4096
  s_nop 0
  buffer_load_dwordx4 v14, s[8:11], s38 offen offset:0 lds
  buffer_load_dwordx4 v15, s[8:11], s38 offen offset:1024 lds
  buffer_load_dwordx4 v16, s[8:11], s38 offen offset:2048 lds
  buffer_load_dwordx4 v17, s[8:11], s38 offen offset:3072 lds
  s_add_u32 s38, s38, 131072
TL_X2:
  s_add_u32 m0, s41, 32768
  s_nop 0
  buffer_load_dwordx4 v14, s[8:11], s38 offen offset:0 lds
  buffer_load_dwordx4 v15, s[8:11], s38 offen offset:1024 lds
  buffer_load_dwordx4 v16, s[8:11], s38 offen offset:2048 lds
  buffer_load_dwordx4 v17, s[8:11], s38 offen offset:3072 lds
  s_add_u32 s38, s38, 131072
  s_add_u32 m0, s41, 36864
  s_nop 0
  buffer_load_dwordx4 v14, s[8:11], s38 offen offset:0 lds
  buffer_load_dwordx4 v15, s[8:11], s38 offen offset:1024 lds
  buffer_load_dwordx4 v16, s[8:11], s38 offen offset:2048 lds
  buffer_load_dwordx4 v17, s[8:11], s38 offen offset:3072 lds
  s_add_u32 s38, s38, 131072
  s_add_u32 m0, s65, 0
  s_nop 0
  buffer_load_dwordx4 v14, s[8:11], s38 offen offset:0 lds
  buffer_load_dwordx4 v15, s[8:11], s38 offen offset:1024 lds
  buffer_load_dwordx4 v16, s[8:11], s38 offen offset:2048 lds
  buffer_load_dwordx4 v17, s[8:11], s38 offen offset:3072 lds
  s_add_u32 s38, s38, 131072
  s_add_u32 m0, s65, 4096
  s_nop 0
  buffer_load_dwordx4 v14, s[8:11], s38 offen offset:0 lds
  buffer_load_dwordx4 v15, s[8:11], s38 offen offset:1024 lds
  buffer_load_dwordx4 v16, s[8:11], s38 offen offset:2048 lds
  buffer_load_dwordx4 v17, s[8:11], s38 offen offset:3072 lds
  s_add_u32 s38, s38, 131072
  s_add_u32 m0, s65, 32768
  s_nop 0
  buffer_load_dwordx4 v14, s[8:11], s38 offen offset:0 lds
  buffer_load_dwordx4 v15, s[8:11], s38 offen offset:1024 lds
  buffer_load_dwordx4 v16, s[8:11], s38 offen offset:2048 lds
  buffer_load_dwordx4 v17, s[8:11], s38 offen offset:3072 lds
  s_add_u32 s38, s38, 131072
TL_M2:
  s_lshl_b32 s43, s3, 2
  s_add_u32 s43, s43, s20
  s_mul_i32 s43, s43, 896
  s_add_u32 s43, s43, 94535680
  v_min_u32 v25, 768, v0
  buffer_load_dword v25, v25, s[12:15], s43 offen sc1
  s_mul_i32 s39, s20, 401408
  s_lshl_b32 s60, s3, 12
  s_add_u32 s39, s39, s60
  s_add_u32 s39, s39, 78643200
  s_lshl_b32 s60, s27, 6
  s_lshl_b32 s61, s20, 4
  s_add_u32 s60, s60, s61
  v_lshrrev_b32 v26, 3, v1
  v_add_u32 v27, s60, v26
  v_lshlrev_b32 v28, 1, v27
  v_mul_u32_u24 v8, 896, v27
  v_and_b32 v27, 7, v1
  v_lshl_add_u32 v8, v27, 4, v8
  s_lshl_b32 s60, s3, 7
  v_add_u32 v8, s60, v8
  v_add_u32 v7, 7168, v8
  v_lshl_add_u32 v24, v28, 3, v8
  v_lshlrev_b32 v6, 1, v27
  v_xor_b32 v6, v6, v26
  v_lshlrev_b32 v6, 4, v6
  v_lshl_add_u32 v6, v27, 9, v6
  s_lshl_b32 s60, s20, 12
  v_add_u32 v6, s60, v6
  v_xor_b32 v4, 128, v6
  s_lshl_b32 s60, s20, 14
  v_and_b32 v5, 32, v1
  v_xor_b32 v5, v5, v9
  v_add_u32 v5, s60, v5
  v_xor_b32 v29, 64, v5
  v_xor_b32 v30, 128, v5
  v_xor_b32 v31, 192, v5
  buffer_load_ushort v22, v28, s[80:83], 0 offen
  buffer_load_ushort v23, v28, s[80:83], 0 offen offset:16
  s_waitcnt vmcnt(0)
  v_cmp_eq_u32 vcc, 1, v25
  s_nop 1
  s_ff0_i32_b64 s52, vcc
  s_cmp_ge_u32 s52, 1
  s_cbranch_scc0 TL_G_56
TL_GB_57:
  buffer_load_dwordx4 v[96:99], v9, s[12:15], s39 offen offset:0 sc1
  ds_read_b64_tr_b16 a[112:113], v18 offset:0
  ds_read_b64_tr_b16 a[114:115], v18 offset:2048
  buffer_load_dwordx4 v[100:103], v9, s[12:15], s39 offen offset:1024 sc1
  ds_read_b64_tr_b16 a[116:117], v19 offset:0
  ds_read_b64_tr_b16 a[118:119], v19 offset:2048
  buffer_load_dwordx4 v[104:107], v9, s[12:15], s39 offen offset:2048 sc1
  ds_read_b64_tr_b16 a[120:121], v20 offset:0
  ds_read_b64_tr_b16 a[122:123], v20 offset:2048
  buffer_load_dwordx4 v[108:111], v9, s[12:15], s39 offen offset:3072 sc1
  s_add_u32 s39, s39, 28672
  ds_read_b64_tr_b16 a[124:125], v21 offset:0
  ds_read_b64_tr_b16 a[126:127], v21 offset:2048
  buffer_load_dwordx4 v[112:115], v9, s[12:15], s39 offen offset:0 sc1
  ds_read_b64_tr_b16 a[128:129], v18 offset:4096
  ds_read_b64_tr_b16 a[130:131], v18 offset:6144
  buffer_load_dwordx4 v[116:119], v9, s[12:15], s39 offen offset:1024 sc1
  ds_read_b64_tr_b16 a[132:133], v19 offset:4096
  ds_read_b64_tr_b16 a[134:135], v19 offset:6144
  buffer_load_dwordx4 v[120:123], v9, s[12:15], s39 offen offset:2048 sc1
  ds_read_b64_tr_b16 a[136:137], v20 offset:4096
  ds_read_b64_tr_b16 a[138:139], v20 offset:6144
  buffer_load_dwordx4 v[124:127], v9, s[12:15], s39 offen offset:3072 sc1
  s_add_u32 s39, s39, 28672
  ds_read_b64_tr_b16 a[140:141], v21 offset:4096
  ds_read_b64_tr_b16 a[142:143], v21 offset:6144
  s_cmp_ge_u32 s52, 2
  s_cbranch_scc0 TL_G_58
TL_GB_59:
  buffer_load_dwordx4 v[128:131], v9, s[12:15], s39 offen offset:0 sc1
  ds_read_b64_tr_b16 a[144:145], v18 offset:32768
  ds_read_b64_tr_b16 a[146:147], v18 offset:34816
  buffer_load_dwordx4 v[132:135], v9, s[12:15], s39 offen offset:1024 sc1
  ds_read_b64_tr_b16 a[148:149], v19 offset:32768
  ds_read_b64_tr_b16 a[150:151], v19 offset:34816
  buffer_load_dwordx4 v[136:139], v9, s[12:15], s39 offen offset:2048 sc1
  ds_read_b64_tr_b16 a[152:153], v20 offset:32768
  ds_read_b64_tr_b16 a[154:155], v20 offset:34816
  buffer_load_dwordx4 v[140:143], v9, s[12:15], s39 offen offset:3072 sc1
  s_add_u32 s39, s39, 28672
  ds_read_b64_tr_b16 a[156:157], v21 offset:32768
  ds_read_b64_tr_b16 a[158:159], v21 offset:34816
  buffer_load_dwordx4 v[144:147], v9, s[12:15], s39 offen offset:0 sc1
  ds_read_b64_tr_b16 a[160:161], v18 offset:36864
  ds_read_b64_tr_b16 a[162:163], v18 offset:38912
  buffer_load_dwordx4 v[148:151], v9, s[12:15], s39 offen offset:1024 sc1
  ds_read_b64_tr_b16 a[164:165], v19 offset:36864
  ds_read_b64_tr_b16 a[166:167], v19 offset:38912
  buffer_load_dwordx4 v[152:155], v9, s[12:15], s39 offen offset:2048 sc1
  ds_read_b64_tr_b16 a[168:169], v20 offset:36864
  ds_read_b64_tr_b16 a[170:171], v20 offset:38912
  buffer_load_dwordx4 v[156:159], v9, s[12:15], s39 offen offset:3072 sc1
  s_add_u32 s39, s39, 28672
  ds_read_b64_tr_b16 a[172:173], v21 offset:36864
  ds_read_b64_tr_b16 a[174:175], v21 offset:38912
  s_cmp_ge_u32 s52, 3
  s_cbranch_scc0 TL_G_60
TL_GB_61:
  buffer_load_dwordx4 v[160:163], v9, s[12:15], s39 offen offset:0 sc1
  ds_read_b64_tr_b16 a[176:177], v241 offset:0
  ds_read_b64_tr_b16 a[178:179], v241 offset:2048
  buffer_load_dwordx4 v[164:167], v9, s[12:15], s39 offen offset:1024 sc1
  ds_read_b64_tr_b16 a[180:181], v242 offset:0
  ds_read_b64_tr_b16 a[182:183], v242 offset:2048
  buffer_load_dwordx4 v[168:171], v9, s[12:15], s39 offen offset:2048 sc1
  ds_read_b64_tr_b16 a[184:185], v243 offset:0
  ds_read_b64_tr_b16 a[186:187], v243 offset:2048
  buffer_load_dwordx4 v[172:175], v9, s[12:15], s39 offen offset:3072 sc1
  s_add_u32 s39, s39, 28672
  ds_read_b64_tr_b16 a[188:189], v244 offset:0
  ds_read_b64_tr_b16 a[190:191], v244 offset:2048
  buffer_load_dwordx4 v[176:179], v9, s[12:15], s39 offen offset:0 sc1
  ds_read_b64_tr_b16 a[192:193], v241 offset:4096
  ds_read_b64_tr_b16 a[194:195], v241 offset:6144
  buffer_load_dwordx4 v[180:183], v9, s[12:15], s39 offen offset:1024 sc1
  ds_read_b64_tr_b16 a[196:197], v242 offset:4096
  ds_read_b64_tr_b16 a[198:199], v242 offset:6144
  buffer_load_dwordx4 v[184:187], v9, s[12:15], s39 offen offset:2048 sc1
  ds_read_b64_tr_b16 a[200:201], v243 offset:4096
  ds_read_b64_tr_b16 a[202:203], v243 offset:6144
  buffer_load_dwordx4 v[188:191], v9, s[12:15], s39 offen offset:3072 sc1
  s_add_u32 s39, s39, 28672
  ds_read_b64_tr_b16 a[204:205], v244 offset:4096
  ds_read_b64_tr_b16 a[206:207], v244 offset:6144
  s_cmp_ge_u32 s52, 4
  s_cbranch_scc0 TL_G_62
TL_GB_63:
  buffer_load_dwordx4 v[192:195], v9, s[12:15], s39 offen offset:0 sc1
  ds_read_b64_tr_b16 a[208:209], v241 offset:32768
  ds_read_b64_tr_b16 a[210:211], v241 offset:34816
  buffer_load_dwordx4 v[196:199], v9, s[12:15], s39 offen offset:1024 sc1
  ds_read_b64_tr_b16 a[212:213], v242 offset:32768
  ds_read_b64_tr_b16 a[214:215], v242 offset:34816
  buffer_load_dwordx4 v[200:203], v9, s[12:15], s39 offen offset:2048 sc1
  ds_read_b64_tr_b16 a[216:217], v243 offset:32768
  ds_read_b64_tr_b16 a[218:219], v243 offset:34816
  buffer_load_dwordx4 v[204:207], v9, s[12:15], s39 offen offset:3072 sc1
  s_add_u32 s39, s39, 28672
  ds_read_b64_tr_b16 a[220:221], v244 offset:32768
  ds_read_b64_tr_b16 a[222:223], v244 offset:34816
  s_mov_b32 s61, 74448896
  s_waitcnt vmcnt(24)
  v_mfma_f32_16x16x32_bf16 v[32:35], v[96:99], a[0:3], 0
  v_mfma_f32_16x16x32_bf16 v[36:39], v[100:103], a[0:3], 0
  v_mfma_f32_16x16x32_bf16 v[40:43], v[104:107], a[0:3], 0
  buffer_load_dwordx4 v[208:211], v9, s[12:15], s39 offen offset:0 sc1
  v_mfma_f32_16x16x32_bf16 v[44:47], v[108:111], a[0:3], 0
  v_mfma_f32_16x16x32_bf16 v[60:63], v[108:111], a[4:7], 0
  v_mfma_f32_16x16x32_bf16 v[56:59], v[104:107], a[4:7], 0
  buffer_load_dwordx4 v[212:215], v9, s[12:15], s39 offen offset:1024 sc1
  v_mfma_f32_16x16x32_bf16 v[52:55], v[100:103], a[4:7], 0
  v_mfma_f32_16x16x32_bf16 v[48:51], v[96:99], a[4:7], 0
  v_mfma_f32_16x16x32_bf16 v[64:67], v[96:99], a[8:11], 0
  buffer_load_dwordx4 v[216:219], v9, s[12:15], s39 offen offset:2048 sc1
  v_mfma_f32_16x16x32_bf16 v[68:71], v[100:103], a[8:11], 0
  v_mfma_f32_16x16x32_bf16 v[72:75], v[104:107], a[8:11], 0
  v_mfma_f32_16x16x32_bf16 v[76:79], v[108:111], a[8:11], 0
  buffer_load_dwordx4 v[220:223], v9, s[12:15], s39 offen offset:3072 sc1
  s_add_u32 s39, s39, 28672
  v_mfma_f32_16x16x32_bf16 v[92:95], v[108:111], a[12:15], 0
  v_mfma_f32_16x16x32_bf16 v[88:91], v[104:107], a[12:15], 0
  v_mfma_f32_16x16x32_bf16 v[84:87], v[100:103], a[12:15], 0
  v_mfma_f32_16x16x32_bf16 v[80:83], v[96:99], a[12:15], 0
  s_waitcnt vmcnt(24)
  v_mfma_f32_16x16x32_bf16 v[32:35], v[112:115], a[16:19], v[32:35]
  v_mfma_f32_16x16x32_bf16 v[36:39], v[116:119], a[16:19], v[36:39]
  v_mfma_f32_16x16x32_bf16 v[40:43], v[120:123], a[16:19], v[40:43]
  s_cmp_ge_u32 s52, 5
  s_cbranch_scc0 TL_G_64
TL_GB_65:
  buffer_load_dwordx4 v[224:227], v9, s[12:15], s39 offen offset:0 sc1
  v_mfma_f32_16x16x32_bf16 v[44:47], v[124:127], a[16:19], v[44:47]
  v_mfma_f32_16x16x32_bf16 v[60:63], v[124:127], a[20:23], v[60:63]
  v_mfma_f32_16x16x32_bf16 v[56:59], v[120:123], a[20:23], v[56:59]
  buffer_load_dwordx4 v[228:231], v9, s[12:15], s39 offen offset:1024 sc1
  v_mfma_f32_16x16x32_bf16 v[52:55], v[116:119], a[20:23], v[52:55]
  v_mfma_f32_16x16x32_bf16 v[48:51], v[112:115], a[20:23], v[48:51]
  v_mfma_f32_16x16x32_bf16 v[64:67], v[112:115], a[24:27], v[64:67]
  buffer_load_dwordx4 v[232:235], v9, s[12:15], s39 offen offset:2048 sc1
  v_mfma_f32_16x16x32_bf16 v[68:71], v[116:119], a[24:27], v[68:71]
  v_mfma_f32_16x16x32_bf16 v[72:75], v[120:123], a[24:27], v[72:75]
  v_mfma_f32_16x16x32_bf16 v[76:79], v[124:127], a[24:27], v[76:79]
  buffer_load_dwordx4 v[236:239], v9, s[12:15], s39 offen offset:3072 sc1
  s_add_u32 s39, s39, 28672
  v_mfma_f32_16x16x32_bf16 v[92:95], v[124:127], a[28:31], v[92:95]
  v_mfma_f32_16x16x32_bf16 v[88:91], v[120:123], a[28:31], v[88:91]
  v_mfma_f32_16x16x32_bf16 v[84:87], v[116:119], a[28:31], v[84:87]
  v_mfma_f32_16x16x32_bf16 v[80:83], v[112:115], a[28:31], v[80:83]
  s_waitcnt vmcnt(24)
  v_mfma_f32_16x16x32_bf16 v[32:35], v[128:131], a[32:35], v[32:35]
  v_mfma_f32_16x16x32_bf16 v[36:39], v[132:135], a[32:35], v[36:39]
  v_mfma_f32_16x16x32_bf16 v[40:43], v[136:139], a[32:35], v[40:43]
  buffer_load_dwordx4 v[240:243], v9, s[12:15], s39 offen offset:0 sc1
  v_mfma_f32_16x16x32_bf16 v[44:47], v[140:143], a[32:35], v[44:47]
  v_mfma_f32_16x16x32_bf16 v[60:63], v[140:143], a[36:39], v[60:63]
  v_mfma_f32_16x16x32_bf16 v[56:59], v[136:139], a[36:39], v[56:59]
  buffer_load_dwordx4 v[244:247], v9, s[12:15], s39 offen offset:1024 sc1
  v_mfma_f32_16x16x32_bf16 v[52:55], v[132:135], a[36:39], v[52:55]
  v_mfma_f32_16x16x32_bf16 v[48:51], v[128:131], a[36:39], v[48:51]
  v_mfma_f32_16x16x32_bf16 v[64:67], v[128:131], a[40:43], v[64:67]
  buffer_load_dwordx4 v[248:251], v9, s[12:15], s39 offen offset:2048 sc1
  v_mfma_f32_16x16x32_bf16 v[68:71], v[132:135], a[40:43], v[68:71]
  v_mfma_f32_16x16x32_bf16 v[72:75], v[136:139], a[40:43], v[72:75]
  v_mfma_f32_16x16x32_bf16 v[76:79], v[140:143], a[40:43], v[76:79]
  buffer_load_dwordx4 v[252:255], v9, s[12:15], s39 offen offset:3072 sc1
  s_add_u32 s39, s39, 28672
  v_mfma_f32_16x16x32_bf16 v[92:95], v[140:143], a[44:47], v[92:95]
  v_mfma_f32_16x16x32_bf16 v[88:91], v[136:139], a[44:47], v[88:91]
  v_mfma_f32_16x16x32_bf16 v[84:87], v[132:135], a[44:47], v[84:87]
  v_mfma_f32_16x16x32_bf16 v[80:83], v[128:131], a[44:47], v[80:83]
  s_waitcnt vmcnt(24)
  v_mfma_f32_16x16x32_bf16 v[32:35], v[144:147], a[48:51], v[32:35]
  v_mfma_f32_16x16x32_bf16 v[36:39], v[148:151], a[48:51], v[36:39]
  v_mfma_f32_16x16x32_bf16 v[40:43], v[152:155], a[48:51], v[40:43]
  s_cmp_ge_u32 s52, 6
  s_cbranch_scc0 TL_G_66
TL_GB_67:
  buffer_load_dwordx4 v[96:99], v9, s[12:15], s39 offen offset:0 sc1
  v_mfma_f32_16x16x32_bf16 v[44:47], v[156:159], a[48:51], v[44:47]
  v_mfma_f32_16x16x32_bf16 v[60:63], v[156:159], a[52:55], v[60:63]
  v_mfma_f32_16x16x32_bf16 v[56:59], v[152:155], a[52:55], v[56:59]
  buffer_load_dwordx4 v[100:103], v9, s[12:15], s39 offen offset:1024 sc1
  v_mfma_f32_16x16x32_bf16 v[52:55], v[148:151], a[52:55], v[52:55]
  v_mfma_f32_16x16x32_bf16 v[48:51], v[144:147], a[52:55], v[48:51]
  v_mfma_f32_16x16x32_bf16 v[64:67], v[144:147], a[56:59], v[64:67]
  buffer_load_dwordx4 v[104:107], v9, s[12:15], s39 offen offset:2048 sc1
  v_mfma_f32_16x16x32_bf16 v[68:71], v[148:151], a[56:59], v[68:71]
  v_mfma_f32_16x16x32_bf16 v[72:75], v[152:155], a[56:59], v[72:75]
  v_mfma_f32_16x16x32_bf16 v[76:79], v[156:159], a[56:59], v[76:79]
  buffer_load_dwordx4 v[108:111], v9, s[12:15], s39 offen offset:3072 sc1
  s_add_u32 s39, s39, 28672
  v_mfma_f32_16x16x32_bf16 v[92:95], v[156:159], a[60:63], v[92:95]
  v_mfma_f32_16x16x32_bf16 v[88:91], v[152:155], a[60:63], v[88:91]
  v_mfma_f32_16x16x32_bf16 v[84:87], v[148:151], a[60:63], v[84:87]
  v_mfma_f32_16x16x32_bf16 v[80:83], v[144:147], a[60:63], v[80:83]
  s_waitcnt vmcnt(24)
  v_mfma_f32_16x16x32_bf16 v[32:35], v[160:163], a[64:67], v[32:35]
  v_mfma_f32_16x16x32_bf16 v[36:39], v[164:167], a[64:67], v[36:39]
  v_mfma_f32_16x16x32_bf16 v[40:43], v[168:171], a[64:67], v[40:43]
  buffer_load_dwordx4 v[112:115], v9, s[12:15], s39 offen offset:0 sc1
  v_mfma_f32_16x16x32_bf16 v[44:47], v[172:175], a[64:67], v[44:47]
  v_mfma_f32_16x16x32_bf16 v[60:63], v[172:175], a[68:71], v[60:63]
  v_mfma_f32_16x16x32_bf16 v[56:59], v[168:171], a[68:71], v[56:59]
  buffer_load_dwordx4 v[116:119], v9, s[12:15], s39 offen offset:1024 sc1
  v_mfma_f32_16x16x32_bf16 v[52:55], v[164:167], a[68:71], v[52:55]
  v_mfma_f32_16x16x32_bf16 v[48:51], v[160:163], a[68:71], v[48:51]
  v_mfma_f32_16x16x32_bf16 v[64:67], v[160:163], a[72:75], v[64:67]
  buffer_load_dwordx4 v[120:123], v9, s[12:15], s39 offen offset:2048 sc1
  v_mfma_f32_16x16x32_bf16 v[68:71], v[164:167], a[72:75], v[68:71]
  v_mfma_f32_16x16x32_bf16 v[72:75], v[168:171], a[72:75], v[72:75]
  v_mfma_f32_16x16x32_bf16 v[76:79], v[172:175], a[72:75], v[76:79]
  buffer_load_dwordx4 v[124:127], v9, s[12:15], s39 offen offset:3072 sc1
  s_add_u32 s39, s39, 28672
  v_mfma_f32_16x16x32_bf16 v[92:95], v[172:175], a[76:79], v[92:95]
  v_mfma_f32_16x16x32_bf16 v[88:91], v[168:171], a[76:79], v[88:91]
  v_mfma_f32_16x16x32_bf16 v[84:87], v[164:167], a[76:79], v[84:87]
  v_mfma_f32_16x16x32_bf16 v[80:83], v[160:163], a[76:79], v[80:83]
  s_waitcnt vmcnt(24)
  v_mfma_f32_16x16x32_bf16 v[32:35], v[176:179], a[80:83], v[32:35]
  v_mfma_f32_16x16x32_bf16 v[36:39], v[180:183], a[80:83], v[36:39]
  v_mfma_f32_16x16x32_bf16 v[40:43], v[184:187], a[80:83], v[40:43]
  s_cmp_ge_u32 s52, 7
  s_cbranch_scc0 TL_G_68
TL_GB_69:
  buffer_load_dwordx4 v[128:131], v9, s[12:15], s39 offen offset:0 sc1
  v_mfma_f32_16x16x32_bf16 v[44:47], v[188:191], a[80:83], v[44:47]
  v_mfma_f32_16x16x32_bf16 v[60:63], v[188:191], a[84:87], v[60:63]
  v_mfma_f32_16x16x32_bf16 v[56:59], v[184:187], a[84:87], v[56:59]
  buffer_load_dwordx4 v[132:135], v9, s[12:15], s39 offen offset:1024 sc1
  v_mfma_f32_16x16x32_bf16 v[52:55], v[180:183], a[84:87], v[52:55]
  v_mfma_f32_16x16x32_bf16 v[48:51], v[176:179], a[84:87], v[48:51]
  v_mfma_f32_16x16x32_bf16 v[64:67], v[176:179], a[88:91], v[64:67]
  buffer_load_dwordx4 v[136:139], v9, s[12:15], s39 offen offset:2048 sc1
  v_mfma_f32_16x16x32_bf16 v[68:71], v[180:183], a[88:91], v[68:71]
  v_mfma_f32_16x16x32_bf16 v[72:75], v[184:187], a[88:91], v[72:75]
  v_mfma_f32_16x16x32_bf16 v[76:79], v[188:191], a[88:91], v[76:79]
  buffer_load_dwordx4 v[140:143], v9, s[12:15], s39 offen offset:3072 sc1
  s_add_u32 s39, s39, 28672
  v_mfma_f32_16x16x32_bf16 v[92:95], v[188:191], a[92:95], v[92:95]
  v_mfma_f32_16x16x32_bf16 v[88:91], v[184:187], a[92:95], v[88:91]
  v_mfma_f32_16x16x32_bf16 v[84:87], v[180:183], a[92:95], v[84:87]
  v_mfma_f32_16x16x32_bf16 v[80:83], v[176:179], a[92:95], v[80:83]
  s_waitcnt vmcnt(24)
  v_mfma_f32_16x16x32_bf16 v[32:35], v[192:195], a[96:99], v[32:35]
  v_mfma_f32_16x16x32_bf16 v[36:39], v[196:199], a[96:99], v[36:39]
  v_mfma_f32_16x16x32_bf16 v[40:43], v[200:203], a[96:99], v[40:43]
  buffer_load_dwordx4 v[144:147], v9, s[12:15], s39 offen offset:0 sc1
  v_mfma_f32_16x16x32_bf16 v[44:47], v[204:207], a[96:99], v[44:47]
  v_mfma_f32_16x16x32_bf16 v[60:63], v[204:207], a[100:103], v[60:63]
  v_mfma_f32_16x16x32_bf16 v[56:59], v[200:203], a[100:103], v[56:59]
  buffer_load_dwordx4 v[148:151], v9, s[12:15], s39 offen offset:1024 sc1
  v_mfma_f32_16x16x32_bf16 v[52:55], v[196:199], a[100:103], v[52:55]
  v_mfma_f32_16x16x32_bf16 v[48:51], v[192:195], a[100:103], v[48:51]
  v_mfma_f32_16x16x32_bf16 v[64:67], v[192:195], a[104:107], v[64:67]
  buffer_load_dwordx4 v[152:155], v9, s[12:15], s39 offen offset:2048 sc1
  v_mfma_f32_16x16x32_bf16 v[68:71], v[196:199], a[104:107], v[68:71]
  v_mfma_f32_16x16x32_bf16 v[72:75], v[200:203], a[104:107], v[72:75]
  v_mfma_f32_16x16x32_bf16 v[76:79], v[204:207], a[104:107], v[76:79]
  buffer_load_dwordx4 v[156:159], v9, s[12:15], s39 offen offset:3072 sc1
  s_add_u32 s39, s39, 28672
  v_mfma_f32_16x16x32_bf16 v[92:95], v[204:207], a[108:111], v[92:95]
  v_mfma_f32_16x16x32_bf16 v[88:91], v[200:203], a[108:111], v[88:91]
  v_mfma_f32_16x16x32_bf16 v[84:87], v[196:199], a[108:111], v[84:87]
  v_mfma_f32_16x16x32_bf16 v[80:83], v[192:195], a[108:111], v[80:83]
  s_waitcnt vmcnt(24) lgkmcnt(0)
  v_mfma_f32_16x16x32_bf16 v[32:35], v[208:211], a[112:115], v[32:35]
  v_mfma_f32_16x16x32_bf16 v[36:39], v[212:215], a[112:115], v[36:39]
  v_mfma_f32_16x16x32_bf16 v[40:43], v[216:219], a[112:115], v[40:43]
  buffer_load_dwordx4 v[10:13], v24, s[12:15], s61 offen sc1
  v_mfma_f32_16x16x32_bf16 v[44:47], v[220:223], a[112:115], v[44:47]
  v_mfma_f32_16x16x32_bf16 v[60:63], v[220:223], a[116:119], v[60:63]
  v_mfma_f32_16x16x32_bf16 v[56:59], v[216:219], a[116:119], v[56:59]
  s_add_u32 s61, s61, 7296
  buffer_load_dwordx4 v[14:17], v24, s[12:15], s61 offen sc1
  v_mfma_f32_16x16x32_bf16 v[52:55], v[212:215], a[116:119], v[52:55]
  v_mfma_f32_16x16x32_bf16 v[48:51], v[208:211], a[116:119], v[48:51]
  v_mfma_f32_16x16x32_bf16 v[64:67], v[208:211], a[120:123], v[64:67]
  v_mfma_f32_16x16x32_bf16 v[68:71], v[212:215], a[120:123], v[68:71]
  v_mfma_f32_16x16x32_bf16 v[72:75], v[216:219], a[120:123], v[72:75]
  v_mfma_f32_16x16x32_bf16 v[76:79], v[220:223], a[120:123], v[76:79]
  v_mfma_f32_16x16x32_bf16 v[92:95], v[220:223], a[124:127], v[92:95]
  v_mfma_f32_16x16x32_bf16 v[88:91], v[216:219], a[124:127], v[88:91]
  v_mfma_f32_16x16x32_bf16 v[84:87], v[212:215], a[124:127], v[84:87]
  v_mfma_f32_16x16x32_bf16 v[80:83], v[208:211], a[124:127], v[80:83]
  s_waitcnt vmcnt(22) lgkmcnt(0)
  v_mfma_f32_16x16x32_bf16 v[32:35], v[224:227], a[128:131], v[32:35]
  v_mfma_f32_16x16x32_bf16 v[36:39], v[228:231], a[128:131], v[36:39]
  v_mfma_f32_16x16x32_bf16 v[40:43], v[232:235], a[128:131], v[40:43]
  v_mfma_f32_16x16x32_bf16 v[44:47], v[236:239], a[128:131], v[44:47]
  v_mfma_f32_16x16x32_bf16 v[60:63], v[236:239], a[132:135], v[60:63]
  v_mfma_f32_16x16x32_bf16 v[56:59], v[232:235], a[132:135], v[56:59]
  v_mfma_f32_16x16x32_bf16 v[52:55], v[228:231], a[132:135], v[52:55]
  v_mfma_f32_16x16x32_bf16 v[48:51], v[224:227], a[132:135], v[48:51]
  v_mfma_f32_16x16x32_bf16 v[64:67], v[224:227], a[136:139], v[64:67]
  v_mfma_f32_16x16x32_bf16 v[68:71], v[228:231], a[136:139], v[68:71]
  v_mfma_f32_16x16x32_bf16 v[72:75], v[232:235], a[136:139], v[72:75]
  v_mfma_f32_16x16x32_bf16 v[76:79], v[236:239], a[136:139], v[76:79]
  v_mfma_f32_16x16x32_bf16 v[92:95], v[236:239], a[140:143], v[92:95]
  v_mfma_f32_16x16x32_bf16 v[88:91], v[232:235], a[140:143], v[88:91]
  v_mfma_f32_16x16x32_bf16 v[84:87], v[228:231], a[140:143], v[84:87]
  v_mfma_f32_16x16x32_bf16 v[80:83], v[224:227], a[140:143], v[80:83]
  s_waitcnt vmcnt(18) lgkmcnt(0)
  v_mfma_f32_16x16x32_bf16 v[32:35], v[240:243], a[144:147], v[32:35]
  v_mfma_f32_16x16x32_bf16 v[36:39], v[244:247], a[144:147], v[36:39]
  v_mfma_f32_16x16x32_bf16 v[40:43], v[248:251], a[144:147], v[40:43]
  v_mfma_f32_16x16x32_bf16 v[44:47], v[252:255], a[144:147], v[44:47]
  v_mfma_f32_16x16x32_bf16 v[60:63], v[252:255], a[148:151], v[60:63]
  v_mfma_f32_16x16x32_bf16 v[56:59], v[248:251], a[148:151], v[56:59]
  v_mfma_f32_16x16x32_bf16 v[52:55], v[244:247], a[148:151], v[52:55]
  v_mfma_f32_16x16x32_bf16 v[48:51], v[240:243], a[148:151], v[48:51]
  v_mfma_f32_16x16x32_bf16 v[64:67], v[240:243], a[152:155], v[64:67]
  v_mfma_f32_16x16x32_bf16 v[68:71], v[244:247], a[152:155], v[68:71]
  v_mfma_f32_16x16x32_bf16 v[72:75], v[248:251], a[152:155], v[72:75]
  v_mfma_f32_16x16x32_bf16 v[76:79], v[252:255], a[152:155], v[76:79]
  v_mfma_f32_16x16x32_bf16 v[92:95], v[252:255], a[156:159], v[92:95]
  v_mfma_f32_16x16x32_bf16 v[88:91], v[248:251], a[156:159], v[88:91]
  v_mfma_f32_16x16x32_bf16 v[84:87], v[244:247], a[156:159], v[84:87]
  v_mfma_f32_16x16x32_bf16 v[80:83], v[240:243], a[156:159], v[80:83]
  s_waitcnt vmcnt(14) lgkmcnt(0)
  v_mfma_f32_16x16x32_bf16 v[32:35], v[96:99], a[160:163], v[32:35]
  v_mfma_f32_16x16x32_bf16 v[36:39], v[100:103], a[160:163], v[36:39]
  v_mfma_f32_16x16x32_bf16 v[40:43], v[104:107], a[160:163], v[40:43]
  v_mfma_f32_16x16x32_bf16 v[44:47], v[108:111], a[160:163], v[44:47]
  v_mfma_f32_16x16x32_bf16 v[60:63], v[108:111], a[164:167], v[60:63]
  v_mfma_f32_16x16x32_bf16 v[56:59], v[104:107], a[164:167], v[56:59]
  v_mfma_f32_16x16x32_bf16 v[52:55], v[100:103], a[164:167], v[52:55]
  v_mfma_f32_16x16x32_bf16 v[48:51], v[96:99], a[164:167], v[48:51]
  v_mfma_f32_16x16x32_bf16 v[64:67], v[96:99], a[168:171], v[64:67]
  v_mfma_f32_16x16x32_bf16 v[68:71], v[100:103], a[168:171], v[68:71]
  v_mfma_f32_16x16x32_bf16 v[72:75], v[104:107], a[168:171], v[72:75]
  v_mfma_f32_16x16x32_bf16 v[76:79], v[108:111], a[168:171], v[76:79]
  v_mfma_f32_16x16x32_bf16 v[92:95], v[108:111], a[172:175], v[92:95]
  v_mfma_f32_16x16x32_bf16 v[88:91], v[104:107], a[172:175], v[88:91]
  v_mfma_f32_16x16x32_bf16 v[84:87], v[100:103], a[172:175], v[84:87]
  v_mfma_f32_16x16x32_bf16 v[80:83], v[96:99], a[172:175], v[80:83]
  s_waitcnt vmcnt(10) lgkmcnt(0)
  v_mfma_f32_16x16x32_bf16 v[32:35], v[112:115], a[176:179], v[32:35]
  v_mfma_f32_16x16x32_bf16 v[36:39], v[116:119], a[176:179], v[36:39]
  v_mfma_f32_16x16x32_bf16 v[40:43], v[120:123], a[176:179], v[40:43]
  v_mfma_f32_16x16x32_bf16 v[44:47], v[124:127], a[176:179], v[44:47]
  v_mfma_f32_16x16x32_bf16 v[60:63], v[124:127], a[180:183], v[60:63]
  v_mfma_f32_16x16x32_bf16 v[56:59], v[120:123], a[180:183], v[56:59]
  v_mfma_f32_16x16x32_bf16 v[52:55], v[116:119], a[180:183], v[52:55]
  v_mfma_f32_16x16x32_bf16 v[48:51], v[112:115], a[180:183], v[48:51]
  v_mfma_f32_16x16x32_bf16 v[64:67], v[112:115], a[184:187], v[64:67]
  v_mfma_f32_16x16x32_bf16 v[68:71], v[116:119], a[184:187], v[68:71]
  v_mfma_f32_16x16x32_bf16 v[72:75], v[120:123], a[184:187], v[72:75]
  v_mfma_f32_16x16x32_bf16 v[76:79], v[124:127], a[184:187], v[76:79]
  v_mfma_f32_16x16x32_bf16 v[92:95], v[124:127], a[188:191], v[92:95]
  v_mfma_f32_16x16x32_bf16 v[88:91], v[120:123], a[188:191], v[88:91]
  v_mfma_f32_16x16x32_bf16 v[84:87], v[116:119], a[188:191], v[84:87]
  v_mfma_f32_16x16x32_bf16 v[80:83], v[112:115], a[188:191], v[80:83]
  s_waitcnt vmcnt(6) lgkmcnt(0)
  v_mfma_f32_16x16x32_bf16 v[32:35], v[128:131], a[192:195], v[32:35]
  v_mfma_f32_16x16x32_bf16 v[36:39], v[132:135], a[192:195], v[36:39]
  v_mfma_f32_16x16x32_bf16 v[40:43], v[136:139], a[192:195], v[40:43]
  v_mfma_f32_16x16x32_bf16 v[44:47], v[140:143], a[192:195], v[44:47]
  v_mfma_f32_16x16x32_bf16 v[60:63], v[140:143], a[196:199], v[60:63]
  v_mfma_f32_16x16x32_bf16 v[56:59], v[136:139], a[196:199], v[56:59]
  v_mfma_f32_16x16x32_bf16 v[52:55], v[132:135], a[196:199], v[52:55]
  v_mfma_f32_16x16x32_bf16 v[48:51], v[128:131], a[196:199], v[48:51]
  v_mfma_f32_16x16x32_bf16 v[64:67], v[128:131], a[200:203], v[64:67]
  v_mfma_f32_16x16x32_bf16 v[68:71], v[132:135], a[200:203], v[68:71]
  v_mfma_f32_16x16x32_bf16 v[72:75], v[136:139], a[200:203], v[72:75]
  v_mfma_f32_16x16x32_bf16 v[76:79], v[140:143], a[200:203], v[76:79]
  v_mfma_f32_16x16x32_bf16 v[92:95], v[140:143], a[204:207], v[92:95]
  v_mfma_f32_16x16x32_bf16 v[88:91], v[136:139], a[204:207], v[88:91]
  v_mfma_f32_16x16x32_bf16 v[84:87], v[132:135], a[204:207], v[84:87]
  v_mfma_f32_16x16x32_bf16 v[80:83], v[128:131], a[204:207], v[80:83]
  s_waitcnt vmcnt(2) lgkmcnt(0)
  v_mfma_f32_16x16x32_bf16 v[32:35], v[144:147], a[208:211], v[32:35]
  v_mfma_f32_16x16x32_bf16 v[36:39], v[148:151], a[208:211], v[36:39]
  v_mfma_f32_16x16x32_bf16 v[40:43], v[152:155], a[208:211], v[40:43]
  v_mfma_f32_16x16x32_bf16 v[44:47], v[156:159], a[208:211], v[44:47]
  v_mfma_f32_16x16x32_bf16 v[60:63], v[156:159], a[212:215], v[60:63]
  v_mfma_f32_16x16x32_bf16 v[56:59], v[152:155], a[212:215], v[56:59]
  v_mfma_f32_16x16x32_bf16 v[52:55], v[148:151], a[212:215], v[52:55]
  v_mfma_f32_16x16x32_bf16 v[48:51], v[144:147], a[212:215], v[48:51]
  v_mfma_f32_16x16x32_bf16 v[64:67], v[144:147], a[216:219], v[64:67]
  v_mfma_f32_16x16x32_bf16 v[68:71], v[148:151], a[216:219], v[68:71]
  v_mfma_f32_16x16x32_bf16 v[72:75], v[152:155], a[216:219], v[72:75]
  v_mfma_f32_16x16x32_bf16 v[76:79], v[156:159], a[216:219], v[76:79]
  v_mfma_f32_16x16x32_bf16 v[92:95], v[156:159], a[220:223], v[92:95]
  v_mfma_f32_16x16x32_bf16 v[88:91], v[152:155], a[220:223], v[88:91]
  v_mfma_f32_16x16x32_bf16 v[84:87], v[148:151], a[220:223], v[84:87]
  v_mfma_f32_16x16x32_bf16 v[80:83], v[144:147], a[220:223], v[80:83]
  s_barrier
  s_waitcnt vmcnt(0)
  v_lshlrev_b32 v22, 16, v22
  v_lshlrev_b32 v96, 16, v10
  v_and_b32 v97, 0xffff0000, v10
  v_lshlrev_b32 v98, 16, v11
  v_and_b32 v99, 0xffff0000, v11
  v_lshlrev_b32 v100, 16, v12
  v_and_b32 v101, 0xffff0000, v12
  v_lshlrev_b32 v102, 16, v13
  ds_write_b128 v5, v[32:35] offset:0
  v_and_b32 v103, 0xffff0000, v13
  v_add_f32 v96, v96, v22
  ds_write_b128 v29, v[36:39] offset:1024
  v_add_f32 v97, v97, v22
  v_add_f32 v98, v98, v22
  ds_write_b128 v30, v[40:43] offset:2048
  v_add_f32 v99, v99, v22
  v_add_f32 v100, v100, v22
  ds_write_b128 v31, v[44:47] offset:3072
  v_add_f32 v101, v101, v22
  v_add_f32 v102, v102, v22
  ds_write_b128 v5, v[48:51] offset:4096
  v_add_f32 v103, v103, v22
  v_lshlrev_b32 v23, 16, v23
  ds_write_b128 v29, v[52:55] offset:5120
  v_lshlrev_b32 v104, 16, v14
  v_and_b32 v105, 0xffff0000, v14
  ds_write_b128 v30, v[56:59] offset:6144
  v_lshlrev_b32 v106, 16, v15
  v_and_b32 v107, 0xffff0000, v15
  ds_write_b128 v31, v[60:63] offset:7168
  v_lshlrev_b32 v108, 16, v16
  v_and_b32 v109, 0xffff0000, v16
  ds_write_b128 v5, v[64:67] offset:8192
  v_lshlrev_b32 v110, 16, v17
  v_and_b32 v111, 0xffff0000, v17
  ds_write_b128 v29, v[68:71] offset:9216
  v_add_f32 v104, v104, v23
  v_add_f32 v105, v105, v23
  ds_write_b128 v30, v[72:75] offset:10240
  v_add_f32 v106, v106, v23
  v_add_f32 v107, v107, v23
  ds_write_b128 v31, v[76:79] offset:11264
  v_add_f32 v108, v108, v23
  v_add_f32 v109, v109, v23
  ds_write_b128 v5, v[80:83] offset:12288
  v_add_f32 v110, v110, v23
  v_add_f32 v111, v111, v23
  ds_write_b128 v29, v[84:87] offset:13312
  ds_write_b128 v30, v[88:91] offset:14336
  ds_write_b128 v31, v[92:95] offset:15360
  s_waitcnt lgkmcnt(0)
  s_barrier
  ds_read_b128 v[32:35], v6 offset:0
  ds_read_b128 v[36:39], v6 offset:256
  ds_read_b128 v[40:43], v4 offset:0
  ds_read_b128 v[44:47], v4 offset:256
  ds_read_b128 v[48:51], v6 offset:16384
  ds_read_b128 v[52:55], v6 offset:16640
  ds_read_b128 v[56:59], v4 offset:16384
  ds_read_b128 v[60:63], v4 offset:16640
  ds_read_b128 v[64:67], v6 offset:32768
  ds_read_b128 v[68:71], v6 offset:33024
  ds_read_b128 v[72:75], v4 offset:32768
  ds_read_b128 v[76:79], v4 offset:33024
  ds_read_b128 v[80:83], v6 offset:49152
  ds_read_b128 v[84:87], v6 offset:49408
  ds_read_b128 v[88:91], v4 offset:49152
  ds_read_b128 v[92:95], v4 offset:49408
  s_waitcnt lgkmcnt(12)
  v_pk_add_f32 v[96:97], v[96:97], v[32:33]
  v_pk_add_f32 v[98:99], v[98:99], v[34:35]
  v_pk_add_f32 v[100:101], v[100:101], v[36:37]
  v_pk_add_f32 v[102:103], v[102:103], v[38:39]
  v_pk_add_f32 v[104:105], v[104:105], v[40:41]
  v_pk_add_f32 v[106:107], v[106:107], v[42:43]
  v_pk_add_f32 v[108:109], v[108:109], v[44:45]
  v_pk_add_f32 v[110:111], v[110:111], v[46:47]
  s_waitcnt lgkmcnt(8)
  v_pk_add_f32 v[96:97], v[96:97], v[48:49]
  v_pk_add_f32 v[98:99], v[98:99], v[50:51]
  v_pk_add_f32 v[100:101], v[100:101], v[52:53]
  v_pk_add_f32 v[102:103], v[102:103], v[54:55]
  v_pk_add_f32 v[104:105], v[104:105], v[56:57]
  v_pk_add_f32 v[106:107], v[106:107], v[58:59]
  v_pk_add_f32 v[108:109], v[108:109], v[60:61]
  v_pk_add_f32 v[110:111], v[110:111], v[62:63]
  s_waitcnt lgkmcnt(4)
  v_pk_add_f32 v[96:97], v[96:97], v[64:65]
  v_pk_add_f32 v[98:99], v[98:99], v[66:67]
  v_pk_add_f32 v[100:101], v[100:101], v[68:69]
  v_pk_add_f32 v[102:103], v[102:103], v[70:71]
  v_pk_add_f32 v[104:105], v[104:105], v[72:73]
  v_pk_add_f32 v[106:107], v[106:107], v[74:75]
  v_pk_add_f32 v[108:109], v[108:109], v[76:77]
  v_pk_add_f32 v[110:111], v[110:111], v[78:79]
  s_waitcnt lgkmcnt(0)
  v_pk_add_f32 v[96:97], v[96:97], v[80:81]
  v_pk_add_f32 v[98:99], v[98:99], v[82:83]
  v_pk_add_f32 v[100:101], v[100:101], v[84:85]
  v_pk_add_f32 v[102:103], v[102:103], v[86:87]
  v_pk_add_f32 v[104:105], v[104:105], v[88:89]
  v_pk_add_f32 v[106:107], v[106:107], v[90:91]
  v_pk_add_f32 v[108:109], v[108:109], v[92:93]
  v_pk_add_f32 v[110:111], v[110:111], v[94:95]
  v_cvt_pk_bf16_f32 v32, v96, v97
  v_cvt_pk_bf16_f32 v33, v98, v99
  v_cvt_pk_bf16_f32 v34, v100, v101
  v_cvt_pk_bf16_f32 v35, v102, v103
  v_cvt_pk_bf16_f32 v36, v104, v105
  v_cvt_pk_bf16_f32 v37, v106, v107
  v_cvt_pk_bf16_f32 v38, v108, v109
  v_cvt_pk_bf16_f32 v39, v110, v111
  buffer_store_dwordx4 v[32:35], v8, s[84:87], 0 offen sc1
  buffer_store_dwordx4 v[36:39], v7, s[84:87], 0 offen sc1
  s_endpgm
TL_G_24:
  s_mov_b32 s53, 4
  s_call_b64 s[34:35], TL_P1
  s_branch TL_GB_25
TL_G_26:
  s_mov_b32 s53, 8
  s_call_b64 s[34:35], TL_P1
  s_branch TL_GB_27
TL_G_28:
  s_mov_b32 s53, 12
  s_call_b64 s[34:35], TL_P1
  s_branch TL_GB_29
TL_G_30:
  s_mov_b32 s53, 16
  s_call_b64 s[34:35], TL_P1
  s_branch TL_GB_31
TL_G_32:
  s_mov_b32 s53, 20
  s_call_b64 s[34:35], TL_P1
  s_branch TL_GB_33
TL_G_34:
  s_mov_b32 s53, 24
  s_call_b64 s[34:35], TL_P1
  s_branch TL_GB_35
TL_G_36:
  s_mov_b32 s53, 28
  s_call_b64 s[34:35], TL_P1
  s_branch TL_GB_37
TL_G_38:
  s_mov_b32 s53, 32
  s_call_b64 s[34:35], TL_P1
  s_branch TL_GB_39
TL_G_40:
  s_mov_b32 s53, 36
  s_call_b64 s[34:35], TL_P1
  s_branch TL_GB_41
TL_G_42:
  s_mov_b32 s53, 40
  s_call_b64 s[34:35], TL_P1
  s_branch TL_GB_43
TL_G_44:
  s_mov_b32 s53, 44
  s_call_b64 s[34:35], TL_P1
  s_branch TL_GB_45
TL_G_46:
  s_mov_b32 s53, 48
  s_call_b64 s[34:35], TL_P1
  s_branch TL_GB_47
TL_G_48:
  s_mov_b32 s53, 52
  s_call_b64 s[34:35], TL_P1
  s_branch TL_GB_49
TL_G_50:
  s_mov_b32 s53, 56
  s_call_b64 s[34:35], TL_P1
  s_branch TL_GB_51
TL_G_52:
  s_mov_b32 s53, 60
  s_call_b64 s[34:35], TL_P1
  s_branch TL_GB_53
TL_G_54:
  s_mov_b32 s53, 64
  s_call_b64 s[34:35], TL_P1
  s_branch TL_GB_55
TL_G_56:
  s_mov_b32 s53, 1
  s_call_b64 s[34:35], TL_P2
  s_branch TL_GB_57
TL_G_58:
  s_mov_b32 s53, 2
  s_call_b64 s[34:35], TL_P2
  s_branch TL_GB_59
TL_G_60:
  s_mov_b32 s53, 3
  s_call_b64 s[34:35], TL_P2
  s_branch TL_GB_61
TL_G_62:
  s_mov_b32 s53, 4
  s_call_b64 s[34:35], TL_P2
  s_branch TL_GB_63
TL_G_64:
  s_mov_b32 s53, 5
  s_call_b64 s[34:35], TL_P2
  s_branch TL_GB_65
TL_G_66:
  s_mov_b32 s53, 6
  s_call_b64 s[34:35], TL_P2
  s_branch TL_GB_67
TL_G_68:
  s_mov_b32 s53, 7
  s_call_b64 s[34:35], TL_P2
  s_branch TL_GB_69
TL_P1:
  s_mov_b32 s59, 0x40000
  s_waitcnt vmcnt(4)
  v_cmp_eq_u32 vcc, 1, v25
  s_nop 1
  s_ff0_i32_b64 s52, vcc
  s_cmp_ge_u32 s52, s53
  s_cbranch_scc1 TL_P1X
TL_P1L:
  s_lshl_b64 exec, 15, s52
  buffer_load_dword v25, v3, s[12:15], s43 offen sc1
  s_mov_b64 exec, -1
  s_waitcnt vmcnt(0)
  v_cmp_eq_u32 vcc, 1, v25
  s_nop 1
  s_ff0_i32_b64 s52, vcc
  s_cmp_ge_u32 s52, s53
  s_cbranch_scc1 TL_P1R
  s_and_b32 s60, s51, 3
  s_cbranch_scc1 TL_P1S
  s_cmp_eq_u32 s51, 0
  s_cbranch_scc0 TL_P1T
  ds_read_b64_tr_b16 a[128:129], v18 offset:0
  ds_read_b64_tr_b16 a[130:131], v18 offset:512
  ds_read_b64_tr_b16 a[132:133], v19 offset:0
  ds_read_b64_tr_b16 a[134:135], v19 offset:512
  ds_read_b64_tr_b16 a[136:137], v20 offset:0
  ds_read_b64_tr_b16 a[138:139], v20 offset:512
  ds_read_b64_tr_b16 a[140:141], v21 offset:0
  ds_read_b64_tr_b16 a[142:143], v21 offset:512
  ds_read_b64_tr_b16 a[144:145], v18 offset:4096
  ds_read_b64_tr_b16 a[146:147], v18 offset:4608
  ds_read_b64_tr_b16 a[148:149], v19 offset:4096
  ds_read_b64_tr_b16 a[150:151], v19 offset:4608
  ds_read_b64_tr_b16 a[152:153], v20 offset:4096
  ds_read_b64_tr_b16 a[154:155], v20 offset:4608
  ds_read_b64_tr_b16 a[156:157], v21 offset:4096
  ds_read_b64_tr_b16 a[158:159], v21 offset:4608
  ds_read_b64_tr_b16 a[160:161], v18 offset:32768
  ds_read_b64_tr_b16 a[162:163], v18 offset:33280
  ds_read_b64_tr_b16 a[164:165], v19 offset:32768
  ds_read_b64_tr_b16 a[166:167], v19 offset:33280
  ds_read_b64_tr_b16 a[168:169], v20 offset:32768
  ds_read_b64_tr_b16 a[170:171], v20 offset:33280
  ds_read_b64_tr_b16 a[172:173], v21 offset:32768
  ds_read_b64_tr_b16 a[174:175], v21 offset:33280
  ds_read_b64_tr_b16 a[176:177], v18 offset:36864
  ds_read_b64_tr_b16 a[178:179], v18 offset:37376
  ds_read_b64_tr_b16 a[180:181], v19 offset:36864
  ds_read_b64_tr_b16 a[182:183], v19 offset:37376
  ds_read_b64_tr_b16 a[184:185], v20 offset:36864
  ds_read_b64_tr_b16 a[186:187], v20 offset:37376
  ds_read_b64_tr_b16 a[188:189], v21 offset:36864
  ds_read_b64_tr_b16 a[190:191], v21 offset:37376
  ds_read_b64_tr_b16 a[192:193], v241 offset:0
  ds_read_b64_tr_b16 a[194:195], v241 offset:512
  ds_read_b64_tr_b16 a[196:197], v242 offset:0
  ds_read_b64_tr_b16 a[198:199], v242 offset:512
  ds_read_b64_tr_b16 a[200:201], v243 offset:0
  ds_read_b64_tr_b16 a[202:203], v243 offset:512
  ds_read_b64_tr_b16 a[204:205], v244 offset:0
  ds_read_b64_tr_b16 a[206:207], v244 offset:512
  ds_read_b64_tr_b16 a[208:209], v241 offset:4096
  ds_read_b64_tr_b16 a[210:211], v241 offset:4608
  ds_read_b64_tr_b16 a[212:213], v242 offset:4096
  ds_read_b64_tr_b16 a[214:215], v242 offset:4608
  ds_read_b64_tr_b16 a[216:217], v243 offset:4096
  ds_read_b64_tr_b16 a[218:219], v243 offset:4608
  ds_read_b64_tr_b16 a[220:221], v244 offset:4096
  ds_read_b64_tr_b16 a[222:223], v244 offset:4608
  ds_read_b64_tr_b16 a[224:225], v241 offset:32768
  ds_read_b64_tr_b16 a[226:227], v241 offset:33280
  ds_read_b64_tr_b16 a[228:229], v242 offset:32768
  ds_read_b64_tr_b16 a[230:231], v242 offset:33280
  ds_read_b64_tr_b16 a[232:233], v243 offset:32768
  ds_read_b64_tr_b16 a[234:235], v243 offset:33280
  ds_read_b64_tr_b16 a[236:237], v244 offset:32768
  ds_read_b64_tr_b16 a[238:239], v244 offset:33280
  ds_read_b64_tr_b16 a[240:241], v241 offset:36864
  ds_read_b64_tr_b16 a[242:243], v241 offset:37376
  ds_read_b64_tr_b16 a[244:245], v242 offset:36864
  ds_read_b64_tr_b16 a[246:247], v242 offset:37376
  ds_read_b64_tr_b16 a[248:249], v243 offset:36864
  ds_read_b64_tr_b16 a[250:251], v243 offset:37376
  ds_read_b64_tr_b16 a[252:253], v244 offset:36864
  ds_read_b64_tr_b16 a[254:255], v244 offset:37376
  v_lshrrev_b32 v27, 2, v1
  v_bfe_u32 v26, v27, 1, 2
  v_lshlrev_b32 v27, 7, v27
  v_and_b32 v28, 3, v1
  v_lshl_add_u32 v27, v28, 3, v27
  v_lshl_add_u32 v27, v26, 5, v27
  v_add_u32 v18, s41, v27
  v_xor_b32 v19, 32, v18
  v_xor_b32 v20, 64, v18
  v_xor_b32 v21, 96, v18
  v_add_u32 v241, s65, v27
  v_xor_b32 v242, 32, v241
  v_xor_b32 v243, 64, v241
  v_xor_b32 v244, 96, v241
TL_P1T:
  s_waitcnt lgkmcnt(0)
  s_add_u32 m0, s41, 0
  s_nop 0
  buffer_load_dwordx4 v14, s[8:11], s38 offen offset:0 lds
  buffer_load_dwordx4 v15, s[8:11], s38 offen offset:1024 lds
  buffer_load_dwordx4 v16, s[8:11], s38 offen offset:2048 lds
  buffer_load_dwordx4 v17, s[8:11], s38 offen offset:3072 lds
  s_add_u32 s38, s38, 131072
  s_add_u32 m0, s41, 4096
  s_nop 0
  buffer_load_dwordx4 v14, s[8:11], s38 offen offset:0 lds
  buffer_load_dwordx4 v15, s[8:11], s38 offen offset:1024 lds
  buffer_load_dwordx4 v16, s[8:11], s38 offen offset:2048 lds
  buffer_load_dwordx4 v17, s[8:11], s38 offen offset:3072 lds
  s_add_u32 s38, s38, 131072
  s_add_u32 m0, s41, 32768
  s_nop 0
  buffer_load_dwordx4 v14, s[8:11], s38 offen offset:0 lds
  buffer_load_dwordx4 v15, s[8:11], s38 offen offset:1024 lds
  buffer_load_dwordx4 v16, s[8:11], s38 offen offset:2048 lds
  buffer_load_dwordx4 v17, s[8:11], s38 offen offset:3072 lds
  s_add_u32 s38, s38, 131072
  s_add_u32 m0, s41, 36864
  s_nop 0
  buffer_load_dwordx4 v14, s[8:11], s38 offen offset:0 lds
  buffer_load_dwordx4 v15, s[8:11], s38 offen offset:1024 lds
  buffer_load_dwordx4 v16, s[8:11], s38 offen offset:2048 lds
  buffer_load_dwordx4 v17, s[8:11], s38 offen offset:3072 lds
  s_add_u32 s38, s38, 131072
  s_add_u32 m0, s65, 0
  s_nop 0
  buffer_load_dwordx4 v14, s[8:11], s38 offen offset:0 lds
  buffer_load_dwordx4 v15, s[8:11], s38 offen offset:1024 lds
  buffer_load_dwordx4 v16, s[8:11], s38 offen offset:2048 lds
  buffer_load_dwordx4 v17, s[8:11], s38 offen offset:3072 lds
  s_add_u32 s38, s38, 131072
  s_add_u32 m0, s65, 4096
  s_nop 0
  buffer_load_dwordx4 v14, s[8:11], s38 offen offset:0 lds
  buffer_load_dwordx4 v15, s[8:11], s38 offen offset:1024 lds
  buffer_load_dwordx4 v16, s[8:11], s38 offen offset:2048 lds
  buffer_load_dwordx4 v17, s[8:11], s38 offen offset:3072 lds
  s_add_u32 s38, s38, 131072
  s_add_u32 m0, s65, 32768
  s_nop 0
  buffer_load_dwordx4 v14, s[8:11], s38 offen offset:0 lds
  buffer_load_dwordx4 v15, s[8:11], s38 offen offset:1024 lds
  buffer_load_dwordx4 v16, s[8:11], s38 offen offset:2048 lds
  buffer_load_dwordx4 v17, s[8:11], s38 offen offset:3072 lds
  s_add_u32 s38, s38, 131072
  s_mov_b32 s51, 1
TL_P1S:
  s_sleep 1
  s_sub_u32 s59, s59, 1
  s_cbranch_scc0 TL_P1L
TL_P1R:
  s_min_u32 s60, s52, 63
  s_lshl_b64 exec, -1, s60
  buffer_load_dword v25, v3, s[12:15], s43 offen sc1
  s_mov_b64 exec, -1
TL_P1X:
  s_setpc_b64 s[34:35]
TL_P2:
  s_mov_b32 s59, 0x40000
TL_P2L:
  v_min_u32 v25, 768, v0
  buffer_load_dword v25, v25, s[12:15], s43 offen sc1
  s_waitcnt vmcnt(0)
  v_cmp_eq_u32 vcc, 1, v25
  s_nop 1
  s_ff0_i32_b64 s52, vcc
  s_cmp_ge_u32 s52, s53
  s_cbranch_scc1 TL_P2R
  s_sleep 1
  s_sub_u32 s59, s59, 1
  s_cbranch_scc0 TL_P2L
TL_P2R:
  s_setpc_b64 s[34:35]
AT_LQ:
  s_add_u32 s26, s55, 0
  buffer_load_dwordx4 a[96:99], v9, s[12:15], s26 offen offset:0 sc1
  s_waitcnt lgkmcnt(4)
  v_mfma_f32_16x16x32_bf16 v[132:135], a[0:3], v[56:59], v[132:135]
  s_add_u32 s32, s32, 32768
  ds_read_b128 a[48:51], v8 offset:12288
  ds_read_b128 a[52:55], v8 offset:13312
  v_mfma_f32_16x16x32_bf16 v[132:135], a[4:7], v[60:63], v[132:135]
  s_and_b32 s32, s32, 0x1ffff
  ds_read_b128 a[56:59], v8 offset:14336
  v_add_f32 v13, v13, v15
  v_mfma_f32_16x16x32_bf16 v[140:143], a[8:11], v[56:59], v[140:143]
  s_sub_u32 s43, s50, 1
  ds_read_b128 a[60:63], v8 offset:15360
  v_mov_b32 v2, v12
  v_mfma_f32_16x16x32_bf16 v[140:143], a[12:15], v[60:63], v[140:143]
  buffer_load_dwordx4 a[160:163], v9, s[12:15], s26 offen offset:1024 sc1
  v_mfma_f32_16x16x32_bf16 v[148:151], a[16:19], v[56:59], v[148:151]
  s_mov_b32 s46, 1
  ds_read_b128 a[0:3], v8 offset:16384
  ds_read_b128 a[4:7], v8 offset:17408
  v_mfma_f32_16x16x32_bf16 v[148:151], a[20:23], v[60:63], v[148:151]
  s_mov_b32 s45, 0
  ds_read_b128 a[8:11], v8 offset:18432
  v_mov_b32 v3, v13
  v_mfma_f32_16x16x32_bf16 v[156:159], a[24:27], v[56:59], v[156:159]
  s_waitcnt lgkmcnt(7)
  ds_read_b128 a[12:15], v8 offset:19456
  v_cvt_pk_bf16_f32 v16, v128, v129
  v_mfma_f32_16x16x32_bf16 v[156:159], a[28:31], v[60:63], v[156:159]
  buffer_load_dwordx4 a[100:103], v9, s[12:15], s26 offen offset:2048 sc1
  v_mfma_f32_16x16x32_bf16 v[164:167], a[32:35], v[56:59], v[164:167]
  s_mov_b32 s44, 0
  ds_read_b128 a[16:19], v8 offset:20480
  ds_read_b128 a[20:23], v8 offset:21504
  v_mfma_f32_16x16x32_bf16 v[164:167], a[36:39], v[60:63], v[164:167]
  ds_read_b128 a[24:27], v8 offset:22528
  v_permlane16_swap_b32 v12, v2
  v_mfma_f32_16x16x32_bf16 v[172:175], a[40:43], v[56:59], v[172:175]
  s_waitcnt lgkmcnt(7)
  ds_read_b128 a[28:31], v8 offset:23552
  v_permlane16_swap_b32 v13, v3
  v_mfma_f32_16x16x32_bf16 v[172:175], a[44:47], v[60:63], v[172:175]
  buffer_load_dwordx4 a[164:167], v9, s[12:15], s26 offen offset:3072 sc1
  s_add_u32 s26, s26, 4096
  v_mfma_f32_16x16x32_bf16 v[180:183], a[48:51], v[56:59], v[180:183]
  s_nop 0
  ds_read_b128 a[32:35], v8 offset:24576
  ds_read_b128 a[36:39], v8 offset:25600
  v_mfma_f32_16x16x32_bf16 v[180:183], a[52:55], v[60:63], v[180:183]
  ds_read_b128 a[40:43], v8 offset:26624
  v_add_f32 v12, v12, v2
  v_mfma_f32_16x16x32_bf16 v[188:191], a[56:59], v[56:59], v[188:191]
  s_waitcnt lgkmcnt(7)
  ds_read_b128 a[44:47], v8 offset:27648
  v_add_f32 v13, v13, v3
  v_mfma_f32_16x16x32_bf16 v[188:191], a[60:63], v[60:63], v[188:191]
  buffer_load_dwordx4 a[104:107], v9, s[12:15], s26 offen offset:0 sc1
  v_mfma_f32_16x16x32_bf16 v[196:199], a[0:3], v[56:59], v[196:199]
  s_nop 0
  ds_read_b128 a[48:51], v8 offset:28672
  ds_read_b128 a[52:55], v8 offset:29696
  v_mfma_f32_16x16x32_bf16 v[196:199], a[4:7], v[60:63], v[196:199]
  ds_read_b128 a[56:59], v8 offset:30720
  v_mov_b32 v2, v12
  v_mfma_f32_16x16x32_bf16 v[204:207], a[8:11], v[56:59], v[204:207]
  s_waitcnt lgkmcnt(7)
  ds_read_b128 a[60:63], v8 offset:31744
  v_mov_b32 v3, v13
  v_mfma_f32_16x16x32_bf16 v[204:207], a[12:15], v[60:63], v[204:207]
  buffer_load_dwordx4 a[168:171], v9, s[12:15], s26 offen offset:1024 sc1
  v_mfma_f32_16x16x32_bf16 v[212:215], a[16:19], v[56:59], v[212:215]
  v_permlane32_swap_b32 v12, v2
  v_permlane32_swap_b32 v13, v3
  v_mfma_f32_16x16x32_bf16 v[212:215], a[20:23], v[60:63], v[212:215]
  v_add_f32 v12, v12, v2
  v_add_f32 v13, v13, v3
  v_mfma_f32_16x16x32_bf16 v[220:223], a[24:27], v[56:59], v[220:223]
  s_waitcnt lgkmcnt(4)
  v_accvgpr_write_b32 a72, v12
  v_accvgpr_write_b32 a73, v13
  v_mfma_f32_16x16x32_bf16 v[220:223], a[28:31], v[60:63], v[220:223]
  buffer_load_dwordx4 a[108:111], v9, s[12:15], s26 offen offset:2048 sc1
  v_mfma_f32_16x16x32_bf16 v[228:231], a[32:35], v[56:59], v[228:231]
  v_mov_b32 v12, 0
  v_mov_b32 v13, 0
  v_mfma_f32_16x16x32_bf16 v[228:231], a[36:39], v[60:63], v[228:231]
  v_add_u32 v8, s32, v9
  v_cvt_pk_bf16_f32 v17, v130, v131
  v_mfma_f32_16x16x32_bf16 v[236:239], a[40:43], v[56:59], v[236:239]
  s_waitcnt lgkmcnt(0)
  v_cvt_pk_bf16_f32 v18, v136, v137
  v_cvt_pk_bf16_f32 v19, v138, v139
  v_mfma_f32_16x16x32_bf16 v[236:239], a[44:47], v[60:63], v[236:239]
  buffer_load_dwordx4 a[172:175], v9, s[12:15], s26 offen offset:3072 sc1
  s_add_u32 s26, s26, 4096
  v_mfma_f32_16x16x32_bf16 v[244:247], a[48:51], v[56:59], v[244:247]
  v_accvgpr_write_b32 a192, v16
  v_accvgpr_write_b32 a193, v17
  v_mfma_f32_16x16x32_bf16 v[244:247], a[52:55], v[60:63], v[244:247]
  v_accvgpr_write_b32 a194, v18
  v_accvgpr_write_b32 a195, v19
  v_mfma_f32_16x16x32_bf16 v[252:255], a[56:59], v[56:59], v[252:255]
  v_cvt_pk_bf16_f32 v20, v144, v145
  v_cvt_pk_bf16_f32 v21, v146, v147
  v_mfma_f32_16x16x32_bf16 v[252:255], a[60:63], v[60:63], v[252:255]
  buffer_load_dwordx4 a[112:115], v9, s[12:15], s26 offen offset:0 sc1
  v_cvt_pk_bf16_f32 v22, v152, v153
  v_cvt_pk_bf16_f32 v23, v154, v155
  v_accvgpr_write_b32 a196, v20
  v_accvgpr_write_b32 a197, v21
  v_accvgpr_write_b32 a198, v22
  v_accvgpr_write_b32 a199, v23
  v_cvt_pk_bf16_f32 v16, v160, v161
  buffer_load_dwordx4 a[176:179], v9, s[12:15], s26 offen offset:1024 sc1
  v_cvt_pk_bf16_f32 v17, v162, v163
  v_cvt_pk_bf16_f32 v18, v168, v169
  v_cvt_pk_bf16_f32 v19, v170, v171
  v_accvgpr_write_b32 a200, v16
  v_accvgpr_write_b32 a201, v17
  v_accvgpr_write_b32 a202, v18
  v_accvgpr_write_b32 a203, v19
  buffer_load_dwordx4 a[116:119], v9, s[12:15], s26 offen offset:2048 sc1
  v_cvt_pk_bf16_f32 v20, v176, v177
  v_cvt_pk_bf16_f32 v21, v178, v179
  v_cvt_pk_bf16_f32 v22, v184, v185
  v_cvt_pk_bf16_f32 v23, v186, v187
  v_accvgpr_write_b32 a204, v20
  v_accvgpr_write_b32 a205, v21
  v_accvgpr_write_b32 a206, v22
  buffer_load_dwordx4 a[180:183], v9, s[12:15], s26 offen offset:3072 sc1
  s_add_u32 s26, s26, 4096
  v_accvgpr_write_b32 a207, v23
  v_cvt_pk_bf16_f32 v16, v192, v193
  v_cvt_pk_bf16_f32 v17, v194, v195
  v_cvt_pk_bf16_f32 v18, v200, v201
  v_cvt_pk_bf16_f32 v19, v202, v203
  v_accvgpr_write_b32 a208, v16
  v_accvgpr_write_b32 a209, v17
  buffer_load_dwordx4 a[120:123], v9, s[12:15], s26 offen offset:0 sc1
  v_accvgpr_write_b32 a210, v18
  v_accvgpr_write_b32 a211, v19
  v_cvt_pk_bf16_f32 v20, v208, v209
  v_cvt_pk_bf16_f32 v21, v210, v211
  v_cvt_pk_bf16_f32 v22, v216, v217
  v_cvt_pk_bf16_f32 v23, v218, v219
  v_accvgpr_write_b32 a212, v20
  buffer_load_dwordx4 a[184:187], v9, s[12:15], s26 offen offset:1024 sc1
  v_accvgpr_write_b32 a213, v21
  v_accvgpr_write_b32 a214, v22
  v_accvgpr_write_b32 a215, v23
  v_cvt_pk_bf16_f32 v16, v224, v225
  v_cvt_pk_bf16_f32 v17, v226, v227
  v_cvt_pk_bf16_f32 v18, v232, v233
  v_cvt_pk_bf16_f32 v19, v234, v235
  buffer_load_dwordx4 a[124:127], v9, s[12:15], s26 offen offset:2048 sc1
  v_accvgpr_write_b32 a216, v16
  v_accvgpr_write_b32 a217, v17
  v_accvgpr_write_b32 a218, v18
  v_accvgpr_write_b32 a219, v19
  v_cvt_pk_bf16_f32 v20, v240, v241
  v_cvt_pk_bf16_f32 v21, v242, v243
  v_cvt_pk_bf16_f32 v22, v248, v249
  buffer_load_dwordx4 a[188:191], v9, s[12:15], s26 offen offset:3072 sc1
  s_add_u32 s26, s26, 4096
  v_cvt_pk_bf16_f32 v23, v250, v251
  v_accvgpr_write_b32 a220, v20
  v_accvgpr_write_b32 a221, v21
  v_accvgpr_write_b32 a222, v22
  v_accvgpr_write_b32 a223, v23
  v_cvt_pk_bf16_f32 v16, v132, v133
  v_cvt_pk_bf16_f32 v17, v134, v135
  buffer_load_dwordx4 v[28:31], v9, s[12:15], s26 offen offset:0 sc1
  v_cvt_pk_bf16_f32 v18, v140, v141
  v_cvt_pk_bf16_f32 v19, v142, v143
  v_accvgpr_write_b32 a224, v16
  v_accvgpr_write_b32 a225, v17
  v_accvgpr_write_b32 a226, v18
  v_accvgpr_write_b32 a227, v19
  v_cvt_pk_bf16_f32 v20, v148, v149
  s_mov_b32 m0, s31
  s_nop 0
  buffer_load_dwordx4 v4, s[68:71], s24 offen lds
  s_add_u32 m0, m0, 4096
  s_add_u32 s24, s24, s30
  v_cvt_pk_bf16_f32 v21, v150, v151
  v_cvt_pk_bf16_f32 v22, v156, v157
  v_cvt_pk_bf16_f32 v23, v158, v159
  v_accvgpr_write_b32 a228, v20
  v_accvgpr_write_b32 a229, v21
  v_accvgpr_write_b32 a230, v22
  v_accvgpr_write_b32 a231, v23
  buffer_load_dwordx4 v4, s[68:71], s24 offen lds
  s_add_u32 m0, m0, 4096
  s_add_u32 s24, s24, s30
  v_cvt_pk_bf16_f32 v16, v164, v165
  v_cvt_pk_bf16_f32 v17, v166, v167
  v_cvt_pk_bf16_f32 v18, v172, v173
  v_cvt_pk_bf16_f32 v19, v174, v175
  v_accvgpr_write_b32 a232, v16
  v_accvgpr_write_b32 a233, v17
  v_accvgpr_write_b32 a234, v18
  buffer_load_dwordx4 v4, s[68:71], s24 offen lds
  s_add_u32 m0, m0, 4096
  s_add_u32 s24, s24, s30
  v_accvgpr_write_b32 a235, v19
  v_cvt_pk_bf16_f32 v20, v180, v181
  v_cvt_pk_bf16_f32 v21, v182, v183
  v_cvt_pk_bf16_f32 v22, v188, v189
  v_cvt_pk_bf16_f32 v23, v190, v191
  v_accvgpr_write_b32 a236, v20
  v_accvgpr_write_b32 a237, v21
  buffer_load_dwordx4 v4, s[68:71], s24 offen lds
  s_add_u32 m0, m0, 4096
  s_add_u32 s24, s24, s30
  v_accvgpr_write_b32 a238, v22
  v_accvgpr_write_b32 a239, v23
  v_cvt_pk_bf16_f32 v16, v196, v197
  v_cvt_pk_bf16_f32 v17, v198, v199
  v_cvt_pk_bf16_f32 v18, v204, v205
  v_cvt_pk_bf16_f32 v19, v206, v207
  v_accvgpr_write_b32 a240, v16
  buffer_load_dwordx4 v4, s[68:71], s24 offen lds
  s_add_u32 m0, m0, 4096
  s_add_u32 s24, s24, s30
  v_accvgpr_write_b32 a241, v17
  v_accvgpr_write_b32 a242, v18
  v_accvgpr_write_b32 a243, v19
  v_cvt_pk_bf16_f32 v20, v212, v213
  v_cvt_pk_bf16_f32 v21, v214, v215
  v_cvt_pk_bf16_f32 v22, v220, v221
  v_cvt_pk_bf16_f32 v23, v222, v223
  buffer_load_dwordx4 v4, s[68:71], s24 offen lds
  s_add_u32 m0, m0, 4096
  s_add_u32 s24, s24, s30
  v_accvgpr_write_b32 a244, v20
  v_accvgpr_write_b32 a245, v21
  v_accvgpr_write_b32 a246, v22
  v_accvgpr_write_b32 a247, v23
  v_cvt_pk_bf16_f32 v16, v228, v229
  v_cvt_pk_bf16_f32 v17, v230, v231
  v_cvt_pk_bf16_f32 v18, v236, v237
  buffer_load_dwordx4 v4, s[68:71], s24 offen lds
  s_add_u32 m0, m0, 4096
  s_add_u32 s24, s24, s30
  v_cvt_pk_bf16_f32 v19, v238, v239
  v_accvgpr_write_b32 a64, v16
  v_accvgpr_write_b32 a65, v17
  v_accvgpr_write_b32 a66, v18
  v_accvgpr_write_b32 a67, v19
  v_cvt_pk_bf16_f32 v20, v244, v245
  v_cvt_pk_bf16_f32 v21, v246, v247
  buffer_load_dwordx4 v4, s[68:71], s24 offen lds
  s_add_u32 s31, s31, 32768
  s_and_b32 s31, s31, 0x1ffff
  s_add_u32 s25, s25, 1
  s_cmp_eq_u32 s25, s28
  s_cbranch_scc1 AT_NS_70
AT_NB_71:
  v_readlane_b32 s24, v5, s25
  s_nop 3
  v_cvt_pk_bf16_f32 v22, v252, v253
  v_cvt_pk_bf16_f32 v23, v254, v255
  v_accvgpr_write_b32 a68, v20
  v_accvgpr_write_b32 a69, v21
  v_accvgpr_write_b32 a70, v22
  v_accvgpr_write_b32 a71, v23
  s_waitcnt vmcnt(8)
  s_barrier
  v_mov_b64 v[10:11], v[28:29]
  ds_read_b128 a[0:3], v8 offset:0
  v_mov_b32 v96, v10
  ds_read_b128 a[4:7], v8 offset:1024
  v_mov_b32 v97, v10
  ds_read_b128 a[8:11], v8 offset:2048
  v_mov_b64 v[98:99], v[96:97]
  ds_read_b128 a[12:15], v8 offset:3072
  v_mov_b64 v[104:105], v[96:97]
  ds_read_b128 a[16:19], v8 offset:4096
  v_mov_b64 v[106:107], v[96:97]
  ds_read_b128 a[20:23], v8 offset:5120
  v_mov_b64 v[112:113], v[96:97]
  ds_read_b128 a[24:27], v8 offset:6144
  v_mov_b64 v[114:115], v[96:97]
  ds_read_b128 a[28:31], v8 offset:7168
  v_mov_b64 v[120:121], v[96:97]
  ds_read_b128 a[32:35], v8 offset:8192
  v_mov_b64 v[122:123], v[96:97]
  ds_read_b128 a[36:39], v8 offset:9216
  v_mov_b32 v100, v11
  ds_read_b128 a[40:43], v8 offset:10240
  v_mov_b32 v101, v11
  ds_read_b128 a[44:47], v8 offset:11264
  v_mov_b64 v[102:103], v[100:101]
  v_mov_b64 v[108:109], v[100:101]
  v_mov_b64 v[110:111], v[100:101]
  v_mov_b64 v[116:117], v[100:101]
  v_mov_b64 v[118:119], v[100:101]
  v_mov_b64 v[124:125], v[100:101]
  v_mov_b64 v[126:127], v[100:101]
  s_waitcnt lgkmcnt(4)
  v_mfma_f32_16x16x32_bf16 v[64:67], a[0:3], a[96:99], v[96:99]
  s_add_u32 s32, s32, 32768
  ds_read_b128 a[48:51], v8 offset:12288
  v_mfma_f32_16x16x32_bf16 v[64:67], a[4:7], a[100:103], v[64:67]
  s_and_b32 s32, s32, 0x1ffff
  v_mfma_f32_16x16x32_bf16 v[64:67], a[8:11], a[104:107], v[64:67]
  s_mov_b32 m0, s31
  ds_read_b128 a[52:55], v8 offset:13312
  v_mfma_f32_16x16x32_bf16 v[64:67], a[12:15], a[108:111], v[64:67]
  buffer_load_dwordx4 v4, s[68:71], s24 offen lds
  v_mfma_f32_16x16x32_bf16 v[64:67], a[16:19], a[112:115], v[64:67]
  s_add_u32 m0, m0, 4096
  ds_read_b128 a[56:59], v8 offset:14336
  v_mfma_f32_16x16x32_bf16 v[64:67], a[20:23], a[116:119], v[64:67]
  s_add_u32 s24, s24, s30
  v_mfma_f32_16x16x32_bf16 v[64:67], a[24:27], a[120:123], v[64:67]
  ds_read_b128 a[60:63], v8 offset:15360
  v_mfma_f32_16x16x32_bf16 v[64:67], a[28:31], a[124:127], v[64:67]
  buffer_load_dwordx4 v4, s[68:71], s24 offen lds
  v_mfma_f32_16x16x32_bf16 v[68:71], a[0:3], a[160:163], v[100:103]
  s_add_u32 m0, m0, 4096
  ds_read_b128 a[0:3], v8 offset:16384
  v_mfma_f32_16x16x32_bf16 v[68:71], a[4:7], a[164:167], v[68:71]
  s_add_u32 s24, s24, s30
  v_mfma_f32_16x16x32_bf16 v[68:71], a[8:11], a[168:171], v[68:71]
  ds_read_b128 a[4:7], v8 offset:17408
  v_mfma_f32_16x16x32_bf16 v[68:71], a[12:15], a[172:175], v[68:71]
  v_mfma_f32_16x16x32_bf16 v[68:71], a[16:19], a[176:179], v[68:71]
  ds_read_b128 a[8:11], v8 offset:18432
  v_mfma_f32_16x16x32_bf16 v[68:71], a[20:23], a[180:183], v[68:71]
  buffer_load_dwordx4 v4, s[68:71], s24 offen lds
  v_mfma_f32_16x16x32_bf16 v[68:71], a[24:27], a[184:187], v[68:71]
  s_add_u32 m0, m0, 4096
  ds_read_b128 a[12:15], v8 offset:19456
  v_mfma_f32_16x16x32_bf16 v[68:71], a[28:31], a[188:191], v[68:71]
  s_waitcnt lgkmcnt(3)
  s_add_u32 s24, s24, s30
  v_mfma_f32_16x16x32_bf16 v[72:75], a[32:35], a[96:99], v[104:107]
  ds_read_b128 a[16:19], v8 offset:20480
  v_mfma_f32_16x16x32_bf16 v[72:75], a[36:39], a[100:103], v[72:75]
  buffer_load_dwordx4 v4, s[68:71], s24 offen lds
  v_mfma_f32_16x16x32_bf16 v[72:75], a[40:43], a[104:107], v[72:75]
  s_add_u32 m0, m0, 4096
  ds_read_b128 a[20:23], v8 offset:21504
  v_mfma_f32_16x16x32_bf16 v[72:75], a[44:47], a[108:111], v[72:75]
  s_add_u32 s24, s24, s30
  v_exp_f32 v16, v64
  v_mfma_f32_16x16x32_bf16 v[72:75], a[48:51], a[112:115], v[72:75]
  ds_read_b128 a[24:27], v8 offset:22528
  v_mfma_f32_16x16x32_bf16 v[72:75], a[52:55], a[116:119], v[72:75]
  v_exp_f32 v17, v65
  v_mfma_f32_16x16x32_bf16 v[72:75], a[56:59], a[120:123], v[72:75]
  ds_read_b128 a[28:31], v8 offset:23552
  v_add_f32 v14, v16, v17
  v_mfma_f32_16x16x32_bf16 v[72:75], a[60:63], a[124:127], v[72:75]
  buffer_load_dwordx4 v4, s[68:71], s24 offen lds
  v_mfma_f32_16x16x32_bf16 v[76:79], a[32:35], a[160:163], v[108:111]
  s_add_u32 m0, m0, 4096
  ds_read_b128 a[32:35], v8 offset:24576
  v_cvt_pk_bf16_f32 v32, v16, v17
  v_mfma_f32_16x16x32_bf16 v[76:79], a[36:39], a[164:167], v[76:79]
  s_add_u32 s24, s24, s30
  v_exp_f32 v18, v66
  v_mfma_f32_16x16x32_bf16 v[76:79], a[40:43], a[168:171], v[76:79]
  ds_read_b128 a[36:39], v8 offset:25600
  v_add_f32 v14, v14, v18
  v_mfma_f32_16x16x32_bf16 v[76:79], a[44:47], a[172:175], v[76:79]
  buffer_load_dwordx4 v4, s[68:71], s24 offen lds
  v_mfma_f32_16x16x32_bf16 v[76:79], a[48:51], a[176:179], v[76:79]
  s_add_u32 m0, m0, 4096
  ds_read_b128 a[40:43], v8 offset:26624
  v_mfma_f32_16x16x32_bf16 v[76:79], a[52:55], a[180:183], v[76:79]
  s_add_u32 s24, s24, s30
  v_exp_f32 v19, v67
  v_mfma_f32_16x16x32_bf16 v[76:79], a[56:59], a[184:187], v[76:79]
  ds_read_b128 a[44:47], v8 offset:27648
  v_add_f32 v14, v14, v19
  v_mfma_f32_16x16x32_bf16 v[76:79], a[60:63], a[188:191], v[76:79]
  v_exp_f32 v20, v68
  v_mfma_f32_16x16x32_bf16 v[80:83], a[0:3], a[96:99], v[112:115]
  s_waitcnt lgkmcnt(3)
  ds_read_b128 a[48:51], v8 offset:28672
  v_cvt_pk_bf16_f32 v33, v18, v19
  v_mfma_f32_16x16x32_bf16 v[80:83], a[4:7], a[100:103], v[80:83]
  buffer_load_dwordx4 v4, s[68:71], s24 offen lds
  v_mfma_f32_16x16x32_bf16 v[80:83], a[8:11], a[104:107], v[80:83]
  s_add_u32 m0, m0, 4096
  ds_read_b128 a[52:55], v8 offset:29696
  v_mfma_f32_16x16x32_bf16 v[80:83], a[12:15], a[108:111], v[80:83]
  s_add_u32 s24, s24, s30
  v_exp_f32 v21, v69
  v_mfma_f32_16x16x32_bf16 v[80:83], a[16:19], a[112:115], v[80:83]
  ds_read_b128 a[56:59], v8 offset:30720
  v_add_f32 v15, v20, v21
  v_mfma_f32_16x16x32_bf16 v[80:83], a[20:23], a[116:119], v[80:83]
  buffer_load_dwordx4 v4, s[68:71], s24 offen lds
  v_mfma_f32_16x16x32_bf16 v[80:83], a[24:27], a[120:123], v[80:83]
  s_add_u32 s31, s31, 32768
  ds_read_b128 a[60:63], v8 offset:31744
  v_add_u32 v8, s32, v9
  v_mfma_f32_16x16x32_bf16 v[80:83], a[28:31], a[124:127], v[80:83]
  s_and_b32 s31, s31, 0x1ffff
  v_exp_f32 v22, v70
  v_mfma_f32_16x16x32_bf16 v[84:87], a[0:3], a[160:163], v[116:119]
  s_waitcnt vmcnt(16)
  v_mfma_f32_16x16x32_bf16 v[84:87], a[4:7], a[164:167], v[84:87]
  s_barrier
  v_mfma_f32_16x16x32_bf16 v[84:87], a[8:11], a[168:171], v[84:87]
  s_add_u32 s25, s25, 1
  ds_read_b128 a[0:3], v8 offset:0
  v_cvt_pk_bf16_f32 v40, v20, v21
  v_mfma_f32_16x16x32_bf16 v[84:87], a[12:15], a[172:175], v[84:87]
  s_cmp_eq_u32 s25, s28
  v_exp_f32 v23, v71
  v_mfma_f32_16x16x32_bf16 v[84:87], a[16:19], a[176:179], v[84:87]
  s_cbranch_scc1 AT_NS_72
AT_NB_73:
  ds_read_b128 a[4:7], v8 offset:1024
  v_readlane_b32 s24, v5, s25
  v_mfma_f32_16x16x32_bf16 v[84:87], a[20:23], a[180:183], v[84:87]
  v_exp_f32 v28, v72
  v_mfma_f32_16x16x32_bf16 v[84:87], a[24:27], a[184:187], v[84:87]
  ds_read_b128 a[8:11], v8 offset:2048
  v_add_f32 v15, v15, v22
  v_mfma_f32_16x16x32_bf16 v[84:87], a[28:31], a[188:191], v[84:87]
  v_exp_f32 v29, v73
  v_mfma_f32_16x16x32_bf16 v[88:91], a[32:35], a[96:99], v[120:123]
  s_waitcnt lgkmcnt(3)
  ds_read_b128 a[12:15], v8 offset:3072
  v_add_f32 v15, v15, v23
  v_mfma_f32_16x16x32_bf16 v[88:91], a[36:39], a[100:103], v[88:91]
  v_exp_f32 v30, v74
  v_mfma_f32_16x16x32_bf16 v[88:91], a[40:43], a[104:107], v[88:91]
  ds_read_b128 a[16:19], v8 offset:4096
  v_cvt_pk_bf16_f32 v41, v22, v23
  v_mfma_f32_16x16x32_bf16 v[88:91], a[44:47], a[108:111], v[88:91]
  v_exp_f32 v31, v75
  v_mfma_f32_16x16x32_bf16 v[88:91], a[48:51], a[112:115], v[88:91]
  ds_read_b128 a[20:23], v8 offset:5120
  v_add_f32 v14, v14, v28
  v_mfma_f32_16x16x32_bf16 v[88:91], a[52:55], a[116:119], v[88:91]
  v_exp_f32 v16, v76
  v_mfma_f32_16x16x32_bf16 v[88:91], a[56:59], a[120:123], v[88:91]
  ds_read_b128 a[24:27], v8 offset:6144
  v_add_f32 v14, v14, v29
  v_mfma_f32_16x16x32_bf16 v[88:91], a[60:63], a[124:127], v[88:91]
  v_exp_f32 v17, v77
  v_mfma_f32_16x16x32_bf16 v[92:95], a[32:35], a[160:163], v[124:127]
  ds_read_b128 a[28:31], v8 offset:7168
  v_cvt_pk_bf16_f32 v34, v28, v29
  v_mfma_f32_16x16x32_bf16 v[92:95], a[36:39], a[164:167], v[92:95]
  v_exp_f32 v18, v78
  v_mfma_f32_16x16x32_bf16 v[92:95], a[40:43], a[168:171], v[92:95]
  ds_read_b128 a[32:35], v8 offset:8192
  v_add_f32 v14, v14, v30
  v_mfma_f32_16x16x32_bf16 v[92:95], a[44:47], a[172:175], v[92:95]
  v_exp_f32 v19, v79
  v_mfma_f32_16x16x32_bf16 v[92:95], a[48:51], a[176:179], v[92:95]
  ds_read_b128 a[36:39], v8 offset:9216
  v_add_f32 v14, v14, v31
  v_mfma_f32_16x16x32_bf16 v[92:95], a[52:55], a[180:183], v[92:95]
  buffer_load_dword v25, off, s[12:15], s51 sc1
  v_mfma_f32_16x16x32_bf16 v[92:95], a[56:59], a[184:187], v[92:95]
  ds_read_b128 a[40:43], v8 offset:10240
  v_cvt_pk_bf16_f32 v35, v30, v31
  v_mfma_f32_16x16x32_bf16 v[92:95], a[60:63], a[188:191], v[92:95]
  ds_read_b128 a[44:47], v8 offset:11264
  v_add_f32 v15, v15, v16
  v_exp_f32 v20, v80
  v_exp_f32 v21, v81
  v_exp_f32 v22, v82
  v_exp_f32 v23, v83
  v_exp_f32 v28, v84
  v_exp_f32 v29, v85
  v_exp_f32 v30, v86
  v_exp_f32 v31, v87
  v_add_f32 v15, v15, v17
  v_cvt_pk_bf16_f32 v42, v16, v17
  v_exp_f32 v16, v88
  v_exp_f32 v17, v89
  v_add_f32 v15, v15, v18
  v_add_f32 v15, v15, v19
  v_cvt_pk_bf16_f32 v43, v18, v19
  v_exp_f32 v18, v90
  v_exp_f32 v19, v91
  v_add_f32 v14, v14, v20
  v_add_f32 v14, v14, v21
  v_cvt_pk_bf16_f32 v36, v20, v21
  v_exp_f32 v20, v92
  v_exp_f32 v21, v93
  v_add_f32 v14, v14, v22
  v_add_f32 v14, v14, v23
  v_cvt_pk_bf16_f32 v37, v22, v23
  v_exp_f32 v22, v94
  v_exp_f32 v23, v95
  v_add_f32 v15, v15, v28
  v_add_f32 v15, v15, v29
  v_cvt_pk_bf16_f32 v44, v28, v29
  v_add_f32 v15, v15, v30
  v_add_f32 v15, v15, v31
  v_cvt_pk_bf16_f32 v45, v30, v31
  v_add_f32 v14, v14, v16
  v_add_f32 v14, v14, v17
  v_cvt_pk_bf16_f32 v38, v16, v17
  v_add_f32 v14, v14, v18
  v_add_f32 v14, v14, v19
  v_cvt_pk_bf16_f32 v39, v18, v19
  v_add_f32 v15, v15, v20
  v_add_f32 v15, v15, v21
  v_cvt_pk_bf16_f32 v46, v20, v21
  v_add_f32 v15, v15, v22
  v_add_f32 v15, v15, v23
  v_cvt_pk_bf16_f32 v47, v22, v23
  v_max_f32 v26, v14, v15
  v_cmp_nge_f32 vcc, 0x53800000, v26
  s_cbranch_vccnz AT_HZ
  s_branch AT_BODYZ
AT_LB:
  s_waitcnt lgkmcnt(4)
  v_mfma_f32_16x16x32_bf16 v[128:131], a[0:3], v[32:35], v[128:131]
  s_add_u32 s32, s32, 32768
  ds_read_b128 a[48:51], v8 offset:12288
  v_add_f32 v12, v12, v14
  v_mfma_f32_16x16x32_bf16 v[128:131], a[4:7], v[36:39], v[128:131]
  s_and_b32 s32, s32, 0x1ffff
  v_add_f32 v13, v13, v15
  v_mov_b32 v2, v12
  v_mfma_f32_16x16x32_bf16 v[132:135], a[4:7], v[44:47], v[132:135]
  s_add_u32 s26, s55, 35651584
  ds_read_b128 a[52:55], v8 offset:13312
  v_mov_b32 v3, v13
  v_mfma_f32_16x16x32_bf16 v[132:135], a[0:3], v[40:43], v[132:135]
  s_lshl_b32 s57, s40, 3
  v_mfma_f32_16x16x32_bf16 v[136:139], a[8:11], v[32:35], v[136:139]
  s_add_u32 s57, s57, s20
  ds_read_b128 a[56:59], v8 offset:14336
  v_permlane16_swap_b32 v12, v2
  v_mfma_f32_16x16x32_bf16 v[136:139], a[12:15], v[36:39], v[136:139]
  s_lshl_b32 s57, s57, 4
  v_permlane16_swap_b32 v13, v3
  v_mfma_f32_16x16x32_bf16 v[140:143], a[12:15], v[44:47], v[140:143]
  s_add_u32 s57, s57, s21
  ds_read_b128 a[60:63], v8 offset:15360
  v_add_f32 v12, v12, v2
  v_mfma_f32_16x16x32_bf16 v[140:143], a[8:11], v[40:43], v[140:143]
  s_mul_i32 s57, s57, 14336
  v_add_f32 v13, v13, v3
  v_mov_b32 v2, v12
  v_mfma_f32_16x16x32_bf16 v[144:147], a[16:19], v[32:35], v[144:147]
  s_add_u32 s57, s57, 45088768
  ds_read_b128 a[0:3], v8 offset:16384
  v_mov_b32 v3, v13
  v_mfma_f32_16x16x32_bf16 v[144:147], a[20:23], v[36:39], v[144:147]
  s_add_u32 s58, s57, 917504
  v_mfma_f32_16x16x32_bf16 v[148:151], a[20:23], v[44:47], v[148:151]
  ds_read_b128 a[4:7], v8 offset:17408
  v_permlane32_swap_b32 v12, v2
  v_mfma_f32_16x16x32_bf16 v[148:151], a[16:19], v[40:43], v[148:151]
  v_permlane32_swap_b32 v13, v3
  v_mfma_f32_16x16x32_bf16 v[152:155], a[24:27], v[32:35], v[152:155]
  ds_read_b128 a[8:11], v8 offset:18432
  v_add_f32 v12, v12, v2
  v_mfma_f32_16x16x32_bf16 v[152:155], a[28:31], v[36:39], v[152:155]
  v_add_f32 v13, v13, v3
  v_mfma_f32_16x16x32_bf16 v[156:159], a[28:31], v[44:47], v[156:159]
  ds_read_b128 a[12:15], v8 offset:19456
  v_mfma_f32_16x16x32_bf16 v[156:159], a[24:27], v[40:43], v[156:159]
  s_waitcnt lgkmcnt(3)
  v_cvt_pk_bf16_f32 v48, v128, v129
  v_cvt_pk_bf16_f32 v49, v130, v131
  v_mfma_f32_16x16x32_bf16 v[160:163], a[32:35], v[32:35], v[160:163]
  ds_read_b128 a[16:19], v8 offset:20480
  v_cvt_pk_bf16_f32 v50, v136, v137
  v_mfma_f32_16x16x32_bf16 v[160:163], a[36:39], v[36:39], v[160:163]
  v_cvt_pk_bf16_f32 v51, v138, v139
  v_cvt_pk_bf16_f32 v52, v132, v133
  v_mfma_f32_16x16x32_bf16 v[164:167], a[36:39], v[44:47], v[164:167]
  ds_read_b128 a[20:23], v8 offset:21504
  v_cvt_pk_bf16_f32 v53, v134, v135
  v_mfma_f32_16x16x32_bf16 v[164:167], a[32:35], v[40:43], v[164:167]
  buffer_store_dwordx4 v[48:51], v9, s[12:15], s26 offen offset:0 sc1
  v_cvt_pk_bf16_f32 v54, v140, v141
  v_cvt_pk_bf16_f32 v55, v142, v143
  v_mfma_f32_16x16x32_bf16 v[168:171], a[40:43], v[32:35], v[168:171]
  ds_read_b128 a[24:27], v8 offset:22528
  v_mfma_f32_16x16x32_bf16 v[168:171], a[44:47], v[36:39], v[168:171]
  buffer_store_dwordx4 v[52:55], v9, s[12:15], s26 offen offset:1024 sc1
  v_mfma_f32_16x16x32_bf16 v[172:175], a[44:47], v[44:47], v[172:175]
  ds_read_b128 a[28:31], v8 offset:23552
  v_mfma_f32_16x16x32_bf16 v[172:175], a[40:43], v[40:43], v[172:175]
  v_cvt_pk_bf16_f32 v56, v144, v145
  v_cvt_pk_bf16_f32 v57, v146, v147
  v_mfma_f32_16x16x32_bf16 v[176:179], a[48:51], v[32:35], v[176:179]
  ds_read_b128 a[32:35], v8 offset:24576
  v_cvt_pk_bf16_f32 v58, v152, v153
  v_mfma_f32_16x16x32_bf16 v[176:179], a[52:55], v[36:39], v[176:179]
  v_cvt_pk_bf16_f32 v59, v154, v155
  v_cvt_pk_bf16_f32 v60, v148, v149
  v_mfma_f32_16x16x32_bf16 v[180:183], a[52:55], v[44:47], v[180:183]
  ds_read_b128 a[36:39], v8 offset:25600
  v_cvt_pk_bf16_f32 v61, v150, v151
  v_mfma_f32_16x16x32_bf16 v[180:183], a[48:51], v[40:43], v[180:183]
  buffer_store_dwordx4 v[56:59], v9, s[12:15], s26 offen offset:2048 sc1
  v_cvt_pk_bf16_f32 v62, v156, v157
  v_cvt_pk_bf16_f32 v63, v158, v159
  v_mfma_f32_16x16x32_bf16 v[184:187], a[56:59], v[32:35], v[184:187]
  ds_read_b128 a[40:43], v8 offset:26624
  v_mfma_f32_16x16x32_bf16 v[184:187], a[60:63], v[36:39], v[184:187]
  buffer_store_dwordx4 v[60:63], v9, s[12:15], s26 offen offset:3072 sc1
  s_add_u32 s26, s26, 4096
  v_mfma_f32_16x16x32_bf16 v[188:191], a[60:63], v[44:47], v[188:191]
  ds_read_b128 a[44:47], v8 offset:27648
  v_mfma_f32_16x16x32_bf16 v[188:191], a[56:59], v[40:43], v[188:191]
  v_cvt_pk_bf16_f32 v48, v160, v161
  v_cvt_pk_bf16_f32 v49, v162, v163
  v_mfma_f32_16x16x32_bf16 v[192:195], a[0:3], v[32:35], v[192:195]
  s_waitcnt lgkmcnt(3)
  ds_read_b128 a[48:51], v8 offset:28672
  v_cvt_pk_bf16_f32 v50, v168, v169
  v_mfma_f32_16x16x32_bf16 v[192:195], a[4:7], v[36:39], v[192:195]
  v_cvt_pk_bf16_f32 v51, v170, v171
  v_cvt_pk_bf16_f32 v52, v164, v165
  v_mfma_f32_16x16x32_bf16 v[196:199], a[4:7], v[44:47], v[196:199]
  ds_read_b128 a[52:55], v8 offset:29696
  v_cvt_pk_bf16_f32 v53, v166, v167
  v_mfma_f32_16x16x32_bf16 v[196:199], a[0:3], v[40:43], v[196:199]
  buffer_store_dwordx4 v[48:51], v9, s[12:15], s26 offen offset:0 sc1
  v_cvt_pk_bf16_f32 v54, v172, v173
  v_cvt_pk_bf16_f32 v55, v174, v175
  v_mfma_f32_16x16x32_bf16 v[200:203], a[8:11], v[32:35], v[200:203]
  ds_read_b128 a[56:59], v8 offset:30720
  v_mfma_f32_16x16x32_bf16 v[200:203], a[12:15], v[36:39], v[200:203]
  buffer_store_dwordx4 v[52:55], v9, s[12:15], s26 offen offset:1024 sc1
  v_mfma_f32_16x16x32_bf16 v[204:207], a[12:15], v[44:47], v[204:207]
  ds_read_b128 a[60:63], v8 offset:31744
  v_mfma_f32_16x16x32_bf16 v[204:207], a[8:11], v[40:43], v[204:207]
  v_cvt_pk_bf16_f32 v56, v176, v177
  v_cvt_pk_bf16_f32 v57, v178, v179
  v_mfma_f32_16x16x32_bf16 v[208:211], a[16:19], v[32:35], v[208:211]
  v_cvt_pk_bf16_f32 v58, v184, v185
  v_cvt_pk_bf16_f32 v59, v186, v187
  v_mfma_f32_16x16x32_bf16 v[208:211], a[20:23], v[36:39], v[208:211]
  buffer_store_dwordx4 v[56:59], v9, s[12:15], s26 offen offset:2048 sc1
  v_cvt_pk_bf16_f32 v60, v180, v181
  v_cvt_pk_bf16_f32 v61, v182, v183
  v_cvt_pk_bf16_f32 v62, v188, v189
  v_mfma_f32_16x16x32_bf16 v[212:215], a[20:23], v[44:47], v[212:215]
  v_cvt_pk_bf16_f32 v63, v190, v191
  v_mfma_f32_16x16x32_bf16 v[212:215], a[16:19], v[40:43], v[212:215]
  buffer_store_dwordx4 v[60:63], v9, s[12:15], s26 offen offset:3072 sc1
  s_add_u32 s26, s26, 4096
  v_mfma_f32_16x16x32_bf16 v[216:219], a[24:27], v[32:35], v[216:219]
  v_mfma_f32_16x16x32_bf16 v[216:219], a[28:31], v[36:39], v[216:219]
  v_mfma_f32_16x16x32_bf16 v[220:223], a[28:31], v[44:47], v[220:223]
  v_mfma_f32_16x16x32_bf16 v[220:223], a[24:27], v[40:43], v[220:223]
  v_cvt_pk_bf16_f32 v48, v192, v193
  v_cvt_pk_bf16_f32 v49, v194, v195
  v_mfma_f32_16x16x32_bf16 v[224:227], a[32:35], v[32:35], v[224:227]
  s_waitcnt lgkmcnt(0)
  v_cvt_pk_bf16_f32 v50, v200, v201
  v_cvt_pk_bf16_f32 v51, v202, v203
  v_mfma_f32_16x16x32_bf16 v[224:227], a[36:39], v[36:39], v[224:227]
  buffer_store_dwordx4 v[48:51], v9, s[12:15], s26 offen offset:0 sc1
  v_cvt_pk_bf16_f32 v52, v196, v197
  v_cvt_pk_bf16_f32 v53, v198, v199
  v_cvt_pk_bf16_f32 v54, v204, v205
  v_mfma_f32_16x16x32_bf16 v[228:231], a[36:39], v[44:47], v[228:231]
  v_cvt_pk_bf16_f32 v55, v206, v207
  v_mfma_f32_16x16x32_bf16 v[228:231], a[32:35], v[40:43], v[228:231]
  buffer_store_dwordx4 v[52:55], v9, s[12:15], s26 offen offset:1024 sc1
  v_mfma_f32_16x16x32_bf16 v[232:235], a[40:43], v[32:35], v[232:235]
  v_mfma_f32_16x16x32_bf16 v[232:235], a[44:47], v[36:39], v[232:235]
  v_mfma_f32_16x16x32_bf16 v[236:239], a[44:47], v[44:47], v[236:239]
  v_mfma_f32_16x16x32_bf16 v[236:239], a[40:43], v[40:43], v[236:239]
  v_cvt_pk_bf16_f32 v56, v208, v209
  v_cvt_pk_bf16_f32 v57, v210, v211
  v_mfma_f32_16x16x32_bf16 v[240:243], a[48:51], v[32:35], v[240:243]
  v_cvt_pk_bf16_f32 v58, v216, v217
  v_cvt_pk_bf16_f32 v59, v218, v219
  v_mfma_f32_16x16x32_bf16 v[240:243], a[52:55], v[36:39], v[240:243]
  buffer_store_dwordx4 v[56:59], v9, s[12:15], s26 offen offset:2048 sc1
  v_cvt_pk_bf16_f32 v60, v212, v213
  v_cvt_pk_bf16_f32 v61, v214, v215
  v_cvt_pk_bf16_f32 v62, v220, v221
  v_mfma_f32_16x16x32_bf16 v[244:247], a[52:55], v[44:47], v[244:247]
  v_cvt_pk_bf16_f32 v63, v222, v223
  v_mfma_f32_16x16x32_bf16 v[244:247], a[48:51], v[40:43], v[244:247]
  buffer_store_dwordx4 v[60:63], v9, s[12:15], s26 offen offset:3072 sc1
  s_add_u32 s26, s26, 4096
  v_mfma_f32_16x16x32_bf16 v[248:251], a[56:59], v[32:35], v[248:251]
  v_mfma_f32_16x16x32_bf16 v[248:251], a[60:63], v[36:39], v[248:251]
  v_mfma_f32_16x16x32_bf16 v[252:255], a[60:63], v[44:47], v[252:255]
  v_mfma_f32_16x16x32_bf16 v[252:255], a[56:59], v[40:43], v[252:255]
  v_cvt_pk_bf16_f32 v48, v224, v225
  v_cvt_pk_bf16_f32 v49, v226, v227
  v_cvt_pk_bf16_f32 v50, v232, v233
  v_cvt_pk_bf16_f32 v51, v234, v235
  v_cvt_pk_bf16_f32 v52, v228, v229
  buffer_store_dwordx4 v[48:51], v9, s[12:15], s26 offen offset:0 sc1
  v_cvt_pk_bf16_f32 v53, v230, v231
  v_cvt_pk_bf16_f32 v54, v236, v237
  v_cvt_pk_bf16_f32 v55, v238, v239
  s_nop 0
  buffer_store_dwordx4 v[52:55], v9, s[12:15], s26 offen offset:1024 sc1
  v_cvt_pk_bf16_f32 v56, v240, v241
  v_cvt_pk_bf16_f32 v57, v242, v243
  v_cvt_pk_bf16_f32 v58, v248, v249
  v_cvt_pk_bf16_f32 v59, v250, v251
  v_cvt_pk_bf16_f32 v60, v244, v245
  buffer_store_dwordx4 v[56:59], v9, s[12:15], s26 offen offset:2048 sc1
  v_cvt_pk_bf16_f32 v61, v246, v247
  v_cvt_pk_bf16_f32 v62, v252, v253
  v_cvt_pk_bf16_f32 v63, v254, v255
  s_nop 0
  buffer_store_dwordx4 v[60:63], v9, s[12:15], s26 offen offset:3072 sc1
  s_add_u32 s26, s26, 4096
  buffer_store_dwordx4 v[10:13], v9, s[12:15], s26 offen sc1
  v_lshrrev_b32 v2, 2, v1
  v_bfe_u32 v3, v2, 1, 2
  v_lshlrev_b32 v2, 7, v2
  v_and_b32 v26, 3, v1
  v_lshl_add_u32 v2, v26, 3, v2
  v_lshl_add_u32 v2, v3, 5, v2
  v_add_u32 v16, s32, v2
  v_xor_b32 v17, 32, v16
  v_xor_b32 v18, 64, v16
  s_mov_b32 m0, s31
  s_nop 0
  buffer_load_dwordx4 v4, s[68:71], s24 offen lds
  s_add_u32 m0, m0, 4096
  s_add_u32 s24, s24, s30
  v_xor_b32 v19, 96, v16
  v_accvgpr_read_b32 v20, a72
  v_accvgpr_read_b32 v21, a73
  v_rcp_f32 v20, v20
  v_rcp_f32 v21, v21
  v_accvgpr_read_b32 v64, a192
  v_accvgpr_read_b32 v65, a193
  v_accvgpr_read_b32 v66, a194
  v_accvgpr_read_b32 v67, a195
  buffer_load_dwordx4 v4, s[68:71], s24 offen lds
  s_add_u32 m0, m0, 4096
  s_add_u32 s24, s24, s30
  v_accvgpr_read_b32 v68, a196
  v_accvgpr_read_b32 v69, a197
  v_accvgpr_read_b32 v70, a198
  v_accvgpr_read_b32 v71, a199
  v_accvgpr_read_b32 v72, a200
  v_accvgpr_read_b32 v73, a201
  v_accvgpr_read_b32 v74, a202
  v_accvgpr_read_b32 v75, a203
  v_accvgpr_read_b32 v76, a204
  buffer_load_dwordx4 v4, s[68:71], s24 offen lds
  s_add_u32 m0, m0, 4096
  s_add_u32 s24, s24, s30
  v_accvgpr_read_b32 v77, a205
  v_accvgpr_read_b32 v78, a206
  v_accvgpr_read_b32 v79, a207
  v_accvgpr_read_b32 v80, a208
  v_accvgpr_read_b32 v81, a209
  v_accvgpr_read_b32 v82, a210
  v_accvgpr_read_b32 v83, a211
  v_accvgpr_read_b32 v84, a212
  v_accvgpr_read_b32 v85, a213
  buffer_load_dwordx4 v4, s[68:71], s24 offen lds
  s_add_u32 m0, m0, 4096
  s_add_u32 s24, s24, s30
  v_accvgpr_read_b32 v86, a214
  v_accvgpr_read_b32 v87, a215
  v_accvgpr_read_b32 v88, a216
  v_accvgpr_read_b32 v89, a217
  v_accvgpr_read_b32 v90, a218
  v_accvgpr_read_b32 v91, a219
  v_accvgpr_read_b32 v92, a220
  v_accvgpr_read_b32 v93, a221
  v_accvgpr_read_b32 v94, a222
  buffer_load_dwordx4 v4, s[68:71], s24 offen lds
  s_add_u32 m0, m0, 4096
  s_add_u32 s24, s24, s30
  v_accvgpr_read_b32 v95, a223
  v_accvgpr_read_b32 v96, a224
  v_accvgpr_read_b32 v97, a225
  v_accvgpr_read_b32 v98, a226
  v_accvgpr_read_b32 v99, a227
  v_accvgpr_read_b32 v100, a228
  v_accvgpr_read_b32 v101, a229
  v_accvgpr_read_b32 v102, a230
  v_accvgpr_read_b32 v103, a231
  buffer_load_dwordx4 v4, s[68:71], s24 offen lds
  s_add_u32 m0, m0, 4096
  s_add_u32 s24, s24, s30
  v_accvgpr_read_b32 v104, a232
  v_accvgpr_read_b32 v105, a233
  v_accvgpr_read_b32 v106, a234
  v_accvgpr_read_b32 v107, a235
  v_accvgpr_read_b32 v108, a236
  v_accvgpr_read_b32 v109, a237
  v_accvgpr_read_b32 v110, a238
  v_accvgpr_read_b32 v111, a239
  v_accvgpr_read_b32 v112, a240
  buffer_load_dwordx4 v4, s[68:71], s24 offen lds
  s_add_u32 m0, m0, 4096
  s_add_u32 s24, s24, s30
  v_accvgpr_read_b32 v113, a241
  v_accvgpr_read_b32 v114, a242
  v_accvgpr_read_b32 v115, a243
  v_accvgpr_read_b32 v116, a244
  v_accvgpr_read_b32 v117, a245
  v_accvgpr_read_b32 v118, a246
  v_accvgpr_read_b32 v119, a247
  v_accvgpr_read_b32 v120, a64
  v_accvgpr_read_b32 v121, a65
  buffer_load_dwordx4 v4, s[68:71], s24 offen lds
  s_add_u32 s31, s31, 32768
  s_and_b32 s31, s31, 0x1ffff
  s_add_u32 s25, s25, 1
  s_cmp_eq_u32 s25, s28
  s_cbranch_scc1 AT_NS_74
AT_NB_75:
  v_readlane_b32 s24, v5, s25
  s_nop 3
  v_accvgpr_read_b32 v122, a66
  v_accvgpr_read_b32 v123, a67
  v_accvgpr_read_b32 v124, a68
  v_accvgpr_read_b32 v125, a69
  v_accvgpr_read_b32 v126, a70
  v_accvgpr_read_b32 v127, a71
  s_add_u32 s60, s44, 1
  v_mov_b32 v2, s60
  s_waitcnt vmcnt(8)
  s_mov_b64 exec, 1
  buffer_store_dword v2, off, s[12:15], s67 sc1
  s_mov_b64 exec, -1
  s_barrier
  ds_read_b64_tr_b16 a[0:1], v16 offset:0
  ds_read_b64_tr_b16 a[2:3], v16 offset:2048
  ds_read_b64_tr_b16 a[4:5], v16 offset:4096
  ds_read_b64_tr_b16 a[6:7], v16 offset:6144
  ds_read_b64_tr_b16 a[8:9], v16 offset:8192
  ds_read_b64_tr_b16 a[10:11], v16 offset:10240
  ds_read_b64_tr_b16 a[12:13], v16 offset:12288
  ds_read_b64_tr_b16 a[14:15], v16 offset:14336
  ds_read_b64_tr_b16 a[16:17], v16 offset:16384
  ds_read_b64_tr_b16 a[18:19], v16 offset:18432
  ds_read_b64_tr_b16 a[20:21], v16 offset:20480
  ds_read_b64_tr_b16 a[22:23], v16 offset:22528
  ds_read_b64_tr_b16 a[24:25], v16 offset:24576
  ds_read_b64_tr_b16 a[26:27], v16 offset:26624
  ds_read_b64_tr_b16 a[28:29], v16 offset:28672
  ds_read_b64_tr_b16 a[30:31], v16 offset:30720
  ds_read_b64_tr_b16 a[32:33], v17 offset:0
  ds_read_b64_tr_b16 a[34:35], v17 offset:2048
  ds_read_b64_tr_b16 a[36:37], v17 offset:4096
  ds_read_b64_tr_b16 a[38:39], v17 offset:6144
  ds_read_b64_tr_b16 a[40:41], v17 offset:8192
  ds_read_b64_tr_b16 a[42:43], v17 offset:10240
  ds_read_b64_tr_b16 a[44:45], v17 offset:12288
  ds_read_b64_tr_b16 a[46:47], v17 offset:14336
  s_branch AT_OPROJ
AT_BLK0:
  v_add_f32 v32, 0x0, v24
  v_min_f32 v32, 0, v32
  v_add_f32 v33, 0xf1800000, v24
  v_min_f32 v33, 0, v33
  v_add_f32 v34, 0xf2000000, v24
  v_min_f32 v34, 0, v34
  v_add_f32 v35, 0xf2400000, v24
  v_min_f32 v35, 0, v35
  v_add_f32 v36, 0xf3800000, v24
  v_min_f32 v36, 0, v36
  v_add_f32 v37, 0xf3880000, v24
  v_min_f32 v37, 0, v37
  v_add_f32 v38, 0xf3900000, v24
  v_min_f32 v38, 0, v38
  v_add_f32 v39, 0xf3980000, v24
  v_min_f32 v39, 0, v39
  v_add_f32 v40, 0xf4000000, v24
  v_min_f32 v40, 0, v40
  v_add_f32 v41, 0xf4040000, v24
  v_min_f32 v41, 0, v41
  v_add_f32 v42, 0xf4080000, v24
  v_min_f32 v42, 0, v42
  v_add_f32 v43, 0xf40c0000, v24
  v_min_f32 v43, 0, v43
  v_add_f32 v44, 0xf4400000, v24
  v_min_f32 v44, 0, v44
  v_add_f32 v45, 0xf4440000, v24
  v_min_f32 v45, 0, v45
  v_add_f32 v46, 0xf4480000, v24
  v_min_f32 v46, 0, v46
  v_add_f32 v47, 0xf44c0000, v24
  v_min_f32 v47, 0, v47
  s_branch AT_BLK0_B
AT_H0:
  s_nop 7
  v_max3_f32 v2, v64, v65, v66
  v_max3_f32 v2, v2, v67, v72
  v_max3_f32 v2, v2, v73, v74
  v_max3_f32 v2, v2, v75, v80
  v_max3_f32 v2, v2, v81, v82
  v_max3_f32 v2, v2, v83, v88
  v_max3_f32 v2, v2, v89, v90
  v_max_f32 v2, v2, v91
  v_max3_f32 v3, v68, v69, v70
  v_max3_f32 v3, v3, v71, v76
  v_max3_f32 v3, v3, v77, v78
  v_max3_f32 v3, v3, v79, v84
  v_max3_f32 v3, v3, v85, v86
  v_max3_f32 v3, v3, v87, v92
  v_max3_f32 v3, v3, v93, v94
  v_max_f32 v3, v3, v95
  v_mov_b32 v16, v2
  v_mov_b32 v17, v3
  s_nop 1
  v_permlane16_swap_b32 v2, v16
  v_permlane16_swap_b32 v3, v17
  s_nop 0
  v_max_f32 v2, v2, v16
  v_max_f32 v3, v3, v17
  v_mov_b32 v16, v2
  v_mov_b32 v17, v3
  s_nop 1
  v_permlane32_swap_b32 v2, v16
  v_permlane32_swap_b32 v3, v17
  s_nop 0
  v_max_f32 v2, v2, v16
  v_max_f32 v3, v3, v17
  v_max_f32 v2, 0, v2
  v_sub_f32 v10, v10, v2
  v_sub_f32 v64, v64, v2
  v_sub_f32 v65, v65, v2
  v_sub_f32 v66, v66, v2
  v_sub_f32 v67, v67, v2
  v_sub_f32 v72, v72, v2
  v_sub_f32 v73, v73, v2
  v_sub_f32 v74, v74, v2
  v_sub_f32 v75, v75, v2
  v_sub_f32 v80, v80, v2
  v_sub_f32 v81, v81, v2
  v_sub_f32 v82, v82, v2
  v_sub_f32 v83, v83, v2
  v_sub_f32 v88, v88, v2
  v_sub_f32 v89, v89, v2
  v_sub_f32 v90, v90, v2
  v_sub_f32 v91, v91, v2
  v_mov_b32 v96, v10
  v_mov_b32 v97, v10
  v_mov_b64 v[98:99], v[96:97]
  v_mov_b64 v[104:105], v[96:97]
  v_mov_b64 v[106:107], v[96:97]
  v_mov_b64 v[112:113], v[96:97]
  v_mov_b64 v[114:115], v[96:97]
  v_mov_b64 v[120:121], v[96:97]
  v_mov_b64 v[122:123], v[96:97]
  v_max_f32 v3, 0, v3
  v_sub_f32 v11, v11, v3
  v_sub_f32 v68, v68, v3
  v_sub_f32 v69, v69, v3
  v_sub_f32 v70, v70, v3
  v_sub_f32 v71, v71, v3
  v_sub_f32 v76, v76, v3
  v_sub_f32 v77, v77, v3
  v_sub_f32 v78, v78, v3
  v_sub_f32 v79, v79, v3
  v_sub_f32 v84, v84, v3
  v_sub_f32 v85, v85, v3
  v_sub_f32 v86, v86, v3
  v_sub_f32 v87, v87, v3
  v_sub_f32 v92, v92, v3
  v_sub_f32 v93, v93, v3
  v_sub_f32 v94, v94, v3
  v_sub_f32 v95, v95, v3
  v_mov_b32 v100, v11
  v_mov_b32 v101, v11
  v_mov_b64 v[102:103], v[100:101]
  v_mov_b64 v[108:109], v[100:101]
  v_mov_b64 v[110:111], v[100:101]
  v_mov_b64 v[116:117], v[100:101]
  v_mov_b64 v[118:119], v[100:101]
  v_mov_b64 v[124:125], v[100:101]
  v_mov_b64 v[126:127], v[100:101]
  s_mov_b32 s44, 1
  v_exp_f32 v2, -v2
  v_exp_f32 v3, -v3
  s_nop 0
  v_mul_f32 v12, v12, v2
  v_pk_mul_f32 v[128:129], v[128:129], v[2:3] op_sel:[0,0] op_sel_hi:[1,0]
  v_pk_mul_f32 v[130:131], v[130:131], v[2:3] op_sel:[0,0] op_sel_hi:[1,0]
  v_pk_mul_f32 v[136:137], v[136:137], v[2:3] op_sel:[0,0] op_sel_hi:[1,0]
  v_pk_mul_f32 v[138:139], v[138:139], v[2:3] op_sel:[0,0] op_sel_hi:[1,0]
  v_pk_mul_f32 v[144:145], v[144:145], v[2:3] op_sel:[0,0] op_sel_hi:[1,0]
  v_pk_mul_f32 v[146:147], v[146:147], v[2:3] op_sel:[0,0] op_sel_hi:[1,0]
  v_pk_mul_f32 v[152:153], v[152:153], v[2:3] op_sel:[0,0] op_sel_hi:[1,0]
  v_pk_mul_f32 v[154:155], v[154:155], v[2:3] op_sel:[0,0] op_sel_hi:[1,0]
  v_pk_mul_f32 v[160:161], v[160:161], v[2:3] op_sel:[0,0] op_sel_hi:[1,0]
  v_pk_mul_f32 v[162:163], v[162:163], v[2:3] op_sel:[0,0] op_sel_hi:[1,0]
  v_pk_mul_f32 v[168:169], v[168:169], v[2:3] op_sel:[0,0] op_sel_hi:[1,0]
  v_pk_mul_f32 v[170:171], v[170:171], v[2:3] op_sel:[0,0] op_sel_hi:[1,0]
  v_pk_mul_f32 v[176:177], v[176:177], v[2:3] op_sel:[0,0] op_sel_hi:[1,0]
  v_pk_mul_f32 v[178:179], v[178:179], v[2:3] op_sel:[0,0] op_sel_hi:[1,0]
  v_pk_mul_f32 v[184:185], v[184:185], v[2:3] op_sel:[0,0] op_sel_hi:[1,0]
  v_pk_mul_f32 v[186:187], v[186:187], v[2:3] op_sel:[0,0] op_sel_hi:[1,0]
  v_pk_mul_f32 v[192:193], v[192:193], v[2:3] op_sel:[0,0] op_sel_hi:[1,0]
  v_pk_mul_f32 v[194:195], v[194:195], v[2:3] op_sel:[0,0] op_sel_hi:[1,0]
  v_pk_mul_f32 v[200:201], v[200:201], v[2:3] op_sel:[0,0] op_sel_hi:[1,0]
  v_pk_mul_f32 v[202:203], v[202:203], v[2:3] op_sel:[0,0] op_sel_hi:[1,0]
  v_pk_mul_f32 v[208:209], v[208:209], v[2:3] op_sel:[0,0] op_sel_hi:[1,0]
  v_pk_mul_f32 v[210:211], v[210:211], v[2:3] op_sel:[0,0] op_sel_hi:[1,0]
  v_pk_mul_f32 v[216:217], v[216:217], v[2:3] op_sel:[0,0] op_sel_hi:[1,0]
  v_pk_mul_f32 v[218:219], v[218:219], v[2:3] op_sel:[0,0] op_sel_hi:[1,0]
  v_pk_mul_f32 v[224:225], v[224:225], v[2:3] op_sel:[0,0] op_sel_hi:[1,0]
  v_pk_mul_f32 v[226:227], v[226:227], v[2:3] op_sel:[0,0] op_sel_hi:[1,0]
  v_pk_mul_f32 v[232:233], v[232:233], v[2:3] op_sel:[0,0] op_sel_hi:[1,0]
  v_pk_mul_f32 v[234:235], v[234:235], v[2:3] op_sel:[0,0] op_sel_hi:[1,0]
  v_pk_mul_f32 v[240:241], v[240:241], v[2:3] op_sel:[0,0] op_sel_hi:[1,0]
  v_pk_mul_f32 v[242:243], v[242:243], v[2:3] op_sel:[0,0] op_sel_hi:[1,0]
  v_pk_mul_f32 v[248:249], v[248:249], v[2:3] op_sel:[0,0] op_sel_hi:[1,0]
  v_pk_mul_f32 v[250:251], v[250:251], v[2:3] op_sel:[0,0] op_sel_hi:[1,0]
  v_mul_f32 v13, v13, v3
  v_pk_mul_f32 v[132:133], v[132:133], v[2:3] op_sel:[0,1] op_sel_hi:[1,1]
  v_pk_mul_f32 v[134:135], v[134:135], v[2:3] op_sel:[0,1] op_sel_hi:[1,1]
  v_pk_mul_f32 v[140:141], v[140:141], v[2:3] op_sel:[0,1] op_sel_hi:[1,1]
  v_pk_mul_f32 v[142:143], v[142:143], v[2:3] op_sel:[0,1] op_sel_hi:[1,1]
  v_pk_mul_f32 v[148:149], v[148:149], v[2:3] op_sel:[0,1] op_sel_hi:[1,1]
  v_pk_mul_f32 v[150:151], v[150:151], v[2:3] op_sel:[0,1] op_sel_hi:[1,1]
  v_pk_mul_f32 v[156:157], v[156:157], v[2:3] op_sel:[0,1] op_sel_hi:[1,1]
  v_pk_mul_f32 v[158:159], v[158:159], v[2:3] op_sel:[0,1] op_sel_hi:[1,1]
  v_pk_mul_f32 v[164:165], v[164:165], v[2:3] op_sel:[0,1] op_sel_hi:[1,1]
  v_pk_mul_f32 v[166:167], v[166:167], v[2:3] op_sel:[0,1] op_sel_hi:[1,1]
  v_pk_mul_f32 v[172:173], v[172:173], v[2:3] op_sel:[0,1] op_sel_hi:[1,1]
  v_pk_mul_f32 v[174:175], v[174:175], v[2:3] op_sel:[0,1] op_sel_hi:[1,1]
  v_pk_mul_f32 v[180:181], v[180:181], v[2:3] op_sel:[0,1] op_sel_hi:[1,1]
  v_pk_mul_f32 v[182:183], v[182:183], v[2:3] op_sel:[0,1] op_sel_hi:[1,1]
  v_pk_mul_f32 v[188:189], v[188:189], v[2:3] op_sel:[0,1] op_sel_hi:[1,1]
  v_pk_mul_f32 v[190:191], v[190:191], v[2:3] op_sel:[0,1] op_sel_hi:[1,1]
  v_pk_mul_f32 v[196:197], v[196:197], v[2:3] op_sel:[0,1] op_sel_hi:[1,1]
  v_pk_mul_f32 v[198:199], v[198:199], v[2:3] op_sel:[0,1] op_sel_hi:[1,1]
  v_pk_mul_f32 v[204:205], v[204:205], v[2:3] op_sel:[0,1] op_sel_hi:[1,1]
  v_pk_mul_f32 v[206:207], v[206:207], v[2:3] op_sel:[0,1] op_sel_hi:[1,1]
  v_pk_mul_f32 v[212:213], v[212:213], v[2:3] op_sel:[0,1] op_sel_hi:[1,1]
  v_pk_mul_f32 v[214:215], v[214:215], v[2:3] op_sel:[0,1] op_sel_hi:[1,1]
  v_pk_mul_f32 v[220:221], v[220:221], v[2:3] op_sel:[0,1] op_sel_hi:[1,1]
  v_pk_mul_f32 v[222:223], v[222:223], v[2:3] op_sel:[0,1] op_sel_hi:[1,1]
  v_pk_mul_f32 v[228:229], v[228:229], v[2:3] op_sel:[0,1] op_sel_hi:[1,1]
  v_pk_mul_f32 v[230:231], v[230:231], v[2:3] op_sel:[0,1] op_sel_hi:[1,1]
  v_pk_mul_f32 v[236:237], v[236:237], v[2:3] op_sel:[0,1] op_sel_hi:[1,1]
  v_pk_mul_f32 v[238:239], v[238:239], v[2:3] op_sel:[0,1] op_sel_hi:[1,1]
  v_pk_mul_f32 v[244:245], v[244:245], v[2:3] op_sel:[0,1] op_sel_hi:[1,1]
  v_pk_mul_f32 v[246:247], v[246:247], v[2:3] op_sel:[0,1] op_sel_hi:[1,1]
  v_pk_mul_f32 v[252:253], v[252:253], v[2:3] op_sel:[0,1] op_sel_hi:[1,1]
  v_pk_mul_f32 v[254:255], v[254:255], v[2:3] op_sel:[0,1] op_sel_hi:[1,1]
  v_exp_f32 v16, v64
  v_exp_f32 v17, v65
  v_exp_f32 v18, v66
  v_exp_f32 v19, v67
  v_exp_f32 v20, v68
  v_exp_f32 v21, v69
  v_exp_f32 v22, v70
  v_exp_f32 v23, v71
  v_add_f32 v14, v16, v17
  v_cvt_pk_bf16_f32 v48, v16, v17
  v_add_f32 v14, v14, v18
  v_add_f32 v14, v14, v19
  v_cvt_pk_bf16_f32 v49, v18, v19
  v_exp_f32 v28, v72
  v_exp_f32 v29, v73
  v_exp_f32 v30, v74
  v_exp_f32 v31, v75
  v_add_f32 v15, v20, v21
  v_cvt_pk_bf16_f32 v56, v20, v21
  v_add_f32 v15, v15, v22
  v_add_f32 v15, v15, v23
  v_cvt_pk_bf16_f32 v57, v22, v23
  v_exp_f32 v16, v76
  v_exp_f32 v17, v77
  v_exp_f32 v18, v78
  v_exp_f32 v19, v79
  v_add_f32 v14, v14, v28
  v_add_f32 v14, v14, v29
  v_cvt_pk_bf16_f32 v50, v28, v29
  v_add_f32 v14, v14, v30
  v_add_f32 v14, v14, v31
  v_cvt_pk_bf16_f32 v51, v30, v31
  v_exp_f32 v20, v80
  v_exp_f32 v21, v81
  v_exp_f32 v22, v82
  v_exp_f32 v23, v83
  v_add_f32 v15, v15, v16
  v_add_f32 v15, v15, v17
  v_cvt_pk_bf16_f32 v58, v16, v17
  v_add_f32 v15, v15, v18
  v_add_f32 v15, v15, v19
  v_cvt_pk_bf16_f32 v59, v18, v19
  v_exp_f32 v28, v84
  v_exp_f32 v29, v85
  v_exp_f32 v30, v86
  v_exp_f32 v31, v87
  v_add_f32 v14, v14, v20
  v_add_f32 v14, v14, v21
  v_cvt_pk_bf16_f32 v52, v20, v21
  v_add_f32 v14, v14, v22
  v_add_f32 v14, v14, v23
  v_cvt_pk_bf16_f32 v53, v22, v23
  v_exp_f32 v16, v88
  v_exp_f32 v17, v89
  v_exp_f32 v18, v90
  v_exp_f32 v19, v91
  v_add_f32 v15, v15, v28
  v_add_f32 v15, v15, v29
  v_cvt_pk_bf16_f32 v60, v28, v29
  v_add_f32 v15, v15, v30
  v_add_f32 v15, v15, v31
  v_cvt_pk_bf16_f32 v61, v30, v31
  v_exp_f32 v20, v92
  v_exp_f32 v21, v93
  v_exp_f32 v22, v94
  v_exp_f32 v23, v95
  v_add_f32 v14, v14, v16
  v_add_f32 v14, v14, v17
  v_cvt_pk_bf16_f32 v54, v16, v17
  v_add_f32 v14, v14, v18
  v_add_f32 v14, v14, v19
  v_cvt_pk_bf16_f32 v55, v18, v19
  s_nop 0
  v_add_f32 v15, v15, v20
  v_add_f32 v15, v15, v21
  v_cvt_pk_bf16_f32 v62, v20, v21
  v_add_f32 v15, v15, v22
  v_add_f32 v15, v15, v23
  v_cvt_pk_bf16_f32 v63, v22, v23
  s_branch AT_H0B
AT_H1:
  s_call_b64 s[36:37], AT_FIX0
  s_branch AT_H1B
AT_HZ:
  s_call_b64 s[36:37], AT_FIX0
  s_branch AT_FZ
AT_FIX0:
  s_nop 7
  v_max3_f32 v2, v64, v65, v66
  v_max3_f32 v2, v2, v67, v72
  v_max3_f32 v2, v2, v73, v74
  v_max3_f32 v2, v2, v75, v80
  v_max3_f32 v2, v2, v81, v82
  v_max3_f32 v2, v2, v83, v88
  v_max3_f32 v2, v2, v89, v90
  v_max_f32 v2, v2, v91
  v_max3_f32 v3, v68, v69, v70
  v_max3_f32 v3, v3, v71, v76
  v_max3_f32 v3, v3, v77, v78
  v_max3_f32 v3, v3, v79, v84
  v_max3_f32 v3, v3, v85, v86
  v_max3_f32 v3, v3, v87, v92
  v_max3_f32 v3, v3, v93, v94
  v_max_f32 v3, v3, v95
  v_mov_b32 v16, v2
  v_mov_b32 v17, v3
  s_nop 1
  v_permlane16_swap_b32 v2, v16
  v_permlane16_swap_b32 v3, v17
  s_nop 0
  v_max_f32 v2, v2, v16
  v_max_f32 v3, v3, v17
  v_mov_b32 v16, v2
  v_mov_b32 v17, v3
  s_nop 1
  v_permlane32_swap_b32 v2, v16
  v_permlane32_swap_b32 v3, v17
  s_nop 0
  v_max_f32 v2, v2, v16
  v_max_f32 v3, v3, v17
  v_max_f32 v2, 0, v2
  v_sub_f32 v10, v10, v2
  v_sub_f32 v64, v64, v2
  v_sub_f32 v65, v65, v2
  v_sub_f32 v66, v66, v2
  v_sub_f32 v67, v67, v2
  v_sub_f32 v72, v72, v2
  v_sub_f32 v73, v73, v2
  v_sub_f32 v74, v74, v2
  v_sub_f32 v75, v75, v2
  v_sub_f32 v80, v80, v2
  v_sub_f32 v81, v81, v2
  v_sub_f32 v82, v82, v2
  v_sub_f32 v83, v83, v2
  v_sub_f32 v88, v88, v2
  v_sub_f32 v89, v89, v2
  v_sub_f32 v90, v90, v2
  v_sub_f32 v91, v91, v2
  v_mov_b32 v96, v10
  v_mov_b32 v97, v10
  v_mov_b64 v[98:99], v[96:97]
  v_mov_b64 v[104:105], v[96:97]
  v_mov_b64 v[106:107], v[96:97]
  v_mov_b64 v[112:113], v[96:97]
  v_mov_b64 v[114:115], v[96:97]
  v_mov_b64 v[120:121], v[96:97]
  v_mov_b64 v[122:123], v[96:97]
  v_max_f32 v3, 0, v3
  v_sub_f32 v11, v11, v3
  v_sub_f32 v68, v68, v3
  v_sub_f32 v69, v69, v3
  v_sub_f32 v70, v70, v3
  v_sub_f32 v71, v71, v3
  v_sub_f32 v76, v76, v3
  v_sub_f32 v77, v77, v3
  v_sub_f32 v78, v78, v3
  v_sub_f32 v79, v79, v3
  v_sub_f32 v84, v84, v3
  v_sub_f32 v85, v85, v3
  v_sub_f32 v86, v86, v3
  v_sub_f32 v87, v87, v3
  v_sub_f32 v92, v92, v3
  v_sub_f32 v93, v93, v3
  v_sub_f32 v94, v94, v3
  v_sub_f32 v95, v95, v3
  v_mov_b32 v100, v11
  v_mov_b32 v101, v11
  v_mov_b64 v[102:103], v[100:101]
  v_mov_b64 v[108:109], v[100:101]
  v_mov_b64 v[110:111], v[100:101]
  v_mov_b64 v[116:117], v[100:101]
  v_mov_b64 v[118:119], v[100:101]
  v_mov_b64 v[124:125], v[100:101]
  v_mov_b64 v[126:127], v[100:101]
  s_mov_b32 s44, 1
  v_exp_f32 v2, -v2
  v_exp_f32 v3, -v3
  s_nop 0
  v_mul_f32 v12, v12, v2
  v_pk_mul_f32 v[128:129], v[128:129], v[2:3] op_sel:[0,0] op_sel_hi:[1,0]
  v_pk_mul_f32 v[130:131], v[130:131], v[2:3] op_sel:[0,0] op_sel_hi:[1,0]
  v_pk_mul_f32 v[136:137], v[136:137], v[2:3] op_sel:[0,0] op_sel_hi:[1,0]
  v_pk_mul_f32 v[138:139], v[138:139], v[2:3] op_sel:[0,0] op_sel_hi:[1,0]
  v_pk_mul_f32 v[144:145], v[144:145], v[2:3] op_sel:[0,0] op_sel_hi:[1,0]
  v_pk_mul_f32 v[146:147], v[146:147], v[2:3] op_sel:[0,0] op_sel_hi:[1,0]
  v_pk_mul_f32 v[152:153], v[152:153], v[2:3] op_sel:[0,0] op_sel_hi:[1,0]
  v_pk_mul_f32 v[154:155], v[154:155], v[2:3] op_sel:[0,0] op_sel_hi:[1,0]
  v_pk_mul_f32 v[160:161], v[160:161], v[2:3] op_sel:[0,0] op_sel_hi:[1,0]
  v_pk_mul_f32 v[162:163], v[162:163], v[2:3] op_sel:[0,0] op_sel_hi:[1,0]
  v_pk_mul_f32 v[168:169], v[168:169], v[2:3] op_sel:[0,0] op_sel_hi:[1,0]
  v_pk_mul_f32 v[170:171], v[170:171], v[2:3] op_sel:[0,0] op_sel_hi:[1,0]
  v_pk_mul_f32 v[176:177], v[176:177], v[2:3] op_sel:[0,0] op_sel_hi:[1,0]
  v_pk_mul_f32 v[178:179], v[178:179], v[2:3] op_sel:[0,0] op_sel_hi:[1,0]
  v_pk_mul_f32 v[184:185], v[184:185], v[2:3] op_sel:[0,0] op_sel_hi:[1,0]
  v_pk_mul_f32 v[186:187], v[186:187], v[2:3] op_sel:[0,0] op_sel_hi:[1,0]
  v_pk_mul_f32 v[192:193], v[192:193], v[2:3] op_sel:[0,0] op_sel_hi:[1,0]
  v_pk_mul_f32 v[194:195], v[194:195], v[2:3] op_sel:[0,0] op_sel_hi:[1,0]
  v_pk_mul_f32 v[200:201], v[200:201], v[2:3] op_sel:[0,0] op_sel_hi:[1,0]
  v_pk_mul_f32 v[202:203], v[202:203], v[2:3] op_sel:[0,0] op_sel_hi:[1,0]
  v_pk_mul_f32 v[208:209], v[208:209], v[2:3] op_sel:[0,0] op_sel_hi:[1,0]
  v_pk_mul_f32 v[210:211], v[210:211], v[2:3] op_sel:[0,0] op_sel_hi:[1,0]
  v_pk_mul_f32 v[216:217], v[216:217], v[2:3] op_sel:[0,0] op_sel_hi:[1,0]
  v_pk_mul_f32 v[218:219], v[218:219], v[2:3] op_sel:[0,0] op_sel_hi:[1,0]
  v_pk_mul_f32 v[224:225], v[224:225], v[2:3] op_sel:[0,0] op_sel_hi:[1,0]
  v_pk_mul_f32 v[226:227], v[226:227], v[2:3] op_sel:[0,0] op_sel_hi:[1,0]
  v_pk_mul_f32 v[232:233], v[232:233], v[2:3] op_sel:[0,0] op_sel_hi:[1,0]
  v_pk_mul_f32 v[234:235], v[234:235], v[2:3] op_sel:[0,0] op_sel_hi:[1,0]
  v_pk_mul_f32 v[240:241], v[240:241], v[2:3] op_sel:[0,0] op_sel_hi:[1,0]
  v_pk_mul_f32 v[242:243], v[242:243], v[2:3] op_sel:[0,0] op_sel_hi:[1,0]
  v_pk_mul_f32 v[248:249], v[248:249], v[2:3] op_sel:[0,0] op_sel_hi:[1,0]
  v_pk_mul_f32 v[250:251], v[250:251], v[2:3] op_sel:[0,0] op_sel_hi:[1,0]
  v_mul_f32 v13, v13, v3
  v_pk_mul_f32 v[132:133], v[132:133], v[2:3] op_sel:[0,1] op_sel_hi:[1,1]
  v_pk_mul_f32 v[134:135], v[134:135], v[2:3] op_sel:[0,1] op_sel_hi:[1,1]
  v_pk_mul_f32 v[140:141], v[140:141], v[2:3] op_sel:[0,1] op_sel_hi:[1,1]
  v_pk_mul_f32 v[142:143], v[142:143], v[2:3] op_sel:[0,1] op_sel_hi:[1,1]
  v_pk_mul_f32 v[148:149], v[148:149], v[2:3] op_sel:[0,1] op_sel_hi:[1,1]
  v_pk_mul_f32 v[150:151], v[150:151], v[2:3] op_sel:[0,1] op_sel_hi:[1,1]
  v_pk_mul_f32 v[156:157], v[156:157], v[2:3] op_sel:[0,1] op_sel_hi:[1,1]
  v_pk_mul_f32 v[158:159], v[158:159], v[2:3] op_sel:[0,1] op_sel_hi:[1,1]
  v_pk_mul_f32 v[164:165], v[164:165], v[2:3] op_sel:[0,1] op_sel_hi:[1,1]
  v_pk_mul_f32 v[166:167], v[166:167], v[2:3] op_sel:[0,1] op_sel_hi:[1,1]
  v_pk_mul_f32 v[172:173], v[172:173], v[2:3] op_sel:[0,1] op_sel_hi:[1,1]
  v_pk_mul_f32 v[174:175], v[174:175], v[2:3] op_sel:[0,1] op_sel_hi:[1,1]
  v_pk_mul_f32 v[180:181], v[180:181], v[2:3] op_sel:[0,1] op_sel_hi:[1,1]
  v_pk_mul_f32 v[182:183], v[182:183], v[2:3] op_sel:[0,1] op_sel_hi:[1,1]
  v_pk_mul_f32 v[188:189], v[188:189], v[2:3] op_sel:[0,1] op_sel_hi:[1,1]
  v_pk_mul_f32 v[190:191], v[190:191], v[2:3] op_sel:[0,1] op_sel_hi:[1,1]
  v_pk_mul_f32 v[196:197], v[196:197], v[2:3] op_sel:[0,1] op_sel_hi:[1,1]
  v_pk_mul_f32 v[198:199], v[198:199], v[2:3] op_sel:[0,1] op_sel_hi:[1,1]
  v_pk_mul_f32 v[204:205], v[204:205], v[2:3] op_sel:[0,1] op_sel_hi:[1,1]
  v_pk_mul_f32 v[206:207], v[206:207], v[2:3] op_sel:[0,1] op_sel_hi:[1,1]
  v_pk_mul_f32 v[212:213], v[212:213], v[2:3] op_sel:[0,1] op_sel_hi:[1,1]
  v_pk_mul_f32 v[214:215], v[214:215], v[2:3] op_sel:[0,1] op_sel_hi:[1,1]
  v_pk_mul_f32 v[220:221], v[220:221], v[2:3] op_sel:[0,1] op_sel_hi:[1,1]
  v_pk_mul_f32 v[222:223], v[222:223], v[2:3] op_sel:[0,1] op_sel_hi:[1,1]
  v_pk_mul_f32 v[228:229], v[228:229], v[2:3] op_sel:[0,1] op_sel_hi:[1,1]
  v_pk_mul_f32 v[230:231], v[230:231], v[2:3] op_sel:[0,1] op_sel_hi:[1,1]
  v_pk_mul_f32 v[236:237], v[236:237], v[2:3] op_sel:[0,1] op_sel_hi:[1,1]
  v_pk_mul_f32 v[238:239], v[238:239], v[2:3] op_sel:[0,1] op_sel_hi:[1,1]
  v_pk_mul_f32 v[244:245], v[244:245], v[2:3] op_sel:[0,1] op_sel_hi:[1,1]
  v_pk_mul_f32 v[246:247], v[246:247], v[2:3] op_sel:[0,1] op_sel_hi:[1,1]
  v_pk_mul_f32 v[252:253], v[252:253], v[2:3] op_sel:[0,1] op_sel_hi:[1,1]
  v_pk_mul_f32 v[254:255], v[254:255], v[2:3] op_sel:[0,1] op_sel_hi:[1,1]
  v_exp_f32 v16, v64
  v_exp_f32 v17, v65
  v_exp_f32 v18, v66
  v_exp_f32 v19, v67
  v_exp_f32 v20, v68
  v_exp_f32 v21, v69
  v_exp_f32 v22, v70
  v_exp_f32 v23, v71
  v_add_f32 v14, v16, v17
  v_cvt_pk_bf16_f32 v32, v16, v17
  v_add_f32 v14, v14, v18
  v_add_f32 v14, v14, v19
  v_cvt_pk_bf16_f32 v33, v18, v19
  v_exp_f32 v28, v72
  v_exp_f32 v29, v73
  v_exp_f32 v30, v74
  v_exp_f32 v31, v75
  v_add_f32 v15, v20, v21
  v_cvt_pk_bf16_f32 v40, v20, v21
  v_add_f32 v15, v15, v22
  v_add_f32 v15, v15, v23
  v_cvt_pk_bf16_f32 v41, v22, v23
  v_exp_f32 v16, v76
  v_exp_f32 v17, v77
  v_exp_f32 v18, v78
  v_exp_f32 v19, v79
  v_add_f32 v14, v14, v28
  v_add_f32 v14, v14, v29
  v_cvt_pk_bf16_f32 v34, v28, v29
  v_add_f32 v14, v14, v30
  v_add_f32 v14, v14, v31
  v_cvt_pk_bf16_f32 v35, v30, v31
  v_exp_f32 v20, v80
  v_exp_f32 v21, v81
  v_exp_f32 v22, v82
  v_exp_f32 v23, v83
  v_add_f32 v15, v15, v16
  v_add_f32 v15, v15, v17
  v_cvt_pk_bf16_f32 v42, v16, v17
  v_add_f32 v15, v15, v18
  v_add_f32 v15, v15, v19
  v_cvt_pk_bf16_f32 v43, v18, v19
  v_exp_f32 v28, v84
  v_exp_f32 v29, v85
  v_exp_f32 v30, v86
  v_exp_f32 v31, v87
  v_add_f32 v14, v14, v20
  v_add_f32 v14, v14, v21
  v_cvt_pk_bf16_f32 v36, v20, v21
  v_add_f32 v14, v14, v22
  v_add_f32 v14, v14, v23
  v_cvt_pk_bf16_f32 v37, v22, v23
  v_exp_f32 v16, v88
  v_exp_f32 v17, v89
  v_exp_f32 v18, v90
  v_exp_f32 v19, v91
  v_add_f32 v15, v15, v28
  v_add_f32 v15, v15, v29
  v_cvt_pk_bf16_f32 v44, v28, v29
  v_add_f32 v15, v15, v30
  v_add_f32 v15, v15, v31
  v_cvt_pk_bf16_f32 v45, v30, v31
  v_exp_f32 v20, v92
  v_exp_f32 v21, v93
  v_exp_f32 v22, v94
  v_exp_f32 v23, v95
  v_add_f32 v14, v14, v16
  v_add_f32 v14, v14, v17
  v_cvt_pk_bf16_f32 v38, v16, v17
  v_add_f32 v14, v14, v18
  v_add_f32 v14, v14, v19
  v_cvt_pk_bf16_f32 v39, v18, v19
  s_nop 0
  v_add_f32 v15, v15, v20
  v_add_f32 v15, v15, v21
  v_cvt_pk_bf16_f32 v46, v20, v21
  v_add_f32 v15, v15, v22
  v_add_f32 v15, v15, v23
  v_cvt_pk_bf16_f32 v47, v22, v23
  s_setpc_b64 s[36:37]
AT_SLOW:
  s_cmp_eq_u32 s46, 0
  s_cbranch_scc1 AT_SLOW_B
  s_waitcnt vmcnt(0)
  v_min_f32 v26, v10, v28
  v_sub_f32 v2, v26, v10
  v_sub_f32 v28, v26, v28
  v_exp_f32 v2, v2
  v_exp_f32 v28, v28
  s_nop 0
  v_mul_f32 v12, v12, v2
  v_mul_f32 v30, v30, v28
  v_min_f32 v26, v11, v29
  v_sub_f32 v3, v26, v11
  v_sub_f32 v29, v26, v29
  v_exp_f32 v3, v3
  v_exp_f32 v29, v29
  s_nop 0
  v_mul_f32 v13, v13, v3
  v_mul_f32 v31, v31, v29
  v_accvgpr_read_b32 v23, a192
  v_accvgpr_write_b32 a192, 0
  v_pk_mul_f32 v[128:129], v[128:129], v[2:3] op_sel:[0,0] op_sel_hi:[1,0]
  v_lshlrev_b32 v22, 16, v23
  v_and_b32 v23, 0xffff0000, v23
  v_pk_fma_f32 v[128:129], v[22:23], v[28:29], v[128:129] op_sel:[0,0,0] op_sel_hi:[1,0,1]
  v_accvgpr_read_b32 v23, a193
  v_accvgpr_write_b32 a193, 0
  v_pk_mul_f32 v[130:131], v[130:131], v[2:3] op_sel:[0,0] op_sel_hi:[1,0]
  v_lshlrev_b32 v22, 16, v23
  v_and_b32 v23, 0xffff0000, v23
  v_pk_fma_f32 v[130:131], v[22:23], v[28:29], v[130:131] op_sel:[0,0,0] op_sel_hi:[1,0,1]
  v_accvgpr_read_b32 v23, a194
  v_accvgpr_write_b32 a194, 0
  v_pk_mul_f32 v[136:137], v[136:137], v[2:3] op_sel:[0,0] op_sel_hi:[1,0]
  v_lshlrev_b32 v22, 16, v23
  v_and_b32 v23, 0xffff0000, v23
  v_pk_fma_f32 v[136:137], v[22:23], v[28:29], v[136:137] op_sel:[0,0,0] op_sel_hi:[1,0,1]
  v_accvgpr_read_b32 v23, a195
  v_accvgpr_write_b32 a195, 0
  v_pk_mul_f32 v[138:139], v[138:139], v[2:3] op_sel:[0,0] op_sel_hi:[1,0]
  v_lshlrev_b32 v22, 16, v23
  v_and_b32 v23, 0xffff0000, v23
  v_pk_fma_f32 v[138:139], v[22:23], v[28:29], v[138:139] op_sel:[0,0,0] op_sel_hi:[1,0,1]
  v_accvgpr_read_b32 v23, a196
  v_accvgpr_write_b32 a196, 0
  v_pk_mul_f32 v[132:133], v[132:133], v[2:3] op_sel:[0,1] op_sel_hi:[1,1]
  v_lshlrev_b32 v22, 16, v23
  v_and_b32 v23, 0xffff0000, v23
  v_pk_fma_f32 v[132:133], v[22:23], v[28:29], v[132:133] op_sel:[0,1,0] op_sel_hi:[1,1,1]
  v_accvgpr_read_b32 v23, a197
  v_accvgpr_write_b32 a197, 0
  v_pk_mul_f32 v[134:135], v[134:135], v[2:3] op_sel:[0,1] op_sel_hi:[1,1]
  v_lshlrev_b32 v22, 16, v23
  v_and_b32 v23, 0xffff0000, v23
  v_pk_fma_f32 v[134:135], v[22:23], v[28:29], v[134:135] op_sel:[0,1,0] op_sel_hi:[1,1,1]
  v_accvgpr_read_b32 v23, a198
  v_accvgpr_write_b32 a198, 0
  v_pk_mul_f32 v[140:141], v[140:141], v[2:3] op_sel:[0,1] op_sel_hi:[1,1]
  v_lshlrev_b32 v22, 16, v23
  v_and_b32 v23, 0xffff0000, v23
  v_pk_fma_f32 v[140:141], v[22:23], v[28:29], v[140:141] op_sel:[0,1,0] op_sel_hi:[1,1,1]
  v_accvgpr_read_b32 v23, a199
  v_accvgpr_write_b32 a199, 0
  v_pk_mul_f32 v[142:143], v[142:143], v[2:3] op_sel:[0,1] op_sel_hi:[1,1]
  v_lshlrev_b32 v22, 16, v23
  v_and_b32 v23, 0xffff0000, v23
  v_pk_fma_f32 v[142:143], v[22:23], v[28:29], v[142:143] op_sel:[0,1,0] op_sel_hi:[1,1,1]
  v_accvgpr_read_b32 v23, a200
  v_accvgpr_write_b32 a200, 0
  v_pk_mul_f32 v[144:145], v[144:145], v[2:3] op_sel:[0,0] op_sel_hi:[1,0]
  v_lshlrev_b32 v22, 16, v23
  v_and_b32 v23, 0xffff0000, v23
  v_pk_fma_f32 v[144:145], v[22:23], v[28:29], v[144:145] op_sel:[0,0,0] op_sel_hi:[1,0,1]
  v_accvgpr_read_b32 v23, a201
  v_accvgpr_write_b32 a201, 0
  v_pk_mul_f32 v[146:147], v[146:147], v[2:3] op_sel:[0,0] op_sel_hi:[1,0]
  v_lshlrev_b32 v22, 16, v23
  v_and_b32 v23, 0xffff0000, v23
  v_pk_fma_f32 v[146:147], v[22:23], v[28:29], v[146:147] op_sel:[0,0,0] op_sel_hi:[1,0,1]
  v_accvgpr_read_b32 v23, a202
  v_accvgpr_write_b32 a202, 0
  v_pk_mul_f32 v[152:153], v[152:153], v[2:3] op_sel:[0,0] op_sel_hi:[1,0]
  v_lshlrev_b32 v22, 16, v23
  v_and_b32 v23, 0xffff0000, v23
  v_pk_fma_f32 v[152:153], v[22:23], v[28:29], v[152:153] op_sel:[0,0,0] op_sel_hi:[1,0,1]
  v_accvgpr_read_b32 v23, a203
  v_accvgpr_write_b32 a203, 0
  v_pk_mul_f32 v[154:155], v[154:155], v[2:3] op_sel:[0,0] op_sel_hi:[1,0]
  v_lshlrev_b32 v22, 16, v23
  v_and_b32 v23, 0xffff0000, v23
  v_pk_fma_f32 v[154:155], v[22:23], v[28:29], v[154:155] op_sel:[0,0,0] op_sel_hi:[1,0,1]
  v_accvgpr_read_b32 v23, a204
  v_accvgpr_write_b32 a204, 0
  v_pk_mul_f32 v[148:149], v[148:149], v[2:3] op_sel:[0,1] op_sel_hi:[1,1]
  v_lshlrev_b32 v22, 16, v23
  v_and_b32 v23, 0xffff0000, v23
  v_pk_fma_f32 v[148:149], v[22:23], v[28:29], v[148:149] op_sel:[0,1,0] op_sel_hi:[1,1,1]
  v_accvgpr_read_b32 v23, a205
  v_accvgpr_write_b32 a205, 0
  v_pk_mul_f32 v[150:151], v[150:151], v[2:3] op_sel:[0,1] op_sel_hi:[1,1]
  v_lshlrev_b32 v22, 16, v23
  v_and_b32 v23, 0xffff0000, v23
  v_pk_fma_f32 v[150:151], v[22:23], v[28:29], v[150:151] op_sel:[0,1,0] op_sel_hi:[1,1,1]
  v_accvgpr_read_b32 v23, a206
  v_accvgpr_write_b32 a206, 0
  v_pk_mul_f32 v[156:157], v[156:157], v[2:3] op_sel:[0,1] op_sel_hi:[1,1]
  v_lshlrev_b32 v22, 16, v23
  v_and_b32 v23, 0xffff0000, v23
  v_pk_fma_f32 v[156:157], v[22:23], v[28:29], v[156:157] op_sel:[0,1,0] op_sel_hi:[1,1,1]
  v_accvgpr_read_b32 v23, a207
  v_accvgpr_write_b32 a207, 0
  v_pk_mul_f32 v[158:159], v[158:159], v[2:3] op_sel:[0,1] op_sel_hi:[1,1]
  v_lshlrev_b32 v22, 16, v23
  v_and_b32 v23, 0xffff0000, v23
  v_pk_fma_f32 v[158:159], v[22:23], v[28:29], v[158:159] op_sel:[0,1,0] op_sel_hi:[1,1,1]
  v_accvgpr_read_b32 v23, a208
  v_accvgpr_write_b32 a208, 0
  v_pk_mul_f32 v[160:161], v[160:161], v[2:3] op_sel:[0,0] op_sel_hi:[1,0]
  v_lshlrev_b32 v22, 16, v23
  v_and_b32 v23, 0xffff0000, v23
  v_pk_fma_f32 v[160:161], v[22:23], v[28:29], v[160:161] op_sel:[0,0,0] op_sel_hi:[1,0,1]
  v_accvgpr_read_b32 v23, a209
  v_accvgpr_write_b32 a209, 0
  v_pk_mul_f32 v[162:163], v[162:163], v[2:3] op_sel:[0,0] op_sel_hi:[1,0]
  v_lshlrev_b32 v22, 16, v23
  v_and_b32 v23, 0xffff0000, v23
  v_pk_fma_f32 v[162:163], v[22:23], v[28:29], v[162:163] op_sel:[0,0,0] op_sel_hi:[1,0,1]
  v_accvgpr_read_b32 v23, a210
  v_accvgpr_write_b32 a210, 0
  v_pk_mul_f32 v[168:169], v[168:169], v[2:3] op_sel:[0,0] op_sel_hi:[1,0]
  v_lshlrev_b32 v22, 16, v23
  v_and_b32 v23, 0xffff0000, v23
  v_pk_fma_f32 v[168:169], v[22:23], v[28:29], v[168:169] op_sel:[0,0,0] op_sel_hi:[1,0,1]
  v_accvgpr_read_b32 v23, a211
  v_accvgpr_write_b32 a211, 0
  v_pk_mul_f32 v[170:171], v[170:171], v[2:3] op_sel:[0,0] op_sel_hi:[1,0]
  v_lshlrev_b32 v22, 16, v23
  v_and_b32 v23, 0xffff0000, v23
  v_pk_fma_f32 v[170:171], v[22:23], v[28:29], v[170:171] op_sel:[0,0,0] op_sel_hi:[1,0,1]
  v_accvgpr_read_b32 v23, a212
  v_accvgpr_write_b32 a212, 0
  v_pk_mul_f32 v[164:165], v[164:165], v[2:3] op_sel:[0,1] op_sel_hi:[1,1]
  v_lshlrev_b32 v22, 16, v23
  v_and_b32 v23, 0xffff0000, v23
  v_pk_fma_f32 v[164:165], v[22:23], v[28:29], v[164:165] op_sel:[0,1,0] op_sel_hi:[1,1,1]
  v_accvgpr_read_b32 v23, a213
  v_accvgpr_write_b32 a213, 0
  v_pk_mul_f32 v[166:167], v[166:167], v[2:3] op_sel:[0,1] op_sel_hi:[1,1]
  v_lshlrev_b32 v22, 16, v23
  v_and_b32 v23, 0xffff0000, v23
  v_pk_fma_f32 v[166:167], v[22:23], v[28:29], v[166:167] op_sel:[0,1,0] op_sel_hi:[1,1,1]
  v_accvgpr_read_b32 v23, a214
  v_accvgpr_write_b32 a214, 0
  v_pk_mul_f32 v[172:173], v[172:173], v[2:3] op_sel:[0,1] op_sel_hi:[1,1]
  v_lshlrev_b32 v22, 16, v23
  v_and_b32 v23, 0xffff0000, v23
  v_pk_fma_f32 v[172:173], v[22:23], v[28:29], v[172:173] op_sel:[0,1,0] op_sel_hi:[1,1,1]
  v_accvgpr_read_b32 v23, a215
  v_accvgpr_write_b32 a215, 0
  v_pk_mul_f32 v[174:175], v[174:175], v[2:3] op_sel:[0,1] op_sel_hi:[1,1]
  v_lshlrev_b32 v22, 16, v23
  v_and_b32 v23, 0xffff0000, v23
  v_pk_fma_f32 v[174:175], v[22:23], v[28:29], v[174:175] op_sel:[0,1,0] op_sel_hi:[1,1,1]
  v_accvgpr_read_b32 v23, a216
  v_accvgpr_write_b32 a216, 0
  v_pk_mul_f32 v[176:177], v[176:177], v[2:3] op_sel:[0,0] op_sel_hi:[1,0]
  v_lshlrev_b32 v22, 16, v23
  v_and_b32 v23, 0xffff0000, v23
  v_pk_fma_f32 v[176:177], v[22:23], v[28:29], v[176:177] op_sel:[0,0,0] op_sel_hi:[1,0,1]
  v_accvgpr_read_b32 v23, a217
  v_accvgpr_write_b32 a217, 0
  v_pk_mul_f32 v[178:179], v[178:179], v[2:3] op_sel:[0,0] op_sel_hi:[1,0]
  v_lshlrev_b32 v22, 16, v23
  v_and_b32 v23, 0xffff0000, v23
  v_pk_fma_f32 v[178:179], v[22:23], v[28:29], v[178:179] op_sel:[0,0,0] op_sel_hi:[1,0,1]
  v_accvgpr_read_b32 v23, a218
  v_accvgpr_write_b32 a218, 0
  v_pk_mul_f32 v[184:185], v[184:185], v[2:3] op_sel:[0,0] op_sel_hi:[1,0]
  v_lshlrev_b32 v22, 16, v23
  v_and_b32 v23, 0xffff0000, v23
  v_pk_fma_f32 v[184:185], v[22:23], v[28:29], v[184:185] op_sel:[0,0,0] op_sel_hi:[1,0,1]
  v_accvgpr_read_b32 v23, a219
  v_accvgpr_write_b32 a219, 0
  v_pk_mul_f32 v[186:187], v[186:187], v[2:3] op_sel:[0,0] op_sel_hi:[1,0]
  v_lshlrev_b32 v22, 16, v23
  v_and_b32 v23, 0xffff0000, v23
  v_pk_fma_f32 v[186:187], v[22:23], v[28:29], v[186:187] op_sel:[0,0,0] op_sel_hi:[1,0,1]
  v_accvgpr_read_b32 v23, a220
  v_accvgpr_write_b32 a220, 0
  v_pk_mul_f32 v[180:181], v[180:181], v[2:3] op_sel:[0,1] op_sel_hi:[1,1]
  v_lshlrev_b32 v22, 16, v23
  v_and_b32 v23, 0xffff0000, v23
  v_pk_fma_f32 v[180:181], v[22:23], v[28:29], v[180:181] op_sel:[0,1,0] op_sel_hi:[1,1,1]
  v_accvgpr_read_b32 v23, a221
  v_accvgpr_write_b32 a221, 0
  v_pk_mul_f32 v[182:183], v[182:183], v[2:3] op_sel:[0,1] op_sel_hi:[1,1]
  v_lshlrev_b32 v22, 16, v23
  v_and_b32 v23, 0xffff0000, v23
  v_pk_fma_f32 v[182:183], v[22:23], v[28:29], v[182:183] op_sel:[0,1,0] op_sel_hi:[1,1,1]
  v_accvgpr_read_b32 v23, a222
  v_accvgpr_write_b32 a222, 0
  v_pk_mul_f32 v[188:189], v[188:189], v[2:3] op_sel:[0,1] op_sel_hi:[1,1]
  v_lshlrev_b32 v22, 16, v23
  v_and_b32 v23, 0xffff0000, v23
  v_pk_fma_f32 v[188:189], v[22:23], v[28:29], v[188:189] op_sel:[0,1,0] op_sel_hi:[1,1,1]
  v_accvgpr_read_b32 v23, a223
  v_accvgpr_write_b32 a223, 0
  v_pk_mul_f32 v[190:191], v[190:191], v[2:3] op_sel:[0,1] op_sel_hi:[1,1]
  v_lshlrev_b32 v22, 16, v23
  v_and_b32 v23, 0xffff0000, v23
  v_pk_fma_f32 v[190:191], v[22:23], v[28:29], v[190:191] op_sel:[0,1,0] op_sel_hi:[1,1,1]
  v_accvgpr_read_b32 v23, a224
  v_accvgpr_write_b32 a224, 0
  v_pk_mul_f32 v[192:193], v[192:193], v[2:3] op_sel:[0,0] op_sel_hi:[1,0]
  v_lshlrev_b32 v22, 16, v23
  v_and_b32 v23, 0xffff0000, v23
  v_pk_fma_f32 v[192:193], v[22:23], v[28:29], v[192:193] op_sel:[0,0,0] op_sel_hi:[1,0,1]
  v_accvgpr_read_b32 v23, a225
  v_accvgpr_write_b32 a225, 0
  v_pk_mul_f32 v[194:195], v[194:195], v[2:3] op_sel:[0,0] op_sel_hi:[1,0]
  v_lshlrev_b32 v22, 16, v23
  v_and_b32 v23, 0xffff0000, v23
  v_pk_fma_f32 v[194:195], v[22:23], v[28:29], v[194:195] op_sel:[0,0,0] op_sel_hi:[1,0,1]
  v_accvgpr_read_b32 v23, a226
  v_accvgpr_write_b32 a226, 0
  v_pk_mul_f32 v[200:201], v[200:201], v[2:3] op_sel:[0,0] op_sel_hi:[1,0]
  v_lshlrev_b32 v22, 16, v23
  v_and_b32 v23, 0xffff0000, v23
  v_pk_fma_f32 v[200:201], v[22:23], v[28:29], v[200:201] op_sel:[0,0,0] op_sel_hi:[1,0,1]
  v_accvgpr_read_b32 v23, a227
  v_accvgpr_write_b32 a227, 0
  v_pk_mul_f32 v[202:203], v[202:203], v[2:3] op_sel:[0,0] op_sel_hi:[1,0]
  v_lshlrev_b32 v22, 16, v23
  v_and_b32 v23, 0xffff0000, v23
  v_pk_fma_f32 v[202:203], v[22:23], v[28:29], v[202:203] op_sel:[0,0,0] op_sel_hi:[1,0,1]
  v_accvgpr_read_b32 v23, a228
  v_accvgpr_write_b32 a228, 0
  v_pk_mul_f32 v[196:197], v[196:197], v[2:3] op_sel:[0,1] op_sel_hi:[1,1]
  v_lshlrev_b32 v22, 16, v23
  v_and_b32 v23, 0xffff0000, v23
  v_pk_fma_f32 v[196:197], v[22:23], v[28:29], v[196:197] op_sel:[0,1,0] op_sel_hi:[1,1,1]
  v_accvgpr_read_b32 v23, a229
  v_accvgpr_write_b32 a229, 0
  v_pk_mul_f32 v[198:199], v[198:199], v[2:3] op_sel:[0,1] op_sel_hi:[1,1]
  v_lshlrev_b32 v22, 16, v23
  v_and_b32 v23, 0xffff0000, v23
  v_pk_fma_f32 v[198:199], v[22:23], v[28:29], v[198:199] op_sel:[0,1,0] op_sel_hi:[1,1,1]
  v_accvgpr_read_b32 v23, a230
  v_accvgpr_write_b32 a230, 0
  v_pk_mul_f32 v[204:205], v[204:205], v[2:3] op_sel:[0,1] op_sel_hi:[1,1]
  v_lshlrev_b32 v22, 16, v23
  v_and_b32 v23, 0xffff0000, v23
  v_pk_fma_f32 v[204:205], v[22:23], v[28:29], v[204:205] op_sel:[0,1,0] op_sel_hi:[1,1,1]
  v_accvgpr_read_b32 v23, a231
  v_accvgpr_write_b32 a231, 0
  v_pk_mul_f32 v[206:207], v[206:207], v[2:3] op_sel:[0,1] op_sel_hi:[1,1]
  v_lshlrev_b32 v22, 16, v23
  v_and_b32 v23, 0xffff0000, v23
  v_pk_fma_f32 v[206:207], v[22:23], v[28:29], v[206:207] op_sel:[0,1,0] op_sel_hi:[1,1,1]
  v_accvgpr_read_b32 v23, a232
  v_accvgpr_write_b32 a232, 0
  v_pk_mul_f32 v[208:209], v[208:209], v[2:3] op_sel:[0,0] op_sel_hi:[1,0]
  v_lshlrev_b32 v22, 16, v23
  v_and_b32 v23, 0xffff0000, v23
  v_pk_fma_f32 v[208:209], v[22:23], v[28:29], v[208:209] op_sel:[0,0,0] op_sel_hi:[1,0,1]
  v_accvgpr_read_b32 v23, a233
  v_accvgpr_write_b32 a233, 0
  v_pk_mul_f32 v[210:211], v[210:211], v[2:3] op_sel:[0,0] op_sel_hi:[1,0]
  v_lshlrev_b32 v22, 16, v23
  v_and_b32 v23, 0xffff0000, v23
  v_pk_fma_f32 v[210:211], v[22:23], v[28:29], v[210:211] op_sel:[0,0,0] op_sel_hi:[1,0,1]
  v_accvgpr_read_b32 v23, a234
  v_accvgpr_write_b32 a234, 0
  v_pk_mul_f32 v[216:217], v[216:217], v[2:3] op_sel:[0,0] op_sel_hi:[1,0]
  v_lshlrev_b32 v22, 16, v23
  v_and_b32 v23, 0xffff0000, v23
  v_pk_fma_f32 v[216:217], v[22:23], v[28:29], v[216:217] op_sel:[0,0,0] op_sel_hi:[1,0,1]
  v_accvgpr_read_b32 v23, a235
  v_accvgpr_write_b32 a235, 0
  v_pk_mul_f32 v[218:219], v[218:219], v[2:3] op_sel:[0,0] op_sel_hi:[1,0]
  v_lshlrev_b32 v22, 16, v23
  v_and_b32 v23, 0xffff0000, v23
  v_pk_fma_f32 v[218:219], v[22:23], v[28:29], v[218:219] op_sel:[0,0,0] op_sel_hi:[1,0,1]
  v_accvgpr_read_b32 v23, a236
  v_accvgpr_write_b32 a236, 0
  v_pk_mul_f32 v[212:213], v[212:213], v[2:3] op_sel:[0,1] op_sel_hi:[1,1]
  v_lshlrev_b32 v22, 16, v23
  v_and_b32 v23, 0xffff0000, v23
  v_pk_fma_f32 v[212:213], v[22:23], v[28:29], v[212:213] op_sel:[0,1,0] op_sel_hi:[1,1,1]
  v_accvgpr_read_b32 v23, a237
  v_accvgpr_write_b32 a237, 0
  v_pk_mul_f32 v[214:215], v[214:215], v[2:3] op_sel:[0,1] op_sel_hi:[1,1]
  v_lshlrev_b32 v22, 16, v23
  v_and_b32 v23, 0xffff0000, v23
  v_pk_fma_f32 v[214:215], v[22:23], v[28:29], v[214:215] op_sel:[0,1,0] op_sel_hi:[1,1,1]
  v_accvgpr_read_b32 v23, a238
  v_accvgpr_write_b32 a238, 0
  v_pk_mul_f32 v[220:221], v[220:221], v[2:3] op_sel:[0,1] op_sel_hi:[1,1]
  v_lshlrev_b32 v22, 16, v23
  v_and_b32 v23, 0xffff0000, v23
  v_pk_fma_f32 v[220:221], v[22:23], v[28:29], v[220:221] op_sel:[0,1,0] op_sel_hi:[1,1,1]
  v_accvgpr_read_b32 v23, a239
  v_accvgpr_write_b32 a239, 0
  v_pk_mul_f32 v[222:223], v[222:223], v[2:3] op_sel:[0,1] op_sel_hi:[1,1]
  v_lshlrev_b32 v22, 16, v23
  v_and_b32 v23, 0xffff0000, v23
  v_pk_fma_f32 v[222:223], v[22:23], v[28:29], v[222:223] op_sel:[0,1,0] op_sel_hi:[1,1,1]
  v_accvgpr_read_b32 v23, a240
  v_accvgpr_write_b32 a240, 0
  v_pk_mul_f32 v[224:225], v[224:225], v[2:3] op_sel:[0,0] op_sel_hi:[1,0]
  v_lshlrev_b32 v22, 16, v23
  v_and_b32 v23, 0xffff0000, v23
  v_pk_fma_f32 v[224:225], v[22:23], v[28:29], v[224:225] op_sel:[0,0,0] op_sel_hi:[1,0,1]
  v_accvgpr_read_b32 v23, a241
  v_accvgpr_write_b32 a241, 0
  v_pk_mul_f32 v[226:227], v[226:227], v[2:3] op_sel:[0,0] op_sel_hi:[1,0]
  v_lshlrev_b32 v22, 16, v23
  v_and_b32 v23, 0xffff0000, v23
  v_pk_fma_f32 v[226:227], v[22:23], v[28:29], v[226:227] op_sel:[0,0,0] op_sel_hi:[1,0,1]
  v_accvgpr_read_b32 v23, a242
  v_accvgpr_write_b32 a242, 0
  v_pk_mul_f32 v[232:233], v[232:233], v[2:3] op_sel:[0,0] op_sel_hi:[1,0]
  v_lshlrev_b32 v22, 16, v23
  v_and_b32 v23, 0xffff0000, v23
  v_pk_fma_f32 v[232:233], v[22:23], v[28:29], v[232:233] op_sel:[0,0,0] op_sel_hi:[1,0,1]
  v_accvgpr_read_b32 v23, a243
  v_accvgpr_write_b32 a243, 0
  v_pk_mul_f32 v[234:235], v[234:235], v[2:3] op_sel:[0,0] op_sel_hi:[1,0]
  v_lshlrev_b32 v22, 16, v23
  v_and_b32 v23, 0xffff0000, v23
  v_pk_fma_f32 v[234:235], v[22:23], v[28:29], v[234:235] op_sel:[0,0,0] op_sel_hi:[1,0,1]
  v_accvgpr_read_b32 v23, a244
  v_accvgpr_write_b32 a244, 0
  v_pk_mul_f32 v[228:229], v[228:229], v[2:3] op_sel:[0,1] op_sel_hi:[1,1]
  v_lshlrev_b32 v22, 16, v23
  v_and_b32 v23, 0xffff0000, v23
  v_pk_fma_f32 v[228:229], v[22:23], v[28:29], v[228:229] op_sel:[0,1,0] op_sel_hi:[1,1,1]
  v_accvgpr_read_b32 v23, a245
  v_accvgpr_write_b32 a245, 0
  v_pk_mul_f32 v[230:231], v[230:231], v[2:3] op_sel:[0,1] op_sel_hi:[1,1]
  v_lshlrev_b32 v22, 16, v23
  v_and_b32 v23, 0xffff0000, v23
  v_pk_fma_f32 v[230:231], v[22:23], v[28:29], v[230:231] op_sel:[0,1,0] op_sel_hi:[1,1,1]
  v_accvgpr_read_b32 v23, a246
  v_accvgpr_write_b32 a246, 0
  v_pk_mul_f32 v[236:237], v[236:237], v[2:3] op_sel:[0,1] op_sel_hi:[1,1]
  v_lshlrev_b32 v22, 16, v23
  v_and_b32 v23, 0xffff0000, v23
  v_pk_fma_f32 v[236:237], v[22:23], v[28:29], v[236:237] op_sel:[0,1,0] op_sel_hi:[1,1,1]
  v_accvgpr_read_b32 v23, a247
  v_accvgpr_write_b32 a247, 0
  v_pk_mul_f32 v[238:239], v[238:239], v[2:3] op_sel:[0,1] op_sel_hi:[1,1]
  v_lshlrev_b32 v22, 16, v23
  v_and_b32 v23, 0xffff0000, v23
  v_pk_fma_f32 v[238:239], v[22:23], v[28:29], v[238:239] op_sel:[0,1,0] op_sel_hi:[1,1,1]
  v_accvgpr_read_b32 v23, a64
  v_accvgpr_write_b32 a64, 0
  v_pk_mul_f32 v[240:241], v[240:241], v[2:3] op_sel:[0,0] op_sel_hi:[1,0]
  v_lshlrev_b32 v22, 16, v23
  v_and_b32 v23, 0xffff0000, v23
  v_pk_fma_f32 v[240:241], v[22:23], v[28:29], v[240:241] op_sel:[0,0,0] op_sel_hi:[1,0,1]
  v_accvgpr_read_b32 v23, a65
  v_accvgpr_write_b32 a65, 0
  v_pk_mul_f32 v[242:243], v[242:243], v[2:3] op_sel:[0,0] op_sel_hi:[1,0]
  v_lshlrev_b32 v22, 16, v23
  v_and_b32 v23, 0xffff0000, v23
  v_pk_fma_f32 v[242:243], v[22:23], v[28:29], v[242:243] op_sel:[0,0,0] op_sel_hi:[1,0,1]
  v_accvgpr_read_b32 v23, a66
  v_accvgpr_write_b32 a66, 0
  v_pk_mul_f32 v[248:249], v[248:249], v[2:3] op_sel:[0,0] op_sel_hi:[1,0]
  v_lshlrev_b32 v22, 16, v23
  v_and_b32 v23, 0xffff0000, v23
  v_pk_fma_f32 v[248:249], v[22:23], v[28:29], v[248:249] op_sel:[0,0,0] op_sel_hi:[1,0,1]
  v_accvgpr_read_b32 v23, a67
  v_accvgpr_write_b32 a67, 0
  v_pk_mul_f32 v[250:251], v[250:251], v[2:3] op_sel:[0,0] op_sel_hi:[1,0]
  v_lshlrev_b32 v22, 16, v23
  v_and_b32 v23, 0xffff0000, v23
  v_pk_fma_f32 v[250:251], v[22:23], v[28:29], v[250:251] op_sel:[0,0,0] op_sel_hi:[1,0,1]
  v_accvgpr_read_b32 v23, a68
  v_accvgpr_write_b32 a68, 0
  v_pk_mul_f32 v[244:245], v[244:245], v[2:3] op_sel:[0,1] op_sel_hi:[1,1]
  v_lshlrev_b32 v22, 16, v23
  v_and_b32 v23, 0xffff0000, v23
  v_pk_fma_f32 v[244:245], v[22:23], v[28:29], v[244:245] op_sel:[0,1,0] op_sel_hi:[1,1,1]
  v_accvgpr_read_b32 v23, a69
  v_accvgpr_write_b32 a69, 0
  v_pk_mul_f32 v[246:247], v[246:247], v[2:3] op_sel:[0,1] op_sel_hi:[1,1]
  v_lshlrev_b32 v22, 16, v23
  v_and_b32 v23, 0xffff0000, v23
  v_pk_fma_f32 v[246:247], v[22:23], v[28:29], v[246:247] op_sel:[0,1,0] op_sel_hi:[1,1,1]
  v_accvgpr_read_b32 v23, a70
  v_accvgpr_write_b32 a70, 0
  v_pk_mul_f32 v[252:253], v[252:253], v[2:3] op_sel:[0,1] op_sel_hi:[1,1]
  v_lshlrev_b32 v22, 16, v23
  v_and_b32 v23, 0xffff0000, v23
  v_pk_fma_f32 v[252:253], v[22:23], v[28:29], v[252:253] op_sel:[0,1,0] op_sel_hi:[1,1,1]
  v_accvgpr_read_b32 v23, a71
  v_accvgpr_write_b32 a71, 0
  v_pk_mul_f32 v[254:255], v[254:255], v[2:3] op_sel:[0,1] op_sel_hi:[1,1]
  v_lshlrev_b32 v22, 16, v23
  v_and_b32 v23, 0xffff0000, v23
  v_pk_fma_f32 v[254:255], v[22:23], v[28:29], v[254:255] op_sel:[0,1,0] op_sel_hi:[1,1,1]
  s_nop 1
  s_branch AT_SLOW_B
AT_KVS:
  s_mov_b32 s59, 0x40000
AT_KV_P:
  v_cmp_le_u32 vcc, 1, v6
  s_nop 1
  s_cmp_eq_u64 vcc, -1
  s_cbranch_scc1 AT_KVS_B
  s_sub_u32 s59, s59, 1
  s_cbranch_scc1 AT_KVS_B
  s_sleep 1
  v_and_b32 v6, 0x180, v0
  buffer_load_dword v6, v6, s[12:15], s56 offen sc1
  s_waitcnt vmcnt(0)
  s_branch AT_KV_P
KV_X0:
  s_mov_b32 s59, 0x40000
KV_XX0_P:
  v_cmp_le_u32 vcc, 16, v25
  s_nop 1
  s_cmp_eq_u32 vcc_lo, 0xffff
  s_cbranch_scc1 KV_X0_B
  s_sub_u32 s59, s59, 1
  s_cbranch_scc1 KV_X0_B
  s_sleep 1
  buffer_load_dword v25, v31, s[72:75], 0 offen sc1
  s_waitcnt vmcnt(0)
  s_branch KV_XX0_P
KV_X1:
  s_mov_b32 s59, 0x40000
KV_XX1_P:
  v_cmp_le_u32 vcc, 16, v25
  s_nop 1
  s_cmp_eq_u32 vcc_lo, 0xffff
  s_cbranch_scc1 KV_X1_B
  s_sub_u32 s59, s59, 1
  s_cbranch_scc1 KV_X1_B
  s_sleep 1
  buffer_load_dword v25, v31, s[72:75], 0 offen sc1
  s_waitcnt vmcnt(0)
  s_branch KV_XX1_P
AT_NS_18:
  s_call_b64 s[34:35], AT_EV
  s_branch AT_NB_19
AT_NS_20:
  s_call_b64 s[34:35], AT_EV
  s_branch AT_NB_21
AT_NS_22:
  s_call_b64 s[34:35], AT_EV
  s_branch AT_NB_23
AT_NS_70:
  s_call_b64 s[34:35], AT_EV
  s_branch AT_NB_71
AT_NS_72:
  s_call_b64 s[34:35], AT_EV
  s_branch AT_NB_73
AT_NS_74:
  s_call_b64 s[34:35], AT_EV
  s_branch AT_NB_75
KV_SS_1:
  v_mov_b32 v2, 1
  s_mov_b64 exec, 1
  buffer_atomic_add v2, off, s[72:75], s65
  s_mov_b64 exec, -1
  s_branch KV_SB_2
KV_SS_3:
  v_mov_b32 v2, 1
  s_mov_b64 exec, 1
  buffer_atomic_add v2, off, s[72:75], s65
  s_mov_b64 exec, -1
  s_branch KV_SB_4
MN_END:
  s_endpgm
.section .rodata,"a"
.p2align 6
.amdhsa_kernel sequential_preLN__compressed_kv_cla__mixer_token_mlp__prompt_kernel
.amdhsa_next_free_vgpr 512
.amdhsa_next_free_sgpr 102
.amdhsa_accum_offset 256
.amdhsa_group_segment_fixed_size 0
.amdhsa_kernarg_size 112
.amdhsa_user_sgpr_count 2
.amdhsa_user_sgpr_kernarg_segment_ptr 1
.amdhsa_system_sgpr_workgroup_id_x 1
.end_amdhsa_kernel
.text
ALL_END:
  s_endpgm
```
